```python
import torch

def _softmax(x, axis=-1):
    return torch.softmax(x, dim=axis)
def _gelu(x):
    return torch.nn.functional.gelu(x, approximate="tanh")
def _silu(x):
    return torch.nn.functional.silu(x)
def _sigmoid(x):
    return torch.sigmoid(x)
def _layernorm(x, axis=-1, eps=1e-5):
    m = x.mean(dim=axis, keepdim=True)
    v = x.var(dim=axis, keepdim=True, unbiased=False)
    return (x - m) / torch.sqrt(v + eps)
def _scatter_add(tgt, idx, src, axis=0):
    return tgt.clone().index_add_(axis, idx, src)
def _segment_sum(src, seg, n):
    out = torch.zeros((n,) + src.shape[1:], dtype=src.dtype)
    return out.index_add_(0, seg, src)
def _pad(x, pw):
    flat = tuple(v for pair in reversed(pw) for v in pair)
    return torch.nn.functional.pad(x, flat)

kernel_name = 'parallel_sum__mha_block__glu_gated_bilinear__prompt'

def setup_inputs():

    _w = (lambda a: (lambda t: t.to(torch.bfloat16) if t.is_floating_point() else t)(torch.as_tensor(a)))
    def _A_setup():
        B, S, D, H = 1, 2048, 1024, 32
        return {
            "x": _w((lambda *s: torch.randn(*s, dtype=torch.bfloat16) * 0.05)(B, S, D)),
            "wqkv": _w((lambda *s: torch.randn(*s, dtype=torch.bfloat16) * 0.05)(D, 3 * D)),
            "wo": _w((lambda *s: torch.randn(*s, dtype=torch.bfloat16) * 0.05)(D, D)),
        }
    _A_in = _A_setup()

    def _B_setup():
        B, S, D, F = 1, 2048, 1024, 3584
        return {
            "x": _w((lambda *s: torch.randn(*s, dtype=torch.bfloat16) * 0.05)(B, S, D)),
            "w_gate": _w((lambda *s: torch.randn(*s, dtype=torch.bfloat16) * 0.8)(D, F) * (D ** -0.5)),
            "w_up": _w((lambda *s: torch.randn(*s, dtype=torch.bfloat16) * 0.8)(D, F) * (D ** -0.5)),
            "w_down": _w((lambda *s: torch.randn(*s, dtype=torch.bfloat16) * 0.8)(F, D) * (F ** -0.5)),
        }
    _B_in = _B_setup()

    return {
        "A_x": _A_in["x"],
        "A_wqkv": _A_in["wqkv"],
        "A_wo": _A_in["wo"],
        "B_x": _B_in["x"],
        "B_w_gate": _B_in["w_gate"],
        "B_w_up": _B_in["w_up"],
        "B_w_down": _B_in["w_down"],
    }

def reference(A_x, A_wqkv, A_wo, B_x, B_w_gate, B_w_up, B_w_down):
    def _A_ref(x, wqkv, wo):
        B, S, D = x.shape
        H = 32
        Dh = D // H
        qkv = (lambda x, *d: x.permute(*d))((x @ wqkv).reshape(B, S, 3, H, Dh), 2, 0, 3, 1, 4)
        q, k, v = qkv[0], qkv[1], qkv[2]
        scores = torch.einsum("bhqd,bhkd->bhqk", q, k) * (Dh ** -0.5)
        p = _softmax(scores, axis=-1)
        o = torch.einsum("bhqk,bhkd->bhqd", p, v)
        return (lambda x, *d: x.permute(*d))(o, 0, 2, 1, 3).reshape(B, S, D) @ wo

    def _B_ref(x, w_gate, w_up, w_down):
        g = torch.einsum("bsd,df->bsf", x, w_gate)
        u = torch.einsum("bsd,df->bsf", x, w_up)
        h = g * u
        return torch.einsum("bsf,fd->bsd", h, w_down)

    x = A_x
    xn = _layernorm(x, axis=-1)
    return x + _A_ref(xn, A_wqkv, A_wo) + _B_ref(xn, B_w_gate, B_w_up, B_w_down)
```

```asm
; @launch grid=(256,1,1) block=(256,1,1) lds=163840
.amdgcn_target "amdgcn-amd-amdhsa--gfx950"
.text
.globl parallel_sum__mha_block__glu_gated_bilinear__prompt_kernel
.p2align 8
.type parallel_sum__mha_block__glu_gated_bilinear__prompt_kernel,@function
parallel_sum__mha_block__glu_gated_bilinear__prompt_kernel:

    s_cmp_lt_u32 s2, 256
    s_cbranch_scc1 L_start
    s_endpgm
L_start:
    s_load_dwordx2 s[8:9], s[0:1], 0
    s_load_dwordx2 s[80:81], s[0:1], 8
    s_load_dwordx4 s[52:55], s[0:1], 32
    s_load_dwordx2 s[32:33], s[0:1], 72
    s_load_dwordx2 s[50:51], s[0:1], 48
    s_load_dwordx2 s[56:57], s[0:1], 16
    s_load_dwordx2 s[68:69], s[0:1], 64
    v_lshrrev_b32_e64 v1, 6, v0
    v_and_b32_e64 v0, 63, v0
    s_and_b32 s72, s2, 7
    v_readfirstlane_b32 s77, v1
    s_bfe_u32 s73, s2, 0x30003
    s_lshr_b32 s74, s2, 6
    s_lshr_b32 s75, s77, 1
    s_and_b32 s76, s77, 1
    s_lshl_b32 s47, s77, 10
    s_getpc_b64 s[84:85]
L_pcs:
    s_lshl_b32 s82, s73, 12
    s_add_u32 s82, s82, s47
    s_min_u32 s82, s82, L_g1_tA-L_g1_A-1024
    s_mov_b32 s83, L_g1_A-L_pcs
    s_cmp_eq_u32 s74, 3
    s_cselect_b32 s83, L_g1_B-L_pcs, s83
    s_add_u32 s82, s82, s83
    v_cmp_gt_u32 vcc, 32, v0
    v_bfe_u32 v22, v0, 2, 3
    v_mov_b32 v20, s82
    v_mov_b32 v21, s47
    v_cndmask_b32_e64 v20, v20, v21, vcc
    v_lshl_add_u32 v22, v22, 7, v20
    global_load_dword v57, v22, s[84:85]
    s_mov_b32 s36, 65536
    s_mov_b32 s37, 131072
    s_mov_b32 s38, 196608
    s_mov_b32 s39, 262144
    s_mov_b32 s40, 327680
    s_mov_b32 s41, 393216
    s_mov_b32 s42, 458752
    s_mov_b32 s43, 196608
    s_mov_b32 s44, 229376
    s_mov_b32 s45, 393216
    s_mov_b32 s46, 458752
    s_lshr_b32 s78, s74, 1
    s_lshl_b32 s78, s78, 4
    s_lshl_b32 s82, s72, 1
    s_add_u32 s78, s78, s82
    s_and_b32 s82, s74, 1
    s_add_u32 s78, s78, s82
    s_mul_i32 s3, s72, 7
    s_lshl_b32 s82, s74, 1
    s_add_u32 s3, s3, s82
    s_cmp_eq_u32 s74, 3
    s_cselect_b32 s59, s43, s44
    s_cselect_b32 s79, s45, s46
    v_lshrrev_b32 v16, 3, v0
    s_lshl_b32 s82, s77, 3
    v_add_u32 v16, s82, v16
    v_and_b32 v17, 7, v0
    v_bfe_u32 v18, v16, 1, 3
    v_xor_b32 v18, v18, v17
    v_lshlrev_b32 v18, 4, v18
    s_lshl_b32 s82, s73, 8
    v_add_u32 v19, s82, v16
    v_lshl_add_u32 v8, v19, 11, v18
    v_bfe_u32 v18, v16, 1, 1
    v_bfe_u32 v19, v16, 3, 1
    v_lshl_add_u32 v18, v19, 1, v18
    v_lshlrev_b32 v18, 1, v18
    v_xor_b32_e64 v18, v18, v17
    v_lshlrev_b32_e64 v18, 4, v18
    s_movk_i32 s83, 6144
    v_mad_u32_u24 v9, v16, s83, v18
    s_movk_i32 s83, 7168
    v_mad_u32_u24 v10, v16, s83, v18
    s_lshr_b32 s83, s79, 6
    v_mad_u32_u24 v15, v16, s83, v18
    s_xor_b32 s84, s73, 7
    s_mul_i32 s84, s84, 3
    s_add_u32 s84, s84, s77
    s_sub_u32 s84, s84, 1
    s_and_b32 s85, s84, 3
    s_lshr_b32 s84, s84, 2
    s_lshl_b32 s85, s85, 4
    s_mov_b32 s61, 16
    s_cmp_eq_u32 s84, 0
    s_cselect_b32 s49, s45, s79
    s_cmp_ge_u32 s84, 3
    s_cselect_b32 s49, s46, s49
    s_lshr_b32 s83, s49, 6
    s_lshl_b32 s48, s74, 6
    s_add_u32 s48, s48, s82
    s_cmp_eq_u32 s77, 0
    s_cselect_b32 s84, 6, s84
    s_cselect_b32 s85, s48, s85
    s_cselect_b32 s83, 2048, s83
    s_cselect_b32 s49, 128, s49
    s_cselect_b32 s48, 64, s61
    v_add_u32 v16, s85, v0
    v_mul_u32_u24 v16, s83, v16
    v_cmp_gt_u32 vcc, s48, v0
    v_mov_b32 v17, 0x7f000000
    s_lshl_b32 s82, s78, 7
    v_cndmask_b32_e64 v12, v17, v16, vcc
    s_mul_i32 s45, s72, 0
    s_and_b32 s45, s45, 15
    s_mov_b32 s100, s45
    s_mul_i32 s101, s100, 0x80
    v_add_u32 v8, s101, v8
    s_mul_i32 s101, s100, 393216
    v_add_u32 v9, s101, v9
    s_mul_i32 s101, s100, 458752
    v_add_u32 v10, s101, v10
    s_mul_i32 s101, s100, s79
    v_add_u32 v15, s101, v15
    s_mul_i32 s101, s100, s49
    v_add_u32 v12, s101, v12
    s_mov_b32 s60, s82
    s_lshl_b32 s63, s3, 7
    s_lshl_b32 s83, s72, 8
    s_add_u32 s83, s83, 4096
    s_add_u32 s85, s83, 128
    s_add_u32 s64, s63, 128
    s_cmp_eq_u32 s74, 3
    s_cselect_b32 s61, s83, s63
    s_cselect_b32 s62, s85, s63
    s_cselect_b32 s63, s63, s64
    s_mov_b32 s64, s63
    s_lshl_b32 s83, s79, 4
    s_sub_u32 s14, 6291456, s60
    s_mov_b32 s15, 0x20000
    s_sub_u32 s18, s83, s61
    s_mov_b32 s19, 0x20000
    s_sub_u32 s22, s83, s62
    s_mov_b32 s23, 0x20000
    s_sub_u32 s26, 7340032, s63
    s_mov_b32 s27, 0x20000
    s_sub_u32 s30, 7340032, s64
    s_mov_b32 s31, 0x20000
    s_mov_b32 s10, 4194304
    s_mov_b32 s11, 0x20000
    s_cmp_eq_u32 s84, 5
    s_cselect_b32 s6, 0, s10
    s_mov_b32 s7, 0x20000
    s_cmp_eq_u32 s84, 0
    s_cselect_b32 s6, s14, s6
    s_cmp_eq_u32 s84, 1
    s_cselect_b32 s6, s18, s6
    s_cmp_eq_u32 s84, 2
    s_cselect_b32 s6, s22, s6
    s_cmp_eq_u32 s84, 3
    s_cselect_b32 s6, s26, s6
    s_cmp_eq_u32 s84, 4
    s_cselect_b32 s6, s30, s6
    s_cmp_eq_u32 s74, 3
    s_waitcnt lgkmcnt(0)
    s_cselect_b64 s[16:17], s[80:81], s[52:53]
    s_cselect_b64 s[20:21], s[80:81], s[54:55]
    s_and_b32 s9, s9, 0xffff
    s_mov_b64 s[4:5], s[8:9]
    s_add_u32 s12, s80, s60
    s_addc_u32 s13, s81, 0
    s_and_b32 s13, s13, 0xffff
    s_cmp_eq_u32 s84, 0
    s_cselect_b64 s[4:5], s[12:13], s[4:5]
    s_add_u32 s16, s16, s61
    s_addc_u32 s17, s17, 0
    s_nop 0
    s_and_b32 s17, s17, 0xffff
    s_cmp_eq_u32 s84, 1
    s_cselect_b64 s[4:5], s[16:17], s[4:5]
    s_add_u32 s20, s20, s62
    s_addc_u32 s21, s21, 0
    s_and_b32 s21, s21, 0xffff
    s_cmp_eq_u32 s84, 2
    s_cselect_b64 s[4:5], s[20:21], s[4:5]
    s_add_u32 s24, s52, s63
    s_addc_u32 s25, s53, 0
    s_and_b32 s25, s25, 0xffff
    s_cmp_eq_u32 s84, 3
    s_cselect_b64 s[4:5], s[24:25], s[4:5]
    s_add_u32 s28, s54, s64
    s_addc_u32 s29, s55, 0
    s_and_b32 s29, s29, 0xffff
    s_cmp_eq_u32 s84, 4
    s_cselect_b64 s[4:5], s[28:29], s[4:5]
    buffer_load_dword v57, v12, s[4:7], 0 offen
    s_add_u32 s101, s45, 1
    s_and_b32 s101, s101, 15
    s_cselect_b32 s100, 1, -15
    s_mul_i32 s101, s100, s49
    v_add_u32 v12, s101, v12
    buffer_load_dword v57, v12, s[4:7], 0 offen
    s_add_u32 s101, s45, 2
    s_and_b32 s101, s101, 15
    s_cselect_b32 s100, 1, -15
    s_mul_i32 s101, s100, s49
    v_add_u32_e64 v12, s101, v12
    s_add_u32 m0, s47, 65536
    s_nop 0
    buffer_load_dwordx4 v9, s[12:15], 0 offen nt lds
    s_add_u32 m0, s47, 69632
    s_nop 0
    buffer_load_dwordx4 v9, s[12:15], s43 offen nt lds
    s_lshl_b32 s82, s73, 2
    s_add_u32 s82, s82, s77
    s_lshl_b32 s82, s82, 10
    s_lshl_b32 s83, s2, 2
    s_add_u32 s83, s83, s77
    s_lshl_b32 s84, s83, 12
    v_and_b32 v40, 31, v0
    v_lshlrev_b32 v40, 4, v40
    v_lshrrev_b32 v41, 5, v0
    v_lshl_add_u32 v40, v41, 11, v40
    v_add_u32 v162, s84, v40
    s_lshr_b32 s84, s83, 6
    s_lshl_b32 s84, s84, 10
    s_and_b32 s83, s83, 63
    s_lshl_b32 s83, s83, 3
    s_add_u32 s83, s83, s84
    s_add_u32 s81, s83, 54657024
    s_and_b32 s33, s33, 0xffff
    s_mov_b32 s34, 268435456
    s_mov_b32 s35, 0x20000
    s_and_b32 s69, s69, 0xffff
    s_mov_b32 s70, 256
    s_mov_b32 s71, 0x20000
    s_mul_i32 s83, s77, 192
    s_add_u32 s83, s83, s2
    s_sub_u32 s84, s83, 592
    s_cselect_b32 s58, 0, 3
    s_cselect_b32 s83, s83, s84
    s_lshr_b32 s84, s77, 1
    s_lshl_b32 s84, s84, 6
    s_add_u32 s84, s84, s2
    s_lshl_b32 s84, s84, 1
    s_and_b32 s85, s77, 1
    s_add_u32 s84, s84, s85
    s_add_u32 s84, s84, 1392
    s_cmp_ge_u32 s2, 192
    s_cselect_b32 s83, s84, s83
    s_cselect_b32 s58, 0, s58
    s_and_b32 s84, s83, 15
    s_lshr_b32 s83, s83, 4
    s_lshl_b32 s85, s83, 16
    s_lshl_b32 s48, s84, 7
    s_add_u32 s85, s85, s48
    v_lshrrev_b32_e64 v42, 4, v0
    v_and_b32_e64 v43, 15, v0
    v_lshlrev_b32_e64 v44, 13, v42
    v_and_b32_e64 v45, 3, v0
    v_lshl_add_u32 v44, v45, 3, v44
    v_bfe_u32 v45, v0, 2, 1
    v_lshl_add_u32 v44, v45, 6, v44
    v_bfe_u32 v45, v0, 3, 1
    v_lshl_add_u32 v44, v45, 5, v44
    v_add_u32_e64 v13, s85, v44
    v_and_b32_e64 v44, 7, v0
    v_lshl_add_u32 v44, v45, 4, v44
    v_bfe_u32 v45, v0, 4, 1
    v_lshl_add_u32 v44, v45, 5, v44
    v_lshlrev_b32 v44, 4, v44
    s_cmp_eq_u32 s58, 3
    s_cbranch_scc1 L_g1_rO
    s_mov_b32 s60, s50
    s_and_b32 s61, s51, 0xffff
    s_mov_b32 s62, 7340032
    s_mov_b32 s63, 0x20000
    s_lshr_b32 s85, s84, 1
    s_mul_i32 s85, s85, 917504
    s_nop 0
    s_add_u32 s85, s85, 41943040
    s_add_u32 s64, s32, s85
    s_addc_u32 s65, s33, 0
    s_and_b32 s65, s65, 0xffff
    s_mov_b32 s66, 917504
    s_mov_b32 s67, 0x20000
    s_lshl_b32 s83, s83, 2
    s_and_b32 s84, s84, 1
    s_add_u32 s83, s83, s84
    s_lshl_b32 s83, s83, 11
    v_lshl_add_u32 v44, v41, 12, v44
    s_mov_b32 s57, 2424832
    s_mov_b32 s58, 303104
    s_branch L_g1_rC
L_g1_rO:
    s_mov_b32 s60, s56
    s_and_b32 s61, s57, 0xffff
    s_mov_b32 s62, 2097152
    s_mov_b32 s63, 0x20000
    s_lshl_b32 s85, s84, 17
    s_add_u32 s85, s85, 50331648
    s_add_u32 s64, s32, s85
    s_addc_u32 s65, s33, 0
    s_and_b32 s65, s65, 0xffff
    s_mov_b32 s66, 131072
    s_mov_b32 s67, 0x20000
    s_lshl_b32 s83, s83, 12
    v_lshl_add_u32 v44, v41, 11, v44
    s_mov_b32 s57, 720896
    s_mov_b32 s58, 45056
L_g1_rC:
    v_add_u32 v14, s83, v44
    v_lshrrev_b32 v44, 1, v43
    v_xor_b32 v44, v44, v42
    v_lshlrev_b32 v44, 4, v44
    v_lshl_add_u32 v44, v43, 7, v44
    s_mul_i32 s83, s75, 16448
    v_xor_b32 v2, s83, v44
    v_xor_b32 v3, 64, v2
    v_bfe_u32 v45, v0, 2, 2
    v_lshl_add_u32 v44, v42, 3, v45
    v_lshlrev_b32 v44, 7, v44
    v_lshrrev_b32 v45, 1, v45
    v_and_b32_e64 v46, 1, v42
    v_lshl_add_u32 v45, v46, 1, v45
    s_lshl_b32 s83, s76, 1
    v_xor_b32 v45, s83, v45
    v_lshl_add_u32 v44, v45, 5, v44
    v_and_b32_e64 v45, 3, v0
    v_lshl_add_u32 v44, v45, 3, v44
    s_lshl_b32 s83, s75, 12
    v_add_u32 v44, s83, v44
    v_add_u32 v4, 65536, v44
    v_xor_b32_e64 v5, 32, v4
    v_add_u32 v6, 106496, v44
    v_xor_b32 v7, 32, v6
    v_xor_b32 v44, 4096, v44
    v_add_u32 v58, 65536, v44
    v_xor_b32 v59, 32, v58
    v_add_u32 v60, 106496, v44
    v_xor_b32 v61, 32, v60
    v_lshlrev_b32 v11, 4, v0
    v_lshlrev_b32_e64 v44, 4, v43
    v_lshl_add_u32 v44, v46, 9, v44
    v_lshl_add_u32 v1, v41, 12, v44
    v_bfe_u32 v44, v0, 1, 1
    v_cmp_eq_u32_e64 vcc, v44, v41
    v_mov_b32 v45, 0x3f803f80
    v_and_b32_e64 v44, 1, v0
    v_cndmask_b32_e64 v32, 0, v45, vcc
    v_cndmask_b32_e64 v33, 0, v45, vcc
    v_cndmask_b32_e64 v34, 0, v45, vcc
    v_cndmask_b32 v35, 0, v45, vcc
    v_mul_u32_u24 v44, 0xaaaa, v44
    v_add_u32 v56, 0x4444, v44
    s_lshl_b32 s48, s73, 1
    s_add_u32 s48, s48, s75
    s_lshl_b32 s83, s48, 10
    s_add_u32 s80, s83, 54657024
    s_and_b32 s83, s78, 15
    s_lshl_b32 s83, s83, 1
    s_add_u32 s83, s83, s76
    s_lshl_b32 s83, s83, 4
    s_add_u32 s83, s83, s48
    s_lshl_b32 s84, s83, 13
    s_add_u32 s84, s84, 4194304
    s_lshl_b32 s85, s83, 14
    s_add_u32 s85, s85, 8388608
    s_cmp_lt_u32 s78, 16
    s_cselect_b32 s50, s84, s85
    s_movk_i32 s83, 4096
    s_cselect_b32 s51, 2048, s83
    s_cselect_b32 s52, 0x3e8293ee, 1.0
    s_mul_i32 s83, s48, 144
    s_lshl_b32 s85, s3, 1
    s_add_u32 s83, s83, s85
    s_add_u32 s83, s83, s76
    s_lshl_b32 s83, s83, 13
    s_add_u32 s53, s83, 16777216
    s_add_u32 s54, s53, 16384
    s_lshl_b32 s83, s72, 2
    s_add_u32 s83, s83, s76
    s_lshl_b32 s83, s83, 4
    s_add_u32 s83, s83, s48
    s_lshl_b32 s83, s83, 14
    s_add_u32 s55, s83, 8388608
    s_add_u32 s56, s55, 524288
    s_lshl_b32 s83, s72, 12
    s_add_u32 s83, s83, 54558720
    s_lshr_b32 s84, s2, 3
    s_lshl_b32 s85, s84, 2
    s_add_u32 s78, s83, s85
    s_lshl_b32 s85, s84, 7
    s_add_u32 s46, s83, s85
    s_and_b32 s84, s84, 3
    s_lshl_b32 s84, s84, 4
    s_bfe_u32 s85, s2, 0x20001
    s_lshl_b32 s85, s85, 6
    s_add_u32 s84, s84, s85
    s_lshr_b32 s85, s2, 5
    s_add_u32 s84, s84, s85
    s_and_b32 s85, s2, 1
    s_lshl_b32 s85, s85, 3
    s_add_u32 s84, s84, s85
    s_lshl_b32 s84, s84, 7
    s_add_u32 s83, s84, 54591488
    s_add_u32 s3, s84, 54525952
    v_mov_b32 v36, 0
    v_mov_b32 v37, 0
    v_mov_b32 v38, 0
    v_mov_b32 v39, 0
    v_mov_b32 v40, 0
    v_mov_b32 v41, 0
    v_mov_b32 v42, 0
    v_mov_b32 v43, 0
    v_mov_b32 v44, 0
    v_mov_b32 v45, 0
    v_mov_b32 v46, 0
    v_mov_b32 v47, 0
    v_mov_b32 v48, 0
    v_mov_b32 v49, 0
    v_mov_b32 v50, 0
    v_mov_b32 v51, 0
    v_mov_b32 v52, 0
    v_mov_b32 v53, 0
    v_mov_b32 v54, 0
    v_mov_b32 v55, 0
    s_and_b32 s84, s77, 1
    s_mul_i32 s84, s84, 98304
    s_add_u32 s3, s3, s84
    s_lshr_b32 s84, s77, 1
    v_lshrrev_b32_e64 v161, 5, v0
    v_add_u32_e64 v161, s84, v161
    v_lshlrev_b32_e64 v161, 28, v161
    v_lshl_add_u32 v160, v0, 2, v161
    v_mov_b32_e64 v161, 0
    s_add_u32 m0, s47, 0
    s_nop 0
    buffer_load_dwordx4 v8, s[8:11], 0 offen  lds
    s_add_u32 m0, s47, 4096
    s_nop 0
    buffer_load_dwordx4 v8, s[8:11], s36 offen  lds
    s_add_u32 m0, s47, 8192
    s_nop 0
    buffer_load_dwordx4 v8, s[8:11], s37 offen  lds
    s_add_u32 m0, s47, 12288
    s_nop 0
    buffer_load_dwordx4 v8, s[8:11], s38 offen  lds
    s_add_u32 m0, s47, 16384
    s_nop 0
    buffer_load_dwordx4 v8, s[8:11], s39 offen  lds
    s_add_u32 m0, s47, 20480
    s_nop 0
    s_nop 0
    buffer_load_dwordx4 v8, s[8:11], s40 offen  lds
    s_add_u32 m0, s47, 24576
    s_nop 0
    buffer_load_dwordx4 v8, s[8:11], s41 offen  lds
    s_add_u32 m0, s47, 28672
    s_nop 0
    buffer_load_dwordx4 v8, s[8:11], s42 offen  lds
    s_add_u32 m0, s47, 73728
    s_nop 0
    s_nop 0
    buffer_load_dwordx4 v15, s[16:19], 0 offen nt lds
    s_add_u32 m0, s47, 77824
    s_nop 0
    buffer_load_dwordx4 v15, s[16:19], s59 offen nt lds
    s_add_u32 m0, s47, 81920
    s_nop 0
    buffer_load_dwordx4 v15, s[20:23], 0 offen nt lds
    s_add_u32 m0, s47, 86016
    s_nop 0
    s_nop 0
    buffer_load_dwordx4 v15, s[20:23], s59 offen nt lds
    s_add_u32 m0, s47, 90112
    s_nop 0
    buffer_load_dwordx4 v10, s[24:27], 0 offen nt lds
    s_add_u32 m0, s47, 94208
    s_nop 0
    buffer_load_dwordx4 v10, s[24:27], s44 offen nt lds
    s_add_u32 m0, s47, 98304
    s_nop 0
    s_nop 0
    buffer_load_dwordx4 v10, s[28:31], 0 offen nt lds
    s_add_u32 m0, s47, 102400
    s_nop 0
    buffer_load_dwordx4 v10, s[28:31], s44 offen nt lds
    s_add_u32 s45, s45, 1
    s_and_b32 s45, s45, 15
    s_cselect_b32 s100, 1, -15
    s_mul_i32 s101, s100, 0x80
    v_add_u32_e64 v8, s101, v8
    s_mul_i32 s101, s100, 393216
    v_add_u32_e64 v9, s101, v9
    s_mul_i32 s101, s100, 458752
    v_add_u32_e64 v10, s101, v10
    s_mul_i32 s101, s100, s79
    v_add_u32_e64 v15, s101, v15
    s_cmp_eq_u32 s74, 3
    s_mov_b32 s72, 0x05040100
    s_mov_b32 s73, 0x07060302
    s_mov_b32 s74, 4096
    s_mov_b32 s75, 32768
    s_mov_b32 s76, 36864
    s_mov_b32 s48, 6
    s_cbranch_scc1 L_g1_B
L_g1_A:
    s_getpc_b64 s[84:85]
L_pc0:
    v_bfe_u32 v163, v0, 2, 3
    v_lshlrev_b32 v163, 7, v163
    v_add_u32_e64 v163, s82, v163
    v_cmp_gt_u32_e64 vcc, 32, v0
    v_min_u32 v62, L_g1_eA-L_g1_tA-4, v163
    v_add_u32 v62, L_g1_tA-L_pc0, v62
    v_min_u32 v163, L_p2_end-L_p2-4, v163
    v_add_u32 v163, L_p2-L_pc0, v163
    v_cndmask_b32 v163, v163, v62, vcc
    v_mov_b32_e64 v63, s85
    v_add_co_u32 v62, vcc, s84, v163
    s_nop 1
    v_addc_co_u32 v63, vcc, 0, v63, vcc
    s_load_dwordx2 s[84:85], s[0:1], 56
    s_waitcnt vmcnt(6)
    s_barrier
    ds_read_b64_tr_b16 v[128:129], v4 offset:0
    ds_read_b64_tr_b16 v[130:131], v4 offset:512
    ds_read_b64_tr_b16 v[136:137], v58 offset:0
    ds_read_b64_tr_b16 v[138:139], v58 offset:512
    ds_read_b128 v[64:67], v2 offset:0
    ds_read_b128 v[68:71], v3 offset:0
    ds_read_b128 v[72:75], v2 offset:2048
    ds_read_b128 v[76:79], v3 offset:2048
    ds_read_b128 v[80:83], v2 offset:4096
    ds_read_b128 v[84:87], v3 offset:4096
    ds_read_b128 v[88:91], v2 offset:6144
    ds_read_b128 v[92:95], v3 offset:6144
    ds_read_b128 v[96:99], v2 offset:8192
    ds_read_b128 v[100:103], v3 offset:8192
    ds_read_b128 v[104:107], v2 offset:10240
    ds_read_b128 v[108:111], v3 offset:10240
    ds_read_b128 v[112:115], v2 offset:12288
    ds_read_b128 v[116:119], v3 offset:12288
    ds_read_b128 v[120:123], v2 offset:14336
    ds_read_b128 v[124:127], v3 offset:14336
    ds_read_b64_tr_b16 v[132:133], v5 offset:0
    ds_read_b64_tr_b16 v[134:135], v5 offset:512
    ds_read_b64_tr_b16 v[140:141], v59 offset:0
    s_nop 0
    ds_read_b64_tr_b16 v[142:143], v59 offset:512
    s_waitcnt lgkmcnt(15)
    v_mfma_f32_16x16x32_bf16 a[0:3], v[128:131], v[64:67], 0
    ds_read_b64_tr_b16 v[144:145], v4 offset:8192
    v_mfma_f32_16x16x32_bf16 a[0:3], v[136:139], v[68:71], a[0:3]
    s_add_u32 m0, s47, 106496
    v_mfma_f32_16x16x32_bf16 a[4:7], v[128:131], v[72:75], 0
    buffer_load_dwordx4 v9, s[12:15], 0 offen nt lds
    v_mfma_f32_16x16x32_bf16 a[4:7], v[136:139], v[76:79], a[4:7]
    v_mfma_f32_16x16x32_bf16 a[8:11], v[128:131], v[80:83], 0
    ds_read_b64_tr_b16 v[146:147], v4 offset:8704
    s_waitcnt lgkmcnt(15)
    v_mfma_f32_16x16x32_bf16 a[8:11], v[136:139], v[84:87], a[8:11]
    s_add_u32 m0, s47, 110592
    s_nop 0
    v_mfma_f32_16x16x32_bf16 a[12:15], v[128:131], v[88:91], 0
    buffer_load_dwordx4 v9, s[12:15], s43 offen nt lds
    s_waitcnt lgkmcnt(14)
    v_mfma_f32_16x16x32_bf16 a[12:15], v[136:139], v[92:95], a[12:15]
    s_waitcnt lgkmcnt(4)
    v_smfmac_f32_16x16x64_bf16 v[36:39], v[32:35], v[128:135], v56
    v_mfma_f32_16x16x32_bf16 a[16:19], v[128:131], v[96:99], 0
    ds_read_b64_tr_b16 v[152:153], v58 offset:8192
    v_mfma_f32_16x16x32_bf16 a[16:19], v[136:139], v[100:103], a[16:19]
    s_add_u32 m0, s47, 114688
    v_mfma_f32_16x16x32_bf16 a[20:23], v[128:131], v[104:107], 0
    buffer_load_dwordx4 v15, s[16:19], 0 offen nt lds
    v_mfma_f32_16x16x32_bf16 a[20:23], v[136:139], v[108:111], a[20:23]
    v_mfma_f32_16x16x32_bf16 a[24:27], v[128:131], v[112:115], 0
    ds_read_b64_tr_b16 v[154:155], v58 offset:8704
    v_mfma_f32_16x16x32_bf16 a[24:27], v[136:139], v[116:119], a[24:27]
    s_add_u32 m0, s47, 118784
    v_mfma_f32_16x16x32_bf16 a[28:31], v[128:131], v[120:123], 0
    buffer_load_dwordx4 v15, s[16:19], s59 offen nt lds
    v_mfma_f32_16x16x32_bf16 a[28:31], v[136:139], v[124:127], a[28:31]
    v_mfma_f32_16x16x32_bf16 a[32:35], v[132:135], v[64:67], 0
    ds_read_b64_tr_b16 v[148:149], v5 offset:8192
    s_waitcnt lgkmcnt(5)
    v_mfma_f32_16x16x32_bf16 a[32:35], v[140:143], v[68:71], a[32:35]
    s_add_u32 m0, s47, 122880
    s_nop 0
    v_mfma_f32_16x16x32_bf16 a[36:39], v[132:135], v[72:75], 0
    buffer_load_dwordx4 v15, s[20:23], 0 offen nt lds
    v_mfma_f32_16x16x32_bf16 a[36:39], v[140:143], v[76:79], a[36:39]
    v_mfma_f32_16x16x32_bf16 a[40:43], v[132:135], v[80:83], 0
    ds_read_b64_tr_b16 v[150:151], v5 offset:8704
    v_mfma_f32_16x16x32_bf16 a[40:43], v[140:143], v[84:87], a[40:43]
    s_add_u32 m0, s47, 126976
    v_mfma_f32_16x16x32_bf16 a[44:47], v[132:135], v[88:91], 0
    buffer_load_dwordx4 v15, s[20:23], s59 offen nt lds
    v_mfma_f32_16x16x32_bf16 a[44:47], v[140:143], v[92:95], a[44:47]
    v_mfma_f32_16x16x32_bf16 a[48:51], v[132:135], v[96:99], 0
    ds_read_b64_tr_b16 v[156:157], v59 offset:8192
    v_mfma_f32_16x16x32_bf16 a[48:51], v[140:143], v[100:103], a[48:51]
    s_add_u32 m0, s47, 131072
    v_mfma_f32_16x16x32_bf16 a[52:55], v[132:135], v[104:107], 0
    buffer_load_dwordx4 v10, s[24:27], 0 offen nt lds
    s_waitcnt vmcnt(7)
    s_barrier
    v_mfma_f32_16x16x32_bf16 a[52:55], v[140:143], v[108:111], a[52:55]
    v_mfma_f32_16x16x32_bf16 a[56:59], v[132:135], v[112:115], 0
    ds_read_b64_tr_b16 v[158:159], v59 offset:8704
    v_mfma_f32_16x16x32_bf16 a[56:59], v[140:143], v[116:119], a[56:59]
    s_add_u32 m0, s47, 135168
    v_mfma_f32_16x16x32_bf16 a[60:63], v[132:135], v[120:123], 0
    buffer_load_dwordx4 v10, s[24:27], s44 offen nt lds
    v_mfma_f32_16x16x32_bf16 a[60:63], v[140:143], v[124:127], a[60:63]
    s_waitcnt lgkmcnt(6)
    v_mfma_f32_16x16x32_bf16 a[64:67], v[144:147], v[64:67], 0
    ds_read_b64_tr_b16 v[128:129], v4 offset:16384
    s_waitcnt lgkmcnt(5)
    v_mfma_f32_16x16x32_bf16 a[64:67], v[152:155], v[68:71], a[64:67]
    s_add_u32 m0, s47, 139264
    v_mfma_f32_16x16x32_bf16 a[68:71], v[144:147], v[72:75], 0
    buffer_load_dwordx4 v10, s[28:31], 0 offen nt lds
    v_mfma_f32_16x16x32_bf16 a[68:71], v[152:155], v[76:79], a[68:71]
    v_mfma_f32_16x16x32_bf16 a[72:75], v[144:147], v[80:83], 0
    ds_read_b64_tr_b16 v[130:131], v4 offset:16896
    v_mfma_f32_16x16x32_bf16 a[72:75], v[152:155], v[84:87], a[72:75]
    s_add_u32 m0, s47, 143360
    v_mfma_f32_16x16x32_bf16 a[76:79], v[144:147], v[88:91], 0
    buffer_load_dwordx4 v10, s[28:31], s44 offen nt lds
    v_mfma_f32_16x16x32_bf16 a[76:79], v[152:155], v[92:95], a[76:79]
    s_waitcnt lgkmcnt(4)
    v_smfmac_f32_16x16x64_bf16 v[40:43], v[32:35], v[144:151], v56
    v_mfma_f32_16x16x32_bf16 a[80:83], v[144:147], v[96:99], 0
    s_nop 0
    ds_read_b64_tr_b16 v[136:137], v58 offset:16384
    v_mfma_f32_16x16x32_bf16 a[80:83], v[152:155], v[100:103], a[80:83]
    s_add_u32 m0, s47, 32768
    v_mfma_f32_16x16x32_bf16 a[84:87], v[144:147], v[104:107], 0
    buffer_load_dwordx4 v8, s[8:11], 0 offen  lds
    v_mfma_f32_16x16x32_bf16 a[84:87], v[152:155], v[108:111], a[84:87]
    v_mfma_f32_16x16x32_bf16 a[88:91], v[144:147], v[112:115], 0
    ds_read_b64_tr_b16 v[138:139], v58 offset:16896
    v_mfma_f32_16x16x32_bf16 a[88:91], v[152:155], v[116:119], a[88:91]
    s_add_u32 m0, s47, 36864
    v_mfma_f32_16x16x32_bf16 a[92:95], v[144:147], v[120:123], 0
    buffer_load_dwordx4 v8, s[8:11], s36 offen  lds
    v_mfma_f32_16x16x32_bf16 a[92:95], v[152:155], v[124:127], a[92:95]
    v_mfma_f32_16x16x32_bf16 a[96:99], v[148:151], v[64:67], 0
    ds_read_b64_tr_b16 v[132:133], v5 offset:16384
    s_waitcnt lgkmcnt(5)
    s_nop 0
    v_mfma_f32_16x16x32_bf16 a[96:99], v[156:159], v[68:71], a[96:99]
    s_add_u32 m0, s47, 40960
    v_mfma_f32_16x16x32_bf16 a[100:103], v[148:151], v[72:75], 0
    buffer_load_dwordx4 v8, s[8:11], s37 offen  lds
    v_mfma_f32_16x16x32_bf16 a[100:103], v[156:159], v[76:79], a[100:103]
    v_mfma_f32_16x16x32_bf16 a[104:107], v[148:151], v[80:83], 0
    ds_read_b64_tr_b16 v[134:135], v5 offset:16896
    v_mfma_f32_16x16x32_bf16 a[104:107], v[156:159], v[84:87], a[104:107]
    s_add_u32 m0, s47, 45056
    v_mfma_f32_16x16x32_bf16 a[108:111], v[148:151], v[88:91], 0
    buffer_load_dwordx4 v8, s[8:11], s38 offen  lds
    v_mfma_f32_16x16x32_bf16 a[108:111], v[156:159], v[92:95], a[108:111]
    v_mfma_f32_16x16x32_bf16 a[112:115], v[148:151], v[96:99], 0
    ds_read_b64_tr_b16 v[140:141], v59 offset:16384
    v_mfma_f32_16x16x32_bf16 a[112:115], v[156:159], v[100:103], a[112:115]
    s_add_u32 m0, s47, 49152
    v_mfma_f32_16x16x32_bf16 a[116:119], v[148:151], v[104:107], 0
    buffer_load_dwordx4 v8, s[8:11], s39 offen  lds
    v_mfma_f32_16x16x32_bf16 a[116:119], v[156:159], v[108:111], a[116:119]
    v_mfma_f32_16x16x32_bf16 a[120:123], v[148:151], v[112:115], 0
    ds_read_b64_tr_b16 v[142:143], v59 offset:16896
    v_mfma_f32_16x16x32_bf16 a[120:123], v[156:159], v[116:119], a[120:123]
    s_add_u32 m0, s47, 53248
    v_mfma_f32_16x16x32_bf16 a[124:127], v[148:151], v[120:123], 0
    buffer_load_dwordx4 v8, s[8:11], s40 offen  lds
    v_mfma_f32_16x16x32_bf16 a[124:127], v[156:159], v[124:127], a[124:127]
    s_waitcnt lgkmcnt(6)
    v_mfma_f32_16x16x32_bf16 a[128:131], v[128:131], v[64:67], 0
    ds_read_b64_tr_b16 v[144:145], v4 offset:24576
    s_waitcnt lgkmcnt(5)
    v_mfma_f32_16x16x32_bf16 a[128:131], v[136:139], v[68:71], a[128:131]
    s_add_u32 m0, s47, 57344
    v_mfma_f32_16x16x32_bf16 a[132:135], v[128:131], v[72:75], 0
    buffer_load_dwordx4 v8, s[8:11], s41 offen  lds
    v_mfma_f32_16x16x32_bf16 a[132:135], v[136:139], v[76:79], a[132:135]
    v_mfma_f32_16x16x32_bf16 a[136:139], v[128:131], v[80:83], 0
    ds_read_b64_tr_b16 v[146:147], v4 offset:25088
    v_mfma_f32_16x16x32_bf16 a[136:139], v[136:139], v[84:87], a[136:139]
    s_add_u32 m0, s47, 61440
    v_mfma_f32_16x16x32_bf16 a[140:143], v[128:131], v[88:91], 0
    buffer_load_dwordx4 v8, s[8:11], s42 offen  lds
    v_mfma_f32_16x16x32_bf16 a[140:143], v[136:139], v[92:95], a[140:143]
    s_waitcnt lgkmcnt(4)
    v_smfmac_f32_16x16x64_bf16 v[44:47], v[32:35], v[128:135], v56
    v_mfma_f32_16x16x32_bf16 a[144:147], v[128:131], v[96:99], 0
    ds_read_b64_tr_b16 v[152:153], v58 offset:24576
    s_nop 0
    v_mfma_f32_16x16x32_bf16 a[144:147], v[136:139], v[100:103], a[144:147]
    buffer_load_dword v57, v12, s[4:7], 0 offen
    v_mfma_f32_16x16x32_bf16 a[148:151], v[128:131], v[104:107], 0
    s_add_u32 s101, s45, 2
    s_and_b32 s101, s101, 15
    s_cselect_b32 s100, 1, -15
    s_mul_i32 s101, s100, s49
    v_add_u32_e64 v12, s101, v12
    v_mfma_f32_16x16x32_bf16 a[148:151], v[136:139], v[108:111], a[148:151]
    buffer_store_dword v161, v160, s[32:35], s46 offen sc1
    v_mfma_f32_16x16x32_bf16 a[152:155], v[128:131], v[112:115], 0
    ds_read_b64_tr_b16 v[154:155], v58 offset:25088
    v_mfma_f32_16x16x32_bf16 a[152:155], v[136:139], v[116:119], a[152:155]
    buffer_store_dword v161, v160, s[32:35], s83 offen sc1
    v_mfma_f32_16x16x32_bf16 a[156:159], v[128:131], v[120:123], 0
    buffer_store_dword v161, v160, s[32:35], s3 offen sc1
    v_mfma_f32_16x16x32_bf16 a[156:159], v[136:139], v[124:127], a[156:159]
    v_mfma_f32_16x16x32_bf16 a[160:163], v[132:135], v[64:67], 0
    ds_read_b64_tr_b16 v[148:149], v5 offset:24576
    s_waitcnt lgkmcnt(5)
    v_mfma_f32_16x16x32_bf16 a[160:163], v[140:143], v[68:71], a[160:163]
    s_nop 0
    v_mfma_f32_16x16x32_bf16 a[164:167], v[132:135], v[72:75], 0
    v_mfma_f32_16x16x32_bf16 a[164:167], v[140:143], v[76:79], a[164:167]
    v_mfma_f32_16x16x32_bf16 a[168:171], v[132:135], v[80:83], 0
    ds_read_b64_tr_b16 v[150:151], v5 offset:25088
    v_mfma_f32_16x16x32_bf16 a[168:171], v[140:143], v[84:87], a[168:171]
    v_mfma_f32_16x16x32_bf16 a[172:175], v[132:135], v[88:91], 0
    v_mfma_f32_16x16x32_bf16 a[172:175], v[140:143], v[92:95], a[172:175]
    v_mfma_f32_16x16x32_bf16 a[176:179], v[132:135], v[96:99], 0
    ds_read_b64_tr_b16 v[156:157], v59 offset:24576
    v_mfma_f32_16x16x32_bf16 a[176:179], v[140:143], v[100:103], a[176:179]
    v_mfma_f32_16x16x32_bf16 a[180:183], v[132:135], v[104:107], 0
    v_mfma_f32_16x16x32_bf16 a[180:183], v[140:143], v[108:111], a[180:183]
    v_mfma_f32_16x16x32_bf16 a[184:187], v[132:135], v[112:115], 0
    ds_read_b64_tr_b16 v[158:159], v59 offset:25088
    v_mfma_f32_16x16x32_bf16 a[184:187], v[140:143], v[116:119], a[184:187]
    v_mfma_f32_16x16x32_bf16 a[188:191], v[132:135], v[120:123], 0
    v_mfma_f32_16x16x32_bf16 a[188:191], v[140:143], v[124:127], a[188:191]
    s_waitcnt lgkmcnt(6)
    v_mfma_f32_16x16x32_bf16 a[192:195], v[144:147], v[64:67], 0
    ds_read_b64_tr_b16 v[128:129], v4 offset:32768
    s_waitcnt lgkmcnt(5)
    v_mfma_f32_16x16x32_bf16 a[192:195], v[152:155], v[68:71], a[192:195]
    s_add_u32 s45, s45, 1
    v_mfma_f32_16x16x32_bf16 a[196:199], v[144:147], v[72:75], 0
    s_nop 0
    v_mfma_f32_16x16x32_bf16 a[196:199], v[152:155], v[76:79], a[196:199]
    s_and_b32 s45, s45, 15
    s_cselect_b32 s100, 1, -15
    v_mfma_f32_16x16x32_bf16 a[200:203], v[144:147], v[80:83], 0
    ds_read_b64_tr_b16 v[130:131], v4 offset:33280
    v_mfma_f32_16x16x32_bf16 a[200:203], v[152:155], v[84:87], a[200:203]
    s_mul_i32 s101, s100, 0x80
    v_mfma_f32_16x16x32_bf16 a[204:207], v[144:147], v[88:91], 0
    v_mfma_f32_16x16x32_bf16 a[204:207], v[152:155], v[92:95], a[204:207]
    s_waitcnt lgkmcnt(4)
    s_nop 0
    v_smfmac_f32_16x16x64_bf16 v[48:51], v[32:35], v[144:151], v56
    v_mfma_f32_16x16x32_bf16 a[208:211], v[144:147], v[96:99], 0
    ds_read_b64_tr_b16 v[136:137], v58 offset:32768
    v_mfma_f32_16x16x32_bf16 a[208:211], v[152:155], v[100:103], a[208:211]
    v_add_u32_e64 v8, s101, v8
    v_mfma_f32_16x16x32_bf16 a[212:215], v[144:147], v[104:107], 0
    v_mfma_f32_16x16x32_bf16 a[212:215], v[152:155], v[108:111], a[212:215]
    s_mul_i32 s101, s100, 393216
    v_mfma_f32_16x16x32_bf16 a[216:219], v[144:147], v[112:115], 0
    ds_read_b64_tr_b16 v[138:139], v58 offset:33280
    v_mfma_f32_16x16x32_bf16 a[216:219], v[152:155], v[116:119], a[216:219]
    v_add_u32_e64 v9, s101, v9
    v_mfma_f32_16x16x32_bf16 a[220:223], v[144:147], v[120:123], 0
    v_mfma_f32_16x16x32_bf16 a[220:223], v[152:155], v[124:127], a[220:223]
    s_mul_i32 s101, s100, 458752
    v_mfma_f32_16x16x32_bf16 a[224:227], v[148:151], v[64:67], 0
    ds_read_b64_tr_b16 v[132:133], v5 offset:32768
    s_waitcnt lgkmcnt(5)
    v_mfma_f32_16x16x32_bf16 a[224:227], v[156:159], v[68:71], a[224:227]
    ds_read_b64_tr_b16 v[134:135], v5 offset:33280
    v_add_u32 v10, s101, v10
    v_mfma_f32_16x16x32_bf16 a[228:231], v[148:151], v[72:75], 0
    ds_read_b64_tr_b16 v[140:141], v59 offset:32768
    v_mfma_f32_16x16x32_bf16 a[228:231], v[156:159], v[76:79], a[228:231]
    s_nop 0
    ds_read_b64_tr_b16 v[142:143], v59 offset:33280
    s_mul_i32 s101, s100, s79
    v_mfma_f32_16x16x32_bf16 a[232:235], v[148:151], v[80:83], 0
    v_mfma_f32_16x16x32_bf16 a[232:235], v[156:159], v[84:87], a[232:235]
    v_add_u32_e64 v15, s101, v15
    v_mfma_f32_16x16x32_bf16 a[236:239], v[148:151], v[88:91], 0
    v_mfma_f32_16x16x32_bf16 a[236:239], v[156:159], v[92:95], a[236:239]
    v_mfma_f32_16x16x32_bf16 a[240:243], v[148:151], v[96:99], 0
    v_mfma_f32_16x16x32_bf16 a[240:243], v[156:159], v[100:103], a[240:243]
    v_mfma_f32_16x16x32_bf16 a[244:247], v[148:151], v[104:107], 0
    v_mfma_f32_16x16x32_bf16 a[244:247], v[156:159], v[108:111], a[244:247]
    v_mfma_f32_16x16x32_bf16 a[248:251], v[148:151], v[112:115], 0
    v_mfma_f32_16x16x32_bf16 a[248:251], v[156:159], v[116:119], a[248:251]
    v_mfma_f32_16x16x32_bf16 a[252:255], v[148:151], v[120:123], 0
    v_mfma_f32_16x16x32_bf16 a[252:255], v[156:159], v[124:127], a[252:255]
    s_waitcnt vmcnt(4) lgkmcnt(0)
    s_barrier
    v_mfma_f32_16x16x32_bf16 v[192:195], v[128:131], v[64:67], 0
    buffer_load_dwordx4 v[20:23], v162, s[8:11], 0 offen offset:512
    buffer_load_dwordx4 v[16:19], v162, s[8:11], 0 offen offset:0
    s_add_u32 m0, s47, 65536
    ds_read_b64_tr_b16 v[144:145], v6 offset:0
    v_mfma_f32_16x16x32_bf16 v[192:195], v[136:139], v[68:71], v[192:195]
    buffer_load_dwordx4 v[28:31], v162, s[8:11], 0 offen offset:1536
    buffer_load_dwordx4 v[24:27], v162, s[8:11], 0 offen offset:1024
    buffer_load_dwordx4 v9, s[12:15], 0 offen nt lds
    v_mfma_f32_16x16x32_bf16 v[196:199], v[128:131], v[72:75], 0
    ds_read_b64_tr_b16 v[146:147], v6 offset:512
    v_mfma_f32_16x16x32_bf16 v[196:199], v[136:139], v[76:79], v[196:199]
    v_mfma_f32_16x16x32_bf16 v[200:203], v[128:131], v[80:83], 0
    s_add_u32 m0, s47, 69632
    ds_read_b64_tr_b16 v[152:153], v60 offset:0
    v_mfma_f32_16x16x32_bf16 v[200:203], v[136:139], v[84:87], v[200:203]
    buffer_load_dwordx4 v9, s[12:15], s43 offen nt lds
    v_mfma_f32_16x16x32_bf16 v[204:207], v[128:131], v[88:91], 0
    ds_read_b64_tr_b16 v[154:155], v60 offset:512
    v_mfma_f32_16x16x32_bf16 v[204:207], v[136:139], v[92:95], v[204:207]
    v_smfmac_f32_16x16x64_bf16 v[52:55], v[32:35], v[128:135], v56
    v_mfma_f32_16x16x32_bf16 v[208:211], v[128:131], v[96:99], 0
    s_add_u32 m0, s47, 73728
    ds_read_b64_tr_b16 v[148:149], v7 offset:0
    v_mfma_f32_16x16x32_bf16 v[208:211], v[136:139], v[100:103], v[208:211]
    buffer_load_dwordx4 v15, s[16:19], 0 offen nt lds
    v_mfma_f32_16x16x32_bf16 v[212:215], v[128:131], v[104:107], 0
    ds_read_b64_tr_b16 v[150:151], v7 offset:512
    v_mfma_f32_16x16x32_bf16 v[212:215], v[136:139], v[108:111], v[212:215]
    v_mfma_f32_16x16x32_bf16 v[216:219], v[128:131], v[112:115], 0
    s_add_u32 m0, s47, 77824
    ds_read_b64_tr_b16 v[156:157], v61 offset:0
    v_mfma_f32_16x16x32_bf16 v[216:219], v[136:139], v[116:119], v[216:219]
    buffer_load_dwordx4 v15, s[16:19], s59 offen nt lds
    v_mfma_f32_16x16x32_bf16 v[220:223], v[128:131], v[120:123], 0
    ds_read_b64_tr_b16 v[158:159], v61 offset:512
    v_mfma_f32_16x16x32_bf16 v[220:223], v[136:139], v[124:127], v[220:223]
    v_mfma_f32_16x16x32_bf16 v[224:227], v[132:135], v[64:67], 0
    ds_read_b128 v[64:67], v2 offset:32768
    v_mfma_f32_16x16x32_bf16 v[224:227], v[140:143], v[68:71], v[224:227]
    ds_read_b128 v[68:71], v3 offset:32768
    v_mfma_f32_16x16x32_bf16 v[228:231], v[132:135], v[72:75], 0
    ds_read_b128 v[72:75], v2 offset:34816
    v_mfma_f32_16x16x32_bf16 v[228:231], v[140:143], v[76:79], v[228:231]
    ds_read_b128 v[76:79], v3 offset:34816
    v_mfma_f32_16x16x32_bf16 v[232:235], v[132:135], v[80:83], 0
    ds_read_b128 v[80:83], v2 offset:36864
    v_mfma_f32_16x16x32_bf16 v[232:235], v[140:143], v[84:87], v[232:235]
    ds_read_b128 v[84:87], v3 offset:36864
    v_mfma_f32_16x16x32_bf16 v[236:239], v[132:135], v[88:91], 0
    ds_read_b128 v[88:91], v2 offset:38912
    v_mfma_f32_16x16x32_bf16 v[236:239], v[140:143], v[92:95], v[236:239]
    ds_read_b128 v[92:95], v3 offset:38912
    v_mfma_f32_16x16x32_bf16 v[240:243], v[132:135], v[96:99], 0
    ds_read_b128 v[96:99], v2 offset:40960
    v_mfma_f32_16x16x32_bf16 v[240:243], v[140:143], v[100:103], v[240:243]
    ds_read_b128 v[100:103], v3 offset:40960
    v_mfma_f32_16x16x32_bf16 v[244:247], v[132:135], v[104:107], 0
    ds_read_b128 v[104:107], v2 offset:43008
    v_mfma_f32_16x16x32_bf16 v[244:247], v[140:143], v[108:111], v[244:247]
    ds_read_b128 v[108:111], v3 offset:43008
    v_mfma_f32_16x16x32_bf16 v[248:251], v[132:135], v[112:115], 0
    ds_read_b128 v[112:115], v2 offset:45056
    v_mfma_f32_16x16x32_bf16 v[248:251], v[140:143], v[116:119], v[248:251]
    ds_read_b128 v[116:119], v3 offset:45056
    v_mfma_f32_16x16x32_bf16 v[252:255], v[132:135], v[120:123], 0
    ds_read_b128 v[120:123], v2 offset:47104
    v_mfma_f32_16x16x32_bf16 v[252:255], v[140:143], v[124:127], v[252:255]
    ds_read_b128 v[124:127], v3 offset:47104
    s_waitcnt lgkmcnt(15)
    v_mfma_f32_16x16x32_bf16 a[0:3], v[144:147], v[64:67], a[0:3]
    ds_read_b64_tr_b16 v[128:129], v6 offset:8192
    s_waitcnt lgkmcnt(15)
    v_mfma_f32_16x16x32_bf16 a[0:3], v[152:155], v[68:71], a[0:3]
    s_add_u32 m0, s47, 81920
    s_waitcnt lgkmcnt(14)
    v_mfma_f32_16x16x32_bf16 a[4:7], v[144:147], v[72:75], a[4:7]
    buffer_load_dwordx4 v15, s[20:23], 0 offen nt lds
    s_waitcnt lgkmcnt(13)
    v_mfma_f32_16x16x32_bf16 a[4:7], v[152:155], v[76:79], a[4:7]
    s_waitcnt lgkmcnt(12)
    v_mfma_f32_16x16x32_bf16 a[8:11], v[144:147], v[80:83], a[8:11]
    ds_read_b64_tr_b16 v[130:131], v6 offset:8704
    s_waitcnt lgkmcnt(12)
    v_mfma_f32_16x16x32_bf16 a[8:11], v[152:155], v[84:87], a[8:11]
    s_add_u32 m0, s47, 86016
    s_waitcnt lgkmcnt(11)
    v_mfma_f32_16x16x32_bf16 a[12:15], v[144:147], v[88:91], a[12:15]
    buffer_load_dwordx4 v15, s[20:23], s59 offen nt lds
    s_waitcnt lgkmcnt(10)
    v_mfma_f32_16x16x32_bf16 a[12:15], v[152:155], v[92:95], a[12:15]
    v_smfmac_f32_16x16x64_bf16 v[36:39], v[32:35], v[144:151], v56
    s_waitcnt lgkmcnt(9)
    s_nop 0
    v_mfma_f32_16x16x32_bf16 a[16:19], v[144:147], v[96:99], a[16:19]
    ds_read_b64_tr_b16 v[136:137], v60 offset:8192
    s_waitcnt lgkmcnt(9)
    v_mfma_f32_16x16x32_bf16 a[16:19], v[152:155], v[100:103], a[16:19]
    s_add_u32 m0, s47, 90112
    s_waitcnt lgkmcnt(8)
    v_mfma_f32_16x16x32_bf16 a[20:23], v[144:147], v[104:107], a[20:23]
    buffer_load_dwordx4 v10, s[24:27], 0 offen nt lds
    s_waitcnt lgkmcnt(7)
    v_mfma_f32_16x16x32_bf16 a[20:23], v[152:155], v[108:111], a[20:23]
    s_waitcnt lgkmcnt(6)
    v_mfma_f32_16x16x32_bf16 a[24:27], v[144:147], v[112:115], a[24:27]
    ds_read_b64_tr_b16 v[138:139], v60 offset:8704
    s_waitcnt lgkmcnt(6)
    v_mfma_f32_16x16x32_bf16 a[24:27], v[152:155], v[116:119], a[24:27]
    s_nop 0
    s_add_u32 m0, s47, 94208
    s_waitcnt lgkmcnt(5)
    v_mfma_f32_16x16x32_bf16 a[28:31], v[144:147], v[120:123], a[28:31]
    buffer_load_dwordx4 v10, s[24:27], s44 offen nt lds
    s_waitcnt lgkmcnt(4)
    v_mfma_f32_16x16x32_bf16 a[28:31], v[152:155], v[124:127], a[28:31]
    v_mfma_f32_16x16x32_bf16 a[32:35], v[148:151], v[64:67], a[32:35]
    ds_read_b64_tr_b16 v[132:133], v7 offset:8192
    v_mfma_f32_16x16x32_bf16 a[32:35], v[156:159], v[68:71], a[32:35]
    s_add_u32 m0, s47, 98304
    v_mfma_f32_16x16x32_bf16 a[36:39], v[148:151], v[72:75], a[36:39]
    buffer_load_dwordx4 v10, s[28:31], 0 offen nt lds
    v_mfma_f32_16x16x32_bf16 a[36:39], v[156:159], v[76:79], a[36:39]
    v_mfma_f32_16x16x32_bf16 a[40:43], v[148:151], v[80:83], a[40:43]
    ds_read_b64_tr_b16 v[134:135], v7 offset:8704
    v_mfma_f32_16x16x32_bf16 a[40:43], v[156:159], v[84:87], a[40:43]
    s_add_u32 m0, s47, 102400
    v_mfma_f32_16x16x32_bf16 a[44:47], v[148:151], v[88:91], a[44:47]
    buffer_load_dwordx4 v10, s[28:31], s44 offen nt lds
    v_mfma_f32_16x16x32_bf16 a[44:47], v[156:159], v[92:95], a[44:47]
    v_mfma_f32_16x16x32_bf16 a[48:51], v[148:151], v[96:99], a[48:51]
    ds_read_b64_tr_b16 v[140:141], v61 offset:8192
    v_mfma_f32_16x16x32_bf16 a[48:51], v[156:159], v[100:103], a[48:51]
    s_add_u32 m0, s47, 0
    v_mfma_f32_16x16x32_bf16 a[52:55], v[148:151], v[104:107], a[52:55]
    s_nop 0
    buffer_load_dwordx4 v8, s[8:11], 0 offen  lds
    v_mfma_f32_16x16x32_bf16 a[52:55], v[156:159], v[108:111], a[52:55]
    v_mfma_f32_16x16x32_bf16 a[56:59], v[148:151], v[112:115], a[56:59]
    ds_read_b64_tr_b16 v[142:143], v61 offset:8704
    v_mfma_f32_16x16x32_bf16 a[56:59], v[156:159], v[116:119], a[56:59]
    s_add_u32 m0, s47, 4096
    v_mfma_f32_16x16x32_bf16 a[60:63], v[148:151], v[120:123], a[60:63]
    buffer_load_dwordx4 v8, s[8:11], s36 offen  lds
    v_mfma_f32_16x16x32_bf16 a[60:63], v[156:159], v[124:127], a[60:63]
    s_waitcnt lgkmcnt(6)
    v_mfma_f32_16x16x32_bf16 a[64:67], v[128:131], v[64:67], a[64:67]
    ds_read_b64_tr_b16 v[144:145], v6 offset:16384
    s_waitcnt lgkmcnt(5)
    v_mfma_f32_16x16x32_bf16 a[64:67], v[136:139], v[68:71], a[64:67]
    s_add_u32 m0, s47, 8192
    v_mfma_f32_16x16x32_bf16 a[68:71], v[128:131], v[72:75], a[68:71]
    buffer_load_dwordx4 v8, s[8:11], s37 offen  lds
    v_mfma_f32_16x16x32_bf16 a[68:71], v[136:139], v[76:79], a[68:71]
    v_mfma_f32_16x16x32_bf16 a[72:75], v[128:131], v[80:83], a[72:75]
    ds_read_b64_tr_b16 v[146:147], v6 offset:16896
    v_mfma_f32_16x16x32_bf16 a[72:75], v[136:139], v[84:87], a[72:75]
    s_add_u32 m0, s47, 12288
    v_mfma_f32_16x16x32_bf16 a[76:79], v[128:131], v[88:91], a[76:79]
    buffer_load_dwordx4 v8, s[8:11], s38 offen  lds
    v_mfma_f32_16x16x32_bf16 a[76:79], v[136:139], v[92:95], a[76:79]
    s_waitcnt lgkmcnt(4)
    v_smfmac_f32_16x16x64_bf16 v[40:43], v[32:35], v[128:135], v56
    v_mfma_f32_16x16x32_bf16 a[80:83], v[128:131], v[96:99], a[80:83]
    s_nop 0
    ds_read_b64_tr_b16 v[152:153], v60 offset:16384
    v_mfma_f32_16x16x32_bf16 a[80:83], v[136:139], v[100:103], a[80:83]
    s_add_u32 m0, s47, 16384
    v_mfma_f32_16x16x32_bf16 a[84:87], v[128:131], v[104:107], a[84:87]
    buffer_load_dwordx4 v8, s[8:11], s39 offen  lds
    v_mfma_f32_16x16x32_bf16 a[84:87], v[136:139], v[108:111], a[84:87]
    v_mfma_f32_16x16x32_bf16 a[88:91], v[128:131], v[112:115], a[88:91]
    ds_read_b64_tr_b16 v[154:155], v60 offset:16896
    v_mfma_f32_16x16x32_bf16 a[88:91], v[136:139], v[116:119], a[88:91]
    s_add_u32 m0, s47, 20480
    v_mfma_f32_16x16x32_bf16 a[92:95], v[128:131], v[120:123], a[92:95]
    buffer_load_dwordx4 v8, s[8:11], s40 offen  lds
    v_mfma_f32_16x16x32_bf16 a[92:95], v[136:139], v[124:127], a[92:95]
    v_mfma_f32_16x16x32_bf16 a[96:99], v[132:135], v[64:67], a[96:99]
    ds_read_b64_tr_b16 v[148:149], v7 offset:16384
    s_waitcnt lgkmcnt(5)
    s_nop 0
    v_mfma_f32_16x16x32_bf16 a[96:99], v[140:143], v[68:71], a[96:99]
    s_add_u32 m0, s47, 24576
    v_mfma_f32_16x16x32_bf16 a[100:103], v[132:135], v[72:75], a[100:103]
    buffer_load_dwordx4 v8, s[8:11], s41 offen  lds
    s_waitcnt vmcnt(19)
    v_lshlrev_b32 v160, 16, v16
    v_and_b32 v161, 0xffff0000, v16
    v_mfma_f32_16x16x32_bf16 a[100:103], v[140:143], v[76:79], a[100:103]
    v_lshlrev_b32 v162, 16, v17
    v_and_b32 v163, 0xffff0000, v17
    v_lshlrev_b32 v164, 16, v18
    v_mfma_f32_16x16x32_bf16 a[104:107], v[132:135], v[80:83], a[104:107]
    ds_read_b64_tr_b16 v[150:151], v7 offset:16896
    v_and_b32 v165, 0xffff0000, v18
    v_lshlrev_b32_e64 v166, 16, v19
    v_mfma_f32_16x16x32_bf16 a[104:107], v[140:143], v[84:87], a[104:107]
    s_add_u32 m0, s47, 28672
    v_and_b32 v167, 0xffff0000, v19
    v_lshlrev_b32_e64 v168, 16, v20
    v_and_b32 v169, 0xffff0000, v20
    v_mfma_f32_16x16x32_bf16 a[108:111], v[132:135], v[88:91], a[108:111]
    buffer_load_dwordx4 v8, s[8:11], s42 offen  lds
    v_lshlrev_b32_e64 v170, 16, v21
    v_and_b32 v171, 0xffff0000, v21
    v_mfma_f32_16x16x32_bf16 a[108:111], v[140:143], v[92:95], a[108:111]
    v_lshlrev_b32 v172, 16, v22
    v_and_b32 v173, 0xffff0000, v22
    v_lshlrev_b32 v174, 16, v23
    v_mfma_f32_16x16x32_bf16 a[112:115], v[132:135], v[96:99], a[112:115]
    ds_read_b64_tr_b16 v[156:157], v61 offset:16384
    v_and_b32 v175, 0xffff0000, v23
    s_waitcnt vmcnt(18)
    v_lshlrev_b32 v176, 16, v24
    v_mfma_f32_16x16x32_bf16 a[112:115], v[140:143], v[100:103], a[112:115]
    v_and_b32 v177, 0xffff0000, v24
    v_lshlrev_b32_e64 v178, 16, v25
    v_and_b32 v179, 0xffff0000, v25
    v_mfma_f32_16x16x32_bf16 a[116:119], v[132:135], v[104:107], a[116:119]
    buffer_load_dword v57, v12, s[4:7], 0 offen
    v_lshlrev_b32_e64 v180, 16, v26
    v_and_b32 v181, 0xffff0000, v26
    v_mfma_f32_16x16x32_bf16 a[116:119], v[140:143], v[108:111], a[116:119]
    s_add_u32 s101, s45, 3
    v_lshlrev_b32 v182, 16, v27
    v_and_b32 v183, 0xffff0000, v27
    v_lshlrev_b32_e64 v184, 16, v28
    v_mfma_f32_16x16x32_bf16 a[120:123], v[132:135], v[112:115], a[120:123]
    ds_read_b64_tr_b16 v[158:159], v61 offset:16896
    v_and_b32 v185, 0xffff0000, v28
    v_lshlrev_b32_e64 v186, 16, v29
    v_mfma_f32_16x16x32_bf16 a[120:123], v[140:143], v[116:119], a[120:123]
    s_and_b32 s101, s101, 15
    s_cselect_b32 s100, 1, -15
    v_and_b32 v187, 0xffff0000, v29
    v_lshlrev_b32_e64 v188, 16, v30
    v_and_b32 v189, 0xffff0000, v30
    v_mfma_f32_16x16x32_bf16 a[124:127], v[132:135], v[120:123], a[124:127]
    v_lshlrev_b32 v190, 16, v31
    v_and_b32 v191, 0xffff0000, v31
    v_add_f32 v16, v160, v164
    v_mfma_f32_16x16x32_bf16 a[124:127], v[140:143], v[124:127], a[124:127]
    s_mul_i32 s101, s100, s49
    v_add_f32 v17, v161, v165
    v_add_f32 v18, v162, v166
    v_add_f32_e64 v19, v163, v167
    s_waitcnt lgkmcnt(6)
    v_mfma_f32_16x16x32_bf16 a[128:131], v[144:147], v[64:67], a[128:131]
    ds_read_b64_tr_b16 v[128:129], v6 offset:24576
    v_add_f32 v16, v16, v168
    v_add_f32_e64 v17, v17, v169
    s_waitcnt lgkmcnt(5)
    v_mfma_f32_16x16x32_bf16 a[128:131], v[152:155], v[68:71], a[128:131]
    v_add_u32 v12, s101, v12
    v_add_f32 v18, v18, v170
    v_add_f32 v19, v19, v171
    v_mfma_f32_16x16x32_bf16 a[132:135], v[144:147], v[72:75], a[132:135]
    v_add_f32 v16, v16, v172
    v_add_f32 v17, v17, v173
    v_add_f32 v18, v18, v174
    v_mfma_f32_16x16x32_bf16 a[132:135], v[152:155], v[76:79], a[132:135]
    v_add_f32 v19, v19, v175
    v_add_f32 v16, v16, v176
    v_add_f32_e64 v17, v17, v177
    v_mfma_f32_16x16x32_bf16 a[136:139], v[144:147], v[80:83], a[136:139]
    ds_read_b64_tr_b16 v[130:131], v6 offset:25088
    v_add_f32 v18, v18, v178
    v_add_f32 v19, v19, v179
    v_mfma_f32_16x16x32_bf16 a[136:139], v[152:155], v[84:87], a[136:139]
    buffer_load_dword v57, v12, s[4:7], 0 offen
    v_add_f32 v16, v16, v180
    v_add_f32 v17, v17, v181
    v_mfma_f32_16x16x32_bf16 a[140:143], v[144:147], v[88:91], a[140:143]
    s_add_u32 s101, s45, 3
    s_and_b32 s101, s101, 15
    s_cselect_b32 s100, 1, -15
    s_mul_i32 s101, s100, s49
    v_add_u32 v12, s101, v12
    v_add_f32 v18, v18, v182
    v_add_f32 v19, v19, v183
    v_mfma_f32_16x16x32_bf16 a[140:143], v[152:155], v[92:95], a[140:143]
    s_waitcnt lgkmcnt(4)
    v_smfmac_f32_16x16x64_bf16 v[44:47], v[32:35], v[144:151], v56
    v_mfma_f32_16x16x32_bf16 a[144:147], v[144:147], v[96:99], a[144:147]
    ds_read_b64_tr_b16 v[136:137], v60 offset:24576
    v_add_f32 v16, v16, v184
    v_add_f32 v17, v17, v185
    v_mfma_f32_16x16x32_bf16 a[144:147], v[152:155], v[100:103], a[144:147]
    v_add_f32 v18, v18, v186
    v_add_f32 v19, v19, v187
    v_add_f32_e64 v16, v16, v188
    v_mfma_f32_16x16x32_bf16 a[148:151], v[144:147], v[104:107], a[148:151]
    v_add_f32_e64 v17, v17, v189
    v_add_f32_e64 v18, v18, v190
    v_add_f32_e64 v19, v19, v191
    v_mfma_f32_16x16x32_bf16 a[148:151], v[152:155], v[108:111], a[148:151]
    v_add_f32_e64 v16, v16, v17
    v_add_f32_e64 v18, v18, v19
    v_add_f32_e64 v16, v16, v18
    v_mfma_f32_16x16x32_bf16 a[152:155], v[144:147], v[112:115], a[152:155]
    ds_read_b64_tr_b16 v[138:139], v60 offset:25088
    v_mfma_f32_16x16x32_bf16 a[152:155], v[152:155], v[116:119], a[152:155]
    v_mfma_f32_16x16x32_bf16 a[156:159], v[144:147], v[120:123], a[156:159]
    v_add_f32_dpp v16, v16, v16 quad_perm:[1,0,3,2] row_mask:0xf bank_mask:0xf
    v_mfma_f32_16x16x32_bf16 a[156:159], v[152:155], v[124:127], a[156:159]
    v_mfma_f32_16x16x32_bf16 a[160:163], v[148:151], v[64:67], a[160:163]
    ds_read_b64_tr_b16 v[132:133], v7 offset:24576
    v_add_f32_dpp v16, v16, v16 quad_perm:[2,3,0,1] row_mask:0xf bank_mask:0xf
    s_waitcnt lgkmcnt(5)
    v_mfma_f32_16x16x32_bf16 a[160:163], v[156:159], v[68:71], a[160:163]
    v_mfma_f32_16x16x32_bf16 a[164:167], v[148:151], v[72:75], a[164:167]
    v_add_f32_dpp v16, v16, v16 row_half_mirror row_mask:0xf bank_mask:0xf
    s_nop 0
    v_mfma_f32_16x16x32_bf16 a[164:167], v[156:159], v[76:79], a[164:167]
    v_mfma_f32_16x16x32_bf16 a[168:171], v[148:151], v[80:83], a[168:171]
    ds_read_b64_tr_b16 v[134:135], v7 offset:25088
    v_add_f32_dpp v16, v16, v16 row_mirror row_mask:0xf bank_mask:0xf
    v_mov_b32 v17, v16
    v_mfma_f32_16x16x32_bf16 a[168:171], v[156:159], v[84:87], a[168:171]
    v_mfma_f32_16x16x32_bf16 a[172:175], v[148:151], v[88:91], a[172:175]
    v_mfma_f32_16x16x32_bf16 a[172:175], v[156:159], v[92:95], a[172:175]
    v_permlane16_swap_b32 v16, v17
    v_mfma_f32_16x16x32_bf16 a[176:179], v[148:151], v[96:99], a[176:179]
    ds_read_b64_tr_b16 v[140:141], v61 offset:24576
    v_mfma_f32_16x16x32_bf16 a[176:179], v[156:159], v[100:103], a[176:179]
    v_add_f32_e64 v16, v16, v17
    v_mul_f32 v16, 0x3a800000, v16
    v_sub_f32 v160, v160, v16
    v_mfma_f32_16x16x32_bf16 a[180:183], v[148:151], v[104:107], a[180:183]
    v_sub_f32 v161, v161, v16
    v_mul_f32 v20, v160, v160
    v_sub_f32 v162, v162, v16
    v_mfma_f32_16x16x32_bf16 a[180:183], v[156:159], v[108:111], a[180:183]
    v_mul_f32 v21, v161, v161
    v_sub_f32 v163, v163, v16
    v_mul_f32_e64 v22, v162, v162
    v_mfma_f32_16x16x32_bf16 a[184:187], v[148:151], v[112:115], a[184:187]
    ds_read_b64_tr_b16 v[142:143], v61 offset:25088
    v_sub_f32 v164, v164, v16
    v_mul_f32 v23, v163, v163
    v_mfma_f32_16x16x32_bf16 a[184:187], v[156:159], v[116:119], a[184:187]
    v_sub_f32 v165, v165, v16
    v_fmac_f32 v20, v164, v164
    v_sub_f32 v166, v166, v16
    v_mfma_f32_16x16x32_bf16 a[188:191], v[148:151], v[120:123], a[188:191]
    v_fmac_f32 v21, v165, v165
    v_sub_f32 v167, v167, v16
    v_fmac_f32 v22, v166, v166
    v_mfma_f32_16x16x32_bf16 a[188:191], v[156:159], v[124:127], a[188:191]
    v_sub_f32 v168, v168, v16
    v_fmac_f32 v23, v167, v167
    v_sub_f32 v169, v169, v16
    s_waitcnt lgkmcnt(6)
    v_mfma_f32_16x16x32_bf16 a[192:195], v[128:131], v[64:67], a[192:195]
    ds_read_b64_tr_b16 v[144:145], v6 offset:32768
    v_fmac_f32 v20, v168, v168
    v_sub_f32 v170, v170, v16
    s_waitcnt lgkmcnt(5)
    v_mfma_f32_16x16x32_bf16 a[192:195], v[136:139], v[68:71], a[192:195]
    s_add_u32 s45, s45, 1
    v_fmac_f32 v21, v169, v169
    v_sub_f32 v171, v171, v16
    v_fmac_f32 v22, v170, v170
    v_mfma_f32_16x16x32_bf16 a[196:199], v[128:131], v[72:75], a[196:199]
    v_sub_f32 v172, v172, v16
    v_fmac_f32 v23, v171, v171
    v_sub_f32 v173, v173, v16
    v_mfma_f32_16x16x32_bf16 a[196:199], v[136:139], v[76:79], a[196:199]
    s_and_b32 s45, s45, 15
    s_cselect_b32 s100, 1, -15
    v_fmac_f32 v20, v172, v172
    v_sub_f32 v174, v174, v16
    v_fmac_f32_e64 v21, v173, v173
    v_mfma_f32_16x16x32_bf16 a[200:203], v[128:131], v[80:83], a[200:203]
    ds_read_b64_tr_b16 v[146:147], v6 offset:33280
    v_sub_f32 v175, v175, v16
    v_fmac_f32 v22, v174, v174
    v_mfma_f32_16x16x32_bf16 a[200:203], v[136:139], v[84:87], a[200:203]
    s_mul_i32 s101, s100, 0x80
    v_sub_f32 v176, v176, v16
    v_fmac_f32 v23, v175, v175
    v_sub_f32 v177, v177, v16
    v_mfma_f32_16x16x32_bf16 a[204:207], v[128:131], v[88:91], a[204:207]
    v_fmac_f32 v20, v176, v176
    v_sub_f32_e64 v178, v178, v16
    v_fmac_f32 v21, v177, v177
    v_mfma_f32_16x16x32_bf16 a[204:207], v[136:139], v[92:95], a[204:207]
    s_waitcnt lgkmcnt(4)
    v_smfmac_f32_16x16x64_bf16 v[48:51], v[32:35], v[128:135], v56
    v_mfma_f32_16x16x32_bf16 a[208:211], v[128:131], v[96:99], a[208:211]
    ds_read_b64_tr_b16 v[152:153], v60 offset:32768
    v_sub_f32 v179, v179, v16
    v_fmac_f32 v22, v178, v178
    v_mfma_f32_16x16x32_bf16 a[208:211], v[136:139], v[100:103], a[208:211]
    v_add_u32 v8, s101, v8
    v_sub_f32 v180, v180, v16
    v_fmac_f32 v23, v179, v179
    v_mfma_f32_16x16x32_bf16 a[212:215], v[128:131], v[104:107], a[212:215]
    v_sub_f32 v181, v181, v16
    v_fmac_f32 v20, v180, v180
    v_sub_f32 v182, v182, v16
    v_mfma_f32_16x16x32_bf16 a[212:215], v[136:139], v[108:111], a[212:215]
    s_mul_i32 s101, s100, 393216
    v_fmac_f32 v21, v181, v181
    v_sub_f32 v183, v183, v16
    v_fmac_f32_e64 v22, v182, v182
    v_mfma_f32_16x16x32_bf16 a[216:219], v[128:131], v[112:115], a[216:219]
    ds_read_b64_tr_b16 v[154:155], v60 offset:33280
    v_sub_f32 v184, v184, v16
    v_fmac_f32 v23, v183, v183
    v_mfma_f32_16x16x32_bf16 a[216:219], v[136:139], v[116:119], a[216:219]
    v_add_u32 v9, s101, v9
    v_sub_f32 v185, v185, v16
    v_fmac_f32 v20, v184, v184
    v_mfma_f32_16x16x32_bf16 a[220:223], v[128:131], v[120:123], a[220:223]
    v_sub_f32 v186, v186, v16
    v_fmac_f32 v21, v185, v185
    v_sub_f32 v187, v187, v16
    v_mfma_f32_16x16x32_bf16 a[220:223], v[136:139], v[124:127], a[220:223]
    s_mul_i32 s101, s100, 458752
    v_fmac_f32 v22, v186, v186
    v_sub_f32 v188, v188, v16
    v_fmac_f32_e64 v23, v187, v187
    v_mfma_f32_16x16x32_bf16 a[224:227], v[132:135], v[64:67], a[224:227]
    ds_read_b64_tr_b16 v[148:149], v7 offset:32768
    v_sub_f32 v189, v189, v16
    v_fmac_f32_e64 v20, v188, v188
    s_waitcnt lgkmcnt(5)
    v_mfma_f32_16x16x32_bf16 a[224:227], v[140:143], v[68:71], a[224:227]
    ds_read_b64_tr_b16 v[150:151], v7 offset:33280
    v_add_u32 v10, s101, v10
    v_sub_f32 v190, v190, v16
    v_mfma_f32_16x16x32_bf16 a[228:231], v[132:135], v[72:75], a[228:231]
    ds_read_b64_tr_b16 v[156:157], v61 offset:32768
    v_fmac_f32 v21, v189, v189
    v_sub_f32 v191, v191, v16
    v_mfma_f32_16x16x32_bf16 a[228:231], v[140:143], v[76:79], a[228:231]
    ds_read_b64_tr_b16 v[158:159], v61 offset:33280
    s_mul_i32 s101, s100, s79
    v_fmac_f32 v22, v190, v190
    v_add_f32 v20, v20, v21
    v_mfma_f32_16x16x32_bf16 a[232:235], v[132:135], v[80:83], a[232:235]
    v_fmac_f32 v23, v191, v191
    v_add_f32 v20, v20, v22
    v_add_f32 v20, v20, v23
    v_mfma_f32_16x16x32_bf16 a[232:235], v[140:143], v[84:87], a[232:235]
    v_add_u32_e64 v15, s101, v15
    v_mfma_f32_16x16x32_bf16 a[236:239], v[132:135], v[88:91], a[236:239]
    v_mfma_f32_16x16x32_bf16 a[236:239], v[140:143], v[92:95], a[236:239]
    v_add_f32_dpp v20, v20, v20 quad_perm:[1,0,3,2] row_mask:0xf bank_mask:0xf
    v_mfma_f32_16x16x32_bf16 a[240:243], v[132:135], v[96:99], a[240:243]
    v_mfma_f32_16x16x32_bf16 a[240:243], v[140:143], v[100:103], a[240:243]
    v_add_f32_dpp v20, v20, v20 quad_perm:[2,3,0,1] row_mask:0xf bank_mask:0xf
    v_mfma_f32_16x16x32_bf16 a[244:247], v[132:135], v[104:107], a[244:247]
    v_mfma_f32_16x16x32_bf16 a[244:247], v[140:143], v[108:111], a[244:247]
    v_add_f32_dpp v20, v20, v20 row_half_mirror row_mask:0xf bank_mask:0xf
    v_mfma_f32_16x16x32_bf16 a[248:251], v[132:135], v[112:115], a[248:251]
    v_mfma_f32_16x16x32_bf16 a[248:251], v[140:143], v[116:119], a[248:251]
    v_add_f32_dpp v20, v20, v20 row_mirror row_mask:0xf bank_mask:0xf
    v_mov_b32 v21, v20
    v_mfma_f32_16x16x32_bf16 a[252:255], v[132:135], v[120:123], a[252:255]
    v_mfma_f32_16x16x32_bf16 a[252:255], v[140:143], v[124:127], a[252:255]
    s_waitcnt vmcnt(2) lgkmcnt(0)
    s_barrier
    v_mfma_f32_16x16x32_bf16 v[192:195], v[144:147], v[64:67], v[192:195]
    s_add_u32 m0, s47, 106496
    ds_read_b64_tr_b16 v[128:129], v4 offset:0
    v_permlane16_swap_b32 v20, v21
    v_mfma_f32_16x16x32_bf16 v[192:195], v[152:155], v[68:71], v[192:195]
    buffer_load_dwordx4 v9, s[12:15], 0 offen nt lds
    v_mfma_f32_16x16x32_bf16 v[196:199], v[144:147], v[72:75], v[196:199]
    ds_read_b64_tr_b16 v[130:131], v4 offset:512
    v_add_f32 v20, v20, v21
    v_mul_f32 v20, 0x3a800000, v20
    v_mfma_f32_16x16x32_bf16 v[196:199], v[152:155], v[76:79], v[196:199]
    v_cvt_pk_bf16_f32 v20, v20, v20
    v_lshlrev_b32 v20, 16, v20
    v_add_f32 v20, 0x3727c5ac, v20
    v_mfma_f32_16x16x32_bf16 v[200:203], v[144:147], v[80:83], v[200:203]
    s_add_u32 m0, s47, 110592
    ds_read_b64_tr_b16 v[136:137], v58 offset:0
    v_cvt_pk_bf16_f32 v20, v20, v20
    v_lshlrev_b32 v20, 16, v20
    v_mfma_f32_16x16x32_bf16 v[200:203], v[152:155], v[84:87], v[200:203]
    buffer_load_dwordx4 v9, s[12:15], s43 offen nt lds
    v_sqrt_f32 v20, v20
    v_cvt_pk_bf16_f32 v16, v16, v16
    v_mfma_f32_16x16x32_bf16 v[204:207], v[144:147], v[88:91], v[204:207]
    ds_read_b64_tr_b16 v[138:139], v58 offset:512
    v_lshlrev_b32_e64 v16, 16, v16
    v_cvt_pk_bf16_f32 v20, v20, v20
    v_mfma_f32_16x16x32_bf16 v[204:207], v[152:155], v[92:95], v[204:207]
    v_smfmac_f32_16x16x64_bf16 v[52:55], v[32:35], v[144:151], v56
    v_mfma_f32_16x16x32_bf16 v[208:211], v[144:147], v[96:99], v[208:211]
    s_add_u32 m0, s47, 114688
    ds_read_b64_tr_b16 v[132:133], v5 offset:0
    v_lshlrev_b32 v20, 16, v20
    v_rcp_f32 v20, v20
    v_mfma_f32_16x16x32_bf16 v[208:211], v[152:155], v[100:103], v[208:211]
    buffer_load_dwordx4 v15, s[16:19], 0 offen nt lds
    v_sub_f32 v16, 0, v16
    v_and_b32 v17, 31, v0
    v_mfma_f32_16x16x32_bf16 v[212:215], v[144:147], v[104:107], v[212:215]
    ds_read_b64_tr_b16 v[134:135], v5 offset:512
    v_cmp_eq_u32 vcc, 0, v17
    v_lshlrev_b32 v18, 9, v17
    v_mfma_f32_16x16x32_bf16 v[212:215], v[152:155], v[108:111], v[212:215]
    v_lshrrev_b32 v19, 5, v0
    v_lshl_add_u32 v18, v19, 2, v18
    v_cndmask_b32 v16, v20, v16, vcc
    v_mfma_f32_16x16x32_bf16 v[216:219], v[144:147], v[112:115], v[216:219]
    s_add_u32 m0, s47, 118784
    ds_read_b64_tr_b16 v[140:141], v59 offset:0
    v_cmp_gt_u32_e64 vcc, 2, v17
    v_mov_b32 v19, 0x7f000000
    v_mfma_f32_16x16x32_bf16 v[216:219], v[152:155], v[116:119], v[216:219]
    buffer_load_dwordx4 v15, s[16:19], s59 offen nt lds
    v_mov_b32 v191, 1
    v_lshlrev_b32 v190, 8, v0
    v_mfma_f32_16x16x32_bf16 v[220:223], v[144:147], v[120:123], v[220:223]
    ds_read_b64_tr_b16 v[142:143], v59 offset:512
    v_cndmask_b32 v18, v19, v18, vcc
    v_add_u32 v190, s47, v190
    v_mfma_f32_16x16x32_bf16 v[220:223], v[152:155], v[124:127], v[220:223]
    buffer_store_dword v16, v18, s[32:35], s81 offen sc1
    v_mfma_f32_16x16x32_bf16 v[224:227], v[148:151], v[64:67], v[224:227]
    ds_read_b128 v[64:67], v2 offset:0
    v_mfma_f32_16x16x32_bf16 v[224:227], v[156:159], v[68:71], v[224:227]
    ds_read_b128 v[68:71], v3 offset:0
    v_mfma_f32_16x16x32_bf16 v[228:231], v[148:151], v[72:75], v[228:231]
    ds_read_b128 v[72:75], v2 offset:2048
    v_mfma_f32_16x16x32_bf16 v[228:231], v[156:159], v[76:79], v[228:231]
    ds_read_b128 v[76:79], v3 offset:2048
    v_mfma_f32_16x16x32_bf16 v[232:235], v[148:151], v[80:83], v[232:235]
    ds_read_b128 v[80:83], v2 offset:4096
    v_mfma_f32_16x16x32_bf16 v[232:235], v[156:159], v[84:87], v[232:235]
    ds_read_b128 v[84:87], v3 offset:4096
    v_mfma_f32_16x16x32_bf16 v[236:239], v[148:151], v[88:91], v[236:239]
    ds_read_b128 v[88:91], v2 offset:6144
    v_mfma_f32_16x16x32_bf16 v[236:239], v[156:159], v[92:95], v[236:239]
    ds_read_b128 v[92:95], v3 offset:6144
    v_mfma_f32_16x16x32_bf16 v[240:243], v[148:151], v[96:99], v[240:243]
    ds_read_b128 v[96:99], v2 offset:8192
    v_mfma_f32_16x16x32_bf16 v[240:243], v[156:159], v[100:103], v[240:243]
    ds_read_b128 v[100:103], v3 offset:8192
    v_mfma_f32_16x16x32_bf16 v[244:247], v[148:151], v[104:107], v[244:247]
    ds_read_b128 v[104:107], v2 offset:10240
    v_mfma_f32_16x16x32_bf16 v[244:247], v[156:159], v[108:111], v[244:247]
    ds_read_b128 v[108:111], v3 offset:10240
    v_mfma_f32_16x16x32_bf16 v[248:251], v[148:151], v[112:115], v[248:251]
    ds_read_b128 v[112:115], v2 offset:12288
    v_mfma_f32_16x16x32_bf16 v[248:251], v[156:159], v[116:119], v[248:251]
    ds_read_b128 v[116:119], v3 offset:12288
    v_mfma_f32_16x16x32_bf16 v[252:255], v[148:151], v[120:123], v[252:255]
    ds_read_b128 v[120:123], v2 offset:14336
    v_mfma_f32_16x16x32_bf16 v[252:255], v[156:159], v[124:127], v[252:255]
    ds_read_b128 v[124:127], v3 offset:14336
.p2align 6
L_g1_loopA:
    s_waitcnt lgkmcnt(15)
    v_mfma_f32_16x16x32_bf16 a[0:3], v[128:131], v[64:67], a[0:3]
    ds_read_b64_tr_b16 v[144:145], v4 offset:8192
    s_waitcnt lgkmcnt(15)
    v_mfma_f32_16x16x32_bf16 a[0:3], v[136:139], v[68:71], a[0:3]
    s_add_u32 m0, s47, 122880
    s_waitcnt lgkmcnt(14)
    v_mfma_f32_16x16x32_bf16 a[4:7], v[128:131], v[72:75], a[4:7]
    buffer_load_dwordx4 v15, s[20:23], 0 offen nt lds
    s_waitcnt lgkmcnt(13)
    v_mfma_f32_16x16x32_bf16 a[4:7], v[136:139], v[76:79], a[4:7]
    s_waitcnt lgkmcnt(12)
    v_mfma_f32_16x16x32_bf16 a[8:11], v[128:131], v[80:83], a[8:11]
    ds_read_b64_tr_b16 v[146:147], v4 offset:8704
    s_waitcnt lgkmcnt(12)
    v_mfma_f32_16x16x32_bf16 a[8:11], v[136:139], v[84:87], a[8:11]
    s_add_u32 m0, s47, 126976
    s_waitcnt lgkmcnt(11)
    v_mfma_f32_16x16x32_bf16 a[12:15], v[128:131], v[88:91], a[12:15]
    buffer_load_dwordx4 v15, s[20:23], s59 offen nt lds
    s_waitcnt lgkmcnt(10)
    v_mfma_f32_16x16x32_bf16 a[12:15], v[136:139], v[92:95], a[12:15]
    v_smfmac_f32_16x16x64_bf16 v[36:39], v[32:35], v[128:135], v56
    s_waitcnt lgkmcnt(9)
    v_mfma_f32_16x16x32_bf16 a[16:19], v[128:131], v[96:99], a[16:19]
    ds_read_b64_tr_b16 v[152:153], v58 offset:8192
    s_waitcnt lgkmcnt(9)
    v_mfma_f32_16x16x32_bf16 a[16:19], v[136:139], v[100:103], a[16:19]
    s_add_u32 m0, s47, 131072
    s_waitcnt lgkmcnt(8)
    v_mfma_f32_16x16x32_bf16 a[20:23], v[128:131], v[104:107], a[20:23]
    buffer_load_dwordx4 v10, s[24:27], 0 offen nt lds
    s_waitcnt lgkmcnt(7)
    v_mfma_f32_16x16x32_bf16 a[20:23], v[136:139], v[108:111], a[20:23]
    s_waitcnt lgkmcnt(6)
    v_mfma_f32_16x16x32_bf16 a[24:27], v[128:131], v[112:115], a[24:27]
    ds_read_b64_tr_b16 v[154:155], v58 offset:8704
    s_waitcnt lgkmcnt(6)
    v_mfma_f32_16x16x32_bf16 a[24:27], v[136:139], v[116:119], a[24:27]
    s_add_u32 m0, s47, 135168
    s_waitcnt lgkmcnt(5)
    v_mfma_f32_16x16x32_bf16 a[28:31], v[128:131], v[120:123], a[28:31]
    buffer_load_dwordx4 v10, s[24:27], s44 offen nt lds
    s_waitcnt lgkmcnt(4)
    v_mfma_f32_16x16x32_bf16 a[28:31], v[136:139], v[124:127], a[28:31]
    v_mfma_f32_16x16x32_bf16 a[32:35], v[132:135], v[64:67], a[32:35]
    ds_read_b64_tr_b16 v[148:149], v5 offset:8192
    v_mfma_f32_16x16x32_bf16 a[32:35], v[140:143], v[68:71], a[32:35]
    s_add_u32 m0, s47, 139264
    v_mfma_f32_16x16x32_bf16 a[36:39], v[140:143], v[76:79], a[36:39]
    buffer_load_dwordx4 v10, s[28:31], 0 offen nt lds
    v_mfma_f32_16x16x32_bf16 a[36:39], v[132:135], v[72:75], a[36:39]
    v_mfma_f32_16x16x32_bf16 a[40:43], v[132:135], v[80:83], a[40:43]
    ds_read_b64_tr_b16 v[150:151], v5 offset:8704
    v_mfma_f32_16x16x32_bf16 a[40:43], v[140:143], v[84:87], a[40:43]
    s_add_u32 m0, s47, 143360
    v_mfma_f32_16x16x32_bf16 a[44:47], v[140:143], v[92:95], a[44:47]
    buffer_load_dwordx4 v10, s[28:31], s44 offen nt lds
    v_mfma_f32_16x16x32_bf16 a[44:47], v[132:135], v[88:91], a[44:47]
    v_mfma_f32_16x16x32_bf16 a[48:51], v[132:135], v[96:99], a[48:51]
    ds_read_b64_tr_b16 v[156:157], v59 offset:8192
    v_mfma_f32_16x16x32_bf16 a[48:51], v[140:143], v[100:103], a[48:51]
    s_add_u32 m0, s47, 32768
    v_mfma_f32_16x16x32_bf16 a[52:55], v[140:143], v[108:111], a[52:55]
    buffer_load_dwordx4 v8, s[8:11], 0 offen  lds
    v_mfma_f32_16x16x32_bf16 a[52:55], v[132:135], v[104:107], a[52:55]
    v_mfma_f32_16x16x32_bf16 a[56:59], v[132:135], v[112:115], a[56:59]
    ds_read_b64_tr_b16 v[158:159], v59 offset:8704
    v_mfma_f32_16x16x32_bf16 a[56:59], v[140:143], v[116:119], a[56:59]
    s_add_u32 m0, s47, 36864
    v_mfma_f32_16x16x32_bf16 a[60:63], v[140:143], v[124:127], a[60:63]
    buffer_load_dwordx4 v8, s[8:11], s36 offen  lds
    v_mfma_f32_16x16x32_bf16 a[60:63], v[132:135], v[120:123], a[60:63]
    s_waitcnt lgkmcnt(6)
    v_mfma_f32_16x16x32_bf16 a[64:67], v[144:147], v[64:67], a[64:67]
    ds_read_b64_tr_b16 v[128:129], v4 offset:16384
    s_waitcnt lgkmcnt(5)
    v_mfma_f32_16x16x32_bf16 a[64:67], v[152:155], v[68:71], a[64:67]
    s_add_u32 m0, s47, 40960
    v_mfma_f32_16x16x32_bf16 a[68:71], v[152:155], v[76:79], a[68:71]
    buffer_load_dwordx4 v8, s[8:11], s37 offen  lds
    v_mfma_f32_16x16x32_bf16 a[68:71], v[144:147], v[72:75], a[68:71]
    v_mfma_f32_16x16x32_bf16 a[72:75], v[144:147], v[80:83], a[72:75]
    ds_read_b64_tr_b16 v[130:131], v4 offset:16896
    v_mfma_f32_16x16x32_bf16 a[72:75], v[152:155], v[84:87], a[72:75]
    s_add_u32 m0, s47, 45056
    v_mfma_f32_16x16x32_bf16 a[76:79], v[152:155], v[92:95], a[76:79]
    buffer_load_dwordx4 v8, s[8:11], s38 offen  lds
    v_mfma_f32_16x16x32_bf16 a[76:79], v[144:147], v[88:91], a[76:79]
    s_waitcnt lgkmcnt(4)
    v_smfmac_f32_16x16x64_bf16 v[40:43], v[32:35], v[144:151], v56
    v_mfma_f32_16x16x32_bf16 a[80:83], v[144:147], v[96:99], a[80:83]
    ds_read_b64_tr_b16 v[136:137], v58 offset:16384
    s_nop 0
    v_mfma_f32_16x16x32_bf16 a[80:83], v[152:155], v[100:103], a[80:83]
    s_add_u32 m0, s47, 49152
    v_mfma_f32_16x16x32_bf16 a[84:87], v[152:155], v[108:111], a[84:87]
    buffer_load_dwordx4 v8, s[8:11], s39 offen  lds
    v_mfma_f32_16x16x32_bf16 a[84:87], v[144:147], v[104:107], a[84:87]
    v_mfma_f32_16x16x32_bf16 a[88:91], v[144:147], v[112:115], a[88:91]
    ds_read_b64_tr_b16 v[138:139], v58 offset:16896
    v_mfma_f32_16x16x32_bf16 a[88:91], v[152:155], v[116:119], a[88:91]
    s_add_u32 m0, s47, 53248
    v_mfma_f32_16x16x32_bf16 a[92:95], v[152:155], v[124:127], a[92:95]
    buffer_load_dwordx4 v8, s[8:11], s40 offen  lds
    v_mfma_f32_16x16x32_bf16 a[92:95], v[144:147], v[120:123], a[92:95]
    v_mfma_f32_16x16x32_bf16 a[96:99], v[148:151], v[64:67], a[96:99]
    ds_read_b64_tr_b16 v[132:133], v5 offset:16384
    s_waitcnt lgkmcnt(5)
    v_mfma_f32_16x16x32_bf16 a[96:99], v[156:159], v[68:71], a[96:99]
    s_nop 0
    s_add_u32 m0, s47, 57344
    v_mfma_f32_16x16x32_bf16 a[100:103], v[156:159], v[76:79], a[100:103]
    buffer_load_dwordx4 v8, s[8:11], s41 offen  lds
    v_mfma_f32_16x16x32_bf16 a[100:103], v[148:151], v[72:75], a[100:103]
    v_mfma_f32_16x16x32_bf16 a[104:107], v[148:151], v[80:83], a[104:107]
    ds_read_b64_tr_b16 v[134:135], v5 offset:16896
    v_mfma_f32_16x16x32_bf16 a[104:107], v[156:159], v[84:87], a[104:107]
    s_add_u32 m0, s47, 61440
    v_mfma_f32_16x16x32_bf16 a[108:111], v[156:159], v[92:95], a[108:111]
    buffer_load_dwordx4 v8, s[8:11], s42 offen  lds
    v_mfma_f32_16x16x32_bf16 a[108:111], v[148:151], v[88:91], a[108:111]
    v_mfma_f32_16x16x32_bf16 a[112:115], v[148:151], v[96:99], a[112:115]
    ds_read_b64_tr_b16 v[140:141], v59 offset:16384
    v_mfma_f32_16x16x32_bf16 a[112:115], v[156:159], v[100:103], a[112:115]
    v_mfma_f32_16x16x32_bf16 a[116:119], v[156:159], v[108:111], a[116:119]
    buffer_load_dword v57, v12, s[4:7], 0 offen
    v_mfma_f32_16x16x32_bf16 a[116:119], v[148:151], v[104:107], a[116:119]
    s_add_u32 s101, s45, 3
    v_mfma_f32_16x16x32_bf16 a[120:123], v[148:151], v[112:115], a[120:123]
    s_nop 0
    ds_read_b64_tr_b16 v[142:143], v59 offset:16896
    v_mfma_f32_16x16x32_bf16 a[120:123], v[156:159], v[116:119], a[120:123]
    s_and_b32 s101, s101, 15
    s_cselect_b32 s100, 1, -15
    v_mfma_f32_16x16x32_bf16 a[124:127], v[156:159], v[124:127], a[124:127]
    buffer_load_dwordx2 v[16:17], v13, s[60:63], 0 offen offset:0 nt
    v_mfma_f32_16x16x32_bf16 a[124:127], v[148:151], v[120:123], a[124:127]
    s_mul_i32 s101, s100, s49
    s_waitcnt lgkmcnt(6)
    v_mfma_f32_16x16x32_bf16 a[128:131], v[128:131], v[64:67], a[128:131]
    ds_read_b64_tr_b16 v[144:145], v4 offset:24576
    s_waitcnt lgkmcnt(5)
    v_mfma_f32_16x16x32_bf16 a[128:131], v[136:139], v[68:71], a[128:131]
    v_add_u32_e64 v12, s101, v12
    v_mfma_f32_16x16x32_bf16 a[132:135], v[136:139], v[76:79], a[132:135]
    s_nop 0
    buffer_load_dwordx2 v[18:19], v13, s[60:63], 0 offen offset:2048 nt
    v_mfma_f32_16x16x32_bf16 a[132:135], v[128:131], v[72:75], a[132:135]
    v_mfma_f32_16x16x32_bf16 a[136:139], v[128:131], v[80:83], a[136:139]
    ds_read_b64_tr_b16 v[146:147], v4 offset:25088
    v_mfma_f32_16x16x32_bf16 a[136:139], v[136:139], v[84:87], a[136:139]
    v_mfma_f32_16x16x32_bf16 a[140:143], v[136:139], v[92:95], a[140:143]
    buffer_load_dwordx2 v[20:21], v13, s[60:63], s74 offen offset:0 nt
    v_mfma_f32_16x16x32_bf16 a[140:143], v[128:131], v[88:91], a[140:143]
    s_waitcnt lgkmcnt(4)
    v_smfmac_f32_16x16x64_bf16 v[44:47], v[32:35], v[128:135], v56
    v_mfma_f32_16x16x32_bf16 a[144:147], v[128:131], v[96:99], a[144:147]
    s_nop 0
    ds_read_b64_tr_b16 v[152:153], v58 offset:24576
    v_mfma_f32_16x16x32_bf16 a[144:147], v[136:139], v[100:103], a[144:147]
    v_mfma_f32_16x16x32_bf16 a[148:151], v[136:139], v[108:111], a[148:151]
    buffer_load_dwordx2 v[22:23], v13, s[60:63], s74 offen offset:2048 nt
    v_mfma_f32_16x16x32_bf16 a[148:151], v[128:131], v[104:107], a[148:151]
    v_mfma_f32_16x16x32_bf16 a[152:155], v[128:131], v[112:115], a[152:155]
    ds_read_b64_tr_b16 v[154:155], v58 offset:25088
    v_mfma_f32_16x16x32_bf16 a[152:155], v[136:139], v[116:119], a[152:155]
    v_mfma_f32_16x16x32_bf16 a[156:159], v[136:139], v[124:127], a[156:159]
    buffer_load_dwordx2 v[24:25], v13, s[60:63], s75 offen offset:0 nt
    v_mfma_f32_16x16x32_bf16 a[156:159], v[128:131], v[120:123], a[156:159]
    v_mfma_f32_16x16x32_bf16 a[160:163], v[132:135], v[64:67], a[160:163]
    ds_read_b64_tr_b16 v[148:149], v5 offset:24576
    s_waitcnt lgkmcnt(5)
    v_mfma_f32_16x16x32_bf16 a[160:163], v[140:143], v[68:71], a[160:163]
    v_mfma_f32_16x16x32_bf16 a[164:167], v[140:143], v[76:79], a[164:167]
    s_nop 0
    buffer_load_dwordx2 v[26:27], v13, s[60:63], s75 offen offset:2048 nt
    v_mfma_f32_16x16x32_bf16 a[164:167], v[132:135], v[72:75], a[164:167]
    v_mfma_f32_16x16x32_bf16 a[168:171], v[132:135], v[80:83], a[168:171]
    ds_read_b64_tr_b16 v[150:151], v5 offset:25088
    v_mfma_f32_16x16x32_bf16 a[168:171], v[140:143], v[84:87], a[168:171]
    v_mfma_f32_16x16x32_bf16 a[172:175], v[140:143], v[92:95], a[172:175]
    buffer_load_dwordx2 v[28:29], v13, s[60:63], s76 offen offset:0 nt
    v_mfma_f32_16x16x32_bf16 a[172:175], v[132:135], v[88:91], a[172:175]
    v_mfma_f32_16x16x32_bf16 a[176:179], v[132:135], v[96:99], a[176:179]
    ds_read_b64_tr_b16 v[156:157], v59 offset:24576
    v_mfma_f32_16x16x32_bf16 a[176:179], v[140:143], v[100:103], a[176:179]
    v_mfma_f32_16x16x32_bf16 a[180:183], v[140:143], v[108:111], a[180:183]
    buffer_load_dwordx2 v[30:31], v13, s[60:63], s76 offen offset:2048 nt
    v_mfma_f32_16x16x32_bf16 a[180:183], v[132:135], v[104:107], a[180:183]
    v_mfma_f32_16x16x32_bf16 a[184:187], v[132:135], v[112:115], a[184:187]
    ds_read_b64_tr_b16 v[158:159], v59 offset:25088
    v_mfma_f32_16x16x32_bf16 a[184:187], v[140:143], v[116:119], a[184:187]
    v_add_u32 v13, s57, v13
    v_mfma_f32_16x16x32_bf16 a[188:191], v[140:143], v[124:127], a[188:191]
    v_mfma_f32_16x16x32_bf16 a[188:191], v[132:135], v[120:123], a[188:191]
    s_waitcnt lgkmcnt(6)
    v_mfma_f32_16x16x32_bf16 a[192:195], v[144:147], v[64:67], a[192:195]
    ds_read_b64_tr_b16 v[128:129], v4 offset:32768
    s_waitcnt lgkmcnt(5)
    v_mfma_f32_16x16x32_bf16 a[192:195], v[152:155], v[68:71], a[192:195]
    s_add_u32 s45, s45, 1
    v_mfma_f32_16x16x32_bf16 a[196:199], v[152:155], v[76:79], a[196:199]
    v_mfma_f32_16x16x32_bf16 a[196:199], v[144:147], v[72:75], a[196:199]
    s_and_b32 s45, s45, 15
    s_cselect_b32 s100, 1, -15
    v_mfma_f32_16x16x32_bf16 a[200:203], v[144:147], v[80:83], a[200:203]
    ds_read_b64_tr_b16 v[130:131], v4 offset:33280
    v_mfma_f32_16x16x32_bf16 a[200:203], v[152:155], v[84:87], a[200:203]
    s_mul_i32 s101, s100, 0x80
    v_mfma_f32_16x16x32_bf16 a[204:207], v[152:155], v[92:95], a[204:207]
    v_mfma_f32_16x16x32_bf16 a[204:207], v[144:147], v[88:91], a[204:207]
    s_waitcnt lgkmcnt(4)
    v_smfmac_f32_16x16x64_bf16 v[48:51], v[32:35], v[144:151], v56
    v_mfma_f32_16x16x32_bf16 a[208:211], v[144:147], v[96:99], a[208:211]
    ds_read_b64_tr_b16 v[136:137], v58 offset:32768
    v_mfma_f32_16x16x32_bf16 a[208:211], v[152:155], v[100:103], a[208:211]
    v_add_u32 v8, s101, v8
    v_mfma_f32_16x16x32_bf16 a[212:215], v[152:155], v[108:111], a[212:215]
    v_mfma_f32_16x16x32_bf16 a[212:215], v[144:147], v[104:107], a[212:215]
    s_mul_i32 s101, s100, 393216
    v_mfma_f32_16x16x32_bf16 a[216:219], v[144:147], v[112:115], a[216:219]
    ds_read_b64_tr_b16 v[138:139], v58 offset:33280
    v_mfma_f32_16x16x32_bf16 a[216:219], v[152:155], v[116:119], a[216:219]
    v_add_u32_e64 v9, s101, v9
    v_mfma_f32_16x16x32_bf16 a[220:223], v[152:155], v[124:127], a[220:223]
    v_mfma_f32_16x16x32_bf16 a[220:223], v[144:147], v[120:123], a[220:223]
    s_mul_i32 s101, s100, 458752
    v_mfma_f32_16x16x32_bf16 a[224:227], v[148:151], v[64:67], a[224:227]
    ds_read_b64_tr_b16 v[132:133], v5 offset:32768
    s_waitcnt lgkmcnt(5)
    v_mfma_f32_16x16x32_bf16 a[224:227], v[156:159], v[68:71], a[224:227]
    ds_read_b64_tr_b16 v[134:135], v5 offset:33280
    v_add_u32 v10, s101, v10
    v_mfma_f32_16x16x32_bf16 a[228:231], v[156:159], v[76:79], a[228:231]
    ds_read_b64_tr_b16 v[140:141], v59 offset:32768
    v_mfma_f32_16x16x32_bf16 a[228:231], v[148:151], v[72:75], a[228:231]
    ds_read_b64_tr_b16 v[142:143], v59 offset:33280
    s_mul_i32 s101, s100, s79
    v_mfma_f32_16x16x32_bf16 a[232:235], v[148:151], v[80:83], a[232:235]
    v_mfma_f32_16x16x32_bf16 a[232:235], v[156:159], v[84:87], a[232:235]
    v_add_u32 v15, s101, v15
    v_mfma_f32_16x16x32_bf16 a[236:239], v[156:159], v[92:95], a[236:239]
    v_mfma_f32_16x16x32_bf16 a[236:239], v[148:151], v[88:91], a[236:239]
    v_mfma_f32_16x16x32_bf16 a[240:243], v[148:151], v[96:99], a[240:243]
    v_mfma_f32_16x16x32_bf16 a[240:243], v[156:159], v[100:103], a[240:243]
    v_mfma_f32_16x16x32_bf16 a[244:247], v[156:159], v[108:111], a[244:247]
    v_mfma_f32_16x16x32_bf16 a[244:247], v[148:151], v[104:107], a[244:247]
    v_mfma_f32_16x16x32_bf16 a[248:251], v[148:151], v[112:115], a[248:251]
    v_mfma_f32_16x16x32_bf16 a[248:251], v[156:159], v[116:119], a[248:251]
    v_mfma_f32_16x16x32_bf16 a[252:255], v[156:159], v[124:127], a[252:255]
    v_mfma_f32_16x16x32_bf16 a[252:255], v[148:151], v[120:123], a[252:255]
    s_waitcnt vmcnt(9) lgkmcnt(0)
    s_barrier
    v_mfma_f32_16x16x32_bf16 v[192:195], v[128:131], v[64:67], v[192:195]
    s_add_u32 m0, s47, 65536
    ds_read_b64_tr_b16 v[144:145], v6 offset:0
    v_mfma_f32_16x16x32_bf16 v[192:195], v[136:139], v[68:71], v[192:195]
    buffer_load_dwordx4 v9, s[12:15], 0 offen nt lds
    v_mfma_f32_16x16x32_bf16 v[196:199], v[136:139], v[76:79], v[196:199]
    ds_read_b64_tr_b16 v[146:147], v6 offset:512
    v_mfma_f32_16x16x32_bf16 v[196:199], v[128:131], v[72:75], v[196:199]
    s_cmp_eq_u32 s48, 3
    s_cselect_b32 s101, 0, 2.0
    buffer_atomic_add v191, v190, s[68:71], s101 offen sc1
    v_mfma_f32_16x16x32_bf16 v[200:203], v[128:131], v[80:83], v[200:203]
    s_add_u32 m0, s47, 69632
    ds_read_b64_tr_b16 v[152:153], v60 offset:0
    v_mfma_f32_16x16x32_bf16 v[200:203], v[136:139], v[84:87], v[200:203]
    buffer_load_dwordx4 v9, s[12:15], s43 offen nt lds
    v_mfma_f32_16x16x32_bf16 v[204:207], v[136:139], v[92:95], v[204:207]
    ds_read_b64_tr_b16 v[154:155], v60 offset:512
    v_mfma_f32_16x16x32_bf16 v[204:207], v[128:131], v[88:91], v[204:207]
    v_smfmac_f32_16x16x64_bf16 v[52:55], v[32:35], v[128:135], v56
    v_mfma_f32_16x16x32_bf16 v[208:211], v[128:131], v[96:99], v[208:211]
    s_add_u32 m0, s47, 73728
    ds_read_b64_tr_b16 v[148:149], v7 offset:0
    v_mfma_f32_16x16x32_bf16 v[208:211], v[136:139], v[100:103], v[208:211]
    buffer_load_dwordx4 v15, s[16:19], 0 offen nt lds
    v_mfma_f32_16x16x32_bf16 v[212:215], v[136:139], v[108:111], v[212:215]
    ds_read_b64_tr_b16 v[150:151], v7 offset:512
    v_mfma_f32_16x16x32_bf16 v[212:215], v[128:131], v[104:107], v[212:215]
    v_mfma_f32_16x16x32_bf16 v[216:219], v[128:131], v[112:115], v[216:219]
    s_add_u32 m0, s47, 77824
    ds_read_b64_tr_b16 v[156:157], v61 offset:0
    v_mfma_f32_16x16x32_bf16 v[216:219], v[136:139], v[116:119], v[216:219]
    buffer_load_dwordx4 v15, s[16:19], s59 offen nt lds
    v_mfma_f32_16x16x32_bf16 v[220:223], v[136:139], v[124:127], v[220:223]
    ds_read_b64_tr_b16 v[158:159], v61 offset:512
    v_mfma_f32_16x16x32_bf16 v[220:223], v[128:131], v[120:123], v[220:223]
    v_mfma_f32_16x16x32_bf16 v[224:227], v[132:135], v[64:67], v[224:227]
    ds_read_b128 v[64:67], v2 offset:32768
    v_mfma_f32_16x16x32_bf16 v[224:227], v[140:143], v[68:71], v[224:227]
    ds_read_b128 v[68:71], v3 offset:32768
    v_mfma_f32_16x16x32_bf16 v[228:231], v[132:135], v[72:75], v[228:231]
    ds_read_b128 v[72:75], v2 offset:34816
    v_mfma_f32_16x16x32_bf16 v[228:231], v[140:143], v[76:79], v[228:231]
    ds_read_b128 v[76:79], v3 offset:34816
    v_mfma_f32_16x16x32_bf16 v[232:235], v[132:135], v[80:83], v[232:235]
    ds_read_b128 v[80:83], v2 offset:36864
    v_mfma_f32_16x16x32_bf16 v[232:235], v[140:143], v[84:87], v[232:235]
    ds_read_b128 v[84:87], v3 offset:36864
    v_mfma_f32_16x16x32_bf16 v[236:239], v[132:135], v[88:91], v[236:239]
    ds_read_b128 v[88:91], v2 offset:38912
    v_mfma_f32_16x16x32_bf16 v[236:239], v[140:143], v[92:95], v[236:239]
    ds_read_b128 v[92:95], v3 offset:38912
    v_mfma_f32_16x16x32_bf16 v[240:243], v[132:135], v[96:99], v[240:243]
    ds_read_b128 v[96:99], v2 offset:40960
    v_mfma_f32_16x16x32_bf16 v[240:243], v[140:143], v[100:103], v[240:243]
    ds_read_b128 v[100:103], v3 offset:40960
    v_mfma_f32_16x16x32_bf16 v[244:247], v[132:135], v[104:107], v[244:247]
    ds_read_b128 v[104:107], v2 offset:43008
    v_mfma_f32_16x16x32_bf16 v[244:247], v[140:143], v[108:111], v[244:247]
    ds_read_b128 v[108:111], v3 offset:43008
    v_mfma_f32_16x16x32_bf16 v[248:251], v[132:135], v[112:115], v[248:251]
    ds_read_b128 v[112:115], v2 offset:45056
    v_mfma_f32_16x16x32_bf16 v[248:251], v[140:143], v[116:119], v[248:251]
    ds_read_b128 v[116:119], v3 offset:45056
    v_mfma_f32_16x16x32_bf16 v[252:255], v[132:135], v[120:123], v[252:255]
    ds_read_b128 v[120:123], v2 offset:47104
    v_mfma_f32_16x16x32_bf16 v[252:255], v[140:143], v[124:127], v[252:255]
    ds_read_b128 v[124:127], v3 offset:47104
    s_waitcnt lgkmcnt(15)
    v_mfma_f32_16x16x32_bf16 a[0:3], v[144:147], v[64:67], a[0:3]
    ds_read_b64_tr_b16 v[128:129], v6 offset:8192
    s_waitcnt lgkmcnt(15)
    v_mfma_f32_16x16x32_bf16 a[0:3], v[152:155], v[68:71], a[0:3]
    s_add_u32 m0, s47, 81920
    s_waitcnt lgkmcnt(14)
    s_nop 0
    v_mfma_f32_16x16x32_bf16 a[4:7], v[144:147], v[72:75], a[4:7]
    buffer_load_dwordx4 v15, s[20:23], 0 offen nt lds
    s_waitcnt lgkmcnt(13)
    v_mfma_f32_16x16x32_bf16 a[4:7], v[152:155], v[76:79], a[4:7]
    s_waitcnt lgkmcnt(12)
    v_mfma_f32_16x16x32_bf16 a[8:11], v[144:147], v[80:83], a[8:11]
    ds_read_b64_tr_b16 v[130:131], v6 offset:8704
    s_waitcnt lgkmcnt(12)
    v_mfma_f32_16x16x32_bf16 a[8:11], v[152:155], v[84:87], a[8:11]
    s_add_u32 m0, s47, 86016
    s_waitcnt lgkmcnt(11)
    v_mfma_f32_16x16x32_bf16 a[12:15], v[144:147], v[88:91], a[12:15]
    buffer_load_dwordx4 v15, s[20:23], s59 offen nt lds
    s_waitcnt lgkmcnt(10)
    v_mfma_f32_16x16x32_bf16 a[12:15], v[152:155], v[92:95], a[12:15]
    s_nop 0
    v_smfmac_f32_16x16x64_bf16 v[36:39], v[32:35], v[144:151], v56
    s_waitcnt lgkmcnt(9)
    v_mfma_f32_16x16x32_bf16 a[16:19], v[144:147], v[96:99], a[16:19]
    ds_read_b64_tr_b16 v[136:137], v60 offset:8192
    s_waitcnt lgkmcnt(9)
    v_mfma_f32_16x16x32_bf16 a[16:19], v[152:155], v[100:103], a[16:19]
    s_add_u32 m0, s47, 90112
    s_waitcnt lgkmcnt(8)
    v_mfma_f32_16x16x32_bf16 a[20:23], v[144:147], v[104:107], a[20:23]
    s_nop 0
    buffer_load_dwordx4 v10, s[24:27], 0 offen nt lds
    s_waitcnt lgkmcnt(7)
    v_mfma_f32_16x16x32_bf16 a[20:23], v[152:155], v[108:111], a[20:23]
    s_waitcnt lgkmcnt(6)
    v_mfma_f32_16x16x32_bf16 a[24:27], v[144:147], v[112:115], a[24:27]
    ds_read_b64_tr_b16 v[138:139], v60 offset:8704
    s_waitcnt lgkmcnt(6)
    v_mfma_f32_16x16x32_bf16 a[24:27], v[152:155], v[116:119], a[24:27]
    s_add_u32 m0, s47, 94208
    s_waitcnt lgkmcnt(5)
    v_mfma_f32_16x16x32_bf16 a[28:31], v[144:147], v[120:123], a[28:31]
    buffer_load_dwordx4 v10, s[24:27], s44 offen nt lds
    s_waitcnt lgkmcnt(4)
    s_nop 0
    v_mfma_f32_16x16x32_bf16 a[28:31], v[152:155], v[124:127], a[28:31]
    v_mfma_f32_16x16x32_bf16 a[32:35], v[148:151], v[64:67], a[32:35]
    ds_read_b64_tr_b16 v[132:133], v7 offset:8192
    v_mfma_f32_16x16x32_bf16 a[32:35], v[156:159], v[68:71], a[32:35]
    s_add_u32 m0, s47, 98304
    v_mfma_f32_16x16x32_bf16 a[36:39], v[156:159], v[76:79], a[36:39]
    buffer_load_dwordx4 v10, s[28:31], 0 offen nt lds
    v_mfma_f32_16x16x32_bf16 a[36:39], v[148:151], v[72:75], a[36:39]
    v_mfma_f32_16x16x32_bf16 a[40:43], v[148:151], v[80:83], a[40:43]
    ds_read_b64_tr_b16 v[134:135], v7 offset:8704
    v_mfma_f32_16x16x32_bf16 a[40:43], v[156:159], v[84:87], a[40:43]
    s_add_u32 m0, s47, 102400
    v_mfma_f32_16x16x32_bf16 a[44:47], v[156:159], v[92:95], a[44:47]
    buffer_load_dwordx4 v10, s[28:31], s44 offen nt lds
    v_mfma_f32_16x16x32_bf16 a[44:47], v[148:151], v[88:91], a[44:47]
    v_mfma_f32_16x16x32_bf16 a[48:51], v[148:151], v[96:99], a[48:51]
    ds_read_b64_tr_b16 v[140:141], v61 offset:8192
    v_mfma_f32_16x16x32_bf16 a[48:51], v[156:159], v[100:103], a[48:51]
    s_add_u32 m0, s47, 0
    v_mfma_f32_16x16x32_bf16 a[52:55], v[156:159], v[108:111], a[52:55]
    buffer_load_dwordx4 v8, s[8:11], 0 offen  lds
    s_nop 0
    v_mfma_f32_16x16x32_bf16 a[52:55], v[148:151], v[104:107], a[52:55]
    v_mfma_f32_16x16x32_bf16 a[56:59], v[148:151], v[112:115], a[56:59]
    ds_read_b64_tr_b16 v[142:143], v61 offset:8704
    v_mfma_f32_16x16x32_bf16 a[56:59], v[156:159], v[116:119], a[56:59]
    s_add_u32 m0, s47, 4096
    v_mfma_f32_16x16x32_bf16 a[60:63], v[156:159], v[124:127], a[60:63]
    buffer_load_dwordx4 v8, s[8:11], s36 offen  lds
    v_mfma_f32_16x16x32_bf16 a[60:63], v[148:151], v[120:123], a[60:63]
    s_waitcnt lgkmcnt(6)
    v_mfma_f32_16x16x32_bf16 a[64:67], v[128:131], v[64:67], a[64:67]
    ds_read_b64_tr_b16 v[144:145], v6 offset:16384
    s_waitcnt lgkmcnt(5)
    v_mfma_f32_16x16x32_bf16 a[64:67], v[136:139], v[68:71], a[64:67]
    s_add_u32 m0, s47, 8192
    v_mfma_f32_16x16x32_bf16 a[68:71], v[136:139], v[76:79], a[68:71]
    buffer_load_dwordx4 v8, s[8:11], s37 offen  lds
    v_mfma_f32_16x16x32_bf16 a[68:71], v[128:131], v[72:75], a[68:71]
    s_waitcnt vmcnt(20)
    v_perm_b32 v160, v18, v16, s72
    v_mfma_f32_16x16x32_bf16 a[72:75], v[128:131], v[80:83], a[72:75]
    s_nop 0
    ds_read_b64_tr_b16 v[146:147], v6 offset:16896
    v_mfma_f32_16x16x32_bf16 a[72:75], v[136:139], v[84:87], a[72:75]
    s_add_u32 m0, s47, 12288
    s_waitcnt vmcnt(18)
    v_perm_b32 v161, v22, v20, s72
    s_nop 0
    v_mfma_f32_16x16x32_bf16 a[76:79], v[136:139], v[92:95], a[76:79]
    buffer_load_dwordx4 v8, s[8:11], s38 offen  lds
    s_nop 0
    v_mfma_f32_16x16x32_bf16 a[76:79], v[128:131], v[88:91], a[76:79]
    s_waitcnt lgkmcnt(4)
    v_smfmac_f32_16x16x64_bf16 v[40:43], v[32:35], v[128:135], v56
    v_mfma_f32_16x16x32_bf16 a[80:83], v[128:131], v[96:99], a[80:83]
    ds_read_b64_tr_b16 v[152:153], v60 offset:16384
    v_mfma_f32_16x16x32_bf16 a[80:83], v[136:139], v[100:103], a[80:83]
    s_add_u32 m0, s47, 16384
    s_waitcnt vmcnt(17)
    v_perm_b32 v162, v26, v24, s72
    s_nop 0
    v_mfma_f32_16x16x32_bf16 a[84:87], v[136:139], v[108:111], a[84:87]
    buffer_load_dwordx4 v8, s[8:11], s39 offen  lds
    v_mfma_f32_16x16x32_bf16 a[84:87], v[128:131], v[104:107], a[84:87]
    s_waitcnt vmcnt(16)
    v_perm_b32 v163, v30, v28, s72
    s_nop 0
    v_mfma_f32_16x16x32_bf16 a[88:91], v[128:131], v[112:115], a[88:91]
    ds_read_b64_tr_b16 v[154:155], v60 offset:16896
    v_mfma_f32_16x16x32_bf16 a[88:91], v[136:139], v[116:119], a[88:91]
    s_add_u32 m0, s47, 20480
    v_perm_b32 v164, v18, v16, s73
    v_mfma_f32_16x16x32_bf16 a[92:95], v[136:139], v[124:127], a[92:95]
    buffer_load_dwordx4 v8, s[8:11], s40 offen  lds
    v_mfma_f32_16x16x32_bf16 a[92:95], v[128:131], v[120:123], a[92:95]
    v_perm_b32 v165, v22, v20, s73
    v_mfma_f32_16x16x32_bf16 a[96:99], v[132:135], v[64:67], a[96:99]
    s_nop 0
    ds_read_b64_tr_b16 v[148:149], v7 offset:16384
    s_waitcnt lgkmcnt(5)
    v_mfma_f32_16x16x32_bf16 a[96:99], v[140:143], v[68:71], a[96:99]
    s_add_u32 m0, s47, 24576
    v_perm_b32 v166, v26, v24, s73
    v_mfma_f32_16x16x32_bf16 a[100:103], v[140:143], v[76:79], a[100:103]
    buffer_load_dwordx4 v8, s[8:11], s41 offen  lds
    v_mfma_f32_16x16x32_bf16 a[100:103], v[132:135], v[72:75], a[100:103]
    v_perm_b32 v167, v30, v28, s73
    v_mfma_f32_16x16x32_bf16 a[104:107], v[132:135], v[80:83], a[104:107]
    ds_read_b64_tr_b16 v[150:151], v7 offset:16896
    v_mfma_f32_16x16x32_bf16 a[104:107], v[140:143], v[84:87], a[104:107]
    s_add_u32 m0, s47, 28672
    v_perm_b32 v168, v19, v17, s72
    v_mfma_f32_16x16x32_bf16 a[108:111], v[140:143], v[92:95], a[108:111]
    buffer_load_dwordx4 v8, s[8:11], s42 offen  lds
    v_mfma_f32_16x16x32_bf16 a[108:111], v[132:135], v[88:91], a[108:111]
    v_perm_b32 v169, v23, v21, s72
    v_mfma_f32_16x16x32_bf16 a[112:115], v[132:135], v[96:99], a[112:115]
    ds_read_b64_tr_b16 v[156:157], v61 offset:16384
    v_mfma_f32_16x16x32_bf16 a[112:115], v[140:143], v[100:103], a[112:115]
    v_perm_b32 v170, v27, v25, s72
    v_mfma_f32_16x16x32_bf16 a[116:119], v[140:143], v[108:111], a[116:119]
    buffer_load_dword v57, v12, s[4:7], 0 offen
    s_nop 0
    v_mfma_f32_16x16x32_bf16 a[116:119], v[132:135], v[104:107], a[116:119]
    s_add_u32 s101, s45, 3
    v_perm_b32 v171, v31, v29, s72
    v_mfma_f32_16x16x32_bf16 a[120:123], v[132:135], v[112:115], a[120:123]
    ds_read_b64_tr_b16 v[158:159], v61 offset:16896
    v_mfma_f32_16x16x32_bf16 a[120:123], v[140:143], v[116:119], a[120:123]
    s_and_b32 s101, s101, 15
    s_cselect_b32 s100, 1, -15
    v_perm_b32 v172, v19, v17, s73
    v_mfma_f32_16x16x32_bf16 a[124:127], v[140:143], v[124:127], a[124:127]
    v_perm_b32 v173, v23, v21, s73
    global_load_dword v57, v[62:63], off
    v_mfma_f32_16x16x32_bf16 a[124:127], v[132:135], v[120:123], a[124:127]
    s_mul_i32 s101, s100, s49
    v_perm_b32 v174, v27, v25, s73
    s_waitcnt lgkmcnt(6)
    v_mfma_f32_16x16x32_bf16 a[128:131], v[144:147], v[64:67], a[128:131]
    ds_read_b64_tr_b16 v[128:129], v6 offset:24576
    s_waitcnt lgkmcnt(5)
    v_mfma_f32_16x16x32_bf16 a[128:131], v[152:155], v[68:71], a[128:131]
    v_add_u32 v12, s101, v12
    v_mfma_f32_16x16x32_bf16 a[132:135], v[152:155], v[76:79], a[132:135]
    v_perm_b32 v175, v31, v29, s73
    v_mfma_f32_16x16x32_bf16 a[132:135], v[144:147], v[72:75], a[132:135]
    v_mfma_f32_16x16x32_bf16 a[136:139], v[144:147], v[80:83], a[136:139]
    ds_read_b64_tr_b16 v[130:131], v6 offset:25088
    v_mfma_f32_16x16x32_bf16 a[136:139], v[152:155], v[84:87], a[136:139]
    v_mfma_f32_16x16x32_bf16 a[140:143], v[152:155], v[92:95], a[140:143]
    v_mfma_f32_16x16x32_bf16 a[140:143], v[144:147], v[88:91], a[140:143]
    s_waitcnt lgkmcnt(4)
    v_smfmac_f32_16x16x64_bf16 v[44:47], v[32:35], v[144:151], v56
    v_mfma_f32_16x16x32_bf16 a[144:147], v[144:147], v[96:99], a[144:147]
    ds_read_b64_tr_b16 v[136:137], v60 offset:24576
    s_nop 0
    v_mfma_f32_16x16x32_bf16 a[144:147], v[152:155], v[100:103], a[144:147]
    v_mfma_f32_16x16x32_bf16 a[148:151], v[152:155], v[108:111], a[148:151]
    buffer_store_dwordx4 v[160:163], v14, s[64:67], 0 offen offset:0 sc1
    v_mfma_f32_16x16x32_bf16 a[148:151], v[144:147], v[104:107], a[148:151]
    v_mfma_f32_16x16x32_bf16 a[152:155], v[144:147], v[112:115], a[152:155]
    ds_read_b64_tr_b16 v[138:139], v60 offset:25088
    v_mfma_f32_16x16x32_bf16 a[152:155], v[152:155], v[116:119], a[152:155]
    v_mfma_f32_16x16x32_bf16 a[156:159], v[152:155], v[124:127], a[156:159]
    v_mfma_f32_16x16x32_bf16 a[156:159], v[144:147], v[120:123], a[156:159]
    v_mfma_f32_16x16x32_bf16 a[160:163], v[148:151], v[64:67], a[160:163]
    s_nop 0
    ds_read_b64_tr_b16 v[132:133], v7 offset:24576
    s_waitcnt lgkmcnt(5)
    v_mfma_f32_16x16x32_bf16 a[160:163], v[156:159], v[68:71], a[160:163]
    v_mfma_f32_16x16x32_bf16 a[164:167], v[156:159], v[76:79], a[164:167]
    v_mfma_f32_16x16x32_bf16 a[164:167], v[148:151], v[72:75], a[164:167]
    v_mfma_f32_16x16x32_bf16 a[168:171], v[148:151], v[80:83], a[168:171]
    ds_read_b64_tr_b16 v[134:135], v7 offset:25088
    v_mfma_f32_16x16x32_bf16 a[168:171], v[156:159], v[84:87], a[168:171]
    v_mfma_f32_16x16x32_bf16 a[172:175], v[156:159], v[92:95], a[172:175]
    buffer_store_dwordx4 v[164:167], v14, s[64:67], 0 offen offset:128 sc1
    v_mfma_f32_16x16x32_bf16 a[172:175], v[148:151], v[88:91], a[172:175]
    v_mfma_f32_16x16x32_bf16 a[176:179], v[148:151], v[96:99], a[176:179]
    ds_read_b64_tr_b16 v[140:141], v61 offset:24576
    v_mfma_f32_16x16x32_bf16 a[176:179], v[156:159], v[100:103], a[176:179]
    v_mfma_f32_16x16x32_bf16 a[180:183], v[156:159], v[108:111], a[180:183]
    v_mfma_f32_16x16x32_bf16 a[180:183], v[148:151], v[104:107], a[180:183]
    v_mfma_f32_16x16x32_bf16 a[184:187], v[148:151], v[112:115], a[184:187]
    ds_read_b64_tr_b16 v[142:143], v61 offset:25088
    v_mfma_f32_16x16x32_bf16 a[184:187], v[156:159], v[116:119], a[184:187]
    v_mfma_f32_16x16x32_bf16 a[188:191], v[156:159], v[124:127], a[188:191]
    v_mfma_f32_16x16x32_bf16 a[188:191], v[148:151], v[120:123], a[188:191]
    s_waitcnt lgkmcnt(6)
    s_nop 0
    v_mfma_f32_16x16x32_bf16 a[192:195], v[128:131], v[64:67], a[192:195]
    ds_read_b64_tr_b16 v[144:145], v6 offset:32768
    s_waitcnt lgkmcnt(5)
    v_mfma_f32_16x16x32_bf16 a[192:195], v[136:139], v[68:71], a[192:195]
    s_add_u32 s45, s45, 1
    v_mfma_f32_16x16x32_bf16 a[196:199], v[136:139], v[76:79], a[196:199]
    buffer_store_dwordx4 v[168:171], v14, s[64:67], 0 offen offset:1024 sc1
    v_mfma_f32_16x16x32_bf16 a[196:199], v[128:131], v[72:75], a[196:199]
    s_and_b32 s45, s45, 15
    s_cselect_b32 s100, 1, -15
    v_mfma_f32_16x16x32_bf16 a[200:203], v[128:131], v[80:83], a[200:203]
    ds_read_b64_tr_b16 v[146:147], v6 offset:33280
    v_mfma_f32_16x16x32_bf16 a[200:203], v[136:139], v[84:87], a[200:203]
    s_mul_i32 s101, s100, 0x80
    v_mfma_f32_16x16x32_bf16 a[204:207], v[136:139], v[92:95], a[204:207]
    v_mfma_f32_16x16x32_bf16 a[204:207], v[128:131], v[88:91], a[204:207]
    s_waitcnt lgkmcnt(4)
    v_smfmac_f32_16x16x64_bf16 v[48:51], v[32:35], v[128:135], v56
    s_nop 0
    v_mfma_f32_16x16x32_bf16 a[208:211], v[128:131], v[96:99], a[208:211]
    ds_read_b64_tr_b16 v[152:153], v60 offset:32768
    v_mfma_f32_16x16x32_bf16 a[208:211], v[136:139], v[100:103], a[208:211]
    v_add_u32_e64 v8, s101, v8
    v_mfma_f32_16x16x32_bf16 a[212:215], v[136:139], v[108:111], a[212:215]
    v_mfma_f32_16x16x32_bf16 a[212:215], v[128:131], v[104:107], a[212:215]
    s_mul_i32 s101, s100, 393216
    v_mfma_f32_16x16x32_bf16 a[216:219], v[128:131], v[112:115], a[216:219]
    ds_read_b64_tr_b16 v[154:155], v60 offset:33280
    v_mfma_f32_16x16x32_bf16 a[216:219], v[136:139], v[116:119], a[216:219]
    v_add_u32_e64 v9, s101, v9
    v_mfma_f32_16x16x32_bf16 a[220:223], v[136:139], v[124:127], a[220:223]
    buffer_store_dwordx4 v[172:175], v14, s[64:67], 0 offen offset:1152 sc1
    v_mfma_f32_16x16x32_bf16 a[220:223], v[128:131], v[120:123], a[220:223]
    s_mul_i32 s101, s100, 458752
    v_mfma_f32_16x16x32_bf16 a[224:227], v[132:135], v[64:67], a[224:227]
    ds_read_b64_tr_b16 v[148:149], v7 offset:32768
    s_waitcnt lgkmcnt(5)
    v_mfma_f32_16x16x32_bf16 a[224:227], v[140:143], v[68:71], a[224:227]
    ds_read_b64_tr_b16 v[150:151], v7 offset:33280
    v_add_u32 v10, s101, v10
    v_mfma_f32_16x16x32_bf16 a[228:231], v[140:143], v[76:79], a[228:231]
    ds_read_b64_tr_b16 v[156:157], v61 offset:32768
    v_mfma_f32_16x16x32_bf16 a[228:231], v[132:135], v[72:75], a[228:231]
    ds_read_b64_tr_b16 v[158:159], v61 offset:33280
    s_mul_i32 s101, s100, s79
    v_mfma_f32_16x16x32_bf16 a[232:235], v[132:135], v[80:83], a[232:235]
    v_mfma_f32_16x16x32_bf16 a[232:235], v[140:143], v[84:87], a[232:235]
    v_add_u32 v15, s101, v15
    v_mfma_f32_16x16x32_bf16 a[236:239], v[140:143], v[92:95], a[236:239]
    v_mfma_f32_16x16x32_bf16 a[236:239], v[132:135], v[88:91], a[236:239]
    v_add_u32_e64 v14, s58, v14
    v_mfma_f32_16x16x32_bf16 a[240:243], v[132:135], v[96:99], a[240:243]
    v_mfma_f32_16x16x32_bf16 a[240:243], v[140:143], v[100:103], a[240:243]
    v_mfma_f32_16x16x32_bf16 a[244:247], v[140:143], v[108:111], a[244:247]
    v_mfma_f32_16x16x32_bf16 a[244:247], v[132:135], v[104:107], a[244:247]
    v_mfma_f32_16x16x32_bf16 a[248:251], v[132:135], v[112:115], a[248:251]
    v_mfma_f32_16x16x32_bf16 a[248:251], v[140:143], v[116:119], a[248:251]
    v_mfma_f32_16x16x32_bf16 a[252:255], v[140:143], v[124:127], a[252:255]
    v_mfma_f32_16x16x32_bf16 a[252:255], v[132:135], v[120:123], a[252:255]
    s_waitcnt vmcnt(6) lgkmcnt(0)
    s_barrier
    v_mfma_f32_16x16x32_bf16 v[192:195], v[144:147], v[64:67], v[192:195]
    s_add_u32 m0, s47, 106496
    ds_read_b64_tr_b16 v[128:129], v4 offset:0
    v_mfma_f32_16x16x32_bf16 v[192:195], v[152:155], v[68:71], v[192:195]
    buffer_load_dwordx4 v9, s[12:15], 0 offen nt lds
    v_mfma_f32_16x16x32_bf16 v[196:199], v[152:155], v[76:79], v[196:199]
    ds_read_b64_tr_b16 v[130:131], v4 offset:512
    v_mfma_f32_16x16x32_bf16 v[196:199], v[144:147], v[72:75], v[196:199]
    v_mfma_f32_16x16x32_bf16 v[200:203], v[144:147], v[80:83], v[200:203]
    s_add_u32 m0, s47, 110592
    ds_read_b64_tr_b16 v[136:137], v58 offset:0
    v_mfma_f32_16x16x32_bf16 v[200:203], v[152:155], v[84:87], v[200:203]
    buffer_load_dwordx4 v9, s[12:15], s43 offen nt lds
    v_mfma_f32_16x16x32_bf16 v[204:207], v[152:155], v[92:95], v[204:207]
    ds_read_b64_tr_b16 v[138:139], v58 offset:512
    v_mfma_f32_16x16x32_bf16 v[204:207], v[144:147], v[88:91], v[204:207]
    v_smfmac_f32_16x16x64_bf16 v[52:55], v[32:35], v[144:151], v56
    v_mfma_f32_16x16x32_bf16 v[208:211], v[144:147], v[96:99], v[208:211]
    s_add_u32 m0, s47, 114688
    ds_read_b64_tr_b16 v[132:133], v5 offset:0
    v_mfma_f32_16x16x32_bf16 v[208:211], v[152:155], v[100:103], v[208:211]
    buffer_load_dwordx4 v15, s[16:19], 0 offen nt lds
    v_mfma_f32_16x16x32_bf16 v[212:215], v[152:155], v[108:111], v[212:215]
    ds_read_b64_tr_b16 v[134:135], v5 offset:512
    v_mfma_f32_16x16x32_bf16 v[212:215], v[144:147], v[104:107], v[212:215]
    v_mfma_f32_16x16x32_bf16 v[216:219], v[144:147], v[112:115], v[216:219]
    s_add_u32 m0, s47, 118784
    ds_read_b64_tr_b16 v[140:141], v59 offset:0
    v_mfma_f32_16x16x32_bf16 v[216:219], v[152:155], v[116:119], v[216:219]
    buffer_load_dwordx4 v15, s[16:19], s59 offen nt lds
    v_mfma_f32_16x16x32_bf16 v[220:223], v[152:155], v[124:127], v[220:223]
    ds_read_b64_tr_b16 v[142:143], v59 offset:512
    v_mfma_f32_16x16x32_bf16 v[220:223], v[144:147], v[120:123], v[220:223]
    v_mfma_f32_16x16x32_bf16 v[224:227], v[148:151], v[64:67], v[224:227]
    ds_read_b128 v[64:67], v2 offset:0
    v_mfma_f32_16x16x32_bf16 v[224:227], v[156:159], v[68:71], v[224:227]
    ds_read_b128 v[68:71], v3 offset:0
    v_mfma_f32_16x16x32_bf16 v[228:231], v[148:151], v[72:75], v[228:231]
    ds_read_b128 v[72:75], v2 offset:2048
    v_mfma_f32_16x16x32_bf16 v[228:231], v[156:159], v[76:79], v[228:231]
    ds_read_b128 v[76:79], v3 offset:2048
    v_mfma_f32_16x16x32_bf16 v[232:235], v[148:151], v[80:83], v[232:235]
    ds_read_b128 v[80:83], v2 offset:4096
    v_mfma_f32_16x16x32_bf16 v[232:235], v[156:159], v[84:87], v[232:235]
    ds_read_b128 v[84:87], v3 offset:4096
    v_mfma_f32_16x16x32_bf16 v[236:239], v[148:151], v[88:91], v[236:239]
    ds_read_b128 v[88:91], v2 offset:6144
    v_mfma_f32_16x16x32_bf16 v[236:239], v[156:159], v[92:95], v[236:239]
    ds_read_b128 v[92:95], v3 offset:6144
    v_mfma_f32_16x16x32_bf16 v[240:243], v[148:151], v[96:99], v[240:243]
    ds_read_b128 v[96:99], v2 offset:8192
    v_mfma_f32_16x16x32_bf16 v[240:243], v[156:159], v[100:103], v[240:243]
    ds_read_b128 v[100:103], v3 offset:8192
    v_mfma_f32_16x16x32_bf16 v[244:247], v[148:151], v[104:107], v[244:247]
    ds_read_b128 v[104:107], v2 offset:10240
    v_mfma_f32_16x16x32_bf16 v[244:247], v[156:159], v[108:111], v[244:247]
    ds_read_b128 v[108:111], v3 offset:10240
    v_mfma_f32_16x16x32_bf16 v[248:251], v[148:151], v[112:115], v[248:251]
    ds_read_b128 v[112:115], v2 offset:12288
    v_mfma_f32_16x16x32_bf16 v[248:251], v[156:159], v[116:119], v[248:251]
    s_sub_u32 s48, s48, 1
    ds_read_b128 v[116:119], v3 offset:12288
    v_mfma_f32_16x16x32_bf16 v[252:255], v[148:151], v[120:123], v[252:255]
    s_cmp_lg_u32 s48, 0
    ds_read_b128 v[120:123], v2 offset:14336
    v_mfma_f32_16x16x32_bf16 v[252:255], v[156:159], v[124:127], v[252:255]
    ds_read_b128 v[124:127], v3 offset:14336
    s_cbranch_scc1 L_g1_loopA
L_g1_tA:
    s_waitcnt lgkmcnt(15)
    v_mfma_f32_16x16x32_bf16 a[0:3], v[128:131], v[64:67], a[0:3]
    ds_read_b64_tr_b16 v[144:145], v4 offset:8192
    buffer_load_dword v13, off, s[68:71], 0 sc1
    s_waitcnt lgkmcnt(15)
    v_mfma_f32_16x16x32_bf16 a[0:3], v[136:139], v[68:71], a[0:3]
    s_add_u32 m0, s47, 122880
    s_waitcnt vmcnt(5)
    v_add_f32 v160, v36, v37
    v_add_f32 v161, v38, v39
    s_waitcnt lgkmcnt(14)
    v_mfma_f32_16x16x32_bf16 a[4:7], v[128:131], v[72:75], a[4:7]
    buffer_load_dwordx4 v15, s[20:23], 0 offen nt lds
    v_and_b32 v12, 15, v0
    s_waitcnt lgkmcnt(13)
    v_mfma_f32_16x16x32_bf16 a[4:7], v[136:139], v[76:79], a[4:7]
    v_lshlrev_b32 v12, 2, v12
    s_add_u32 s83, s47, 147456
    v_add_u32 v12, s83, v12
    s_waitcnt lgkmcnt(12)
    v_mfma_f32_16x16x32_bf16 a[8:11], v[128:131], v[80:83], a[8:11]
    ds_read_b64_tr_b16 v[146:147], v4 offset:8704
    v_add_f32 v162, v40, v41
    s_waitcnt lgkmcnt(12)
    v_mfma_f32_16x16x32_bf16 a[8:11], v[136:139], v[84:87], a[8:11]
    s_add_u32 m0, s47, 126976
    v_add_f32 v163, v42, v43
    v_add_f32_e64 v164, v44, v45
    s_waitcnt lgkmcnt(11)
    v_mfma_f32_16x16x32_bf16 a[12:15], v[128:131], v[88:91], a[12:15]
    buffer_load_dwordx4 v15, s[20:23], s59 offen nt lds
    v_add_f32 v165, v46, v47
    s_waitcnt lgkmcnt(10)
    v_mfma_f32_16x16x32_bf16 a[12:15], v[136:139], v[92:95], a[12:15]
    v_smfmac_f32_16x16x64_bf16 v[36:39], v[32:35], v[128:135], v56
    s_waitcnt lgkmcnt(9)
    v_mfma_f32_16x16x32_bf16 a[16:19], v[128:131], v[96:99], a[16:19]
    ds_read_b64_tr_b16 v[152:153], v58 offset:8192
    v_add_f32_e64 v166, v48, v49
    s_waitcnt lgkmcnt(9)
    v_mfma_f32_16x16x32_bf16 a[16:19], v[136:139], v[100:103], a[16:19]
    s_add_u32 m0, s47, 131072
    v_add_f32 v167, v50, v51
    v_add_f32_e64 v168, v52, v53
    s_waitcnt lgkmcnt(8)
    v_mfma_f32_16x16x32_bf16 a[20:23], v[128:131], v[104:107], a[20:23]
    buffer_load_dwordx4 v10, s[24:27], 0 offen nt lds
    v_add_f32 v169, v54, v55
    s_waitcnt lgkmcnt(7)
    v_mfma_f32_16x16x32_bf16 a[20:23], v[136:139], v[108:111], a[20:23]
    v_smfmac_f32_16x16x64_bf16 v[36:39], v[32:35], v[136:143], v56
    s_waitcnt lgkmcnt(6)
    v_mfma_f32_16x16x32_bf16 a[24:27], v[128:131], v[112:115], a[24:27]
    ds_read_b64_tr_b16 v[154:155], v58 offset:8704
    s_waitcnt lgkmcnt(6)
    v_mfma_f32_16x16x32_bf16 a[24:27], v[136:139], v[116:119], a[24:27]
    s_add_u32 m0, s47, 135168
    ds_write_b32 v12, v160 offset:4096
    s_waitcnt lgkmcnt(6)
    v_mfma_f32_16x16x32_bf16 a[28:31], v[128:131], v[120:123], a[28:31]
    buffer_load_dwordx4 v10, s[24:27], s44 offen nt lds
    s_waitcnt lgkmcnt(5)
    v_mfma_f32_16x16x32_bf16 a[28:31], v[136:139], v[124:127], a[28:31]
    ds_write_b32 v12, v161 offset:4160
    v_mfma_f32_16x16x32_bf16 a[32:35], v[132:135], v[64:67], a[32:35]
    ds_read_b64_tr_b16 v[148:149], v5 offset:8192
    v_mfma_f32_16x16x32_bf16 a[32:35], v[140:143], v[68:71], a[32:35]
    s_add_u32 m0, s47, 139264
    ds_write_b32 v12, v162 offset:4224
    v_mfma_f32_16x16x32_bf16 a[36:39], v[132:135], v[72:75], a[36:39]
    buffer_load_dwordx4 v10, s[28:31], 0 offen nt lds
    v_mfma_f32_16x16x32_bf16 a[36:39], v[140:143], v[76:79], a[36:39]
    ds_write_b32 v12, v163 offset:4288
    v_mfma_f32_16x16x32_bf16 a[40:43], v[132:135], v[80:83], a[40:43]
    ds_read_b64_tr_b16 v[150:151], v5 offset:8704
    v_mfma_f32_16x16x32_bf16 a[40:43], v[140:143], v[84:87], a[40:43]
    s_add_u32 m0, s47, 143360
    ds_write_b32 v12, v164 offset:4352
    v_mfma_f32_16x16x32_bf16 a[44:47], v[132:135], v[88:91], a[44:47]
    buffer_load_dwordx4 v10, s[28:31], s44 offen nt lds
    v_mfma_f32_16x16x32_bf16 a[44:47], v[140:143], v[92:95], a[44:47]
    ds_write_b32 v12, v165 offset:4416
    v_mfma_f32_16x16x32_bf16 a[48:51], v[132:135], v[96:99], a[48:51]
    ds_read_b64_tr_b16 v[156:157], v59 offset:8192
    v_mfma_f32_16x16x32_bf16 a[48:51], v[140:143], v[100:103], a[48:51]
    s_add_u32 m0, s47, 32768
    ds_write_b32 v12, v166 offset:4480
    v_mfma_f32_16x16x32_bf16 a[52:55], v[132:135], v[104:107], a[52:55]
    buffer_load_dwordx4 v8, s[8:11], 0 offen  lds
    v_mfma_f32_16x16x32_bf16 a[52:55], v[140:143], v[108:111], a[52:55]
    ds_write_b32 v12, v167 offset:4544
    v_mfma_f32_16x16x32_bf16 a[56:59], v[132:135], v[112:115], a[56:59]
    ds_read_b64_tr_b16 v[158:159], v59 offset:8704
    v_mfma_f32_16x16x32_bf16 a[56:59], v[140:143], v[116:119], a[56:59]
    s_add_u32 m0, s47, 36864
    ds_write_b32 v12, v168 offset:4608
    v_mfma_f32_16x16x32_bf16 a[60:63], v[132:135], v[120:123], a[60:63]
    buffer_load_dwordx4 v8, s[8:11], s36 offen  lds
    v_mfma_f32_16x16x32_bf16 a[60:63], v[140:143], v[124:127], a[60:63]
    ds_write_b32 v12, v169 offset:4672
    s_waitcnt lgkmcnt(15)
    v_mfma_f32_16x16x32_bf16 a[64:67], v[144:147], v[64:67], a[64:67]
    ds_read_b64_tr_b16 v[128:129], v4 offset:16384
    s_waitcnt lgkmcnt(15)
    v_mfma_f32_16x16x32_bf16 a[64:67], v[152:155], v[68:71], a[64:67]
    s_add_u32 m0, s47, 40960
    v_mfma_f32_16x16x32_bf16 a[68:71], v[144:147], v[72:75], a[68:71]
    buffer_load_dwordx4 v8, s[8:11], s37 offen  lds
    v_mfma_f32_16x16x32_bf16 a[68:71], v[152:155], v[76:79], a[68:71]
    v_mfma_f32_16x16x32_bf16 a[72:75], v[144:147], v[80:83], a[72:75]
    ds_read_b64_tr_b16 v[130:131], v4 offset:16896
    v_mfma_f32_16x16x32_bf16 a[72:75], v[152:155], v[84:87], a[72:75]
    s_add_u32 m0, s47, 45056
    v_mfma_f32_16x16x32_bf16 a[76:79], v[144:147], v[88:91], a[76:79]
    buffer_load_dwordx4 v8, s[8:11], s38 offen  lds
    v_mfma_f32_16x16x32_bf16 a[76:79], v[152:155], v[92:95], a[76:79]
    s_waitcnt lgkmcnt(10)
    s_nop 0
    v_smfmac_f32_16x16x64_bf16 v[40:43], v[32:35], v[144:151], v56
    v_mfma_f32_16x16x32_bf16 a[80:83], v[144:147], v[96:99], a[80:83]
    ds_read_b64_tr_b16 v[136:137], v58 offset:16384
    v_mfma_f32_16x16x32_bf16 a[80:83], v[152:155], v[100:103], a[80:83]
    s_add_u32 m0, s47, 49152
    v_mfma_f32_16x16x32_bf16 a[84:87], v[144:147], v[104:107], a[84:87]
    buffer_load_dwordx4 v8, s[8:11], s39 offen  lds
    v_mfma_f32_16x16x32_bf16 a[84:87], v[152:155], v[108:111], a[84:87]
    s_waitcnt lgkmcnt(5)
    v_smfmac_f32_16x16x64_bf16 v[40:43], v[32:35], v[152:159], v56
    v_mfma_f32_16x16x32_bf16 a[88:91], v[144:147], v[112:115], a[88:91]
    s_nop 0
    ds_read_b64_tr_b16 v[138:139], v58 offset:16896
    v_mfma_f32_16x16x32_bf16 a[88:91], v[152:155], v[116:119], a[88:91]
    s_add_u32 m0, s47, 53248
    v_mfma_f32_16x16x32_bf16 a[92:95], v[144:147], v[120:123], a[92:95]
    buffer_load_dwordx4 v8, s[8:11], s40 offen  lds
    v_mfma_f32_16x16x32_bf16 a[92:95], v[152:155], v[124:127], a[92:95]
    v_mfma_f32_16x16x32_bf16 a[96:99], v[148:151], v[64:67], a[96:99]
    ds_read_b64_tr_b16 v[132:133], v5 offset:16384
    v_mfma_f32_16x16x32_bf16 a[96:99], v[156:159], v[68:71], a[96:99]
    s_add_u32 m0, s47, 57344
    v_mfma_f32_16x16x32_bf16 a[100:103], v[148:151], v[72:75], a[100:103]
    buffer_load_dwordx4 v8, s[8:11], s41 offen  lds
    v_mfma_f32_16x16x32_bf16 a[100:103], v[156:159], v[76:79], a[100:103]
    v_mfma_f32_16x16x32_bf16 a[104:107], v[148:151], v[80:83], a[104:107]
    ds_read_b64_tr_b16 v[134:135], v5 offset:16896
    v_mfma_f32_16x16x32_bf16 a[104:107], v[156:159], v[84:87], a[104:107]
    s_add_u32 m0, s47, 61440
    v_mfma_f32_16x16x32_bf16 a[108:111], v[148:151], v[88:91], a[108:111]
    buffer_load_dwordx4 v8, s[8:11], s42 offen  lds
    v_mfma_f32_16x16x32_bf16 a[108:111], v[156:159], v[92:95], a[108:111]
    v_mfma_f32_16x16x32_bf16 a[112:115], v[148:151], v[96:99], a[112:115]
    ds_read_b64_tr_b16 v[140:141], v59 offset:16384
    s_mov_b32 s12, s84
    v_mfma_f32_16x16x32_bf16 a[112:115], v[156:159], v[100:103], a[112:115]
    s_nop 0
    s_and_b32 s13, s85, 0xffff
    v_mfma_f32_16x16x32_bf16 a[116:119], v[148:151], v[104:107], a[116:119]
    s_mov_b32 s14, 4194304
    v_mfma_f32_16x16x32_bf16 a[116:119], v[156:159], v[108:111], a[116:119]
    s_mov_b32 s15, 0x20000
    v_mfma_f32_16x16x32_bf16 a[120:123], v[148:151], v[112:115], a[120:123]
    ds_read_b64_tr_b16 v[142:143], v59 offset:16896
    v_mfma_f32_16x16x32_bf16 a[120:123], v[156:159], v[116:119], a[120:123]
    v_mfma_f32_16x16x32_bf16 a[124:127], v[148:151], v[120:123], a[124:127]
    s_waitcnt vmcnt(14)
    v_readfirstlane_b32 s84, v13
    v_mfma_f32_16x16x32_bf16 a[124:127], v[156:159], v[124:127], a[124:127]
    s_waitcnt lgkmcnt(6)
    v_mfma_f32_16x16x32_bf16 a[128:131], v[128:131], v[64:67], a[128:131]
    ds_read_b64_tr_b16 v[144:145], v4 offset:24576
    s_waitcnt lgkmcnt(5)
    v_mfma_f32_16x16x32_bf16 a[128:131], v[136:139], v[68:71], a[128:131]
    s_cmp_lt_u32 s84, 256
    v_mfma_f32_16x16x32_bf16 a[132:135], v[128:131], v[72:75], a[132:135]
    s_cbranch_scc1 L_g1_spinA
L_g1_goA:
    buffer_load_dwordx4 v[180:183], v11, s[32:35], s80 offen sc1
    v_mfma_f32_16x16x32_bf16 a[132:135], v[136:139], v[76:79], a[132:135]
    s_mov_b32 s43, s77
    s_cmp_lg_u32 s77, 0
    s_cselect_b32 s60, 2.0, s46
    v_mfma_f32_16x16x32_bf16 a[136:139], v[128:131], v[80:83], a[136:139]
    ds_read_b64_tr_b16 v[146:147], v4 offset:25088
    s_mov_b32 s74, s46
    v_mfma_f32_16x16x32_bf16 a[136:139], v[136:139], v[84:87], a[136:139]
    s_mov_b64 s[28:29], s[8:9]
    v_mfma_f32_16x16x32_bf16 a[140:143], v[128:131], v[88:91], a[140:143]
    v_mov_b32_e64 v8, v12
    s_mov_b64 s[30:31], s[10:11]
    s_and_b32 s62, s2, 7
    v_mfma_f32_16x16x32_bf16 a[140:143], v[136:139], v[92:95], a[140:143]
    s_waitcnt lgkmcnt(4)
    v_smfmac_f32_16x16x64_bf16 v[44:47], v[32:35], v[128:135], v56
    v_mfma_f32_16x16x32_bf16 a[144:147], v[128:131], v[96:99], a[144:147]
    ds_read_b64_tr_b16 v[152:153], v58 offset:24576
    s_lshl_b32 s62, s62, 2
    v_mfma_f32_16x16x32_bf16 a[144:147], v[136:139], v[100:103], a[144:147]
    v_xor_b32 v10, 2048, v12
    s_bfe_u32 s63, s2, 0x20003
    v_mfma_f32_16x16x32_bf16 a[148:151], v[128:131], v[104:107], a[148:151]
    v_lshrrev_b32_e64 v9, 4, v0
    s_add_u32 s62, s62, s63
    v_mfma_f32_16x16x32_bf16 a[148:151], v[136:139], v[108:111], a[148:151]
    s_waitcnt lgkmcnt(3)
    v_smfmac_f32_16x16x64_bf16 v[44:47], v[32:35], v[136:143], v56
    v_mfma_f32_16x16x32_bf16 a[152:155], v[128:131], v[112:115], a[152:155]
    ds_read_b64_tr_b16 v[154:155], v58 offset:25088
    s_lshr_b32 s64, s2, 5
    s_bfe_u32 s65, s2, 0x20001
    s_nop 0
    v_mfma_f32_16x16x32_bf16 a[152:155], v[136:139], v[116:119], a[152:155]
    v_lshlrev_b32 v9, 4, v9
    s_lshl_b32 s65, s65, 2
    v_mfma_f32_16x16x32_bf16 a[156:159], v[128:131], v[120:123], a[156:159]
    v_add_u32 v9, s83, v9
    s_add_u32 s65, s65, s63
    v_mfma_f32_16x16x32_bf16 a[156:159], v[136:139], v[124:127], a[156:159]
    v_add_u32 v15, s83, v11
    s_and_b32 s66, s2, 1
    v_mfma_f32_16x16x32_bf16 a[160:163], v[132:135], v[64:67], a[160:163]
    ds_read_b64_tr_b16 v[148:149], v5 offset:24576
    v_add_u32 v10, 4096, v10
    v_mfma_f32_16x16x32_bf16 a[160:163], v[140:143], v[68:71], a[160:163]
    s_lshl_b32 s66, s66, 3
    s_add_u32 s66, s66, s64
    v_mfma_f32_16x16x32_bf16 a[164:167], v[132:135], v[72:75], a[164:167]
    s_lshl_b32 s57, s43, 10
    v_mfma_f32_16x16x32_bf16 a[164:167], v[140:143], v[76:79], a[164:167]
    s_add_u32 s36, s57, 131072
    v_mfma_f32_16x16x32_bf16 a[168:171], v[132:135], v[80:83], a[168:171]
    ds_read_b64_tr_b16 v[150:151], v5 offset:25088
    s_mov_b32 s37, 0
    v_mfma_f32_16x16x32_bf16 a[168:171], v[140:143], v[84:87], a[168:171]
    s_lshl_b32 s58, s62, 17
    s_lshl_b32 s59, s64, 14
    v_mfma_f32_16x16x32_bf16 a[172:175], v[132:135], v[88:91], a[172:175]
    s_add_u32 s58, s58, s59
    v_mfma_f32_16x16x32_bf16 a[172:175], v[140:143], v[92:95], a[172:175]
    s_lshl_b32 s38, s43, 12
    v_mfma_f32_16x16x32_bf16 a[176:179], v[132:135], v[96:99], a[176:179]
    ds_read_b64_tr_b16 v[156:157], v59 offset:24576
    s_add_u32 s58, s58, s38
    v_mfma_f32_16x16x32_bf16 a[176:179], v[140:143], v[100:103], a[176:179]
    s_add_u32 s40, s58, 4194304
    s_lshl_b32 s58, s62, 18
    v_mfma_f32_16x16x32_bf16 a[180:183], v[132:135], v[104:107], a[180:183]
    s_add_u32 s58, s58, 8388608
    v_mfma_f32_16x16x32_bf16 a[180:183], v[140:143], v[108:111], a[180:183]
    s_add_u32 s8, s32, s58
    s_addc_u32 s9, s33, 0
    v_mfma_f32_16x16x32_bf16 a[184:187], v[132:135], v[112:115], a[184:187]
    ds_read_b64_tr_b16 v[158:159], v59 offset:25088
    s_and_b32 s9, s9, 0xffff
    v_mfma_f32_16x16x32_bf16 a[184:187], v[140:143], v[116:119], a[184:187]
    s_mov_b32 s10, 262144
    s_mov_b32 s11, 0x20000
    v_mfma_f32_16x16x32_bf16 a[188:191], v[132:135], v[120:123], a[188:191]
    s_mul_i32 s58, s65, 1179648
    v_mfma_f32_16x16x32_bf16 a[188:191], v[140:143], v[124:127], a[188:191]
    s_add_u32 s58, s58, 16777216
    s_waitcnt lgkmcnt(6)
    v_mfma_f32_16x16x32_bf16 a[192:195], v[144:147], v[64:67], a[192:195]
    ds_read_b64_tr_b16 v[128:129], v4 offset:32768
    s_add_u32 s16, s32, s58
    s_addc_u32 s17, s33, 0
    s_waitcnt lgkmcnt(5)
    v_mfma_f32_16x16x32_bf16 a[192:195], v[152:155], v[68:71], a[192:195]
    s_and_b32 s17, s17, 0xffff
    s_mov_b32 s18, 1179648
    v_mfma_f32_16x16x32_bf16 a[196:199], v[144:147], v[72:75], a[196:199]
    s_mov_b32 s19, 0x20000
    v_mfma_f32_16x16x32_bf16 a[196:199], v[152:155], v[76:79], a[196:199]
    s_lshr_b32 s58, s66, 1
    v_mfma_f32_16x16x32_bf16 a[200:203], v[144:147], v[80:83], a[200:203]
    ds_read_b64_tr_b16 v[130:131], v4 offset:33280
    s_mul_i32 s58, s58, 917504
    s_and_b32 s59, s66, 1
    v_mfma_f32_16x16x32_bf16 a[200:203], v[152:155], v[84:87], a[200:203]
    s_lshl_b32 s59, s59, 11
    v_mfma_f32_16x16x32_bf16 a[204:207], v[144:147], v[88:91], a[204:207]
    s_add_u32 s58, s58, s59
    s_nop 0
    v_mfma_f32_16x16x32_bf16 a[204:207], v[152:155], v[92:95], a[204:207]
    s_waitcnt lgkmcnt(4)
    v_smfmac_f32_16x16x64_bf16 v[48:51], v[32:35], v[144:151], v56
    v_mfma_f32_16x16x32_bf16 a[208:211], v[144:147], v[96:99], a[208:211]
    ds_read_b64_tr_b16 v[136:137], v58 offset:32768
    s_add_u32 s58, s58, 41943040
    v_mfma_f32_16x16x32_bf16 a[208:211], v[152:155], v[100:103], a[208:211]
    s_add_u32 s20, s32, s58
    s_addc_u32 s21, s33, 0
    s_and_b32 s21, s21, 0xffff
    v_mfma_f32_16x16x32_bf16 a[212:215], v[144:147], v[104:107], a[212:215]
    s_mov_b32 s22, 917504
    v_mfma_f32_16x16x32_bf16 a[212:215], v[152:155], v[108:111], a[212:215]
    s_waitcnt lgkmcnt(3)
    v_smfmac_f32_16x16x64_bf16 v[48:51], v[32:35], v[152:159], v56
    v_mfma_f32_16x16x32_bf16 a[216:219], v[144:147], v[112:115], a[216:219]
    ds_read_b64_tr_b16 v[138:139], v58 offset:33280
    s_mov_b32 s23, 0x20000
    v_mfma_f32_16x16x32_bf16 a[216:219], v[152:155], v[116:119], a[216:219]
    s_lshl_b32 s58, s66, 17
    v_mfma_f32_16x16x32_bf16 a[220:223], v[144:147], v[120:123], a[220:223]
    s_add_u32 s58, s58, 50331648
    s_add_u32 s24, s32, s58
    s_addc_u32 s25, s33, 0
    v_mfma_f32_16x16x32_bf16 a[220:223], v[152:155], v[124:127], a[220:223]
    s_and_b32 s25, s25, 0xffff
    v_mfma_f32_16x16x32_bf16 a[224:227], v[148:151], v[64:67], a[224:227]
    ds_read_b64_tr_b16 v[132:133], v5 offset:32768
    s_mov_b32 s26, 131072
    v_mfma_f32_16x16x32_bf16 a[224:227], v[156:159], v[68:71], a[224:227]
    ds_read_b64_tr_b16 v[134:135], v5 offset:33280
    s_mov_b32 s27, 0x20000
    v_mfma_f32_16x16x32_bf16 a[228:231], v[148:151], v[72:75], a[228:231]
    ds_read_b64_tr_b16 v[140:141], v59 offset:32768
    s_lshl_b32 s39, s43, 15
    s_lshl_b32 s58, s64, 1
    v_mfma_f32_16x16x32_bf16 a[228:231], v[156:159], v[76:79], a[228:231]
    ds_read_b64_tr_b16 v[142:143], v59 offset:33280
    s_lshr_b32 s59, s43, 1
    v_mfma_f32_16x16x32_bf16 a[232:235], v[148:151], v[80:83], a[232:235]
    s_add_u32 s58, s58, s59
    v_mfma_f32_16x16x32_bf16 a[232:235], v[156:159], v[84:87], a[232:235]
    s_mul_i32 s58, s58, 144
    v_mfma_f32_16x16x32_bf16 a[236:239], v[148:151], v[88:91], a[236:239]
    s_add_u32 s58, s58, s62
    s_add_u32 s58, s58, 112
    v_mfma_f32_16x16x32_bf16 a[236:239], v[156:159], v[92:95], a[236:239]
    s_lshl_b32 s58, s58, 2
    v_mfma_f32_16x16x32_bf16 a[240:243], v[148:151], v[96:99], a[240:243]
    s_and_b32 s59, s43, 1
    v_mfma_f32_16x16x32_bf16 a[240:243], v[156:159], v[100:103], a[240:243]
    s_add_u32 s58, s58, s59
    v_mfma_f32_16x16x32_bf16 a[244:247], v[148:151], v[104:107], a[244:247]
    s_lshl_b32 s58, s58, 11
    s_add_u32 s41, s58, 16777216
    v_mfma_f32_16x16x32_bf16 a[244:247], v[156:159], v[108:111], a[244:247]
    s_add_u32 s48, s41, 4096
    v_mfma_f32_16x16x32_bf16 a[248:251], v[148:151], v[112:115], a[248:251]
    s_lshl_b32 s58, s65, 2
    v_mfma_f32_16x16x32_bf16 a[248:251], v[156:159], v[116:119], a[248:251]
    s_add_u32 s58, s58, s43
    v_mfma_f32_16x16x32_bf16 a[252:255], v[148:151], v[120:123], a[252:255]
    s_lshl_b32 s58, s58, 16
    s_lshl_b32 s59, s66, 7
    v_mfma_f32_16x16x32_bf16 a[252:255], v[156:159], v[124:127], a[252:255]
    s_waitcnt vmcnt(1) lgkmcnt(0)
    s_barrier
    v_mfma_f32_16x16x32_bf16 v[192:195], v[128:131], v[64:67], v[192:195]
    ds_read_b64_tr_b16 v[144:145], v6 offset:0
    s_add_u32 s42, s58, s59
    v_mfma_f32_16x16x32_bf16 v[192:195], v[136:139], v[68:71], v[192:195]
    s_waitcnt vmcnt(0)
    ds_write_b128 v15, v[180:183]
    s_lshl_b32 s58, s64, 10
    v_mfma_f32_16x16x32_bf16 v[196:199], v[128:131], v[72:75], v[196:199]
    ds_read_b64_tr_b16 v[146:147], v6 offset:512
    s_add_u32 s58, s58, s62
    s_lshl_b32 s58, s58, 2
    v_mfma_f32_16x16x32_bf16 v[196:199], v[136:139], v[76:79], v[196:199]
    ds_read2_b32 v[160:161], v10 offset0:0 offset1:16
    s_add_u32 s44, s58, 54525952
    v_mfma_f32_16x16x32_bf16 v[200:203], v[128:131], v[80:83], v[200:203]
    ds_read_b64_tr_b16 v[152:153], v60 offset:0
    s_lshl_b32 s58, s65, 4
    v_mfma_f32_16x16x32_bf16 v[200:203], v[136:139], v[84:87], v[200:203]
    ds_read2_b32 v[162:163], v10 offset0:32 offset1:48
    s_add_u32 s58, s58, s66
    v_mfma_f32_16x16x32_bf16 v[204:207], v[128:131], v[88:91], v[204:207]
    ds_read_b64_tr_b16 v[154:155], v60 offset:512
    s_lshl_b32 s58, s58, 7
    s_add_u32 s45, s58, 54525952
    v_mfma_f32_16x16x32_bf16 v[204:207], v[136:139], v[92:95], v[204:207]
    v_smfmac_f32_16x16x64_bf16 v[52:55], v[32:35], v[128:135], v56
    ds_read2_b32 v[164:165], v10 offset0:64 offset1:80
    v_mfma_f32_16x16x32_bf16 v[208:211], v[128:131], v[96:99], v[208:211]
    ds_read_b64_tr_b16 v[148:149], v7 offset:0
    s_lshl_b32 s46, s64, 2
    v_mfma_f32_16x16x32_bf16 v[208:211], v[136:139], v[100:103], v[208:211]
    ds_read2_b32 v[166:167], v10 offset0:96 offset1:112
    s_bfe_u32 s58, s2, 0x30003
    v_mfma_f32_16x16x32_bf16 v[212:215], v[128:131], v[104:107], v[212:215]
    ds_read_b64_tr_b16 v[150:151], v7 offset:512
    s_lshl_b32 s58, s58, 10
    v_mfma_f32_16x16x32_bf16 v[212:215], v[136:139], v[108:111], v[212:215]
    s_nop 0
    v_smfmac_f32_16x16x64_bf16 v[52:55], v[32:35], v[136:143], v56
    ds_read2_b32 v[168:169], v10 offset0:128 offset1:144
    v_mfma_f32_16x16x32_bf16 v[216:219], v[128:131], v[112:115], v[216:219]
    ds_read_b64_tr_b16 v[156:157], v61 offset:0
    s_and_b32 s59, s62, 28
    s_add_u32 s58, s58, s59
    v_mfma_f32_16x16x32_bf16 v[216:219], v[136:139], v[116:119], v[216:219]
    s_lshr_b32 s59, s2, 6
    v_mfma_f32_16x16x32_bf16 v[220:223], v[128:131], v[120:123], v[220:223]
    ds_read_b64_tr_b16 v[158:159], v61 offset:512
    s_add_u32 s58, s58, s59
    v_mfma_f32_16x16x32_bf16 v[220:223], v[136:139], v[124:127], v[220:223]
    s_lshl_b32 s58, s58, 2
    v_mfma_f32_16x16x32_bf16 v[224:227], v[132:135], v[64:67], v[224:227]
    ds_read_b128 v[64:67], v2 offset:32768
    s_nop 0
    s_add_u32 s47, s58, 54591488
    s_add_u32 s49, s45, 65536
    v_mfma_f32_16x16x32_bf16 v[224:227], v[140:143], v[68:71], v[224:227]
    ds_read_b128 v[68:71], v3 offset:32768
    s_cmp_lg_u32 s77, 0
    s_cselect_b32 s47, 2.0, s47
    s_cselect_b32 s49, 2.0, s49
    s_cselect_b32 s61, 0, 1
    v_mfma_f32_16x16x32_bf16 v[228:231], v[132:135], v[72:75], v[228:231]
    ds_read_b128 v[72:75], v2 offset:34816
    s_lshr_b32 s58, s77, 1
    v_mfma_f32_16x16x32_bf16 v[228:231], v[140:143], v[76:79], v[228:231]
    ds_read_b128 v[76:79], v3 offset:34816
    s_nop 0
    s_mul_i32 s59, s58, 98304
    v_mfma_f32_16x16x32_bf16 v[232:235], v[132:135], v[80:83], v[232:235]
    ds_read_b128 v[80:83], v2 offset:36864
    s_add_u32 s45, s45, s59
    s_lshl_b32 s58, s58, 11
    v_mfma_f32_16x16x32_bf16 v[232:235], v[140:143], v[84:87], v[232:235]
    ds_read_b128 v[84:87], v3 offset:36864
    s_add_u32 s44, s44, s58
    v_mfma_f32_16x16x32_bf16 v[236:239], v[132:135], v[88:91], v[236:239]
    ds_read_b128 v[88:91], v2 offset:38912
    s_and_b32 s58, s77, 1
    v_mfma_f32_16x16x32_bf16 v[236:239], v[140:143], v[92:95], v[236:239]
    ds_read_b128 v[92:95], v3 offset:38912
    s_mul_i32 s58, s58, 98304
    v_mfma_f32_16x16x32_bf16 v[240:243], v[132:135], v[96:99], v[240:243]
    ds_read_b128 v[96:99], v2 offset:40960
    s_add_u32 s44, s44, s58
    s_lshr_b32 s58, s63, 1
    v_mfma_f32_16x16x32_bf16 v[240:243], v[140:143], v[100:103], v[240:243]
    ds_read_b128 v[100:103], v3 offset:40960
    s_lshl_b32 s58, s58, 3
    v_mfma_f32_16x16x32_bf16 v[244:247], v[132:135], v[104:107], v[244:247]
    ds_read_b128 v[104:107], v2 offset:43008
    s_lshl_b32 s67, 0xff0000, s58
    s_nop 0
    v_mfma_f32_16x16x32_bf16 v[244:247], v[140:143], v[108:111], v[244:247]
    ds_read_b128 v[108:111], v3 offset:43008
    s_or_b32 s67, s67, 0xff000000
    v_mfma_f32_16x16x32_bf16 v[248:251], v[132:135], v[112:115], v[248:251]
    ds_read_b128 v[112:115], v2 offset:45056
    s_add_u32 s58, s58, s64
    s_bitset1_b32 s67, s58
    v_mfma_f32_16x16x32_bf16 v[248:251], v[140:143], v[116:119], v[248:251]
    ds_read_b128 v[116:119], v3 offset:45056
    s_lshr_b32 s58, s2, 3
    v_mfma_f32_16x16x32_bf16 v[252:255], v[132:135], v[120:123], v[252:255]
    ds_read_b128 v[120:123], v2 offset:47104
    s_bitset0_b32 s67, s58
    v_mfma_f32_16x16x32_bf16 v[252:255], v[140:143], v[124:127], v[252:255]
    ds_read_b128 v[124:127], v3 offset:47104
    s_mov_b32 s66, 1
    s_waitcnt lgkmcnt(15)
    v_mfma_f32_16x16x32_bf16 a[0:3], v[144:147], v[64:67], a[0:3]
    ds_read_b64_tr_b16 v[128:129], v6 offset:8192
    s_waitcnt lgkmcnt(15)
    v_mfma_f32_16x16x32_bf16 a[0:3], v[152:155], v[68:71], a[0:3]
    ds_read2_b32 v[16:17], v8 offset0:0 offset1:16
    s_waitcnt lgkmcnt(15)
    v_mfma_f32_16x16x32_bf16 a[4:7], v[144:147], v[72:75], a[4:7]
    ds_read2_b32 v[24:25], v8 offset0:128 offset1:144
    s_waitcnt lgkmcnt(15)
    v_mfma_f32_16x16x32_bf16 a[4:7], v[152:155], v[76:79], a[4:7]
    s_waitcnt lgkmcnt(14)
    v_mfma_f32_16x16x32_bf16 a[8:11], v[144:147], v[80:83], a[8:11]
    ds_read_b64_tr_b16 v[130:131], v6 offset:8704
    s_waitcnt lgkmcnt(14)
    v_mfma_f32_16x16x32_bf16 a[8:11], v[152:155], v[84:87], a[8:11]
    ds_read2_b32 v[18:19], v8 offset0:32 offset1:48
    s_waitcnt lgkmcnt(14)
    v_mfma_f32_16x16x32_bf16 a[12:15], v[144:147], v[88:91], a[12:15]
    ds_read2_b32 v[26:27], v8 offset0:160 offset1:176
    s_waitcnt lgkmcnt(14)
    v_mfma_f32_16x16x32_bf16 a[12:15], v[152:155], v[92:95], a[12:15]
    s_nop 0
    v_smfmac_f32_16x16x64_bf16 v[36:39], v[32:35], v[144:151], v56
    s_waitcnt lgkmcnt(13)
    v_mfma_f32_16x16x32_bf16 a[16:19], v[144:147], v[96:99], a[16:19]
    ds_read_b64_tr_b16 v[136:137], v60 offset:8192
    s_waitcnt lgkmcnt(13)
    v_mfma_f32_16x16x32_bf16 a[16:19], v[152:155], v[100:103], a[16:19]
    ds_read2_b32 v[20:21], v8 offset0:64 offset1:80
    s_waitcnt lgkmcnt(13)
    v_mfma_f32_16x16x32_bf16 a[20:23], v[144:147], v[104:107], a[20:23]
    s_nop 0
    ds_read2_b32 v[28:29], v8 offset0:192 offset1:208
    s_waitcnt lgkmcnt(13)
    v_mfma_f32_16x16x32_bf16 a[20:23], v[152:155], v[108:111], a[20:23]
    v_smfmac_f32_16x16x64_bf16 v[36:39], v[32:35], v[152:159], v56
    s_waitcnt lgkmcnt(12)
    v_mfma_f32_16x16x32_bf16 a[24:27], v[144:147], v[112:115], a[24:27]
    ds_read_b64_tr_b16 v[138:139], v60 offset:8704
    s_waitcnt lgkmcnt(12)
    v_mfma_f32_16x16x32_bf16 a[24:27], v[152:155], v[116:119], a[24:27]
    s_nop 0
    ds_read2_b32 v[22:23], v8 offset0:96 offset1:112
    s_waitcnt lgkmcnt(12)
    v_mfma_f32_16x16x32_bf16 a[28:31], v[144:147], v[120:123], a[28:31]
    ds_read2_b32 v[30:31], v8 offset0:224 offset1:240
    s_waitcnt lgkmcnt(12)
    v_mfma_f32_16x16x32_bf16 a[28:31], v[152:155], v[124:127], a[28:31]
    v_mfma_f32_16x16x32_bf16 a[32:35], v[148:151], v[64:67], a[32:35]
    ds_read_b64_tr_b16 v[132:133], v7 offset:8192
    v_mfma_f32_16x16x32_bf16 a[32:35], v[156:159], v[68:71], a[32:35]
    v_add_f32 v160, v160, v36
    v_add_f32 v160, v160, v37
    v_mfma_f32_16x16x32_bf16 a[36:39], v[148:151], v[72:75], a[36:39]
    v_add_f32 v161, v161, v38
    v_add_f32 v161, v161, v39
    v_mfma_f32_16x16x32_bf16 a[36:39], v[156:159], v[76:79], a[36:39]
    ds_write_b32 v8, v160 offset:8192
    v_mfma_f32_16x16x32_bf16 a[40:43], v[148:151], v[80:83], a[40:43]
    ds_read_b64_tr_b16 v[134:135], v7 offset:8704
    v_mfma_f32_16x16x32_bf16 a[40:43], v[156:159], v[84:87], a[40:43]
    ds_write_b32 v8, v161 offset:8256
    v_mfma_f32_16x16x32_bf16 a[44:47], v[148:151], v[88:91], a[44:47]
    ds_read_b128 v[172:175], v9 offset:8192
    v_mfma_f32_16x16x32_bf16 a[44:47], v[156:159], v[92:95], a[44:47]
    ds_read_b128 v[176:179], v9 offset:8256
    v_mfma_f32_16x16x32_bf16 a[48:51], v[148:151], v[96:99], a[48:51]
    ds_read_b64_tr_b16 v[140:141], v61 offset:8192
    s_waitcnt lgkmcnt(15)
    v_mul_f32 v24, s52, v24
    v_mfma_f32_16x16x32_bf16 a[48:51], v[156:159], v[100:103], a[48:51]
    v_mul_f32 v25, s52, v25
    s_waitcnt lgkmcnt(13)
    v_mul_f32 v26, s52, v26
    v_mfma_f32_16x16x32_bf16 a[52:55], v[148:151], v[104:107], a[52:55]
    v_mul_f32 v27, s52, v27
    s_waitcnt lgkmcnt(10)
    v_mul_f32 v28, s52, v28
    v_mfma_f32_16x16x32_bf16 a[52:55], v[156:159], v[108:111], a[52:55]
    v_mul_f32 v29, s52, v29
    s_waitcnt lgkmcnt(7)
    v_mul_f32_e64 v30, s52, v30
    v_mfma_f32_16x16x32_bf16 a[56:59], v[148:151], v[112:115], a[56:59]
    ds_read_b64_tr_b16 v[142:143], v61 offset:8704
    v_mul_f32_e64 v31, s52, v31
    v_mfma_f32_16x16x32_bf16 a[56:59], v[156:159], v[116:119], a[56:59]
    v_accvgpr_read_b32 v180, a0
    v_accvgpr_read_b32 v181, a1
    v_mfma_f32_16x16x32_bf16 a[60:63], v[148:151], v[120:123], a[60:63]
    v_accvgpr_read_b32 v182, a2
    v_accvgpr_read_b32 v183, a3
    v_mfma_f32_16x16x32_bf16 a[60:63], v[156:159], v[124:127], a[60:63]
    v_accvgpr_read_b32 v184, a32
    v_accvgpr_read_b32 v185, a33
    v_mfma_f32_16x16x32_bf16 a[64:67], v[128:131], v[64:67], a[64:67]
    ds_read_b64_tr_b16 v[144:145], v6 offset:16384
    v_accvgpr_read_b32 v186, a34
    v_mfma_f32_16x16x32_bf16 a[64:67], v[136:139], v[68:71], a[64:67]
    v_accvgpr_read_b32 v187, a35
    s_waitcnt lgkmcnt(4)
    v_fmac_f32 v180, v16, v172
    v_mfma_f32_16x16x32_bf16 a[68:71], v[128:131], v[72:75], a[68:71]
    v_fmac_f32 v181, v16, v173
    v_fmac_f32 v182, v16, v174
    v_mfma_f32_16x16x32_bf16 a[68:71], v[136:139], v[76:79], a[68:71]
    v_fmac_f32 v183, v16, v175
    s_waitcnt lgkmcnt(3)
    v_fmac_f32_e64 v184, v16, v176
    v_mfma_f32_16x16x32_bf16 a[72:75], v[128:131], v[80:83], a[72:75]
    ds_read_b64_tr_b16 v[146:147], v6 offset:16896
    v_fmac_f32 v185, v16, v177
    v_mfma_f32_16x16x32_bf16 a[72:75], v[136:139], v[84:87], a[72:75]
    v_fmac_f32 v186, v16, v178
    v_fmac_f32_e64 v187, v16, v179
    v_mfma_f32_16x16x32_bf16 a[76:79], v[128:131], v[88:91], a[76:79]
    v_mul_f32 v180, v24, v180
    v_mul_f32 v181, v24, v181
    v_mfma_f32_16x16x32_bf16 a[76:79], v[136:139], v[92:95], a[76:79]
    v_smfmac_f32_16x16x64_bf16 v[40:43], v[32:35], v[128:135], v56
    v_mfma_f32_16x16x32_bf16 a[80:83], v[128:131], v[96:99], a[80:83]
    ds_read_b64_tr_b16 v[152:153], v60 offset:16384
    v_mul_f32 v182, v24, v182
    v_mfma_f32_16x16x32_bf16 a[80:83], v[136:139], v[100:103], a[80:83]
    v_mul_f32 v183, v24, v183
    v_mul_f32 v184, v24, v184
    v_mfma_f32_16x16x32_bf16 a[84:87], v[128:131], v[104:107], a[84:87]
    v_mul_f32 v185, v24, v185
    v_mul_f32 v186, v24, v186
    v_mfma_f32_16x16x32_bf16 a[84:87], v[136:139], v[108:111], a[84:87]
    s_waitcnt lgkmcnt(3)
    v_smfmac_f32_16x16x64_bf16 v[40:43], v[32:35], v[136:143], v56
    v_mfma_f32_16x16x32_bf16 a[88:91], v[128:131], v[112:115], a[88:91]
    ds_read_b64_tr_b16 v[154:155], v60 offset:16896
    v_mul_f32_e64 v187, v24, v187
    v_mfma_f32_16x16x32_bf16 a[88:91], v[136:139], v[116:119], a[88:91]
    v_cvt_pk_bf16_f32 v188, v180, v181
    v_cvt_pk_bf16_f32 v189, v182, v183
    v_mfma_f32_16x16x32_bf16 a[92:95], v[128:131], v[120:123], a[92:95]
    v_cvt_pk_bf16_f32 v190, v184, v185
    v_cvt_pk_bf16_f32 v191, v186, v187
    v_mfma_f32_16x16x32_bf16 a[92:95], v[136:139], v[124:127], a[92:95]
    buffer_store_dwordx4 v[188:191], v11, s[32:35], s50 offen offset:0 sc1
    v_accvgpr_read_b32 v180, a4
    v_mfma_f32_16x16x32_bf16 a[96:99], v[132:135], v[64:67], a[96:99]
    ds_read_b64_tr_b16 v[148:149], v7 offset:16384
    v_accvgpr_read_b32 v181, a5
    v_mfma_f32_16x16x32_bf16 a[96:99], v[140:143], v[68:71], a[96:99]
    v_add_f32 v162, v162, v40
    v_add_f32 v162, v162, v41
    v_mfma_f32_16x16x32_bf16 a[100:103], v[132:135], v[72:75], a[100:103]
    v_add_f32 v163, v163, v42
    v_add_f32 v163, v163, v43
    v_mfma_f32_16x16x32_bf16 a[100:103], v[140:143], v[76:79], a[100:103]
    ds_write_b32 v8, v162 offset:8320
    v_accvgpr_read_b32 v182, a6
    v_mfma_f32_16x16x32_bf16 a[104:107], v[132:135], v[80:83], a[104:107]
    ds_read_b64_tr_b16 v[150:151], v7 offset:16896
    v_accvgpr_read_b32 v183, a7
    v_mfma_f32_16x16x32_bf16 a[104:107], v[140:143], v[84:87], a[104:107]
    ds_write_b32 v8, v163 offset:8384
    v_accvgpr_read_b32 v184, a36
    v_mfma_f32_16x16x32_bf16 a[108:111], v[132:135], v[88:91], a[108:111]
    v_accvgpr_read_b32 v185, a37
    v_accvgpr_read_b32 v186, a38
    v_mfma_f32_16x16x32_bf16 a[108:111], v[140:143], v[92:95], a[108:111]
    v_accvgpr_read_b32 v187, a39
    v_fmac_f32_e64 v180, v17, v172
    v_mfma_f32_16x16x32_bf16 a[112:115], v[132:135], v[96:99], a[112:115]
    ds_read_b64_tr_b16 v[156:157], v61 offset:16384
    v_fmac_f32 v181, v17, v173
    v_mfma_f32_16x16x32_bf16 a[112:115], v[140:143], v[100:103], a[112:115]
    v_fmac_f32 v182, v17, v174
    v_fmac_f32_e64 v183, v17, v175
    v_mfma_f32_16x16x32_bf16 a[116:119], v[132:135], v[104:107], a[116:119]
    v_fmac_f32 v184, v17, v176
    v_fmac_f32 v185, v17, v177
    v_mfma_f32_16x16x32_bf16 a[116:119], v[140:143], v[108:111], a[116:119]
    v_fmac_f32 v186, v17, v178
    v_fmac_f32 v187, v17, v179
    v_mfma_f32_16x16x32_bf16 a[120:123], v[132:135], v[112:115], a[120:123]
    ds_read_b64_tr_b16 v[158:159], v61 offset:16896
    v_mul_f32 v180, v25, v180
    v_mfma_f32_16x16x32_bf16 a[120:123], v[140:143], v[116:119], a[120:123]
    v_mul_f32 v181, v25, v181
    v_mul_f32 v182, v25, v182
    v_mfma_f32_16x16x32_bf16 a[124:127], v[132:135], v[120:123], a[124:127]
    v_mul_f32 v183, v25, v183
    v_mul_f32 v184, v25, v184
    v_mfma_f32_16x16x32_bf16 a[124:127], v[140:143], v[124:127], a[124:127]
    v_mul_f32 v185, v25, v185
    v_mul_f32 v186, v25, v186
    s_waitcnt lgkmcnt(8)
    v_mfma_f32_16x16x32_bf16 a[128:131], v[144:147], v[64:67], a[128:131]
    ds_read_b64_tr_b16 v[128:129], v6 offset:24576
    v_mul_f32 v187, v25, v187
    s_waitcnt lgkmcnt(7)
    v_mfma_f32_16x16x32_bf16 a[128:131], v[152:155], v[68:71], a[128:131]
    v_cvt_pk_bf16_f32 v36, v180, v181
    v_cvt_pk_bf16_f32 v37, v182, v183
    v_mfma_f32_16x16x32_bf16 a[132:135], v[144:147], v[72:75], a[132:135]
    v_cvt_pk_bf16_f32 v38, v184, v185
    v_cvt_pk_bf16_f32 v39, v186, v187
    v_mfma_f32_16x16x32_bf16 a[132:135], v[152:155], v[76:79], a[132:135]
    buffer_store_dwordx4 v[36:39], v11, s[32:35], s50 offen offset:1024 sc1
    s_add_u32 s50, s50, s51
    v_accvgpr_read_b32 v180, a8
    v_mfma_f32_16x16x32_bf16 a[136:139], v[144:147], v[80:83], a[136:139]
    s_nop 0
    ds_read_b64_tr_b16 v[130:131], v6 offset:25088
    v_accvgpr_read_b32 v181, a9
    v_mfma_f32_16x16x32_bf16 a[136:139], v[152:155], v[84:87], a[136:139]
    v_accvgpr_read_b32 v182, a10
    v_accvgpr_read_b32 v183, a11
    v_mfma_f32_16x16x32_bf16 a[140:143], v[144:147], v[88:91], a[140:143]
    v_accvgpr_read_b32 v184, a40
    v_accvgpr_read_b32 v185, a41
    v_mfma_f32_16x16x32_bf16 a[140:143], v[152:155], v[92:95], a[140:143]
    s_waitcnt lgkmcnt(5)
    v_smfmac_f32_16x16x64_bf16 v[44:47], v[32:35], v[144:151], v56
    v_mfma_f32_16x16x32_bf16 a[144:147], v[144:147], v[96:99], a[144:147]
    ds_read_b64_tr_b16 v[136:137], v60 offset:24576
    s_nop 0
    v_accvgpr_read_b32 v186, a42
    v_mfma_f32_16x16x32_bf16 a[144:147], v[152:155], v[100:103], a[144:147]
    v_accvgpr_read_b32 v187, a43
    v_fmac_f32_e64 v180, v18, v172
    v_mfma_f32_16x16x32_bf16 a[148:151], v[144:147], v[104:107], a[148:151]
    v_fmac_f32 v181, v18, v173
    v_fmac_f32_e64 v182, v18, v174
    v_mfma_f32_16x16x32_bf16 a[148:151], v[152:155], v[108:111], a[148:151]
    s_waitcnt lgkmcnt(3)
    v_smfmac_f32_16x16x64_bf16 v[44:47], v[32:35], v[152:159], v56
    v_mfma_f32_16x16x32_bf16 a[152:155], v[144:147], v[112:115], a[152:155]
    ds_read_b64_tr_b16 v[138:139], v60 offset:25088
    v_fmac_f32_e64 v183, v18, v175
    v_mfma_f32_16x16x32_bf16 a[152:155], v[152:155], v[116:119], a[152:155]
    v_fmac_f32 v184, v18, v176
    v_fmac_f32 v185, v18, v177
    v_mfma_f32_16x16x32_bf16 a[156:159], v[144:147], v[120:123], a[156:159]
    v_fmac_f32 v186, v18, v178
    v_fmac_f32 v187, v18, v179
    v_mfma_f32_16x16x32_bf16 a[156:159], v[152:155], v[124:127], a[156:159]
    v_mul_f32 v180, v26, v180
    v_mul_f32 v181, v26, v181
    v_mfma_f32_16x16x32_bf16 a[160:163], v[148:151], v[64:67], a[160:163]
    ds_read_b64_tr_b16 v[132:133], v7 offset:24576
    v_mul_f32 v182, v26, v182
    v_mfma_f32_16x16x32_bf16 a[160:163], v[156:159], v[68:71], a[160:163]
    v_add_f32 v164, v164, v44
    v_add_f32 v164, v164, v45
    v_mfma_f32_16x16x32_bf16 a[164:167], v[148:151], v[72:75], a[164:167]
    v_add_f32 v165, v165, v46
    v_add_f32 v165, v165, v47
    v_mfma_f32_16x16x32_bf16 a[164:167], v[156:159], v[76:79], a[164:167]
    ds_write_b32 v8, v164 offset:8448
    v_mul_f32 v183, v26, v183
    v_mfma_f32_16x16x32_bf16 a[168:171], v[148:151], v[80:83], a[168:171]
    ds_read_b64_tr_b16 v[134:135], v7 offset:25088
    v_mul_f32 v184, v26, v184
    v_mfma_f32_16x16x32_bf16 a[168:171], v[156:159], v[84:87], a[168:171]
    ds_write_b32 v8, v165 offset:8512
    v_mul_f32 v185, v26, v185
    v_mfma_f32_16x16x32_bf16 a[172:175], v[148:151], v[88:91], a[172:175]
    v_mul_f32 v186, v26, v186
    v_mul_f32 v187, v26, v187
    v_mfma_f32_16x16x32_bf16 a[172:175], v[156:159], v[92:95], a[172:175]
    v_cvt_pk_bf16_f32 v188, v180, v181
    v_cvt_pk_bf16_f32 v189, v182, v183
    v_mfma_f32_16x16x32_bf16 a[176:179], v[148:151], v[96:99], a[176:179]
    ds_read_b64_tr_b16 v[140:141], v61 offset:24576
    v_cvt_pk_bf16_f32 v190, v184, v185
    v_mfma_f32_16x16x32_bf16 a[176:179], v[156:159], v[100:103], a[176:179]
    v_cvt_pk_bf16_f32 v191, v186, v187
    buffer_store_dwordx4 v[188:191], v11, s[32:35], s50 offen offset:0 sc1
    v_mfma_f32_16x16x32_bf16 a[180:183], v[148:151], v[104:107], a[180:183]
    v_accvgpr_read_b32 v180, a12
    v_accvgpr_read_b32 v181, a13
    v_mfma_f32_16x16x32_bf16 a[180:183], v[156:159], v[108:111], a[180:183]
    v_accvgpr_read_b32 v182, a14
    v_accvgpr_read_b32 v183, a15
    v_mfma_f32_16x16x32_bf16 a[184:187], v[148:151], v[112:115], a[184:187]
    ds_read_b64_tr_b16 v[142:143], v61 offset:25088
    v_accvgpr_read_b32 v184, a44
    v_mfma_f32_16x16x32_bf16 a[184:187], v[156:159], v[116:119], a[184:187]
    v_accvgpr_read_b32 v185, a45
    v_accvgpr_read_b32 v186, a46
    v_mfma_f32_16x16x32_bf16 a[188:191], v[148:151], v[120:123], a[188:191]
    v_accvgpr_read_b32 v187, a47
    v_fmac_f32 v180, v19, v172
    v_mfma_f32_16x16x32_bf16 a[188:191], v[156:159], v[124:127], a[188:191]
    v_fmac_f32 v181, v19, v173
    v_fmac_f32 v182, v19, v174
    s_waitcnt lgkmcnt(8)
    v_mfma_f32_16x16x32_bf16 a[192:195], v[128:131], v[64:67], a[192:195]
    ds_read_b64_tr_b16 v[144:145], v6 offset:32768
    v_fmac_f32 v183, v19, v175
    s_waitcnt lgkmcnt(7)
    v_mfma_f32_16x16x32_bf16 a[192:195], v[136:139], v[68:71], a[192:195]
    v_fmac_f32 v184, v19, v176
    v_fmac_f32 v185, v19, v177
    v_mfma_f32_16x16x32_bf16 a[196:199], v[128:131], v[72:75], a[196:199]
    v_fmac_f32 v186, v19, v178
    v_fmac_f32 v187, v19, v179
    v_mfma_f32_16x16x32_bf16 a[196:199], v[136:139], v[76:79], a[196:199]
    v_mul_f32 v180, v27, v180
    v_mul_f32 v181, v27, v181
    v_mfma_f32_16x16x32_bf16 a[200:203], v[128:131], v[80:83], a[200:203]
    ds_read_b64_tr_b16 v[146:147], v6 offset:33280
    v_mul_f32_e64 v182, v27, v182
    v_mfma_f32_16x16x32_bf16 a[200:203], v[136:139], v[84:87], a[200:203]
    v_mul_f32 v183, v27, v183
    v_mul_f32 v184, v27, v184
    v_mfma_f32_16x16x32_bf16 a[204:207], v[128:131], v[88:91], a[204:207]
    v_mul_f32_e64 v185, v27, v185
    v_mul_f32 v186, v27, v186
    v_mfma_f32_16x16x32_bf16 a[204:207], v[136:139], v[92:95], a[204:207]
    s_waitcnt lgkmcnt(5)
    v_smfmac_f32_16x16x64_bf16 v[48:51], v[32:35], v[128:135], v56
    v_mfma_f32_16x16x32_bf16 a[208:211], v[128:131], v[96:99], a[208:211]
    ds_read_b64_tr_b16 v[152:153], v60 offset:32768
    v_mul_f32_e64 v187, v27, v187
    v_mfma_f32_16x16x32_bf16 a[208:211], v[136:139], v[100:103], a[208:211]
    v_cvt_pk_bf16_f32 v36, v180, v181
    v_cvt_pk_bf16_f32 v37, v182, v183
    v_mfma_f32_16x16x32_bf16 a[212:215], v[128:131], v[104:107], a[212:215]
    v_cvt_pk_bf16_f32 v38, v184, v185
    v_cvt_pk_bf16_f32 v39, v186, v187
    v_mfma_f32_16x16x32_bf16 a[212:215], v[136:139], v[108:111], a[212:215]
    s_waitcnt lgkmcnt(3)
    v_smfmac_f32_16x16x64_bf16 v[48:51], v[32:35], v[136:143], v56
    v_mfma_f32_16x16x32_bf16 a[216:219], v[128:131], v[112:115], a[216:219]
    ds_read_b64_tr_b16 v[154:155], v60 offset:33280
    buffer_store_dwordx4 v[36:39], v11, s[32:35], s50 offen offset:1024 sc1
    v_mfma_f32_16x16x32_bf16 a[216:219], v[136:139], v[116:119], a[216:219]
    s_add_u32 s50, s50, s51
    v_accvgpr_read_b32 v180, a16
    v_accvgpr_read_b32 v181, a17
    v_mfma_f32_16x16x32_bf16 a[220:223], v[128:131], v[120:123], a[220:223]
    v_accvgpr_read_b32 v182, a18
    v_accvgpr_read_b32 v183, a19
    v_mfma_f32_16x16x32_bf16 a[220:223], v[136:139], v[124:127], a[220:223]
    v_accvgpr_read_b32 v184, a48
    v_accvgpr_read_b32 v185, a49
    v_mfma_f32_16x16x32_bf16 a[224:227], v[132:135], v[64:67], a[224:227]
    ds_read_b64_tr_b16 v[148:149], v7 offset:32768
    v_accvgpr_read_b32 v186, a50
    v_mfma_f32_16x16x32_bf16 a[224:227], v[140:143], v[68:71], a[224:227]
    ds_read_b64_tr_b16 v[150:151], v7 offset:33280
    v_add_f32 v166, v166, v48
    v_add_f32 v166, v166, v49
    v_mfma_f32_16x16x32_bf16 a[228:231], v[132:135], v[72:75], a[228:231]
    ds_read_b64_tr_b16 v[156:157], v61 offset:32768
    v_add_f32 v167, v167, v50
    v_add_f32 v167, v167, v51
    v_mfma_f32_16x16x32_bf16 a[228:231], v[140:143], v[76:79], a[228:231]
    ds_read_b64_tr_b16 v[158:159], v61 offset:33280
    ds_write_b32 v8, v166 offset:8576
    v_mfma_f32_16x16x32_bf16 a[232:235], v[132:135], v[80:83], a[232:235]
    v_accvgpr_read_b32 v187, a51
    v_fmac_f32 v180, v20, v172
    v_mfma_f32_16x16x32_bf16 a[232:235], v[140:143], v[84:87], a[232:235]
    ds_write_b32 v8, v167 offset:8640
    v_fmac_f32 v181, v20, v173
    v_mfma_f32_16x16x32_bf16 a[236:239], v[132:135], v[88:91], a[236:239]
    v_fmac_f32 v182, v20, v174
    v_fmac_f32 v183, v20, v175
    v_mfma_f32_16x16x32_bf16 a[236:239], v[140:143], v[92:95], a[236:239]
    v_fmac_f32 v184, v20, v176
    v_fmac_f32 v185, v20, v177
    v_mfma_f32_16x16x32_bf16 a[240:243], v[132:135], v[96:99], a[240:243]
    v_fmac_f32 v186, v20, v178
    v_fmac_f32 v187, v20, v179
    v_mfma_f32_16x16x32_bf16 a[240:243], v[140:143], v[100:103], a[240:243]
    v_mul_f32 v180, v28, v180
    v_mul_f32 v181, v28, v181
    v_mfma_f32_16x16x32_bf16 a[244:247], v[132:135], v[104:107], a[244:247]
    v_mul_f32 v182, v28, v182
    v_mul_f32 v183, v28, v183
    v_mfma_f32_16x16x32_bf16 a[244:247], v[140:143], v[108:111], a[244:247]
    v_mul_f32 v184, v28, v184
    v_mul_f32 v185, v28, v185
    v_mfma_f32_16x16x32_bf16 a[248:251], v[132:135], v[112:115], a[248:251]
    v_mul_f32_e64 v186, v28, v186
    v_mul_f32_e64 v187, v28, v187
    v_mfma_f32_16x16x32_bf16 a[248:251], v[140:143], v[116:119], a[248:251]
    v_cvt_pk_bf16_f32 v188, v180, v181
    v_cvt_pk_bf16_f32 v189, v182, v183
    v_mfma_f32_16x16x32_bf16 a[252:255], v[132:135], v[120:123], a[252:255]
    v_cvt_pk_bf16_f32 v190, v184, v185
    v_cvt_pk_bf16_f32 v191, v186, v187
    v_mfma_f32_16x16x32_bf16 a[252:255], v[140:143], v[124:127], a[252:255]
    buffer_store_dwordx4 v[188:191], v11, s[32:35], s50 offen offset:0 sc1
    v_accvgpr_read_b32 v180, a20
    s_waitcnt lgkmcnt(8)
    v_mfma_f32_16x16x32_bf16 v[192:195], v[144:147], v[64:67], v[192:195]
    v_accvgpr_read_b32 v181, a21
    v_accvgpr_read_b32 v182, a22
    s_waitcnt lgkmcnt(6)
    v_mfma_f32_16x16x32_bf16 v[192:195], v[152:155], v[68:71], v[192:195]
    v_accvgpr_read_b32 v183, a23
    v_accvgpr_read_b32 v184, a52
    v_mfma_f32_16x16x32_bf16 v[196:199], v[144:147], v[72:75], v[196:199]
    ds_read_b128 v[128:131], v9 offset:8576
    v_accvgpr_read_b32 v185, a53
    v_mfma_f32_16x16x32_bf16 v[196:199], v[152:155], v[76:79], v[196:199]
    v_accvgpr_read_b32 v186, a54
    v_accvgpr_read_b32 v187, a55
    v_mfma_f32_16x16x32_bf16 v[200:203], v[144:147], v[80:83], v[200:203]
    ds_read_b128 v[132:135], v9 offset:8640
    v_fmac_f32_e64 v180, v21, v172
    v_mfma_f32_16x16x32_bf16 v[200:203], v[152:155], v[84:87], v[200:203]
    v_fmac_f32 v181, v21, v173
    v_fmac_f32 v182, v21, v174
    v_mfma_f32_16x16x32_bf16 v[204:207], v[144:147], v[88:91], v[204:207]
    v_fmac_f32 v183, v21, v175
    v_fmac_f32 v184, v21, v176
    v_mfma_f32_16x16x32_bf16 v[204:207], v[152:155], v[92:95], v[204:207]
    s_waitcnt lgkmcnt(6)
    v_smfmac_f32_16x16x64_bf16 v[52:55], v[32:35], v[144:151], v56
    v_mfma_f32_16x16x32_bf16 v[208:211], v[144:147], v[96:99], v[208:211]
    v_fmac_f32 v185, v21, v177
    v_fmac_f32 v186, v21, v178
    v_mfma_f32_16x16x32_bf16 v[208:211], v[152:155], v[100:103], v[208:211]
    v_fmac_f32 v187, v21, v179
    v_mul_f32 v180, v29, v180
    v_mfma_f32_16x16x32_bf16 v[212:215], v[144:147], v[104:107], v[212:215]
    v_mul_f32 v181, v29, v181
    v_mul_f32 v182, v29, v182
    v_mfma_f32_16x16x32_bf16 v[212:215], v[152:155], v[108:111], v[212:215]
    s_waitcnt lgkmcnt(4)
    v_smfmac_f32_16x16x64_bf16 v[52:55], v[32:35], v[152:159], v56
    v_mfma_f32_16x16x32_bf16 v[216:219], v[144:147], v[112:115], v[216:219]
    v_mul_f32 v183, v29, v183
    v_mul_f32 v184, v29, v184
    v_mfma_f32_16x16x32_bf16 v[216:219], v[152:155], v[116:119], v[216:219]
    v_mul_f32 v185, v29, v185
    v_mul_f32 v186, v29, v186
    v_mfma_f32_16x16x32_bf16 v[220:223], v[144:147], v[120:123], v[220:223]
    v_mul_f32_e64 v187, v29, v187
    v_cvt_pk_bf16_f32 v36, v180, v181
    v_mfma_f32_16x16x32_bf16 v[220:223], v[152:155], v[124:127], v[220:223]
    v_cvt_pk_bf16_f32 v37, v182, v183
    v_cvt_pk_bf16_f32 v38, v184, v185
    v_mfma_f32_16x16x32_bf16 v[224:227], v[148:151], v[64:67], v[224:227]
    v_cvt_pk_bf16_f32 v39, v186, v187
    buffer_store_dwordx4 v[36:39], v11, s[32:35], s50 offen offset:1024 sc1
    v_mfma_f32_16x16x32_bf16 v[224:227], v[156:159], v[68:71], v[224:227]
    v_add_f32 v168, v168, v52
    v_add_f32 v168, v168, v53
    v_mfma_f32_16x16x32_bf16 v[228:231], v[148:151], v[72:75], v[228:231]
    v_add_f32_e64 v169, v169, v54
    v_add_f32 v169, v169, v55
    v_mfma_f32_16x16x32_bf16 v[228:231], v[156:159], v[76:79], v[228:231]
    ds_write_b32 v8, v168 offset:8704
    s_add_u32 s50, s50, s51
    v_accvgpr_read_b32 v180, a24
    v_mfma_f32_16x16x32_bf16 v[232:235], v[148:151], v[80:83], v[232:235]
    v_accvgpr_read_b32 v181, a25
    v_accvgpr_read_b32 v182, a26
    v_mfma_f32_16x16x32_bf16 v[232:235], v[156:159], v[84:87], v[232:235]
    ds_write_b32 v8, v169 offset:8768
    v_accvgpr_read_b32 v183, a27
    v_mfma_f32_16x16x32_bf16 v[236:239], v[148:151], v[88:91], v[236:239]
    v_accvgpr_read_b32 v184, a56
    v_accvgpr_read_b32 v185, a57
    v_mfma_f32_16x16x32_bf16 v[236:239], v[156:159], v[92:95], v[236:239]
    v_accvgpr_read_b32 v186, a58
    v_accvgpr_read_b32 v187, a59
    v_mfma_f32_16x16x32_bf16 v[240:243], v[148:151], v[96:99], v[240:243]
    ds_read_b128 v[136:139], v9 offset:8704
    v_fmac_f32_e64 v180, v22, v172
    v_mfma_f32_16x16x32_bf16 v[240:243], v[156:159], v[100:103], v[240:243]
    ds_read_b128 v[140:143], v9 offset:8768
    v_fmac_f32 v181, v22, v173
    v_mfma_f32_16x16x32_bf16 v[244:247], v[148:151], v[104:107], v[244:247]
    ds_read_b128 v[64:67], v9 offset:8320
    v_fmac_f32 v182, v22, v174
    v_mfma_f32_16x16x32_bf16 v[244:247], v[156:159], v[108:111], v[244:247]
    ds_read_b128 v[68:71], v9 offset:8384
    v_fmac_f32_e64 v183, v22, v175
    v_mfma_f32_16x16x32_bf16 v[248:251], v[148:151], v[112:115], v[248:251]
    ds_read_b128 v[72:75], v9 offset:8448
    v_fmac_f32 v184, v22, v176
    v_mfma_f32_16x16x32_bf16 v[248:251], v[156:159], v[116:119], v[248:251]
    ds_read_b128 v[76:79], v9 offset:8512
    v_fmac_f32 v185, v22, v177
    v_mfma_f32_16x16x32_bf16 v[252:255], v[148:151], v[120:123], v[252:255]
    v_fmac_f32 v186, v22, v178
    v_fmac_f32 v187, v22, v179
    v_mfma_f32_16x16x32_bf16 v[252:255], v[156:159], v[124:127], v[252:255]
    v_mul_f32 v180, v30, v180
    v_mul_f32 v181, v30, v181
    v_mul_f32 v182, v30, v182
    v_mul_f32 v183, v30, v183
    v_mul_f32 v184, v30, v184
    v_mul_f32 v185, v30, v185
    v_mul_f32 v186, v30, v186
    v_mul_f32 v187, v30, v187
    v_cvt_pk_bf16_f32 v188, v180, v181
    v_cvt_pk_bf16_f32 v189, v182, v183
    v_cvt_pk_bf16_f32 v190, v184, v185
    v_cvt_pk_bf16_f32 v191, v186, v187
    buffer_store_dwordx4 v[188:191], v11, s[32:35], s50 offen offset:0 sc1
    v_accvgpr_read_b32 v180, a28
    v_accvgpr_read_b32 v181, a29
    v_accvgpr_read_b32 v182, a30
    v_accvgpr_read_b32 v183, a31
    v_accvgpr_read_b32 v184, a60
    v_accvgpr_read_b32 v185, a61
    v_accvgpr_read_b32 v186, a62
    v_accvgpr_read_b32 v187, a63
    v_fmac_f32 v180, v23, v172
    v_fmac_f32 v181, v23, v173
    v_fmac_f32 v182, v23, v174
    v_fmac_f32 v183, v23, v175
    v_fmac_f32 v184, v23, v176
    v_fmac_f32 v185, v23, v177
    v_fmac_f32 v186, v23, v178
    v_fmac_f32 v187, v23, v179
    v_mul_f32 v180, v31, v180
    v_mul_f32 v181, v31, v181
    v_mul_f32 v182, v31, v182
    v_mul_f32 v183, v31, v183
    v_mul_f32 v184, v31, v184
    v_mul_f32 v185, v31, v185
    v_mul_f32_e64 v186, v31, v186
    v_mul_f32_e64 v187, v31, v187
    v_cvt_pk_bf16_f32 v36, v180, v181
    v_cvt_pk_bf16_f32 v37, v182, v183
    v_cvt_pk_bf16_f32 v38, v184, v185
    v_cvt_pk_bf16_f32 v39, v186, v187
    buffer_store_dwordx4 v[36:39], v11, s[32:35], s50 offen offset:1024 sc1
    s_add_u32 s50, s50, s51
    s_nop 0
    ds_read2_b32 v[24:25], v8 offset0:128 offset1:144
    ds_read2_b32 v[26:27], v8 offset0:160 offset1:176
    ds_read2_b32 v[28:29], v8 offset0:192 offset1:208
    ds_read2_b32 v[30:31], v8 offset0:224 offset1:240
    s_mov_b32 s70, s54
    s_mov_b32 s71, s53
    v_accvgpr_read_b32 v172, a192
    v_accvgpr_read_b32 v173, a193
    v_accvgpr_read_b32 v174, a194
    v_accvgpr_read_b32 v175, a195
    v_accvgpr_read_b32 v176, a224
    v_accvgpr_read_b32 v177, a225
    v_accvgpr_read_b32 v178, a226
    v_accvgpr_read_b32 v179, a227
    s_waitcnt lgkmcnt(13)
    v_pk_fma_f32 v[172:173], v[16:17], v[128:129], v[172:173] op_sel:[0,0,0] op_sel_hi:[0,1,1]
    v_pk_fma_f32 v[174:175], v[16:17], v[130:131], v[174:175] op_sel:[0,0,0] op_sel_hi:[0,1,1]
    s_waitcnt lgkmcnt(12)
    v_pk_fma_f32 v[176:177], v[16:17], v[132:133], v[176:177] op_sel:[0,0,0] op_sel_hi:[0,1,1]
    v_pk_fma_f32 v[178:179], v[16:17], v[134:135], v[178:179] op_sel:[0,0,0] op_sel_hi:[0,1,1]
    s_waitcnt lgkmcnt(9)
    v_pk_fma_f32 v[180:181], v[16:17], v[136:137], v[192:193] op_sel:[0,0,0] op_sel_hi:[0,1,1]
    v_pk_fma_f32 v[182:183], v[16:17], v[138:139], v[194:195] op_sel:[0,0,0] op_sel_hi:[0,1,1]
    s_waitcnt lgkmcnt(8)
    v_pk_fma_f32 v[184:185], v[16:17], v[140:141], v[224:225] op_sel:[0,0,0] op_sel_hi:[0,1,1]
    v_pk_fma_f32 v[186:187], v[16:17], v[142:143], v[226:227] op_sel:[0,0,0] op_sel_hi:[0,1,1]
    v_pk_mul_f32 v[172:173], v[172:173], v[180:181]
    v_pk_mul_f32 v[174:175], v[174:175], v[182:183]
    v_pk_mul_f32 v[176:177], v[176:177], v[184:185]
    v_pk_mul_f32 v[178:179], v[178:179], v[186:187]
    s_waitcnt lgkmcnt(3)
    v_pk_mul_f32 v[24:25], v[24:25], v[24:25]
    s_waitcnt lgkmcnt(2)
    v_pk_mul_f32 v[26:27], v[26:27], v[26:27]
    s_waitcnt lgkmcnt(1)
    v_pk_mul_f32 v[28:29], v[28:29], v[28:29]
    s_waitcnt lgkmcnt(0)
    v_pk_mul_f32 v[30:31], v[30:31], v[30:31]
    v_pk_mul_f32 v[172:173], v[172:173], v[24:25] op_sel:[0,0] op_sel_hi:[1,0]
    v_pk_mul_f32 v[174:175], v[174:175], v[24:25] op_sel:[0,0] op_sel_hi:[1,0]
    v_pk_mul_f32 v[176:177], v[176:177], v[24:25] op_sel:[0,0] op_sel_hi:[1,0]
    v_pk_mul_f32 v[178:179], v[178:179], v[24:25] op_sel:[0,0] op_sel_hi:[1,0]
    v_cvt_pk_bf16_f32 v192, v172, v173
    v_cvt_pk_bf16_f32 v193, v174, v175
    v_cvt_pk_bf16_f32 v194, v176, v177
    v_cvt_pk_bf16_f32 v195, v178, v179
    v_accvgpr_read_b32 v172, a196
    v_accvgpr_read_b32 v173, a197
    v_accvgpr_read_b32 v174, a198
    v_accvgpr_read_b32 v175, a199
    v_accvgpr_read_b32 v176, a228
    v_accvgpr_read_b32 v177, a229
    v_accvgpr_read_b32 v178, a230
    v_accvgpr_read_b32 v179, a231
    v_pk_fma_f32 v[172:173], v[16:17], v[128:129], v[172:173] op_sel:[1,0,0] op_sel_hi:[1,1,1]
    v_pk_fma_f32 v[174:175], v[16:17], v[130:131], v[174:175] op_sel:[1,0,0] op_sel_hi:[1,1,1]
    v_pk_fma_f32 v[176:177], v[16:17], v[132:133], v[176:177] op_sel:[1,0,0] op_sel_hi:[1,1,1]
    v_pk_fma_f32 v[178:179], v[16:17], v[134:135], v[178:179] op_sel:[1,0,0] op_sel_hi:[1,1,1]
    v_pk_fma_f32 v[180:181], v[16:17], v[136:137], v[196:197] op_sel:[1,0,0] op_sel_hi:[1,1,1]
    v_pk_fma_f32 v[182:183], v[16:17], v[138:139], v[198:199] op_sel:[1,0,0] op_sel_hi:[1,1,1]
    v_pk_fma_f32 v[184:185], v[16:17], v[140:141], v[228:229] op_sel:[1,0,0] op_sel_hi:[1,1,1]
    v_pk_fma_f32 v[186:187], v[16:17], v[142:143], v[230:231] op_sel:[1,0,0] op_sel_hi:[1,1,1]
    v_pk_mul_f32 v[172:173], v[172:173], v[180:181]
    v_pk_mul_f32 v[174:175], v[174:175], v[182:183]
    v_pk_mul_f32 v[176:177], v[176:177], v[184:185]
    v_pk_mul_f32 v[178:179], v[178:179], v[186:187]
    v_pk_mul_f32 v[172:173], v[172:173], v[24:25] op_sel:[0,1] op_sel_hi:[1,1]
    v_pk_mul_f32 v[174:175], v[174:175], v[24:25] op_sel:[0,1] op_sel_hi:[1,1]
    v_pk_mul_f32 v[176:177], v[176:177], v[24:25] op_sel:[0,1] op_sel_hi:[1,1]
    v_pk_mul_f32 v[178:179], v[178:179], v[24:25] op_sel:[0,1] op_sel_hi:[1,1]
    v_mov_b32 v3, 1
    v_lshlrev_b32_e64 v2, 7, v0
    s_cmp_lg_u32 s77, 0
    s_cselect_b32 s78, 2.0, s78
    s_waitcnt vmcnt(0)
    s_waitcnt lgkmcnt(0)
    s_barrier
    s_mov_b32 exec_hi, 0
    buffer_store_dword v3, v2, s[32:35], s78 offen sc1
    s_mov_b32 exec_hi, -1
    v_cvt_pk_bf16_f32 v196, v172, v173
    v_cvt_pk_bf16_f32 v197, v174, v175
    v_cvt_pk_bf16_f32 v198, v176, v177
    v_cvt_pk_bf16_f32 v199, v178, v179
    v_accvgpr_read_b32 v172, a200
    v_accvgpr_read_b32 v173, a201
    v_accvgpr_read_b32 v174, a202
    v_accvgpr_read_b32 v175, a203
    v_accvgpr_read_b32 v176, a232
    v_accvgpr_read_b32 v177, a233
    v_accvgpr_read_b32 v178, a234
    v_accvgpr_read_b32 v179, a235
    v_pk_fma_f32 v[172:173], v[18:19], v[128:129], v[172:173] op_sel:[0,0,0] op_sel_hi:[0,1,1]
    v_pk_fma_f32 v[174:175], v[18:19], v[130:131], v[174:175] op_sel:[0,0,0] op_sel_hi:[0,1,1]
    v_pk_fma_f32 v[176:177], v[18:19], v[132:133], v[176:177] op_sel:[0,0,0] op_sel_hi:[0,1,1]
    v_pk_fma_f32 v[178:179], v[18:19], v[134:135], v[178:179] op_sel:[0,0,0] op_sel_hi:[0,1,1]
    v_pk_fma_f32 v[180:181], v[18:19], v[136:137], v[200:201] op_sel:[0,0,0] op_sel_hi:[0,1,1]
    v_pk_fma_f32 v[182:183], v[18:19], v[138:139], v[202:203] op_sel:[0,0,0] op_sel_hi:[0,1,1]
    v_pk_fma_f32 v[184:185], v[18:19], v[140:141], v[232:233] op_sel:[0,0,0] op_sel_hi:[0,1,1]
    v_pk_fma_f32 v[186:187], v[18:19], v[142:143], v[234:235] op_sel:[0,0,0] op_sel_hi:[0,1,1]
    v_pk_mul_f32 v[172:173], v[172:173], v[180:181]
    v_pk_mul_f32 v[174:175], v[174:175], v[182:183]
    v_pk_mul_f32 v[176:177], v[176:177], v[184:185]
    v_pk_mul_f32 v[178:179], v[178:179], v[186:187]
    v_pk_mul_f32 v[172:173], v[172:173], v[26:27] op_sel:[0,0] op_sel_hi:[1,0]
    v_pk_mul_f32 v[174:175], v[174:175], v[26:27] op_sel:[0,0] op_sel_hi:[1,0]
    v_pk_mul_f32 v[176:177], v[176:177], v[26:27] op_sel:[0,0] op_sel_hi:[1,0]
    v_pk_mul_f32 v[178:179], v[178:179], v[26:27] op_sel:[0,0] op_sel_hi:[1,0]
    v_lshlrev_b32_e64 v61, 2, v0
    v_and_b32 v61, 0x7c, v61
    v_bfe_u32 v12, v0, 3, 1
    v_lshlrev_b32 v12, 10, v12
    v_lshrrev_b32 v13, 5, v0
    v_lshl_add_u32 v12, v13, 8, v12
    v_bfe_u32 v14, v0, 4, 1
    v_lshl_add_u32 v12, v14, 7, v12
    v_and_b32_e64 v15, 7, v0
    v_lshl_add_u32 v10, v15, 4, v12
    v_lshlrev_b32_e64 v12, 10, v14
    v_lshl_add_u32 v12, v13, 8, v12
    v_and_b32_e64 v15, 15, v0
    v_lshl_add_u32 v3, v15, 4, v12
    v_lshlrev_b32_e64 v9, 4, v0
    v_add_u32_e64 v4, s57, v9
    v_cvt_pk_bf16_f32 v200, v172, v173
    v_cvt_pk_bf16_f32 v201, v174, v175
    v_cvt_pk_bf16_f32 v202, v176, v177
    v_cvt_pk_bf16_f32 v203, v178, v179
    v_accvgpr_read_b32 v172, a204
    v_accvgpr_read_b32 v173, a205
    v_accvgpr_read_b32 v174, a206
    v_accvgpr_read_b32 v175, a207
    v_accvgpr_read_b32 v176, a236
    v_accvgpr_read_b32 v177, a237
    v_accvgpr_read_b32 v178, a238
    v_accvgpr_read_b32 v179, a239
    v_pk_fma_f32 v[172:173], v[18:19], v[128:129], v[172:173] op_sel:[1,0,0] op_sel_hi:[1,1,1]
    v_pk_fma_f32 v[174:175], v[18:19], v[130:131], v[174:175] op_sel:[1,0,0] op_sel_hi:[1,1,1]
    v_pk_fma_f32 v[176:177], v[18:19], v[132:133], v[176:177] op_sel:[1,0,0] op_sel_hi:[1,1,1]
    v_pk_fma_f32 v[178:179], v[18:19], v[134:135], v[178:179] op_sel:[1,0,0] op_sel_hi:[1,1,1]
    v_pk_fma_f32 v[180:181], v[18:19], v[136:137], v[204:205] op_sel:[1,0,0] op_sel_hi:[1,1,1]
    v_pk_fma_f32 v[182:183], v[18:19], v[138:139], v[206:207] op_sel:[1,0,0] op_sel_hi:[1,1,1]
    v_pk_fma_f32 v[184:185], v[18:19], v[140:141], v[236:237] op_sel:[1,0,0] op_sel_hi:[1,1,1]
    v_pk_fma_f32 v[186:187], v[18:19], v[142:143], v[238:239] op_sel:[1,0,0] op_sel_hi:[1,1,1]
    v_pk_mul_f32 v[172:173], v[172:173], v[180:181]
    v_pk_mul_f32 v[174:175], v[174:175], v[182:183]
    v_pk_mul_f32 v[176:177], v[176:177], v[184:185]
    v_pk_mul_f32 v[178:179], v[178:179], v[186:187]
    v_pk_mul_f32 v[172:173], v[172:173], v[26:27] op_sel:[0,1] op_sel_hi:[1,1]
    v_pk_mul_f32 v[174:175], v[174:175], v[26:27] op_sel:[0,1] op_sel_hi:[1,1]
    v_pk_mul_f32 v[176:177], v[176:177], v[26:27] op_sel:[0,1] op_sel_hi:[1,1]
    v_pk_mul_f32 v[178:179], v[178:179], v[26:27] op_sel:[0,1] op_sel_hi:[1,1]
    v_cvt_pk_bf16_f32 v204, v172, v173
    v_cvt_pk_bf16_f32 v205, v174, v175
    v_cvt_pk_bf16_f32 v206, v176, v177
    v_cvt_pk_bf16_f32 v207, v178, v179
    v_accvgpr_read_b32 v172, a208
    v_accvgpr_read_b32 v173, a209
    v_accvgpr_read_b32 v174, a210
    v_accvgpr_read_b32 v175, a211
    v_accvgpr_read_b32 v176, a240
    v_accvgpr_read_b32 v177, a241
    v_accvgpr_read_b32 v178, a242
    v_accvgpr_read_b32 v179, a243
    v_pk_fma_f32 v[172:173], v[20:21], v[128:129], v[172:173] op_sel:[0,0,0] op_sel_hi:[0,1,1]
    v_pk_fma_f32 v[174:175], v[20:21], v[130:131], v[174:175] op_sel:[0,0,0] op_sel_hi:[0,1,1]
    v_pk_fma_f32 v[176:177], v[20:21], v[132:133], v[176:177] op_sel:[0,0,0] op_sel_hi:[0,1,1]
    v_pk_fma_f32 v[178:179], v[20:21], v[134:135], v[178:179] op_sel:[0,0,0] op_sel_hi:[0,1,1]
    v_pk_fma_f32 v[180:181], v[20:21], v[136:137], v[208:209] op_sel:[0,0,0] op_sel_hi:[0,1,1]
    v_pk_fma_f32 v[182:183], v[20:21], v[138:139], v[210:211] op_sel:[0,0,0] op_sel_hi:[0,1,1]
    v_pk_fma_f32 v[184:185], v[20:21], v[140:141], v[240:241] op_sel:[0,0,0] op_sel_hi:[0,1,1]
    v_pk_fma_f32 v[186:187], v[20:21], v[142:143], v[242:243] op_sel:[0,0,0] op_sel_hi:[0,1,1]
    v_pk_mul_f32 v[172:173], v[172:173], v[180:181]
    v_pk_mul_f32 v[174:175], v[174:175], v[182:183]
    v_pk_mul_f32 v[176:177], v[176:177], v[184:185]
    v_pk_mul_f32 v[178:179], v[178:179], v[186:187]
    v_pk_mul_f32 v[172:173], v[172:173], v[28:29] op_sel:[0,0] op_sel_hi:[1,0]
    v_pk_mul_f32 v[174:175], v[174:175], v[28:29] op_sel:[0,0] op_sel_hi:[1,0]
    v_pk_mul_f32 v[176:177], v[176:177], v[28:29] op_sel:[0,0] op_sel_hi:[1,0]
    v_pk_mul_f32 v[178:179], v[178:179], v[28:29] op_sel:[0,0] op_sel_hi:[1,0]
    v_cvt_pk_bf16_f32 v208, v172, v173
    v_cvt_pk_bf16_f32 v209, v174, v175
    v_cvt_pk_bf16_f32 v210, v176, v177
    v_cvt_pk_bf16_f32 v211, v178, v179
    v_accvgpr_read_b32 v172, a212
    v_accvgpr_read_b32 v173, a213
    v_accvgpr_read_b32 v174, a214
    v_accvgpr_read_b32 v175, a215
    v_accvgpr_read_b32 v176, a244
    v_accvgpr_read_b32 v177, a245
    v_accvgpr_read_b32 v178, a246
    v_accvgpr_read_b32 v179, a247
    v_pk_fma_f32 v[172:173], v[20:21], v[128:129], v[172:173] op_sel:[1,0,0] op_sel_hi:[1,1,1]
    v_pk_fma_f32 v[174:175], v[20:21], v[130:131], v[174:175] op_sel:[1,0,0] op_sel_hi:[1,1,1]
    v_pk_fma_f32 v[176:177], v[20:21], v[132:133], v[176:177] op_sel:[1,0,0] op_sel_hi:[1,1,1]
    v_pk_fma_f32 v[178:179], v[20:21], v[134:135], v[178:179] op_sel:[1,0,0] op_sel_hi:[1,1,1]
    v_pk_fma_f32 v[180:181], v[20:21], v[136:137], v[212:213] op_sel:[1,0,0] op_sel_hi:[1,1,1]
    v_pk_fma_f32 v[182:183], v[20:21], v[138:139], v[214:215] op_sel:[1,0,0] op_sel_hi:[1,1,1]
    v_pk_fma_f32 v[184:185], v[20:21], v[140:141], v[244:245] op_sel:[1,0,0] op_sel_hi:[1,1,1]
    v_pk_fma_f32 v[186:187], v[20:21], v[142:143], v[246:247] op_sel:[1,0,0] op_sel_hi:[1,1,1]
    v_pk_mul_f32 v[172:173], v[172:173], v[180:181]
    v_pk_mul_f32 v[174:175], v[174:175], v[182:183]
    v_pk_mul_f32 v[176:177], v[176:177], v[184:185]
    v_pk_mul_f32 v[178:179], v[178:179], v[186:187]
    v_pk_mul_f32 v[172:173], v[172:173], v[28:29] op_sel:[0,1] op_sel_hi:[1,1]
    v_pk_mul_f32 v[174:175], v[174:175], v[28:29] op_sel:[0,1] op_sel_hi:[1,1]
    v_pk_mul_f32 v[176:177], v[176:177], v[28:29] op_sel:[0,1] op_sel_hi:[1,1]
    v_pk_mul_f32 v[178:179], v[178:179], v[28:29] op_sel:[0,1] op_sel_hi:[1,1]
    v_cvt_pk_bf16_f32 v212, v172, v173
    v_cvt_pk_bf16_f32 v213, v174, v175
    v_cvt_pk_bf16_f32 v214, v176, v177
    v_cvt_pk_bf16_f32 v215, v178, v179
    v_accvgpr_read_b32 v172, a216
    v_accvgpr_read_b32 v173, a217
    v_accvgpr_read_b32 v174, a218
    v_accvgpr_read_b32 v175, a219
    v_accvgpr_read_b32 v176, a248
    v_accvgpr_read_b32 v177, a249
    v_accvgpr_read_b32 v178, a250
    v_accvgpr_read_b32 v179, a251
    v_pk_fma_f32 v[172:173], v[22:23], v[128:129], v[172:173] op_sel:[0,0,0] op_sel_hi:[0,1,1]
    v_pk_fma_f32 v[174:175], v[22:23], v[130:131], v[174:175] op_sel:[0,0,0] op_sel_hi:[0,1,1]
    v_pk_fma_f32 v[176:177], v[22:23], v[132:133], v[176:177] op_sel:[0,0,0] op_sel_hi:[0,1,1]
    v_pk_fma_f32 v[178:179], v[22:23], v[134:135], v[178:179] op_sel:[0,0,0] op_sel_hi:[0,1,1]
    v_pk_fma_f32 v[180:181], v[22:23], v[136:137], v[216:217] op_sel:[0,0,0] op_sel_hi:[0,1,1]
    v_pk_fma_f32 v[182:183], v[22:23], v[138:139], v[218:219] op_sel:[0,0,0] op_sel_hi:[0,1,1]
    v_pk_fma_f32 v[184:185], v[22:23], v[140:141], v[248:249] op_sel:[0,0,0] op_sel_hi:[0,1,1]
    v_pk_fma_f32 v[186:187], v[22:23], v[142:143], v[250:251] op_sel:[0,0,0] op_sel_hi:[0,1,1]
    v_pk_mul_f32 v[172:173], v[172:173], v[180:181]
    v_pk_mul_f32 v[174:175], v[174:175], v[182:183]
    v_pk_mul_f32 v[176:177], v[176:177], v[184:185]
    v_pk_mul_f32 v[178:179], v[178:179], v[186:187]
    v_pk_mul_f32 v[172:173], v[172:173], v[30:31] op_sel:[0,0] op_sel_hi:[1,0]
    v_pk_mul_f32 v[174:175], v[174:175], v[30:31] op_sel:[0,0] op_sel_hi:[1,0]
    v_pk_mul_f32 v[176:177], v[176:177], v[30:31] op_sel:[0,0] op_sel_hi:[1,0]
    v_pk_mul_f32 v[178:179], v[178:179], v[30:31] op_sel:[0,0] op_sel_hi:[1,0]
    v_cvt_pk_bf16_f32 v216, v172, v173
    v_cvt_pk_bf16_f32 v217, v174, v175
    v_cvt_pk_bf16_f32 v218, v176, v177
    v_cvt_pk_bf16_f32 v219, v178, v179
    v_accvgpr_read_b32 v172, a220
    v_accvgpr_read_b32 v173, a221
    v_accvgpr_read_b32 v174, a222
    v_accvgpr_read_b32 v175, a223
    v_accvgpr_read_b32 v176, a252
    v_accvgpr_read_b32 v177, a253
    v_accvgpr_read_b32 v178, a254
    v_accvgpr_read_b32 v179, a255
    v_pk_fma_f32 v[172:173], v[22:23], v[128:129], v[172:173] op_sel:[1,0,0] op_sel_hi:[1,1,1]
    v_pk_fma_f32 v[174:175], v[22:23], v[130:131], v[174:175] op_sel:[1,0,0] op_sel_hi:[1,1,1]
    v_pk_fma_f32 v[176:177], v[22:23], v[132:133], v[176:177] op_sel:[1,0,0] op_sel_hi:[1,1,1]
    v_pk_fma_f32 v[178:179], v[22:23], v[134:135], v[178:179] op_sel:[1,0,0] op_sel_hi:[1,1,1]
    v_pk_fma_f32 v[180:181], v[22:23], v[136:137], v[220:221] op_sel:[1,0,0] op_sel_hi:[1,1,1]
    v_pk_fma_f32 v[182:183], v[22:23], v[138:139], v[222:223] op_sel:[1,0,0] op_sel_hi:[1,1,1]
    v_pk_fma_f32 v[184:185], v[22:23], v[140:141], v[252:253] op_sel:[1,0,0] op_sel_hi:[1,1,1]
    v_pk_fma_f32 v[186:187], v[22:23], v[142:143], v[254:255] op_sel:[1,0,0] op_sel_hi:[1,1,1]
    v_pk_mul_f32 v[172:173], v[172:173], v[180:181]
    v_pk_mul_f32 v[174:175], v[174:175], v[182:183]
    v_pk_mul_f32 v[176:177], v[176:177], v[184:185]
    v_pk_mul_f32 v[178:179], v[178:179], v[186:187]
    v_pk_mul_f32 v[172:173], v[172:173], v[30:31] op_sel:[0,1] op_sel_hi:[1,1]
    v_pk_mul_f32 v[174:175], v[174:175], v[30:31] op_sel:[0,1] op_sel_hi:[1,1]
    v_pk_mul_f32 v[176:177], v[176:177], v[30:31] op_sel:[0,1] op_sel_hi:[1,1]
    v_pk_mul_f32 v[178:179], v[178:179], v[30:31] op_sel:[0,1] op_sel_hi:[1,1]
    v_cvt_pk_bf16_f32 v220, v172, v173
    v_cvt_pk_bf16_f32 v221, v174, v175
    v_cvt_pk_bf16_f32 v222, v176, v177
    v_cvt_pk_bf16_f32 v223, v178, v179
    v_accvgpr_read_b32 v172, a64
    v_accvgpr_read_b32 v173, a65
    v_accvgpr_read_b32 v174, a66
    v_accvgpr_read_b32 v175, a67
    v_accvgpr_read_b32 v176, a96
    v_accvgpr_read_b32 v177, a97
    v_accvgpr_read_b32 v178, a98
    v_accvgpr_read_b32 v179, a99
    v_accvgpr_read_b32 v180, a128
    v_accvgpr_read_b32 v181, a129
    v_accvgpr_read_b32 v182, a130
    v_accvgpr_read_b32 v183, a131
    v_accvgpr_read_b32 v184, a160
    v_accvgpr_read_b32 v185, a161
    v_accvgpr_read_b32 v186, a162
    v_accvgpr_read_b32 v187, a163
    v_pk_fma_f32 v[172:173], v[16:17], v[64:65], v[172:173] op_sel:[0,0,0] op_sel_hi:[0,1,1]
    v_pk_fma_f32 v[174:175], v[16:17], v[66:67], v[174:175] op_sel:[0,0,0] op_sel_hi:[0,1,1]
    v_pk_fma_f32 v[176:177], v[16:17], v[68:69], v[176:177] op_sel:[0,0,0] op_sel_hi:[0,1,1]
    v_pk_fma_f32 v[178:179], v[16:17], v[70:71], v[178:179] op_sel:[0,0,0] op_sel_hi:[0,1,1]
    v_pk_fma_f32 v[180:181], v[16:17], v[72:73], v[180:181] op_sel:[0,0,0] op_sel_hi:[0,1,1]
    v_pk_fma_f32 v[182:183], v[16:17], v[74:75], v[182:183] op_sel:[0,0,0] op_sel_hi:[0,1,1]
    v_pk_fma_f32 v[184:185], v[16:17], v[76:77], v[184:185] op_sel:[0,0,0] op_sel_hi:[0,1,1]
    v_pk_fma_f32 v[186:187], v[16:17], v[78:79], v[186:187] op_sel:[0,0,0] op_sel_hi:[0,1,1]
    v_pk_mul_f32 v[172:173], v[172:173], v[180:181]
    v_pk_mul_f32 v[174:175], v[174:175], v[182:183]
    v_pk_mul_f32 v[176:177], v[176:177], v[184:185]
    v_pk_mul_f32 v[178:179], v[178:179], v[186:187]
    v_pk_mul_f32 v[172:173], v[172:173], v[24:25] op_sel:[0,0] op_sel_hi:[1,0]
    v_pk_mul_f32 v[174:175], v[174:175], v[24:25] op_sel:[0,0] op_sel_hi:[1,0]
    v_pk_mul_f32 v[176:177], v[176:177], v[24:25] op_sel:[0,0] op_sel_hi:[1,0]
    v_pk_mul_f32 v[178:179], v[178:179], v[24:25] op_sel:[0,0] op_sel_hi:[1,0]
    v_cvt_pk_bf16_f32 v224, v172, v173
    v_cvt_pk_bf16_f32 v225, v174, v175
    v_cvt_pk_bf16_f32 v226, v176, v177
    v_cvt_pk_bf16_f32 v227, v178, v179
    v_accvgpr_read_b32 v172, a68
    v_accvgpr_read_b32 v173, a69
    v_accvgpr_read_b32 v174, a70
    v_accvgpr_read_b32 v175, a71
    v_accvgpr_read_b32 v176, a100
    v_accvgpr_read_b32 v177, a101
    v_accvgpr_read_b32 v178, a102
    v_accvgpr_read_b32 v179, a103
    v_accvgpr_read_b32 v180, a132
    v_accvgpr_read_b32 v181, a133
    v_accvgpr_read_b32 v182, a134
    v_accvgpr_read_b32 v183, a135
    v_accvgpr_read_b32 v184, a164
    v_accvgpr_read_b32 v185, a165
    v_accvgpr_read_b32 v186, a166
    v_accvgpr_read_b32 v187, a167
    v_pk_fma_f32 v[172:173], v[16:17], v[64:65], v[172:173] op_sel:[1,0,0] op_sel_hi:[1,1,1]
    v_pk_fma_f32 v[174:175], v[16:17], v[66:67], v[174:175] op_sel:[1,0,0] op_sel_hi:[1,1,1]
    v_pk_fma_f32 v[176:177], v[16:17], v[68:69], v[176:177] op_sel:[1,0,0] op_sel_hi:[1,1,1]
    v_pk_fma_f32 v[178:179], v[16:17], v[70:71], v[178:179] op_sel:[1,0,0] op_sel_hi:[1,1,1]
    v_pk_fma_f32 v[180:181], v[16:17], v[72:73], v[180:181] op_sel:[1,0,0] op_sel_hi:[1,1,1]
    v_pk_fma_f32 v[182:183], v[16:17], v[74:75], v[182:183] op_sel:[1,0,0] op_sel_hi:[1,1,1]
    v_pk_fma_f32 v[184:185], v[16:17], v[76:77], v[184:185] op_sel:[1,0,0] op_sel_hi:[1,1,1]
    v_pk_fma_f32 v[186:187], v[16:17], v[78:79], v[186:187] op_sel:[1,0,0] op_sel_hi:[1,1,1]
    v_pk_mul_f32 v[172:173], v[172:173], v[180:181]
    v_pk_mul_f32 v[174:175], v[174:175], v[182:183]
    v_pk_mul_f32 v[176:177], v[176:177], v[184:185]
    v_pk_mul_f32 v[178:179], v[178:179], v[186:187]
    v_pk_mul_f32 v[172:173], v[172:173], v[24:25] op_sel:[0,1] op_sel_hi:[1,1]
    v_pk_mul_f32 v[174:175], v[174:175], v[24:25] op_sel:[0,1] op_sel_hi:[1,1]
    v_pk_mul_f32 v[176:177], v[176:177], v[24:25] op_sel:[0,1] op_sel_hi:[1,1]
    v_pk_mul_f32 v[178:179], v[178:179], v[24:25] op_sel:[0,1] op_sel_hi:[1,1]
    s_cmp_eq_u32 s66, 0
    s_cbranch_scc1 L_lateA
    buffer_load_dword v60, v61, s[32:35], s60 offen sc1
L_lateA:
    v_cvt_pk_bf16_f32 v228, v172, v173
    v_cvt_pk_bf16_f32 v229, v174, v175
    v_cvt_pk_bf16_f32 v230, v176, v177
    v_cvt_pk_bf16_f32 v231, v178, v179
    v_accvgpr_read_b32 v172, a72
    v_accvgpr_read_b32 v173, a73
    v_accvgpr_read_b32 v174, a74
    v_accvgpr_read_b32 v175, a75
    v_accvgpr_read_b32 v176, a104
    v_accvgpr_read_b32 v177, a105
    v_accvgpr_read_b32 v178, a106
    v_accvgpr_read_b32 v179, a107
    v_accvgpr_read_b32 v180, a136
    v_accvgpr_read_b32 v181, a137
    v_accvgpr_read_b32 v182, a138
    v_accvgpr_read_b32 v183, a139
    v_accvgpr_read_b32 v184, a168
    v_accvgpr_read_b32 v185, a169
    v_accvgpr_read_b32 v186, a170
    v_accvgpr_read_b32 v187, a171
    v_pk_fma_f32 v[172:173], v[18:19], v[64:65], v[172:173] op_sel:[0,0,0] op_sel_hi:[0,1,1]
    v_pk_fma_f32 v[174:175], v[18:19], v[66:67], v[174:175] op_sel:[0,0,0] op_sel_hi:[0,1,1]
    v_pk_fma_f32 v[176:177], v[18:19], v[68:69], v[176:177] op_sel:[0,0,0] op_sel_hi:[0,1,1]
    v_pk_fma_f32 v[178:179], v[18:19], v[70:71], v[178:179] op_sel:[0,0,0] op_sel_hi:[0,1,1]
    v_pk_fma_f32 v[180:181], v[18:19], v[72:73], v[180:181] op_sel:[0,0,0] op_sel_hi:[0,1,1]
    v_pk_fma_f32 v[182:183], v[18:19], v[74:75], v[182:183] op_sel:[0,0,0] op_sel_hi:[0,1,1]
    v_pk_fma_f32 v[184:185], v[18:19], v[76:77], v[184:185] op_sel:[0,0,0] op_sel_hi:[0,1,1]
    v_pk_fma_f32 v[186:187], v[18:19], v[78:79], v[186:187] op_sel:[0,0,0] op_sel_hi:[0,1,1]
    v_pk_mul_f32 v[172:173], v[172:173], v[180:181]
    v_pk_mul_f32 v[174:175], v[174:175], v[182:183]
    v_pk_mul_f32 v[176:177], v[176:177], v[184:185]
    v_pk_mul_f32 v[178:179], v[178:179], v[186:187]
    v_pk_mul_f32 v[172:173], v[172:173], v[26:27] op_sel:[0,0] op_sel_hi:[1,0]
    v_pk_mul_f32 v[174:175], v[174:175], v[26:27] op_sel:[0,0] op_sel_hi:[1,0]
    v_pk_mul_f32 v[176:177], v[176:177], v[26:27] op_sel:[0,0] op_sel_hi:[1,0]
    v_pk_mul_f32 v[178:179], v[178:179], v[26:27] op_sel:[0,0] op_sel_hi:[1,0]
    v_cvt_pk_bf16_f32 v232, v172, v173
    v_cvt_pk_bf16_f32 v233, v174, v175
    v_cvt_pk_bf16_f32 v234, v176, v177
    v_cvt_pk_bf16_f32 v235, v178, v179
    v_accvgpr_read_b32 v172, a76
    v_accvgpr_read_b32 v173, a77
    v_accvgpr_read_b32 v174, a78
    v_accvgpr_read_b32 v175, a79
    v_accvgpr_read_b32 v176, a108
    v_accvgpr_read_b32 v177, a109
    v_accvgpr_read_b32 v178, a110
    v_accvgpr_read_b32 v179, a111
    v_accvgpr_read_b32 v180, a140
    v_accvgpr_read_b32 v181, a141
    v_accvgpr_read_b32 v182, a142
    v_accvgpr_read_b32 v183, a143
    v_accvgpr_read_b32 v184, a172
    v_accvgpr_read_b32 v185, a173
    v_accvgpr_read_b32 v186, a174
    v_accvgpr_read_b32 v187, a175
    v_pk_fma_f32 v[172:173], v[18:19], v[64:65], v[172:173] op_sel:[1,0,0] op_sel_hi:[1,1,1]
    v_pk_fma_f32 v[174:175], v[18:19], v[66:67], v[174:175] op_sel:[1,0,0] op_sel_hi:[1,1,1]
    v_pk_fma_f32 v[176:177], v[18:19], v[68:69], v[176:177] op_sel:[1,0,0] op_sel_hi:[1,1,1]
    v_pk_fma_f32 v[178:179], v[18:19], v[70:71], v[178:179] op_sel:[1,0,0] op_sel_hi:[1,1,1]
    v_pk_fma_f32 v[180:181], v[18:19], v[72:73], v[180:181] op_sel:[1,0,0] op_sel_hi:[1,1,1]
    v_pk_fma_f32 v[182:183], v[18:19], v[74:75], v[182:183] op_sel:[1,0,0] op_sel_hi:[1,1,1]
    v_pk_fma_f32 v[184:185], v[18:19], v[76:77], v[184:185] op_sel:[1,0,0] op_sel_hi:[1,1,1]
    v_pk_fma_f32 v[186:187], v[18:19], v[78:79], v[186:187] op_sel:[1,0,0] op_sel_hi:[1,1,1]
    v_pk_mul_f32 v[172:173], v[172:173], v[180:181]
    v_pk_mul_f32 v[174:175], v[174:175], v[182:183]
    v_pk_mul_f32 v[176:177], v[176:177], v[184:185]
    v_pk_mul_f32 v[178:179], v[178:179], v[186:187]
    v_pk_mul_f32 v[172:173], v[172:173], v[26:27] op_sel:[0,1] op_sel_hi:[1,1]
    v_pk_mul_f32 v[174:175], v[174:175], v[26:27] op_sel:[0,1] op_sel_hi:[1,1]
    v_pk_mul_f32 v[176:177], v[176:177], v[26:27] op_sel:[0,1] op_sel_hi:[1,1]
    v_pk_mul_f32 v[178:179], v[178:179], v[26:27] op_sel:[0,1] op_sel_hi:[1,1]
    v_cvt_pk_bf16_f32 v236, v172, v173
    v_cvt_pk_bf16_f32 v237, v174, v175
    v_cvt_pk_bf16_f32 v238, v176, v177
    v_cvt_pk_bf16_f32 v239, v178, v179
    v_accvgpr_read_b32 v172, a80
    v_accvgpr_read_b32 v173, a81
    v_accvgpr_read_b32 v174, a82
    v_accvgpr_read_b32 v175, a83
    v_accvgpr_read_b32 v176, a112
    v_accvgpr_read_b32 v177, a113
    v_accvgpr_read_b32 v178, a114
    v_accvgpr_read_b32 v179, a115
    v_accvgpr_read_b32 v180, a144
    v_accvgpr_read_b32 v181, a145
    v_accvgpr_read_b32 v182, a146
    v_accvgpr_read_b32 v183, a147
    v_accvgpr_read_b32 v184, a176
    v_accvgpr_read_b32 v185, a177
    v_accvgpr_read_b32 v186, a178
    v_accvgpr_read_b32 v187, a179
    v_pk_fma_f32 v[172:173], v[20:21], v[64:65], v[172:173] op_sel:[0,0,0] op_sel_hi:[0,1,1]
    v_pk_fma_f32 v[174:175], v[20:21], v[66:67], v[174:175] op_sel:[0,0,0] op_sel_hi:[0,1,1]
    v_pk_fma_f32 v[176:177], v[20:21], v[68:69], v[176:177] op_sel:[0,0,0] op_sel_hi:[0,1,1]
    v_pk_fma_f32 v[178:179], v[20:21], v[70:71], v[178:179] op_sel:[0,0,0] op_sel_hi:[0,1,1]
    v_pk_fma_f32 v[180:181], v[20:21], v[72:73], v[180:181] op_sel:[0,0,0] op_sel_hi:[0,1,1]
    v_pk_fma_f32 v[182:183], v[20:21], v[74:75], v[182:183] op_sel:[0,0,0] op_sel_hi:[0,1,1]
    v_pk_fma_f32 v[184:185], v[20:21], v[76:77], v[184:185] op_sel:[0,0,0] op_sel_hi:[0,1,1]
    v_pk_fma_f32 v[186:187], v[20:21], v[78:79], v[186:187] op_sel:[0,0,0] op_sel_hi:[0,1,1]
    v_pk_mul_f32 v[172:173], v[172:173], v[180:181]
    v_pk_mul_f32 v[174:175], v[174:175], v[182:183]
    v_pk_mul_f32 v[176:177], v[176:177], v[184:185]
    v_pk_mul_f32 v[178:179], v[178:179], v[186:187]
    v_pk_mul_f32 v[172:173], v[172:173], v[28:29] op_sel:[0,0] op_sel_hi:[1,0]
    v_pk_mul_f32 v[174:175], v[174:175], v[28:29] op_sel:[0,0] op_sel_hi:[1,0]
    v_pk_mul_f32 v[176:177], v[176:177], v[28:29] op_sel:[0,0] op_sel_hi:[1,0]
    v_pk_mul_f32 v[178:179], v[178:179], v[28:29] op_sel:[0,0] op_sel_hi:[1,0]
    v_cvt_pk_bf16_f32 v240, v172, v173
    v_cvt_pk_bf16_f32 v241, v174, v175
    v_cvt_pk_bf16_f32 v242, v176, v177
    v_cvt_pk_bf16_f32 v243, v178, v179
    v_accvgpr_read_b32 v172, a84
    v_accvgpr_read_b32 v173, a85
    v_accvgpr_read_b32 v174, a86
    v_accvgpr_read_b32 v175, a87
    v_accvgpr_read_b32 v176, a116
    v_accvgpr_read_b32 v177, a117
    v_accvgpr_read_b32 v178, a118
    v_accvgpr_read_b32 v179, a119
    v_accvgpr_read_b32 v180, a148
    v_accvgpr_read_b32 v181, a149
    v_accvgpr_read_b32 v182, a150
    v_accvgpr_read_b32 v183, a151
    v_accvgpr_read_b32 v184, a180
    v_accvgpr_read_b32 v185, a181
    v_accvgpr_read_b32 v186, a182
    v_accvgpr_read_b32 v187, a183
    v_pk_fma_f32 v[172:173], v[20:21], v[64:65], v[172:173] op_sel:[1,0,0] op_sel_hi:[1,1,1]
    v_pk_fma_f32 v[174:175], v[20:21], v[66:67], v[174:175] op_sel:[1,0,0] op_sel_hi:[1,1,1]
    v_pk_fma_f32 v[176:177], v[20:21], v[68:69], v[176:177] op_sel:[1,0,0] op_sel_hi:[1,1,1]
    v_pk_fma_f32 v[178:179], v[20:21], v[70:71], v[178:179] op_sel:[1,0,0] op_sel_hi:[1,1,1]
    v_pk_fma_f32 v[180:181], v[20:21], v[72:73], v[180:181] op_sel:[1,0,0] op_sel_hi:[1,1,1]
    v_pk_fma_f32 v[182:183], v[20:21], v[74:75], v[182:183] op_sel:[1,0,0] op_sel_hi:[1,1,1]
    v_pk_fma_f32 v[184:185], v[20:21], v[76:77], v[184:185] op_sel:[1,0,0] op_sel_hi:[1,1,1]
    v_pk_fma_f32 v[186:187], v[20:21], v[78:79], v[186:187] op_sel:[1,0,0] op_sel_hi:[1,1,1]
    v_pk_mul_f32 v[172:173], v[172:173], v[180:181]
    v_pk_mul_f32 v[174:175], v[174:175], v[182:183]
    v_pk_mul_f32 v[176:177], v[176:177], v[184:185]
    v_pk_mul_f32 v[178:179], v[178:179], v[186:187]
    v_pk_mul_f32 v[172:173], v[172:173], v[28:29] op_sel:[0,1] op_sel_hi:[1,1]
    v_pk_mul_f32 v[174:175], v[174:175], v[28:29] op_sel:[0,1] op_sel_hi:[1,1]
    v_pk_mul_f32 v[176:177], v[176:177], v[28:29] op_sel:[0,1] op_sel_hi:[1,1]
    v_pk_mul_f32 v[178:179], v[178:179], v[28:29] op_sel:[0,1] op_sel_hi:[1,1]
    v_cvt_pk_bf16_f32 v244, v172, v173
    v_cvt_pk_bf16_f32 v245, v174, v175
    v_cvt_pk_bf16_f32 v246, v176, v177
    v_cvt_pk_bf16_f32 v247, v178, v179
    v_accvgpr_read_b32 v172, a88
    v_accvgpr_read_b32 v173, a89
    v_accvgpr_read_b32 v174, a90
    v_accvgpr_read_b32 v175, a91
    v_accvgpr_read_b32 v176, a120
    v_accvgpr_read_b32 v177, a121
    v_accvgpr_read_b32 v178, a122
    v_accvgpr_read_b32 v179, a123
    v_accvgpr_read_b32 v180, a152
    v_accvgpr_read_b32 v181, a153
    v_accvgpr_read_b32 v182, a154
    v_accvgpr_read_b32 v183, a155
    v_accvgpr_read_b32 v184, a184
    v_accvgpr_read_b32 v185, a185
    v_accvgpr_read_b32 v186, a186
    v_accvgpr_read_b32 v187, a187
    v_pk_fma_f32 v[172:173], v[22:23], v[64:65], v[172:173] op_sel:[0,0,0] op_sel_hi:[0,1,1]
    v_pk_fma_f32 v[174:175], v[22:23], v[66:67], v[174:175] op_sel:[0,0,0] op_sel_hi:[0,1,1]
    v_pk_fma_f32 v[176:177], v[22:23], v[68:69], v[176:177] op_sel:[0,0,0] op_sel_hi:[0,1,1]
    v_pk_fma_f32 v[178:179], v[22:23], v[70:71], v[178:179] op_sel:[0,0,0] op_sel_hi:[0,1,1]
    v_pk_fma_f32 v[180:181], v[22:23], v[72:73], v[180:181] op_sel:[0,0,0] op_sel_hi:[0,1,1]
    v_pk_fma_f32 v[182:183], v[22:23], v[74:75], v[182:183] op_sel:[0,0,0] op_sel_hi:[0,1,1]
    v_pk_fma_f32 v[184:185], v[22:23], v[76:77], v[184:185] op_sel:[0,0,0] op_sel_hi:[0,1,1]
    v_pk_fma_f32 v[186:187], v[22:23], v[78:79], v[186:187] op_sel:[0,0,0] op_sel_hi:[0,1,1]
    v_pk_mul_f32 v[172:173], v[172:173], v[180:181]
    v_pk_mul_f32 v[174:175], v[174:175], v[182:183]
    v_pk_mul_f32 v[176:177], v[176:177], v[184:185]
    v_pk_mul_f32 v[178:179], v[178:179], v[186:187]
    v_pk_mul_f32 v[172:173], v[172:173], v[30:31] op_sel:[0,0] op_sel_hi:[1,0]
    v_pk_mul_f32 v[174:175], v[174:175], v[30:31] op_sel:[0,0] op_sel_hi:[1,0]
    v_pk_mul_f32 v[176:177], v[176:177], v[30:31] op_sel:[0,0] op_sel_hi:[1,0]
    v_pk_mul_f32 v[178:179], v[178:179], v[30:31] op_sel:[0,0] op_sel_hi:[1,0]
    v_cvt_pk_bf16_f32 v248, v172, v173
    v_cvt_pk_bf16_f32 v249, v174, v175
    v_cvt_pk_bf16_f32 v250, v176, v177
    v_cvt_pk_bf16_f32 v251, v178, v179
    v_accvgpr_read_b32 v172, a92
    v_accvgpr_read_b32 v173, a93
    v_accvgpr_read_b32 v174, a94
    v_accvgpr_read_b32 v175, a95
    v_accvgpr_read_b32 v176, a124
    v_accvgpr_read_b32 v177, a125
    v_accvgpr_read_b32 v178, a126
    v_accvgpr_read_b32 v179, a127
    v_accvgpr_read_b32 v180, a156
    v_accvgpr_read_b32 v181, a157
    v_accvgpr_read_b32 v182, a158
    v_accvgpr_read_b32 v183, a159
    v_accvgpr_read_b32 v184, a188
    v_accvgpr_read_b32 v185, a189
    v_accvgpr_read_b32 v186, a190
    v_accvgpr_read_b32 v187, a191
    v_pk_fma_f32 v[172:173], v[22:23], v[64:65], v[172:173] op_sel:[1,0,0] op_sel_hi:[1,1,1]
    v_pk_fma_f32 v[174:175], v[22:23], v[66:67], v[174:175] op_sel:[1,0,0] op_sel_hi:[1,1,1]
    v_pk_fma_f32 v[176:177], v[22:23], v[68:69], v[176:177] op_sel:[1,0,0] op_sel_hi:[1,1,1]
    v_pk_fma_f32 v[178:179], v[22:23], v[70:71], v[178:179] op_sel:[1,0,0] op_sel_hi:[1,1,1]
    v_pk_fma_f32 v[180:181], v[22:23], v[72:73], v[180:181] op_sel:[1,0,0] op_sel_hi:[1,1,1]
    v_pk_fma_f32 v[182:183], v[22:23], v[74:75], v[182:183] op_sel:[1,0,0] op_sel_hi:[1,1,1]
    v_pk_fma_f32 v[184:185], v[22:23], v[76:77], v[184:185] op_sel:[1,0,0] op_sel_hi:[1,1,1]
    v_pk_fma_f32 v[186:187], v[22:23], v[78:79], v[186:187] op_sel:[1,0,0] op_sel_hi:[1,1,1]
    v_pk_mul_f32 v[172:173], v[172:173], v[180:181]
    v_pk_mul_f32 v[174:175], v[174:175], v[182:183]
    v_pk_mul_f32 v[176:177], v[176:177], v[184:185]
    v_pk_mul_f32 v[178:179], v[178:179], v[186:187]
    v_pk_mul_f32 v[172:173], v[172:173], v[30:31] op_sel:[0,1] op_sel_hi:[1,1]
    v_pk_mul_f32 v[174:175], v[174:175], v[30:31] op_sel:[0,1] op_sel_hi:[1,1]
    v_pk_mul_f32 v[176:177], v[176:177], v[30:31] op_sel:[0,1] op_sel_hi:[1,1]
    v_pk_mul_f32 v[178:179], v[178:179], v[30:31] op_sel:[0,1] op_sel_hi:[1,1]
    v_cvt_pk_bf16_f32 v252, v172, v173
    v_cvt_pk_bf16_f32 v253, v174, v175
    v_cvt_pk_bf16_f32 v254, v176, v177
    v_cvt_pk_bf16_f32 v255, v178, v179
    s_branch L_p2
L_g1_spinA:
    s_mov_b32 s85, 0
L_g1_spA:
    buffer_load_dword v13, off, s[68:71], 0 sc1
    s_add_u32 s85, s85, 1
    s_cmp_gt_u32 s85, 400000
    s_cbranch_scc1 L_g1_goA
    s_waitcnt vmcnt(0)
    v_readfirstlane_b32 s84, v13
    s_cmp_lt_u32 s84, 256
    s_cbranch_scc1 L_g1_spA
    s_branch L_g1_goA
L_g1_eA:
L_g1_B:
    s_getpc_b64 s[84:85]
L_pc1:
    v_bfe_u32 v163, v0, 2, 3
    v_lshlrev_b32 v163, 7, v163
    v_add_u32_e64 v163, s82, v163
    v_cmp_gt_u32_e64 vcc, 32, v0
    v_min_u32 v62, L_g1_eB-L_g1_tB-4, v163
    v_add_u32 v62, L_g1_tB-L_pc1, v62
    v_min_u32 v163, L_p2_end-L_p2-4, v163
    v_add_u32 v163, L_p2-L_pc1, v163
    v_cndmask_b32 v163, v163, v62, vcc
    v_mov_b32_e64 v63, s85
    v_add_co_u32 v62, vcc, s84, v163
    s_nop 1
    v_addc_co_u32 v63, vcc, 0, v63, vcc
    s_load_dwordx2 s[84:85], s[0:1], 56
    s_waitcnt vmcnt(6)
    s_barrier
    ds_read_b64_tr_b16 v[128:129], v4 offset:0
    ds_read_b64_tr_b16 v[130:131], v4 offset:512
    ds_read_b64_tr_b16 v[136:137], v58 offset:0
    ds_read_b64_tr_b16 v[138:139], v58 offset:512
    ds_read_b128 v[64:67], v2 offset:0
    ds_read_b128 v[68:71], v3 offset:0
    ds_read_b128 v[72:75], v2 offset:2048
    ds_read_b128 v[76:79], v3 offset:2048
    ds_read_b128 v[80:83], v2 offset:4096
    ds_read_b128 v[84:87], v3 offset:4096
    ds_read_b128 v[88:91], v2 offset:6144
    ds_read_b128 v[92:95], v3 offset:6144
    ds_read_b128 v[96:99], v2 offset:8192
    ds_read_b128 v[100:103], v3 offset:8192
    ds_read_b128 v[104:107], v2 offset:10240
    ds_read_b128 v[108:111], v3 offset:10240
    ds_read_b128 v[112:115], v2 offset:12288
    ds_read_b128 v[116:119], v3 offset:12288
    ds_read_b128 v[120:123], v2 offset:14336
    ds_read_b128 v[124:127], v3 offset:14336
    ds_read_b64_tr_b16 v[132:133], v5 offset:0
    ds_read_b64_tr_b16 v[134:135], v5 offset:512
    ds_read_b64_tr_b16 v[140:141], v59 offset:0
    s_nop 0
    ds_read_b64_tr_b16 v[142:143], v59 offset:512
    s_waitcnt lgkmcnt(15)
    v_mfma_f32_16x16x32_bf16 a[0:3], v[128:131], v[64:67], 0
    ds_read_b64_tr_b16 v[144:145], v4 offset:8192
    v_mfma_f32_16x16x32_bf16 a[0:3], v[136:139], v[68:71], a[0:3]
    s_add_u32 m0, s47, 106496
    v_mfma_f32_16x16x32_bf16 a[4:7], v[128:131], v[72:75], 0
    buffer_load_dwordx4 v9, s[12:15], 0 offen nt lds
    v_mfma_f32_16x16x32_bf16 a[4:7], v[136:139], v[76:79], a[4:7]
    v_mfma_f32_16x16x32_bf16 a[8:11], v[128:131], v[80:83], 0
    ds_read_b64_tr_b16 v[146:147], v4 offset:8704
    s_waitcnt lgkmcnt(15)
    v_mfma_f32_16x16x32_bf16 a[8:11], v[136:139], v[84:87], a[8:11]
    s_add_u32 m0, s47, 110592
    s_nop 0
    v_mfma_f32_16x16x32_bf16 a[12:15], v[128:131], v[88:91], 0
    buffer_load_dwordx4 v9, s[12:15], s43 offen nt lds
    s_waitcnt lgkmcnt(14)
    v_mfma_f32_16x16x32_bf16 a[12:15], v[136:139], v[92:95], a[12:15]
    s_waitcnt lgkmcnt(4)
    v_smfmac_f32_16x16x64_bf16 v[36:39], v[32:35], v[128:135], v56
    v_mfma_f32_16x16x32_bf16 a[16:19], v[128:131], v[96:99], 0
    ds_read_b64_tr_b16 v[152:153], v58 offset:8192
    v_mfma_f32_16x16x32_bf16 a[16:19], v[136:139], v[100:103], a[16:19]
    s_add_u32 m0, s47, 114688
    v_mfma_f32_16x16x32_bf16 a[20:23], v[128:131], v[104:107], 0
    buffer_load_dwordx4 v15, s[16:19], 0 offen nt lds
    v_mfma_f32_16x16x32_bf16 a[20:23], v[136:139], v[108:111], a[20:23]
    v_mfma_f32_16x16x32_bf16 a[24:27], v[128:131], v[112:115], 0
    ds_read_b64_tr_b16 v[154:155], v58 offset:8704
    v_mfma_f32_16x16x32_bf16 a[24:27], v[136:139], v[116:119], a[24:27]
    s_add_u32 m0, s47, 118784
    v_mfma_f32_16x16x32_bf16 a[28:31], v[128:131], v[120:123], 0
    buffer_load_dwordx4 v15, s[16:19], s59 offen nt lds
    v_mfma_f32_16x16x32_bf16 a[28:31], v[136:139], v[124:127], a[28:31]
    v_mfma_f32_16x16x32_bf16 a[32:35], v[132:135], v[64:67], 0
    ds_read_b64_tr_b16 v[148:149], v5 offset:8192
    s_waitcnt lgkmcnt(5)
    v_mfma_f32_16x16x32_bf16 a[32:35], v[140:143], v[68:71], a[32:35]
    s_add_u32 m0, s47, 122880
    s_nop 0
    v_mfma_f32_16x16x32_bf16 a[36:39], v[132:135], v[72:75], 0
    buffer_load_dwordx4 v15, s[20:23], 0 offen nt lds
    v_mfma_f32_16x16x32_bf16 a[36:39], v[140:143], v[76:79], a[36:39]
    v_mfma_f32_16x16x32_bf16 a[40:43], v[132:135], v[80:83], 0
    ds_read_b64_tr_b16 v[150:151], v5 offset:8704
    v_mfma_f32_16x16x32_bf16 a[40:43], v[140:143], v[84:87], a[40:43]
    s_add_u32 m0, s47, 126976
    v_mfma_f32_16x16x32_bf16 a[44:47], v[132:135], v[88:91], 0
    buffer_load_dwordx4 v15, s[20:23], s59 offen nt lds
    v_mfma_f32_16x16x32_bf16 a[44:47], v[140:143], v[92:95], a[44:47]
    v_mfma_f32_16x16x32_bf16 a[48:51], v[132:135], v[96:99], 0
    ds_read_b64_tr_b16 v[156:157], v59 offset:8192
    v_mfma_f32_16x16x32_bf16 a[48:51], v[140:143], v[100:103], a[48:51]
    s_add_u32 m0, s47, 131072
    v_mfma_f32_16x16x32_bf16 a[52:55], v[132:135], v[104:107], 0
    buffer_load_dwordx4 v10, s[24:27], 0 offen nt lds
    s_waitcnt vmcnt(7)
    s_barrier
    v_mfma_f32_16x16x32_bf16 a[52:55], v[140:143], v[108:111], a[52:55]
    v_mfma_f32_16x16x32_bf16 a[56:59], v[132:135], v[112:115], 0
    ds_read_b64_tr_b16 v[158:159], v59 offset:8704
    v_mfma_f32_16x16x32_bf16 a[56:59], v[140:143], v[116:119], a[56:59]
    s_add_u32 m0, s47, 135168
    v_mfma_f32_16x16x32_bf16 a[60:63], v[132:135], v[120:123], 0
    buffer_load_dwordx4 v10, s[24:27], s44 offen nt lds
    v_mfma_f32_16x16x32_bf16 a[60:63], v[140:143], v[124:127], a[60:63]
    s_waitcnt lgkmcnt(6)
    v_mfma_f32_16x16x32_bf16 v[192:195], v[64:67], v[144:147], 0
    ds_read_b64_tr_b16 v[128:129], v4 offset:16384
    s_waitcnt lgkmcnt(5)
    v_mfma_f32_16x16x32_bf16 v[192:195], v[68:71], v[152:155], v[192:195]
    s_add_u32 m0, s47, 139264
    v_mfma_f32_16x16x32_bf16 v[196:199], v[72:75], v[144:147], 0
    buffer_load_dwordx4 v10, s[28:31], 0 offen nt lds
    v_mfma_f32_16x16x32_bf16 v[196:199], v[76:79], v[152:155], v[196:199]
    v_mfma_f32_16x16x32_bf16 v[200:203], v[80:83], v[144:147], 0
    ds_read_b64_tr_b16 v[130:131], v4 offset:16896
    v_mfma_f32_16x16x32_bf16 v[200:203], v[84:87], v[152:155], v[200:203]
    s_add_u32 m0, s47, 143360
    v_mfma_f32_16x16x32_bf16 v[204:207], v[88:91], v[144:147], 0
    buffer_load_dwordx4 v10, s[28:31], s44 offen nt lds
    v_mfma_f32_16x16x32_bf16 v[204:207], v[92:95], v[152:155], v[204:207]
    s_waitcnt lgkmcnt(4)
    v_smfmac_f32_16x16x64_bf16 v[40:43], v[32:35], v[144:151], v56
    v_mfma_f32_16x16x32_bf16 v[208:211], v[96:99], v[144:147], 0
    s_nop 0
    ds_read_b64_tr_b16 v[136:137], v58 offset:16384
    v_mfma_f32_16x16x32_bf16 v[208:211], v[100:103], v[152:155], v[208:211]
    s_add_u32 m0, s47, 32768
    v_mfma_f32_16x16x32_bf16 v[212:215], v[104:107], v[144:147], 0
    buffer_load_dwordx4 v8, s[8:11], 0 offen  lds
    v_mfma_f32_16x16x32_bf16 v[212:215], v[108:111], v[152:155], v[212:215]
    v_mfma_f32_16x16x32_bf16 v[216:219], v[112:115], v[144:147], 0
    ds_read_b64_tr_b16 v[138:139], v58 offset:16896
    v_mfma_f32_16x16x32_bf16 v[216:219], v[116:119], v[152:155], v[216:219]
    s_add_u32 m0, s47, 36864
    v_mfma_f32_16x16x32_bf16 v[220:223], v[120:123], v[144:147], 0
    buffer_load_dwordx4 v8, s[8:11], s36 offen  lds
    v_mfma_f32_16x16x32_bf16 v[220:223], v[124:127], v[152:155], v[220:223]
    v_mfma_f32_16x16x32_bf16 v[224:227], v[64:67], v[148:151], 0
    ds_read_b64_tr_b16 v[132:133], v5 offset:16384
    s_waitcnt lgkmcnt(5)
    s_nop 0
    v_mfma_f32_16x16x32_bf16 v[224:227], v[68:71], v[156:159], v[224:227]
    s_add_u32 m0, s47, 40960
    v_mfma_f32_16x16x32_bf16 v[228:231], v[72:75], v[148:151], 0
    buffer_load_dwordx4 v8, s[8:11], s37 offen  lds
    v_mfma_f32_16x16x32_bf16 v[228:231], v[76:79], v[156:159], v[228:231]
    v_mfma_f32_16x16x32_bf16 v[232:235], v[80:83], v[148:151], 0
    ds_read_b64_tr_b16 v[134:135], v5 offset:16896
    v_mfma_f32_16x16x32_bf16 v[232:235], v[84:87], v[156:159], v[232:235]
    s_add_u32 m0, s47, 45056
    v_mfma_f32_16x16x32_bf16 v[236:239], v[88:91], v[148:151], 0
    buffer_load_dwordx4 v8, s[8:11], s38 offen  lds
    v_mfma_f32_16x16x32_bf16 v[236:239], v[92:95], v[156:159], v[236:239]
    v_mfma_f32_16x16x32_bf16 v[240:243], v[96:99], v[148:151], 0
    ds_read_b64_tr_b16 v[140:141], v59 offset:16384
    v_mfma_f32_16x16x32_bf16 v[240:243], v[100:103], v[156:159], v[240:243]
    s_add_u32 m0, s47, 49152
    v_mfma_f32_16x16x32_bf16 v[244:247], v[104:107], v[148:151], 0
    buffer_load_dwordx4 v8, s[8:11], s39 offen  lds
    v_mfma_f32_16x16x32_bf16 v[244:247], v[108:111], v[156:159], v[244:247]
    v_mfma_f32_16x16x32_bf16 v[248:251], v[112:115], v[148:151], 0
    ds_read_b64_tr_b16 v[142:143], v59 offset:16896
    v_mfma_f32_16x16x32_bf16 v[248:251], v[116:119], v[156:159], v[248:251]
    s_add_u32 m0, s47, 53248
    v_mfma_f32_16x16x32_bf16 v[252:255], v[120:123], v[148:151], 0
    buffer_load_dwordx4 v8, s[8:11], s40 offen  lds
    v_mfma_f32_16x16x32_bf16 v[252:255], v[124:127], v[156:159], v[252:255]
    s_waitcnt lgkmcnt(6)
    v_mfma_f32_16x16x32_bf16 a[64:67], v[64:67], v[128:131], 0
    ds_read_b64_tr_b16 v[144:145], v4 offset:24576
    s_waitcnt lgkmcnt(5)
    v_mfma_f32_16x16x32_bf16 a[64:67], v[68:71], v[136:139], a[64:67]
    s_add_u32 m0, s47, 57344
    v_mfma_f32_16x16x32_bf16 a[68:71], v[72:75], v[128:131], 0
    buffer_load_dwordx4 v8, s[8:11], s41 offen  lds
    v_mfma_f32_16x16x32_bf16 a[68:71], v[76:79], v[136:139], a[68:71]
    v_mfma_f32_16x16x32_bf16 a[72:75], v[80:83], v[128:131], 0
    ds_read_b64_tr_b16 v[146:147], v4 offset:25088
    v_mfma_f32_16x16x32_bf16 a[72:75], v[84:87], v[136:139], a[72:75]
    s_add_u32 m0, s47, 61440
    v_mfma_f32_16x16x32_bf16 a[76:79], v[88:91], v[128:131], 0
    buffer_load_dwordx4 v8, s[8:11], s42 offen  lds
    v_mfma_f32_16x16x32_bf16 a[76:79], v[92:95], v[136:139], a[76:79]
    s_waitcnt lgkmcnt(4)
    v_smfmac_f32_16x16x64_bf16 v[44:47], v[32:35], v[128:135], v56
    v_mfma_f32_16x16x32_bf16 a[80:83], v[96:99], v[128:131], 0
    ds_read_b64_tr_b16 v[152:153], v58 offset:24576
    s_nop 0
    v_mfma_f32_16x16x32_bf16 a[80:83], v[100:103], v[136:139], a[80:83]
    buffer_load_dword v57, v12, s[4:7], 0 offen
    v_mfma_f32_16x16x32_bf16 a[84:87], v[104:107], v[128:131], 0
    s_add_u32 s101, s45, 2
    s_and_b32 s101, s101, 15
    s_cselect_b32 s100, 1, -15
    s_mul_i32 s101, s100, s49
    v_add_u32_e64 v12, s101, v12
    v_mfma_f32_16x16x32_bf16 a[84:87], v[108:111], v[136:139], a[84:87]
    buffer_store_dword v161, v160, s[32:35], s46 offen sc1
    v_mfma_f32_16x16x32_bf16 a[88:91], v[112:115], v[128:131], 0
    ds_read_b64_tr_b16 v[154:155], v58 offset:25088
    v_mfma_f32_16x16x32_bf16 a[88:91], v[116:119], v[136:139], a[88:91]
    buffer_store_dword v161, v160, s[32:35], s83 offen sc1
    v_mfma_f32_16x16x32_bf16 a[92:95], v[120:123], v[128:131], 0
    buffer_store_dword v161, v160, s[32:35], s3 offen sc1
    v_mfma_f32_16x16x32_bf16 a[92:95], v[124:127], v[136:139], a[92:95]
    v_mfma_f32_16x16x32_bf16 a[96:99], v[64:67], v[132:135], 0
    ds_read_b64_tr_b16 v[148:149], v5 offset:24576
    s_waitcnt lgkmcnt(5)
    v_mfma_f32_16x16x32_bf16 a[96:99], v[68:71], v[140:143], a[96:99]
    s_nop 0
    v_mfma_f32_16x16x32_bf16 a[100:103], v[72:75], v[132:135], 0
    v_mfma_f32_16x16x32_bf16 a[100:103], v[76:79], v[140:143], a[100:103]
    v_mfma_f32_16x16x32_bf16 a[104:107], v[80:83], v[132:135], 0
    ds_read_b64_tr_b16 v[150:151], v5 offset:25088
    v_mfma_f32_16x16x32_bf16 a[104:107], v[84:87], v[140:143], a[104:107]
    v_mfma_f32_16x16x32_bf16 a[108:111], v[88:91], v[132:135], 0
    v_mfma_f32_16x16x32_bf16 a[108:111], v[92:95], v[140:143], a[108:111]
    v_mfma_f32_16x16x32_bf16 a[112:115], v[96:99], v[132:135], 0
    ds_read_b64_tr_b16 v[156:157], v59 offset:24576
    v_mfma_f32_16x16x32_bf16 a[112:115], v[100:103], v[140:143], a[112:115]
    v_mfma_f32_16x16x32_bf16 a[116:119], v[104:107], v[132:135], 0
    v_mfma_f32_16x16x32_bf16 a[116:119], v[108:111], v[140:143], a[116:119]
    v_mfma_f32_16x16x32_bf16 a[120:123], v[112:115], v[132:135], 0
    ds_read_b64_tr_b16 v[158:159], v59 offset:25088
    v_mfma_f32_16x16x32_bf16 a[120:123], v[116:119], v[140:143], a[120:123]
    v_mfma_f32_16x16x32_bf16 a[124:127], v[120:123], v[132:135], 0
    v_mfma_f32_16x16x32_bf16 a[124:127], v[124:127], v[140:143], a[124:127]
    s_waitcnt lgkmcnt(6)
    v_mfma_f32_16x16x32_bf16 a[128:131], v[144:147], v[64:67], 0
    ds_read_b64_tr_b16 v[128:129], v4 offset:32768
    s_waitcnt lgkmcnt(5)
    v_mfma_f32_16x16x32_bf16 a[128:131], v[152:155], v[68:71], a[128:131]
    s_add_u32 s45, s45, 1
    v_mfma_f32_16x16x32_bf16 a[132:135], v[144:147], v[72:75], 0
    s_nop 0
    v_mfma_f32_16x16x32_bf16 a[132:135], v[152:155], v[76:79], a[132:135]
    s_and_b32 s45, s45, 15
    s_cselect_b32 s100, 1, -15
    v_mfma_f32_16x16x32_bf16 a[136:139], v[144:147], v[80:83], 0
    ds_read_b64_tr_b16 v[130:131], v4 offset:33280
    v_mfma_f32_16x16x32_bf16 a[136:139], v[152:155], v[84:87], a[136:139]
    s_mul_i32 s101, s100, 0x80
    v_mfma_f32_16x16x32_bf16 a[140:143], v[144:147], v[88:91], 0
    v_mfma_f32_16x16x32_bf16 a[140:143], v[152:155], v[92:95], a[140:143]
    s_waitcnt lgkmcnt(4)
    s_nop 0
    v_smfmac_f32_16x16x64_bf16 v[48:51], v[32:35], v[144:151], v56
    v_mfma_f32_16x16x32_bf16 a[144:147], v[144:147], v[96:99], 0
    ds_read_b64_tr_b16 v[136:137], v58 offset:32768
    v_mfma_f32_16x16x32_bf16 a[144:147], v[152:155], v[100:103], a[144:147]
    v_add_u32_e64 v8, s101, v8
    v_mfma_f32_16x16x32_bf16 a[148:151], v[144:147], v[104:107], 0
    v_mfma_f32_16x16x32_bf16 a[148:151], v[152:155], v[108:111], a[148:151]
    s_mul_i32 s101, s100, 393216
    v_mfma_f32_16x16x32_bf16 a[152:155], v[144:147], v[112:115], 0
    ds_read_b64_tr_b16 v[138:139], v58 offset:33280
    v_mfma_f32_16x16x32_bf16 a[152:155], v[152:155], v[116:119], a[152:155]
    v_add_u32_e64 v9, s101, v9
    v_mfma_f32_16x16x32_bf16 a[156:159], v[144:147], v[120:123], 0
    v_mfma_f32_16x16x32_bf16 a[156:159], v[152:155], v[124:127], a[156:159]
    s_mul_i32 s101, s100, 458752
    v_mfma_f32_16x16x32_bf16 a[160:163], v[148:151], v[64:67], 0
    ds_read_b64_tr_b16 v[132:133], v5 offset:32768
    s_waitcnt lgkmcnt(5)
    v_mfma_f32_16x16x32_bf16 a[160:163], v[156:159], v[68:71], a[160:163]
    ds_read_b64_tr_b16 v[134:135], v5 offset:33280
    v_add_u32 v10, s101, v10
    v_mfma_f32_16x16x32_bf16 a[164:167], v[148:151], v[72:75], 0
    ds_read_b64_tr_b16 v[140:141], v59 offset:32768
    v_mfma_f32_16x16x32_bf16 a[164:167], v[156:159], v[76:79], a[164:167]
    s_nop 0
    ds_read_b64_tr_b16 v[142:143], v59 offset:33280
    s_mul_i32 s101, s100, s79
    v_mfma_f32_16x16x32_bf16 a[168:171], v[148:151], v[80:83], 0
    v_mfma_f32_16x16x32_bf16 a[168:171], v[156:159], v[84:87], a[168:171]
    v_add_u32_e64 v15, s101, v15
    v_mfma_f32_16x16x32_bf16 a[172:175], v[148:151], v[88:91], 0
    v_mfma_f32_16x16x32_bf16 a[172:175], v[156:159], v[92:95], a[172:175]
    v_mfma_f32_16x16x32_bf16 a[176:179], v[148:151], v[96:99], 0
    v_mfma_f32_16x16x32_bf16 a[176:179], v[156:159], v[100:103], a[176:179]
    v_mfma_f32_16x16x32_bf16 a[180:183], v[148:151], v[104:107], 0
    v_mfma_f32_16x16x32_bf16 a[180:183], v[156:159], v[108:111], a[180:183]
    v_mfma_f32_16x16x32_bf16 a[184:187], v[148:151], v[112:115], 0
    v_mfma_f32_16x16x32_bf16 a[184:187], v[156:159], v[116:119], a[184:187]
    v_mfma_f32_16x16x32_bf16 a[188:191], v[148:151], v[120:123], 0
    v_mfma_f32_16x16x32_bf16 a[188:191], v[156:159], v[124:127], a[188:191]
    s_waitcnt vmcnt(4) lgkmcnt(0)
    s_barrier
    v_mfma_f32_16x16x32_bf16 a[192:195], v[128:131], v[64:67], 0
    buffer_load_dwordx4 v[20:23], v162, s[8:11], 0 offen offset:512
    buffer_load_dwordx4 v[16:19], v162, s[8:11], 0 offen offset:0
    s_add_u32 m0, s47, 65536
    ds_read_b64_tr_b16 v[144:145], v6 offset:0
    v_mfma_f32_16x16x32_bf16 a[192:195], v[136:139], v[68:71], a[192:195]
    buffer_load_dwordx4 v[28:31], v162, s[8:11], 0 offen offset:1536
    buffer_load_dwordx4 v[24:27], v162, s[8:11], 0 offen offset:1024
    buffer_load_dwordx4 v9, s[12:15], 0 offen nt lds
    v_mfma_f32_16x16x32_bf16 a[196:199], v[128:131], v[72:75], 0
    ds_read_b64_tr_b16 v[146:147], v6 offset:512
    v_mfma_f32_16x16x32_bf16 a[196:199], v[136:139], v[76:79], a[196:199]
    v_mfma_f32_16x16x32_bf16 a[200:203], v[128:131], v[80:83], 0
    s_add_u32 m0, s47, 69632
    ds_read_b64_tr_b16 v[152:153], v60 offset:0
    v_mfma_f32_16x16x32_bf16 a[200:203], v[136:139], v[84:87], a[200:203]
    buffer_load_dwordx4 v9, s[12:15], s43 offen nt lds
    v_mfma_f32_16x16x32_bf16 a[204:207], v[128:131], v[88:91], 0
    ds_read_b64_tr_b16 v[154:155], v60 offset:512
    v_mfma_f32_16x16x32_bf16 a[204:207], v[136:139], v[92:95], a[204:207]
    v_smfmac_f32_16x16x64_bf16 v[52:55], v[32:35], v[128:135], v56
    v_mfma_f32_16x16x32_bf16 a[208:211], v[128:131], v[96:99], 0
    s_add_u32 m0, s47, 73728
    ds_read_b64_tr_b16 v[148:149], v7 offset:0
    v_mfma_f32_16x16x32_bf16 a[208:211], v[136:139], v[100:103], a[208:211]
    buffer_load_dwordx4 v15, s[16:19], 0 offen nt lds
    v_mfma_f32_16x16x32_bf16 a[212:215], v[128:131], v[104:107], 0
    ds_read_b64_tr_b16 v[150:151], v7 offset:512
    v_mfma_f32_16x16x32_bf16 a[212:215], v[136:139], v[108:111], a[212:215]
    v_mfma_f32_16x16x32_bf16 a[216:219], v[128:131], v[112:115], 0
    s_add_u32 m0, s47, 77824
    ds_read_b64_tr_b16 v[156:157], v61 offset:0
    v_mfma_f32_16x16x32_bf16 a[216:219], v[136:139], v[116:119], a[216:219]
    buffer_load_dwordx4 v15, s[16:19], s59 offen nt lds
    v_mfma_f32_16x16x32_bf16 a[220:223], v[128:131], v[120:123], 0
    ds_read_b64_tr_b16 v[158:159], v61 offset:512
    v_mfma_f32_16x16x32_bf16 a[220:223], v[136:139], v[124:127], a[220:223]
    v_mfma_f32_16x16x32_bf16 a[224:227], v[132:135], v[64:67], 0
    ds_read_b128 v[64:67], v2 offset:32768
    v_mfma_f32_16x16x32_bf16 a[224:227], v[140:143], v[68:71], a[224:227]
    ds_read_b128 v[68:71], v3 offset:32768
    v_mfma_f32_16x16x32_bf16 a[228:231], v[132:135], v[72:75], 0
    ds_read_b128 v[72:75], v2 offset:34816
    v_mfma_f32_16x16x32_bf16 a[228:231], v[140:143], v[76:79], a[228:231]
    ds_read_b128 v[76:79], v3 offset:34816
    v_mfma_f32_16x16x32_bf16 a[232:235], v[132:135], v[80:83], 0
    ds_read_b128 v[80:83], v2 offset:36864
    v_mfma_f32_16x16x32_bf16 a[232:235], v[140:143], v[84:87], a[232:235]
    ds_read_b128 v[84:87], v3 offset:36864
    v_mfma_f32_16x16x32_bf16 a[236:239], v[132:135], v[88:91], 0
    ds_read_b128 v[88:91], v2 offset:38912
    v_mfma_f32_16x16x32_bf16 a[236:239], v[140:143], v[92:95], a[236:239]
    ds_read_b128 v[92:95], v3 offset:38912
    v_mfma_f32_16x16x32_bf16 a[240:243], v[132:135], v[96:99], 0
    ds_read_b128 v[96:99], v2 offset:40960
    v_mfma_f32_16x16x32_bf16 a[240:243], v[140:143], v[100:103], a[240:243]
    ds_read_b128 v[100:103], v3 offset:40960
    v_mfma_f32_16x16x32_bf16 a[244:247], v[132:135], v[104:107], 0
    ds_read_b128 v[104:107], v2 offset:43008
    v_mfma_f32_16x16x32_bf16 a[244:247], v[140:143], v[108:111], a[244:247]
    ds_read_b128 v[108:111], v3 offset:43008
    v_mfma_f32_16x16x32_bf16 a[248:251], v[132:135], v[112:115], 0
    ds_read_b128 v[112:115], v2 offset:45056
    v_mfma_f32_16x16x32_bf16 a[248:251], v[140:143], v[116:119], a[248:251]
    ds_read_b128 v[116:119], v3 offset:45056
    v_mfma_f32_16x16x32_bf16 a[252:255], v[132:135], v[120:123], 0
    ds_read_b128 v[120:123], v2 offset:47104
    v_mfma_f32_16x16x32_bf16 a[252:255], v[140:143], v[124:127], a[252:255]
    ds_read_b128 v[124:127], v3 offset:47104
    s_waitcnt lgkmcnt(15)
    v_mfma_f32_16x16x32_bf16 a[0:3], v[144:147], v[64:67], a[0:3]
    ds_read_b64_tr_b16 v[128:129], v6 offset:8192
    s_waitcnt lgkmcnt(15)
    v_mfma_f32_16x16x32_bf16 a[0:3], v[152:155], v[68:71], a[0:3]
    s_add_u32 m0, s47, 81920
    s_waitcnt lgkmcnt(14)
    v_mfma_f32_16x16x32_bf16 a[4:7], v[144:147], v[72:75], a[4:7]
    buffer_load_dwordx4 v15, s[20:23], 0 offen nt lds
    s_waitcnt lgkmcnt(13)
    v_mfma_f32_16x16x32_bf16 a[4:7], v[152:155], v[76:79], a[4:7]
    s_waitcnt lgkmcnt(12)
    v_mfma_f32_16x16x32_bf16 a[8:11], v[144:147], v[80:83], a[8:11]
    ds_read_b64_tr_b16 v[130:131], v6 offset:8704
    s_waitcnt lgkmcnt(12)
    v_mfma_f32_16x16x32_bf16 a[8:11], v[152:155], v[84:87], a[8:11]
    s_add_u32 m0, s47, 86016
    s_waitcnt lgkmcnt(11)
    v_mfma_f32_16x16x32_bf16 a[12:15], v[144:147], v[88:91], a[12:15]
    buffer_load_dwordx4 v15, s[20:23], s59 offen nt lds
    s_waitcnt lgkmcnt(10)
    v_mfma_f32_16x16x32_bf16 a[12:15], v[152:155], v[92:95], a[12:15]
    v_smfmac_f32_16x16x64_bf16 v[36:39], v[32:35], v[144:151], v56
    s_waitcnt lgkmcnt(9)
    s_nop 0
    v_mfma_f32_16x16x32_bf16 a[16:19], v[144:147], v[96:99], a[16:19]
    ds_read_b64_tr_b16 v[136:137], v60 offset:8192
    s_waitcnt lgkmcnt(9)
    v_mfma_f32_16x16x32_bf16 a[16:19], v[152:155], v[100:103], a[16:19]
    s_add_u32 m0, s47, 90112
    s_waitcnt lgkmcnt(8)
    v_mfma_f32_16x16x32_bf16 a[20:23], v[144:147], v[104:107], a[20:23]
    buffer_load_dwordx4 v10, s[24:27], 0 offen nt lds
    s_waitcnt lgkmcnt(7)
    v_mfma_f32_16x16x32_bf16 a[20:23], v[152:155], v[108:111], a[20:23]
    s_waitcnt lgkmcnt(6)
    v_mfma_f32_16x16x32_bf16 a[24:27], v[144:147], v[112:115], a[24:27]
    ds_read_b64_tr_b16 v[138:139], v60 offset:8704
    s_waitcnt lgkmcnt(6)
    v_mfma_f32_16x16x32_bf16 a[24:27], v[152:155], v[116:119], a[24:27]
    s_nop 0
    s_add_u32 m0, s47, 94208
    s_waitcnt lgkmcnt(5)
    v_mfma_f32_16x16x32_bf16 a[28:31], v[144:147], v[120:123], a[28:31]
    buffer_load_dwordx4 v10, s[24:27], s44 offen nt lds
    s_waitcnt lgkmcnt(4)
    v_mfma_f32_16x16x32_bf16 a[28:31], v[152:155], v[124:127], a[28:31]
    v_mfma_f32_16x16x32_bf16 a[32:35], v[148:151], v[64:67], a[32:35]
    ds_read_b64_tr_b16 v[132:133], v7 offset:8192
    v_mfma_f32_16x16x32_bf16 a[32:35], v[156:159], v[68:71], a[32:35]
    s_add_u32 m0, s47, 98304
    v_mfma_f32_16x16x32_bf16 a[36:39], v[148:151], v[72:75], a[36:39]
    buffer_load_dwordx4 v10, s[28:31], 0 offen nt lds
    v_mfma_f32_16x16x32_bf16 a[36:39], v[156:159], v[76:79], a[36:39]
    v_mfma_f32_16x16x32_bf16 a[40:43], v[148:151], v[80:83], a[40:43]
    ds_read_b64_tr_b16 v[134:135], v7 offset:8704
    v_mfma_f32_16x16x32_bf16 a[40:43], v[156:159], v[84:87], a[40:43]
    s_add_u32 m0, s47, 102400
    v_mfma_f32_16x16x32_bf16 a[44:47], v[148:151], v[88:91], a[44:47]
    buffer_load_dwordx4 v10, s[28:31], s44 offen nt lds
    v_mfma_f32_16x16x32_bf16 a[44:47], v[156:159], v[92:95], a[44:47]
    v_mfma_f32_16x16x32_bf16 a[48:51], v[148:151], v[96:99], a[48:51]
    ds_read_b64_tr_b16 v[140:141], v61 offset:8192
    v_mfma_f32_16x16x32_bf16 a[48:51], v[156:159], v[100:103], a[48:51]
    s_add_u32 m0, s47, 0
    v_mfma_f32_16x16x32_bf16 a[52:55], v[148:151], v[104:107], a[52:55]
    s_nop 0
    buffer_load_dwordx4 v8, s[8:11], 0 offen  lds
    v_mfma_f32_16x16x32_bf16 a[52:55], v[156:159], v[108:111], a[52:55]
    v_mfma_f32_16x16x32_bf16 a[56:59], v[148:151], v[112:115], a[56:59]
    ds_read_b64_tr_b16 v[142:143], v61 offset:8704
    v_mfma_f32_16x16x32_bf16 a[56:59], v[156:159], v[116:119], a[56:59]
    s_add_u32 m0, s47, 4096
    v_mfma_f32_16x16x32_bf16 a[60:63], v[148:151], v[120:123], a[60:63]
    buffer_load_dwordx4 v8, s[8:11], s36 offen  lds
    v_mfma_f32_16x16x32_bf16 a[60:63], v[156:159], v[124:127], a[60:63]
    s_waitcnt lgkmcnt(6)
    v_mfma_f32_16x16x32_bf16 v[192:195], v[64:67], v[128:131], v[192:195]
    ds_read_b64_tr_b16 v[144:145], v6 offset:16384
    s_waitcnt lgkmcnt(5)
    v_mfma_f32_16x16x32_bf16 v[192:195], v[68:71], v[136:139], v[192:195]
    s_add_u32 m0, s47, 8192
    v_mfma_f32_16x16x32_bf16 v[196:199], v[72:75], v[128:131], v[196:199]
    buffer_load_dwordx4 v8, s[8:11], s37 offen  lds
    v_mfma_f32_16x16x32_bf16 v[196:199], v[76:79], v[136:139], v[196:199]
    v_mfma_f32_16x16x32_bf16 v[200:203], v[80:83], v[128:131], v[200:203]
    ds_read_b64_tr_b16 v[146:147], v6 offset:16896
    v_mfma_f32_16x16x32_bf16 v[200:203], v[84:87], v[136:139], v[200:203]
    s_add_u32 m0, s47, 12288
    v_mfma_f32_16x16x32_bf16 v[204:207], v[88:91], v[128:131], v[204:207]
    buffer_load_dwordx4 v8, s[8:11], s38 offen  lds
    v_mfma_f32_16x16x32_bf16 v[204:207], v[92:95], v[136:139], v[204:207]
    s_waitcnt lgkmcnt(4)
    v_smfmac_f32_16x16x64_bf16 v[40:43], v[32:35], v[128:135], v56
    v_mfma_f32_16x16x32_bf16 v[208:211], v[96:99], v[128:131], v[208:211]
    s_nop 0
    ds_read_b64_tr_b16 v[152:153], v60 offset:16384
    v_mfma_f32_16x16x32_bf16 v[208:211], v[100:103], v[136:139], v[208:211]
    s_add_u32 m0, s47, 16384
    v_mfma_f32_16x16x32_bf16 v[212:215], v[104:107], v[128:131], v[212:215]
    buffer_load_dwordx4 v8, s[8:11], s39 offen  lds
    v_mfma_f32_16x16x32_bf16 v[212:215], v[108:111], v[136:139], v[212:215]
    v_mfma_f32_16x16x32_bf16 v[216:219], v[112:115], v[128:131], v[216:219]
    ds_read_b64_tr_b16 v[154:155], v60 offset:16896
    v_mfma_f32_16x16x32_bf16 v[216:219], v[116:119], v[136:139], v[216:219]
    s_add_u32 m0, s47, 20480
    v_mfma_f32_16x16x32_bf16 v[220:223], v[120:123], v[128:131], v[220:223]
    buffer_load_dwordx4 v8, s[8:11], s40 offen  lds
    v_mfma_f32_16x16x32_bf16 v[220:223], v[124:127], v[136:139], v[220:223]
    v_mfma_f32_16x16x32_bf16 v[224:227], v[64:67], v[132:135], v[224:227]
    ds_read_b64_tr_b16 v[148:149], v7 offset:16384
    s_waitcnt lgkmcnt(5)
    s_nop 0
    v_mfma_f32_16x16x32_bf16 v[224:227], v[68:71], v[140:143], v[224:227]
    s_add_u32 m0, s47, 24576
    v_mfma_f32_16x16x32_bf16 v[228:231], v[72:75], v[132:135], v[228:231]
    buffer_load_dwordx4 v8, s[8:11], s41 offen  lds
    s_waitcnt vmcnt(19)
    v_lshlrev_b32 v160, 16, v16
    v_and_b32 v161, 0xffff0000, v16
    v_mfma_f32_16x16x32_bf16 v[228:231], v[76:79], v[140:143], v[228:231]
    v_lshlrev_b32 v162, 16, v17
    v_and_b32 v163, 0xffff0000, v17
    v_lshlrev_b32 v164, 16, v18
    v_mfma_f32_16x16x32_bf16 v[232:235], v[80:83], v[132:135], v[232:235]
    ds_read_b64_tr_b16 v[150:151], v7 offset:16896
    v_and_b32 v165, 0xffff0000, v18
    v_lshlrev_b32_e64 v166, 16, v19
    v_mfma_f32_16x16x32_bf16 v[232:235], v[84:87], v[140:143], v[232:235]
    s_add_u32 m0, s47, 28672
    v_and_b32 v167, 0xffff0000, v19
    v_lshlrev_b32_e64 v168, 16, v20
    v_and_b32 v169, 0xffff0000, v20
    v_mfma_f32_16x16x32_bf16 v[236:239], v[88:91], v[132:135], v[236:239]
    buffer_load_dwordx4 v8, s[8:11], s42 offen  lds
    v_lshlrev_b32_e64 v170, 16, v21
    v_and_b32 v171, 0xffff0000, v21
    v_mfma_f32_16x16x32_bf16 v[236:239], v[92:95], v[140:143], v[236:239]
    v_lshlrev_b32 v172, 16, v22
    v_and_b32 v173, 0xffff0000, v22
    v_lshlrev_b32 v174, 16, v23
    v_mfma_f32_16x16x32_bf16 v[240:243], v[96:99], v[132:135], v[240:243]
    ds_read_b64_tr_b16 v[156:157], v61 offset:16384
    v_and_b32 v175, 0xffff0000, v23
    s_waitcnt vmcnt(18)
    v_lshlrev_b32 v176, 16, v24
    v_mfma_f32_16x16x32_bf16 v[240:243], v[100:103], v[140:143], v[240:243]
    v_and_b32 v177, 0xffff0000, v24
    v_lshlrev_b32_e64 v178, 16, v25
    v_and_b32 v179, 0xffff0000, v25
    v_mfma_f32_16x16x32_bf16 v[244:247], v[104:107], v[132:135], v[244:247]
    buffer_load_dword v57, v12, s[4:7], 0 offen
    v_lshlrev_b32_e64 v180, 16, v26
    v_and_b32 v181, 0xffff0000, v26
    v_mfma_f32_16x16x32_bf16 v[244:247], v[108:111], v[140:143], v[244:247]
    s_add_u32 s101, s45, 3
    v_lshlrev_b32 v182, 16, v27
    v_and_b32 v183, 0xffff0000, v27
    v_lshlrev_b32_e64 v184, 16, v28
    v_mfma_f32_16x16x32_bf16 v[248:251], v[112:115], v[132:135], v[248:251]
    ds_read_b64_tr_b16 v[158:159], v61 offset:16896
    v_and_b32 v185, 0xffff0000, v28
    v_lshlrev_b32_e64 v186, 16, v29
    v_mfma_f32_16x16x32_bf16 v[248:251], v[116:119], v[140:143], v[248:251]
    s_and_b32 s101, s101, 15
    s_cselect_b32 s100, 1, -15
    v_and_b32 v187, 0xffff0000, v29
    v_lshlrev_b32_e64 v188, 16, v30
    v_and_b32 v189, 0xffff0000, v30
    v_mfma_f32_16x16x32_bf16 v[252:255], v[120:123], v[132:135], v[252:255]
    v_lshlrev_b32 v190, 16, v31
    v_and_b32 v191, 0xffff0000, v31
    v_add_f32 v16, v160, v164
    v_mfma_f32_16x16x32_bf16 v[252:255], v[124:127], v[140:143], v[252:255]
    s_mul_i32 s101, s100, s49
    v_add_f32 v17, v161, v165
    v_add_f32 v18, v162, v166
    v_add_f32_e64 v19, v163, v167
    s_waitcnt lgkmcnt(6)
    v_mfma_f32_16x16x32_bf16 a[64:67], v[64:67], v[144:147], a[64:67]
    ds_read_b64_tr_b16 v[128:129], v6 offset:24576
    v_add_f32 v16, v16, v168
    v_add_f32_e64 v17, v17, v169
    s_waitcnt lgkmcnt(5)
    v_mfma_f32_16x16x32_bf16 a[64:67], v[68:71], v[152:155], a[64:67]
    v_add_u32 v12, s101, v12
    v_add_f32 v18, v18, v170
    v_add_f32 v19, v19, v171
    v_mfma_f32_16x16x32_bf16 a[68:71], v[72:75], v[144:147], a[68:71]
    v_add_f32 v16, v16, v172
    v_add_f32 v17, v17, v173
    v_add_f32 v18, v18, v174
    v_mfma_f32_16x16x32_bf16 a[68:71], v[76:79], v[152:155], a[68:71]
    v_add_f32 v19, v19, v175
    v_add_f32 v16, v16, v176
    v_add_f32_e64 v17, v17, v177
    v_mfma_f32_16x16x32_bf16 a[72:75], v[80:83], v[144:147], a[72:75]
    ds_read_b64_tr_b16 v[130:131], v6 offset:25088
    v_add_f32 v18, v18, v178
    v_add_f32 v19, v19, v179
    v_mfma_f32_16x16x32_bf16 a[72:75], v[84:87], v[152:155], a[72:75]
    buffer_load_dword v57, v12, s[4:7], 0 offen
    v_add_f32 v16, v16, v180
    v_add_f32 v17, v17, v181
    v_mfma_f32_16x16x32_bf16 a[76:79], v[88:91], v[144:147], a[76:79]
    s_add_u32 s101, s45, 3
    s_and_b32 s101, s101, 15
    s_cselect_b32 s100, 1, -15
    s_mul_i32 s101, s100, s49
    v_add_u32 v12, s101, v12
    v_add_f32 v18, v18, v182
    v_add_f32 v19, v19, v183
    v_mfma_f32_16x16x32_bf16 a[76:79], v[92:95], v[152:155], a[76:79]
    s_waitcnt lgkmcnt(4)
    v_smfmac_f32_16x16x64_bf16 v[44:47], v[32:35], v[144:151], v56
    v_mfma_f32_16x16x32_bf16 a[80:83], v[96:99], v[144:147], a[80:83]
    ds_read_b64_tr_b16 v[136:137], v60 offset:24576
    v_add_f32 v16, v16, v184
    v_add_f32 v17, v17, v185
    v_mfma_f32_16x16x32_bf16 a[80:83], v[100:103], v[152:155], a[80:83]
    v_add_f32 v18, v18, v186
    v_add_f32 v19, v19, v187
    v_add_f32_e64 v16, v16, v188
    v_mfma_f32_16x16x32_bf16 a[84:87], v[104:107], v[144:147], a[84:87]
    v_add_f32_e64 v17, v17, v189
    v_add_f32_e64 v18, v18, v190
    v_add_f32_e64 v19, v19, v191
    v_mfma_f32_16x16x32_bf16 a[84:87], v[108:111], v[152:155], a[84:87]
    v_add_f32_e64 v16, v16, v17
    v_add_f32_e64 v18, v18, v19
    v_add_f32_e64 v16, v16, v18
    v_mfma_f32_16x16x32_bf16 a[88:91], v[112:115], v[144:147], a[88:91]
    ds_read_b64_tr_b16 v[138:139], v60 offset:25088
    v_mfma_f32_16x16x32_bf16 a[88:91], v[116:119], v[152:155], a[88:91]
    v_mfma_f32_16x16x32_bf16 a[92:95], v[120:123], v[144:147], a[92:95]
    v_add_f32_dpp v16, v16, v16 quad_perm:[1,0,3,2] row_mask:0xf bank_mask:0xf
    v_mfma_f32_16x16x32_bf16 a[92:95], v[124:127], v[152:155], a[92:95]
    v_mfma_f32_16x16x32_bf16 a[96:99], v[64:67], v[148:151], a[96:99]
    ds_read_b64_tr_b16 v[132:133], v7 offset:24576
    v_add_f32_dpp v16, v16, v16 quad_perm:[2,3,0,1] row_mask:0xf bank_mask:0xf
    s_waitcnt lgkmcnt(5)
    v_mfma_f32_16x16x32_bf16 a[96:99], v[68:71], v[156:159], a[96:99]
    v_mfma_f32_16x16x32_bf16 a[100:103], v[72:75], v[148:151], a[100:103]
    v_add_f32_dpp v16, v16, v16 row_half_mirror row_mask:0xf bank_mask:0xf
    s_nop 0
    v_mfma_f32_16x16x32_bf16 a[100:103], v[76:79], v[156:159], a[100:103]
    v_mfma_f32_16x16x32_bf16 a[104:107], v[80:83], v[148:151], a[104:107]
    ds_read_b64_tr_b16 v[134:135], v7 offset:25088
    v_add_f32_dpp v16, v16, v16 row_mirror row_mask:0xf bank_mask:0xf
    v_mov_b32 v17, v16
    v_mfma_f32_16x16x32_bf16 a[104:107], v[84:87], v[156:159], a[104:107]
    v_mfma_f32_16x16x32_bf16 a[108:111], v[88:91], v[148:151], a[108:111]
    v_mfma_f32_16x16x32_bf16 a[108:111], v[92:95], v[156:159], a[108:111]
    v_permlane16_swap_b32 v16, v17
    v_mfma_f32_16x16x32_bf16 a[112:115], v[96:99], v[148:151], a[112:115]
    ds_read_b64_tr_b16 v[140:141], v61 offset:24576
    v_mfma_f32_16x16x32_bf16 a[112:115], v[100:103], v[156:159], a[112:115]
    v_add_f32_e64 v16, v16, v17
    v_mul_f32 v16, 0x3a800000, v16
    v_sub_f32 v160, v160, v16
    v_mfma_f32_16x16x32_bf16 a[116:119], v[104:107], v[148:151], a[116:119]
    v_sub_f32 v161, v161, v16
    v_mul_f32 v20, v160, v160
    v_sub_f32 v162, v162, v16
    v_mfma_f32_16x16x32_bf16 a[116:119], v[108:111], v[156:159], a[116:119]
    v_mul_f32 v21, v161, v161
    v_sub_f32 v163, v163, v16
    v_mul_f32_e64 v22, v162, v162
    v_mfma_f32_16x16x32_bf16 a[120:123], v[112:115], v[148:151], a[120:123]
    ds_read_b64_tr_b16 v[142:143], v61 offset:25088
    v_sub_f32 v164, v164, v16
    v_mul_f32 v23, v163, v163
    v_mfma_f32_16x16x32_bf16 a[120:123], v[116:119], v[156:159], a[120:123]
    v_sub_f32 v165, v165, v16
    v_fmac_f32 v20, v164, v164
    v_sub_f32 v166, v166, v16
    v_mfma_f32_16x16x32_bf16 a[124:127], v[120:123], v[148:151], a[124:127]
    v_fmac_f32 v21, v165, v165
    v_sub_f32 v167, v167, v16
    v_fmac_f32 v22, v166, v166
    v_mfma_f32_16x16x32_bf16 a[124:127], v[124:127], v[156:159], a[124:127]
    v_sub_f32 v168, v168, v16
    v_fmac_f32 v23, v167, v167
    v_sub_f32 v169, v169, v16
    s_waitcnt lgkmcnt(6)
    v_mfma_f32_16x16x32_bf16 a[128:131], v[128:131], v[64:67], a[128:131]
    ds_read_b64_tr_b16 v[144:145], v6 offset:32768
    v_fmac_f32 v20, v168, v168
    v_sub_f32 v170, v170, v16
    s_waitcnt lgkmcnt(5)
    v_mfma_f32_16x16x32_bf16 a[128:131], v[136:139], v[68:71], a[128:131]
    s_add_u32 s45, s45, 1
    v_fmac_f32 v21, v169, v169
    v_sub_f32 v171, v171, v16
    v_fmac_f32 v22, v170, v170
    v_mfma_f32_16x16x32_bf16 a[132:135], v[128:131], v[72:75], a[132:135]
    v_sub_f32 v172, v172, v16
    v_fmac_f32 v23, v171, v171
    v_sub_f32 v173, v173, v16
    v_mfma_f32_16x16x32_bf16 a[132:135], v[136:139], v[76:79], a[132:135]
    s_and_b32 s45, s45, 15
    s_cselect_b32 s100, 1, -15
    v_fmac_f32 v20, v172, v172
    v_sub_f32 v174, v174, v16
    v_fmac_f32_e64 v21, v173, v173
    v_mfma_f32_16x16x32_bf16 a[136:139], v[128:131], v[80:83], a[136:139]
    ds_read_b64_tr_b16 v[146:147], v6 offset:33280
    v_sub_f32 v175, v175, v16
    v_fmac_f32 v22, v174, v174
    v_mfma_f32_16x16x32_bf16 a[136:139], v[136:139], v[84:87], a[136:139]
    s_mul_i32 s101, s100, 0x80
    v_sub_f32 v176, v176, v16
    v_fmac_f32 v23, v175, v175
    v_sub_f32 v177, v177, v16
    v_mfma_f32_16x16x32_bf16 a[140:143], v[128:131], v[88:91], a[140:143]
    v_fmac_f32 v20, v176, v176
    v_sub_f32_e64 v178, v178, v16
    v_fmac_f32 v21, v177, v177
    v_mfma_f32_16x16x32_bf16 a[140:143], v[136:139], v[92:95], a[140:143]
    s_waitcnt lgkmcnt(4)
    v_smfmac_f32_16x16x64_bf16 v[48:51], v[32:35], v[128:135], v56
    v_mfma_f32_16x16x32_bf16 a[144:147], v[128:131], v[96:99], a[144:147]
    ds_read_b64_tr_b16 v[152:153], v60 offset:32768
    v_sub_f32 v179, v179, v16
    v_fmac_f32 v22, v178, v178
    v_mfma_f32_16x16x32_bf16 a[144:147], v[136:139], v[100:103], a[144:147]
    v_add_u32 v8, s101, v8
    v_sub_f32 v180, v180, v16
    v_fmac_f32 v23, v179, v179
    v_mfma_f32_16x16x32_bf16 a[148:151], v[128:131], v[104:107], a[148:151]
    v_sub_f32 v181, v181, v16
    v_fmac_f32 v20, v180, v180
    v_sub_f32 v182, v182, v16
    v_mfma_f32_16x16x32_bf16 a[148:151], v[136:139], v[108:111], a[148:151]
    s_mul_i32 s101, s100, 393216
    v_fmac_f32 v21, v181, v181
    v_sub_f32 v183, v183, v16
    v_fmac_f32_e64 v22, v182, v182
    v_mfma_f32_16x16x32_bf16 a[152:155], v[128:131], v[112:115], a[152:155]
    ds_read_b64_tr_b16 v[154:155], v60 offset:33280
    v_sub_f32 v184, v184, v16
    v_fmac_f32 v23, v183, v183
    v_mfma_f32_16x16x32_bf16 a[152:155], v[136:139], v[116:119], a[152:155]
    v_add_u32 v9, s101, v9
    v_sub_f32 v185, v185, v16
    v_fmac_f32 v20, v184, v184
    v_mfma_f32_16x16x32_bf16 a[156:159], v[128:131], v[120:123], a[156:159]
    v_sub_f32 v186, v186, v16
    v_fmac_f32 v21, v185, v185
    v_sub_f32 v187, v187, v16
    v_mfma_f32_16x16x32_bf16 a[156:159], v[136:139], v[124:127], a[156:159]
    s_mul_i32 s101, s100, 458752
    v_fmac_f32 v22, v186, v186
    v_sub_f32 v188, v188, v16
    v_fmac_f32_e64 v23, v187, v187
    v_mfma_f32_16x16x32_bf16 a[160:163], v[132:135], v[64:67], a[160:163]
    ds_read_b64_tr_b16 v[148:149], v7 offset:32768
    v_sub_f32 v189, v189, v16
    v_fmac_f32_e64 v20, v188, v188
    s_waitcnt lgkmcnt(5)
    v_mfma_f32_16x16x32_bf16 a[160:163], v[140:143], v[68:71], a[160:163]
    ds_read_b64_tr_b16 v[150:151], v7 offset:33280
    v_add_u32 v10, s101, v10
    v_sub_f32 v190, v190, v16
    v_mfma_f32_16x16x32_bf16 a[164:167], v[132:135], v[72:75], a[164:167]
    ds_read_b64_tr_b16 v[156:157], v61 offset:32768
    v_fmac_f32 v21, v189, v189
    v_sub_f32 v191, v191, v16
    v_mfma_f32_16x16x32_bf16 a[164:167], v[140:143], v[76:79], a[164:167]
    ds_read_b64_tr_b16 v[158:159], v61 offset:33280
    s_mul_i32 s101, s100, s79
    v_fmac_f32 v22, v190, v190
    v_add_f32 v20, v20, v21
    v_mfma_f32_16x16x32_bf16 a[168:171], v[132:135], v[80:83], a[168:171]
    v_fmac_f32 v23, v191, v191
    v_add_f32 v20, v20, v22
    v_add_f32 v20, v20, v23
    v_mfma_f32_16x16x32_bf16 a[168:171], v[140:143], v[84:87], a[168:171]
    v_add_u32_e64 v15, s101, v15
    v_mfma_f32_16x16x32_bf16 a[172:175], v[132:135], v[88:91], a[172:175]
    v_mfma_f32_16x16x32_bf16 a[172:175], v[140:143], v[92:95], a[172:175]
    v_add_f32_dpp v20, v20, v20 quad_perm:[1,0,3,2] row_mask:0xf bank_mask:0xf
    v_mfma_f32_16x16x32_bf16 a[176:179], v[132:135], v[96:99], a[176:179]
    v_mfma_f32_16x16x32_bf16 a[176:179], v[140:143], v[100:103], a[176:179]
    v_add_f32_dpp v20, v20, v20 quad_perm:[2,3,0,1] row_mask:0xf bank_mask:0xf
    v_mfma_f32_16x16x32_bf16 a[180:183], v[132:135], v[104:107], a[180:183]
    v_mfma_f32_16x16x32_bf16 a[180:183], v[140:143], v[108:111], a[180:183]
    v_add_f32_dpp v20, v20, v20 row_half_mirror row_mask:0xf bank_mask:0xf
    v_mfma_f32_16x16x32_bf16 a[184:187], v[132:135], v[112:115], a[184:187]
    v_mfma_f32_16x16x32_bf16 a[184:187], v[140:143], v[116:119], a[184:187]
    v_add_f32_dpp v20, v20, v20 row_mirror row_mask:0xf bank_mask:0xf
    v_mov_b32 v21, v20
    v_mfma_f32_16x16x32_bf16 a[188:191], v[132:135], v[120:123], a[188:191]
    v_mfma_f32_16x16x32_bf16 a[188:191], v[140:143], v[124:127], a[188:191]
    s_waitcnt vmcnt(2) lgkmcnt(0)
    s_barrier
    v_mfma_f32_16x16x32_bf16 a[192:195], v[144:147], v[64:67], a[192:195]
    s_add_u32 m0, s47, 106496
    ds_read_b64_tr_b16 v[128:129], v4 offset:0
    v_permlane16_swap_b32 v20, v21
    v_mfma_f32_16x16x32_bf16 a[192:195], v[152:155], v[68:71], a[192:195]
    buffer_load_dwordx4 v9, s[12:15], 0 offen nt lds
    v_mfma_f32_16x16x32_bf16 a[196:199], v[144:147], v[72:75], a[196:199]
    ds_read_b64_tr_b16 v[130:131], v4 offset:512
    v_add_f32 v20, v20, v21
    v_mul_f32 v20, 0x3a800000, v20
    v_mfma_f32_16x16x32_bf16 a[196:199], v[152:155], v[76:79], a[196:199]
    v_cvt_pk_bf16_f32 v20, v20, v20
    v_lshlrev_b32 v20, 16, v20
    v_add_f32 v20, 0x3727c5ac, v20
    v_mfma_f32_16x16x32_bf16 a[200:203], v[144:147], v[80:83], a[200:203]
    s_add_u32 m0, s47, 110592
    ds_read_b64_tr_b16 v[136:137], v58 offset:0
    v_cvt_pk_bf16_f32 v20, v20, v20
    v_lshlrev_b32 v20, 16, v20
    v_mfma_f32_16x16x32_bf16 a[200:203], v[152:155], v[84:87], a[200:203]
    buffer_load_dwordx4 v9, s[12:15], s43 offen nt lds
    v_sqrt_f32 v20, v20
    v_cvt_pk_bf16_f32 v16, v16, v16
    v_mfma_f32_16x16x32_bf16 a[204:207], v[144:147], v[88:91], a[204:207]
    ds_read_b64_tr_b16 v[138:139], v58 offset:512
    v_lshlrev_b32_e64 v16, 16, v16
    v_cvt_pk_bf16_f32 v20, v20, v20
    v_mfma_f32_16x16x32_bf16 a[204:207], v[152:155], v[92:95], a[204:207]
    v_smfmac_f32_16x16x64_bf16 v[52:55], v[32:35], v[144:151], v56
    v_mfma_f32_16x16x32_bf16 a[208:211], v[144:147], v[96:99], a[208:211]
    s_add_u32 m0, s47, 114688
    ds_read_b64_tr_b16 v[132:133], v5 offset:0
    v_lshlrev_b32 v20, 16, v20
    v_rcp_f32 v20, v20
    v_mfma_f32_16x16x32_bf16 a[208:211], v[152:155], v[100:103], a[208:211]
    buffer_load_dwordx4 v15, s[16:19], 0 offen nt lds
    v_sub_f32 v16, 0, v16
    v_and_b32 v17, 31, v0
    v_mfma_f32_16x16x32_bf16 a[212:215], v[144:147], v[104:107], a[212:215]
    ds_read_b64_tr_b16 v[134:135], v5 offset:512
    v_cmp_eq_u32 vcc, 0, v17
    v_lshlrev_b32 v18, 9, v17
    v_mfma_f32_16x16x32_bf16 a[212:215], v[152:155], v[108:111], a[212:215]
    v_lshrrev_b32 v19, 5, v0
    v_lshl_add_u32 v18, v19, 2, v18
    v_cndmask_b32 v16, v20, v16, vcc
    v_mfma_f32_16x16x32_bf16 a[216:219], v[144:147], v[112:115], a[216:219]
    s_add_u32 m0, s47, 118784
    ds_read_b64_tr_b16 v[140:141], v59 offset:0
    v_cmp_gt_u32_e64 vcc, 2, v17
    v_mov_b32 v19, 0x7f000000
    v_mfma_f32_16x16x32_bf16 a[216:219], v[152:155], v[116:119], a[216:219]
    buffer_load_dwordx4 v15, s[16:19], s59 offen nt lds
    v_mov_b32 v191, 1
    v_lshlrev_b32 v190, 8, v0
    v_mfma_f32_16x16x32_bf16 a[220:223], v[144:147], v[120:123], a[220:223]
    ds_read_b64_tr_b16 v[142:143], v59 offset:512
    v_cndmask_b32 v18, v19, v18, vcc
    v_add_u32 v190, s47, v190
    v_mfma_f32_16x16x32_bf16 a[220:223], v[152:155], v[124:127], a[220:223]
    buffer_store_dword v16, v18, s[32:35], s81 offen sc1
    v_mfma_f32_16x16x32_bf16 a[224:227], v[148:151], v[64:67], a[224:227]
    ds_read_b128 v[64:67], v2 offset:0
    v_mfma_f32_16x16x32_bf16 a[224:227], v[156:159], v[68:71], a[224:227]
    ds_read_b128 v[68:71], v3 offset:0
    v_mfma_f32_16x16x32_bf16 a[228:231], v[148:151], v[72:75], a[228:231]
    ds_read_b128 v[72:75], v2 offset:2048
    v_mfma_f32_16x16x32_bf16 a[228:231], v[156:159], v[76:79], a[228:231]
    ds_read_b128 v[76:79], v3 offset:2048
    v_mfma_f32_16x16x32_bf16 a[232:235], v[148:151], v[80:83], a[232:235]
    ds_read_b128 v[80:83], v2 offset:4096
    v_mfma_f32_16x16x32_bf16 a[232:235], v[156:159], v[84:87], a[232:235]
    ds_read_b128 v[84:87], v3 offset:4096
    v_mfma_f32_16x16x32_bf16 a[236:239], v[148:151], v[88:91], a[236:239]
    ds_read_b128 v[88:91], v2 offset:6144
    v_mfma_f32_16x16x32_bf16 a[236:239], v[156:159], v[92:95], a[236:239]
    ds_read_b128 v[92:95], v3 offset:6144
    v_mfma_f32_16x16x32_bf16 a[240:243], v[148:151], v[96:99], a[240:243]
    ds_read_b128 v[96:99], v2 offset:8192
    v_mfma_f32_16x16x32_bf16 a[240:243], v[156:159], v[100:103], a[240:243]
    ds_read_b128 v[100:103], v3 offset:8192
    v_mfma_f32_16x16x32_bf16 a[244:247], v[148:151], v[104:107], a[244:247]
    ds_read_b128 v[104:107], v2 offset:10240
    v_mfma_f32_16x16x32_bf16 a[244:247], v[156:159], v[108:111], a[244:247]
    ds_read_b128 v[108:111], v3 offset:10240
    v_mfma_f32_16x16x32_bf16 a[248:251], v[148:151], v[112:115], a[248:251]
    ds_read_b128 v[112:115], v2 offset:12288
    v_mfma_f32_16x16x32_bf16 a[248:251], v[156:159], v[116:119], a[248:251]
    ds_read_b128 v[116:119], v3 offset:12288
    v_mfma_f32_16x16x32_bf16 a[252:255], v[148:151], v[120:123], a[252:255]
    ds_read_b128 v[120:123], v2 offset:14336
    v_mfma_f32_16x16x32_bf16 a[252:255], v[156:159], v[124:127], a[252:255]
    ds_read_b128 v[124:127], v3 offset:14336
.p2align 6
L_g1_loopB:
    s_waitcnt lgkmcnt(15)
    v_mfma_f32_16x16x32_bf16 a[0:3], v[128:131], v[64:67], a[0:3]
    ds_read_b64_tr_b16 v[144:145], v4 offset:8192
    s_waitcnt lgkmcnt(15)
    v_mfma_f32_16x16x32_bf16 a[0:3], v[136:139], v[68:71], a[0:3]
    s_add_u32 m0, s47, 122880
    s_waitcnt lgkmcnt(14)
    v_mfma_f32_16x16x32_bf16 a[4:7], v[128:131], v[72:75], a[4:7]
    buffer_load_dwordx4 v15, s[20:23], 0 offen nt lds
    s_waitcnt lgkmcnt(13)
    v_mfma_f32_16x16x32_bf16 a[4:7], v[136:139], v[76:79], a[4:7]
    s_waitcnt lgkmcnt(12)
    v_mfma_f32_16x16x32_bf16 a[8:11], v[128:131], v[80:83], a[8:11]
    ds_read_b64_tr_b16 v[146:147], v4 offset:8704
    s_waitcnt lgkmcnt(12)
    v_mfma_f32_16x16x32_bf16 a[8:11], v[136:139], v[84:87], a[8:11]
    s_add_u32 m0, s47, 126976
    s_waitcnt lgkmcnt(11)
    v_mfma_f32_16x16x32_bf16 a[12:15], v[128:131], v[88:91], a[12:15]
    buffer_load_dwordx4 v15, s[20:23], s59 offen nt lds
    s_waitcnt lgkmcnt(10)
    v_mfma_f32_16x16x32_bf16 a[12:15], v[136:139], v[92:95], a[12:15]
    v_smfmac_f32_16x16x64_bf16 v[36:39], v[32:35], v[128:135], v56
    s_waitcnt lgkmcnt(9)
    v_mfma_f32_16x16x32_bf16 a[16:19], v[128:131], v[96:99], a[16:19]
    ds_read_b64_tr_b16 v[152:153], v58 offset:8192
    s_waitcnt lgkmcnt(9)
    v_mfma_f32_16x16x32_bf16 a[16:19], v[136:139], v[100:103], a[16:19]
    s_add_u32 m0, s47, 131072
    s_waitcnt lgkmcnt(8)
    v_mfma_f32_16x16x32_bf16 a[20:23], v[128:131], v[104:107], a[20:23]
    buffer_load_dwordx4 v10, s[24:27], 0 offen nt lds
    s_waitcnt lgkmcnt(7)
    v_mfma_f32_16x16x32_bf16 a[20:23], v[136:139], v[108:111], a[20:23]
    s_waitcnt lgkmcnt(6)
    v_mfma_f32_16x16x32_bf16 a[24:27], v[128:131], v[112:115], a[24:27]
    ds_read_b64_tr_b16 v[154:155], v58 offset:8704
    s_waitcnt lgkmcnt(6)
    v_mfma_f32_16x16x32_bf16 a[24:27], v[136:139], v[116:119], a[24:27]
    s_add_u32 m0, s47, 135168
    s_waitcnt lgkmcnt(5)
    v_mfma_f32_16x16x32_bf16 a[28:31], v[128:131], v[120:123], a[28:31]
    buffer_load_dwordx4 v10, s[24:27], s44 offen nt lds
    s_waitcnt lgkmcnt(4)
    v_mfma_f32_16x16x32_bf16 a[28:31], v[136:139], v[124:127], a[28:31]
    v_mfma_f32_16x16x32_bf16 a[32:35], v[132:135], v[64:67], a[32:35]
    ds_read_b64_tr_b16 v[148:149], v5 offset:8192
    v_mfma_f32_16x16x32_bf16 a[32:35], v[140:143], v[68:71], a[32:35]
    s_add_u32 m0, s47, 139264
    v_mfma_f32_16x16x32_bf16 a[36:39], v[140:143], v[76:79], a[36:39]
    buffer_load_dwordx4 v10, s[28:31], 0 offen nt lds
    v_mfma_f32_16x16x32_bf16 a[36:39], v[132:135], v[72:75], a[36:39]
    v_mfma_f32_16x16x32_bf16 a[40:43], v[132:135], v[80:83], a[40:43]
    ds_read_b64_tr_b16 v[150:151], v5 offset:8704
    v_mfma_f32_16x16x32_bf16 a[40:43], v[140:143], v[84:87], a[40:43]
    s_add_u32 m0, s47, 143360
    v_mfma_f32_16x16x32_bf16 a[44:47], v[140:143], v[92:95], a[44:47]
    buffer_load_dwordx4 v10, s[28:31], s44 offen nt lds
    v_mfma_f32_16x16x32_bf16 a[44:47], v[132:135], v[88:91], a[44:47]
    v_mfma_f32_16x16x32_bf16 a[48:51], v[132:135], v[96:99], a[48:51]
    ds_read_b64_tr_b16 v[156:157], v59 offset:8192
    v_mfma_f32_16x16x32_bf16 a[48:51], v[140:143], v[100:103], a[48:51]
    s_add_u32 m0, s47, 32768
    v_mfma_f32_16x16x32_bf16 a[52:55], v[140:143], v[108:111], a[52:55]
    buffer_load_dwordx4 v8, s[8:11], 0 offen  lds
    v_mfma_f32_16x16x32_bf16 a[52:55], v[132:135], v[104:107], a[52:55]
    v_mfma_f32_16x16x32_bf16 a[56:59], v[132:135], v[112:115], a[56:59]
    ds_read_b64_tr_b16 v[158:159], v59 offset:8704
    v_mfma_f32_16x16x32_bf16 a[56:59], v[140:143], v[116:119], a[56:59]
    s_add_u32 m0, s47, 36864
    v_mfma_f32_16x16x32_bf16 a[60:63], v[140:143], v[124:127], a[60:63]
    buffer_load_dwordx4 v8, s[8:11], s36 offen  lds
    v_mfma_f32_16x16x32_bf16 a[60:63], v[132:135], v[120:123], a[60:63]
    s_waitcnt lgkmcnt(6)
    v_mfma_f32_16x16x32_bf16 v[192:195], v[64:67], v[144:147], v[192:195]
    ds_read_b64_tr_b16 v[128:129], v4 offset:16384
    s_waitcnt lgkmcnt(5)
    v_mfma_f32_16x16x32_bf16 v[192:195], v[68:71], v[152:155], v[192:195]
    s_add_u32 m0, s47, 40960
    v_mfma_f32_16x16x32_bf16 v[196:199], v[76:79], v[152:155], v[196:199]
    buffer_load_dwordx4 v8, s[8:11], s37 offen  lds
    v_mfma_f32_16x16x32_bf16 v[196:199], v[72:75], v[144:147], v[196:199]
    v_mfma_f32_16x16x32_bf16 v[200:203], v[80:83], v[144:147], v[200:203]
    ds_read_b64_tr_b16 v[130:131], v4 offset:16896
    v_mfma_f32_16x16x32_bf16 v[200:203], v[84:87], v[152:155], v[200:203]
    s_add_u32 m0, s47, 45056
    v_mfma_f32_16x16x32_bf16 v[204:207], v[92:95], v[152:155], v[204:207]
    buffer_load_dwordx4 v8, s[8:11], s38 offen  lds
    v_mfma_f32_16x16x32_bf16 v[204:207], v[88:91], v[144:147], v[204:207]
    s_waitcnt lgkmcnt(4)
    v_smfmac_f32_16x16x64_bf16 v[40:43], v[32:35], v[144:151], v56
    v_mfma_f32_16x16x32_bf16 v[208:211], v[96:99], v[144:147], v[208:211]
    ds_read_b64_tr_b16 v[136:137], v58 offset:16384
    s_nop 0
    v_mfma_f32_16x16x32_bf16 v[208:211], v[100:103], v[152:155], v[208:211]
    s_add_u32 m0, s47, 49152
    v_mfma_f32_16x16x32_bf16 v[212:215], v[108:111], v[152:155], v[212:215]
    buffer_load_dwordx4 v8, s[8:11], s39 offen  lds
    v_mfma_f32_16x16x32_bf16 v[212:215], v[104:107], v[144:147], v[212:215]
    v_mfma_f32_16x16x32_bf16 v[216:219], v[112:115], v[144:147], v[216:219]
    ds_read_b64_tr_b16 v[138:139], v58 offset:16896
    v_mfma_f32_16x16x32_bf16 v[216:219], v[116:119], v[152:155], v[216:219]
    s_add_u32 m0, s47, 53248
    v_mfma_f32_16x16x32_bf16 v[220:223], v[124:127], v[152:155], v[220:223]
    buffer_load_dwordx4 v8, s[8:11], s40 offen  lds
    v_mfma_f32_16x16x32_bf16 v[220:223], v[120:123], v[144:147], v[220:223]
    v_mfma_f32_16x16x32_bf16 v[224:227], v[64:67], v[148:151], v[224:227]
    ds_read_b64_tr_b16 v[132:133], v5 offset:16384
    s_waitcnt lgkmcnt(5)
    v_mfma_f32_16x16x32_bf16 v[224:227], v[68:71], v[156:159], v[224:227]
    s_nop 0
    s_add_u32 m0, s47, 57344
    v_mfma_f32_16x16x32_bf16 v[228:231], v[76:79], v[156:159], v[228:231]
    buffer_load_dwordx4 v8, s[8:11], s41 offen  lds
    v_mfma_f32_16x16x32_bf16 v[228:231], v[72:75], v[148:151], v[228:231]
    v_mfma_f32_16x16x32_bf16 v[232:235], v[80:83], v[148:151], v[232:235]
    ds_read_b64_tr_b16 v[134:135], v5 offset:16896
    v_mfma_f32_16x16x32_bf16 v[232:235], v[84:87], v[156:159], v[232:235]
    s_add_u32 m0, s47, 61440
    v_mfma_f32_16x16x32_bf16 v[236:239], v[92:95], v[156:159], v[236:239]
    buffer_load_dwordx4 v8, s[8:11], s42 offen  lds
    v_mfma_f32_16x16x32_bf16 v[236:239], v[88:91], v[148:151], v[236:239]
    v_mfma_f32_16x16x32_bf16 v[240:243], v[96:99], v[148:151], v[240:243]
    ds_read_b64_tr_b16 v[140:141], v59 offset:16384
    v_mfma_f32_16x16x32_bf16 v[240:243], v[100:103], v[156:159], v[240:243]
    v_mfma_f32_16x16x32_bf16 v[244:247], v[108:111], v[156:159], v[244:247]
    buffer_load_dword v57, v12, s[4:7], 0 offen
    v_mfma_f32_16x16x32_bf16 v[244:247], v[104:107], v[148:151], v[244:247]
    s_add_u32 s101, s45, 3
    v_mfma_f32_16x16x32_bf16 v[248:251], v[112:115], v[148:151], v[248:251]
    s_nop 0
    ds_read_b64_tr_b16 v[142:143], v59 offset:16896
    v_mfma_f32_16x16x32_bf16 v[248:251], v[116:119], v[156:159], v[248:251]
    s_and_b32 s101, s101, 15
    s_cselect_b32 s100, 1, -15
    v_mfma_f32_16x16x32_bf16 v[252:255], v[124:127], v[156:159], v[252:255]
    buffer_load_dwordx2 v[16:17], v13, s[60:63], 0 offen offset:0 nt
    v_mfma_f32_16x16x32_bf16 v[252:255], v[120:123], v[148:151], v[252:255]
    s_mul_i32 s101, s100, s49
    s_waitcnt lgkmcnt(6)
    v_mfma_f32_16x16x32_bf16 a[64:67], v[64:67], v[128:131], a[64:67]
    ds_read_b64_tr_b16 v[144:145], v4 offset:24576
    s_waitcnt lgkmcnt(5)
    v_mfma_f32_16x16x32_bf16 a[64:67], v[68:71], v[136:139], a[64:67]
    v_add_u32 v12, s101, v12
    v_mfma_f32_16x16x32_bf16 a[68:71], v[76:79], v[136:139], a[68:71]
    buffer_load_dwordx2 v[18:19], v13, s[60:63], 0 offen offset:2048 nt
    v_mfma_f32_16x16x32_bf16 a[68:71], v[72:75], v[128:131], a[68:71]
    v_mfma_f32_16x16x32_bf16 a[72:75], v[80:83], v[128:131], a[72:75]
    ds_read_b64_tr_b16 v[146:147], v4 offset:25088
    v_mfma_f32_16x16x32_bf16 a[72:75], v[84:87], v[136:139], a[72:75]
    v_mfma_f32_16x16x32_bf16 a[76:79], v[92:95], v[136:139], a[76:79]
    buffer_load_dwordx2 v[20:21], v13, s[60:63], s74 offen offset:0 nt
    v_mfma_f32_16x16x32_bf16 a[76:79], v[88:91], v[128:131], a[76:79]
    s_waitcnt lgkmcnt(4)
    s_nop 0
    v_smfmac_f32_16x16x64_bf16 v[44:47], v[32:35], v[128:135], v56
    v_mfma_f32_16x16x32_bf16 a[80:83], v[96:99], v[128:131], a[80:83]
    ds_read_b64_tr_b16 v[152:153], v58 offset:24576
    v_mfma_f32_16x16x32_bf16 a[80:83], v[100:103], v[136:139], a[80:83]
    v_mfma_f32_16x16x32_bf16 a[84:87], v[108:111], v[136:139], a[84:87]
    buffer_load_dwordx2 v[22:23], v13, s[60:63], s74 offen offset:2048 nt
    v_mfma_f32_16x16x32_bf16 a[84:87], v[104:107], v[128:131], a[84:87]
    v_mfma_f32_16x16x32_bf16 a[88:91], v[112:115], v[128:131], a[88:91]
    ds_read_b64_tr_b16 v[154:155], v58 offset:25088
    v_mfma_f32_16x16x32_bf16 a[88:91], v[116:119], v[136:139], a[88:91]
    v_mfma_f32_16x16x32_bf16 a[92:95], v[124:127], v[136:139], a[92:95]
    buffer_load_dwordx2 v[24:25], v13, s[60:63], s75 offen offset:0 nt
    v_mfma_f32_16x16x32_bf16 a[92:95], v[120:123], v[128:131], a[92:95]
    v_mfma_f32_16x16x32_bf16 a[96:99], v[64:67], v[132:135], a[96:99]
    ds_read_b64_tr_b16 v[148:149], v5 offset:24576
    s_waitcnt lgkmcnt(5)
    s_nop 0
    v_mfma_f32_16x16x32_bf16 a[96:99], v[68:71], v[140:143], a[96:99]
    v_mfma_f32_16x16x32_bf16 a[100:103], v[76:79], v[140:143], a[100:103]
    buffer_load_dwordx2 v[26:27], v13, s[60:63], s75 offen offset:2048 nt
    v_mfma_f32_16x16x32_bf16 a[100:103], v[72:75], v[132:135], a[100:103]
    v_mfma_f32_16x16x32_bf16 a[104:107], v[80:83], v[132:135], a[104:107]
    ds_read_b64_tr_b16 v[150:151], v5 offset:25088
    v_mfma_f32_16x16x32_bf16 a[104:107], v[84:87], v[140:143], a[104:107]
    v_mfma_f32_16x16x32_bf16 a[108:111], v[92:95], v[140:143], a[108:111]
    buffer_load_dwordx2 v[28:29], v13, s[60:63], s76 offen offset:0 nt
    v_mfma_f32_16x16x32_bf16 a[108:111], v[88:91], v[132:135], a[108:111]
    v_mfma_f32_16x16x32_bf16 a[112:115], v[96:99], v[132:135], a[112:115]
    ds_read_b64_tr_b16 v[156:157], v59 offset:24576
    v_mfma_f32_16x16x32_bf16 a[112:115], v[100:103], v[140:143], a[112:115]
    v_mfma_f32_16x16x32_bf16 a[116:119], v[108:111], v[140:143], a[116:119]
    buffer_load_dwordx2 v[30:31], v13, s[60:63], s76 offen offset:2048 nt
    v_mfma_f32_16x16x32_bf16 a[116:119], v[104:107], v[132:135], a[116:119]
    v_mfma_f32_16x16x32_bf16 a[120:123], v[112:115], v[132:135], a[120:123]
    ds_read_b64_tr_b16 v[158:159], v59 offset:25088
    v_mfma_f32_16x16x32_bf16 a[120:123], v[116:119], v[140:143], a[120:123]
    v_add_u32 v13, s57, v13
    v_mfma_f32_16x16x32_bf16 a[124:127], v[124:127], v[140:143], a[124:127]
    v_mfma_f32_16x16x32_bf16 a[124:127], v[120:123], v[132:135], a[124:127]
    s_waitcnt lgkmcnt(6)
    v_mfma_f32_16x16x32_bf16 a[128:131], v[144:147], v[64:67], a[128:131]
    ds_read_b64_tr_b16 v[128:129], v4 offset:32768
    s_waitcnt lgkmcnt(5)
    v_mfma_f32_16x16x32_bf16 a[128:131], v[152:155], v[68:71], a[128:131]
    s_add_u32 s45, s45, 1
    v_mfma_f32_16x16x32_bf16 a[132:135], v[152:155], v[76:79], a[132:135]
    v_mfma_f32_16x16x32_bf16 a[132:135], v[144:147], v[72:75], a[132:135]
    s_and_b32 s45, s45, 15
    s_cselect_b32 s100, 1, -15
    v_mfma_f32_16x16x32_bf16 a[136:139], v[144:147], v[80:83], a[136:139]
    ds_read_b64_tr_b16 v[130:131], v4 offset:33280
    v_mfma_f32_16x16x32_bf16 a[136:139], v[152:155], v[84:87], a[136:139]
    s_mul_i32 s101, s100, 0x80
    v_mfma_f32_16x16x32_bf16 a[140:143], v[152:155], v[92:95], a[140:143]
    s_nop 0
    v_mfma_f32_16x16x32_bf16 a[140:143], v[144:147], v[88:91], a[140:143]
    s_waitcnt lgkmcnt(4)
    v_smfmac_f32_16x16x64_bf16 v[48:51], v[32:35], v[144:151], v56
    v_mfma_f32_16x16x32_bf16 a[144:147], v[144:147], v[96:99], a[144:147]
    ds_read_b64_tr_b16 v[136:137], v58 offset:32768
    v_mfma_f32_16x16x32_bf16 a[144:147], v[152:155], v[100:103], a[144:147]
    v_add_u32_e64 v8, s101, v8
    v_mfma_f32_16x16x32_bf16 a[148:151], v[152:155], v[108:111], a[148:151]
    v_mfma_f32_16x16x32_bf16 a[148:151], v[144:147], v[104:107], a[148:151]
    s_mul_i32 s101, s100, 393216
    v_mfma_f32_16x16x32_bf16 a[152:155], v[144:147], v[112:115], a[152:155]
    ds_read_b64_tr_b16 v[138:139], v58 offset:33280
    v_mfma_f32_16x16x32_bf16 a[152:155], v[152:155], v[116:119], a[152:155]
    v_add_u32_e64 v9, s101, v9
    v_mfma_f32_16x16x32_bf16 a[156:159], v[152:155], v[124:127], a[156:159]
    v_mfma_f32_16x16x32_bf16 a[156:159], v[144:147], v[120:123], a[156:159]
    s_mul_i32 s101, s100, 458752
    v_mfma_f32_16x16x32_bf16 a[160:163], v[148:151], v[64:67], a[160:163]
    ds_read_b64_tr_b16 v[132:133], v5 offset:32768
    s_waitcnt lgkmcnt(5)
    v_mfma_f32_16x16x32_bf16 a[160:163], v[156:159], v[68:71], a[160:163]
    ds_read_b64_tr_b16 v[134:135], v5 offset:33280
    v_add_u32 v10, s101, v10
    v_mfma_f32_16x16x32_bf16 a[164:167], v[156:159], v[76:79], a[164:167]
    ds_read_b64_tr_b16 v[140:141], v59 offset:32768
    v_mfma_f32_16x16x32_bf16 a[164:167], v[148:151], v[72:75], a[164:167]
    ds_read_b64_tr_b16 v[142:143], v59 offset:33280
    s_mul_i32 s101, s100, s79
    v_mfma_f32_16x16x32_bf16 a[168:171], v[148:151], v[80:83], a[168:171]
    v_mfma_f32_16x16x32_bf16 a[168:171], v[156:159], v[84:87], a[168:171]
    v_add_u32 v15, s101, v15
    v_mfma_f32_16x16x32_bf16 a[172:175], v[156:159], v[92:95], a[172:175]
    v_mfma_f32_16x16x32_bf16 a[172:175], v[148:151], v[88:91], a[172:175]
    v_mfma_f32_16x16x32_bf16 a[176:179], v[148:151], v[96:99], a[176:179]
    v_mfma_f32_16x16x32_bf16 a[176:179], v[156:159], v[100:103], a[176:179]
    v_mfma_f32_16x16x32_bf16 a[180:183], v[156:159], v[108:111], a[180:183]
    v_mfma_f32_16x16x32_bf16 a[180:183], v[148:151], v[104:107], a[180:183]
    v_mfma_f32_16x16x32_bf16 a[184:187], v[148:151], v[112:115], a[184:187]
    v_mfma_f32_16x16x32_bf16 a[184:187], v[156:159], v[116:119], a[184:187]
    v_mfma_f32_16x16x32_bf16 a[188:191], v[156:159], v[124:127], a[188:191]
    v_mfma_f32_16x16x32_bf16 a[188:191], v[148:151], v[120:123], a[188:191]
    s_waitcnt vmcnt(9) lgkmcnt(0)
    s_barrier
    v_mfma_f32_16x16x32_bf16 a[192:195], v[128:131], v[64:67], a[192:195]
    s_add_u32 m0, s47, 65536
    ds_read_b64_tr_b16 v[144:145], v6 offset:0
    v_mfma_f32_16x16x32_bf16 a[192:195], v[136:139], v[68:71], a[192:195]
    buffer_load_dwordx4 v9, s[12:15], 0 offen nt lds
    v_mfma_f32_16x16x32_bf16 a[196:199], v[136:139], v[76:79], a[196:199]
    ds_read_b64_tr_b16 v[146:147], v6 offset:512
    v_mfma_f32_16x16x32_bf16 a[196:199], v[128:131], v[72:75], a[196:199]
    s_cmp_eq_u32 s48, 3
    s_cselect_b32 s101, 0, 2.0
    buffer_atomic_add v191, v190, s[68:71], s101 offen sc1
    v_mfma_f32_16x16x32_bf16 a[200:203], v[128:131], v[80:83], a[200:203]
    s_add_u32 m0, s47, 69632
    ds_read_b64_tr_b16 v[152:153], v60 offset:0
    v_mfma_f32_16x16x32_bf16 a[200:203], v[136:139], v[84:87], a[200:203]
    buffer_load_dwordx4 v9, s[12:15], s43 offen nt lds
    v_mfma_f32_16x16x32_bf16 a[204:207], v[136:139], v[92:95], a[204:207]
    ds_read_b64_tr_b16 v[154:155], v60 offset:512
    v_mfma_f32_16x16x32_bf16 a[204:207], v[128:131], v[88:91], a[204:207]
    v_smfmac_f32_16x16x64_bf16 v[52:55], v[32:35], v[128:135], v56
    v_mfma_f32_16x16x32_bf16 a[208:211], v[128:131], v[96:99], a[208:211]
    s_add_u32 m0, s47, 73728
    ds_read_b64_tr_b16 v[148:149], v7 offset:0
    v_mfma_f32_16x16x32_bf16 a[208:211], v[136:139], v[100:103], a[208:211]
    buffer_load_dwordx4 v15, s[16:19], 0 offen nt lds
    v_mfma_f32_16x16x32_bf16 a[212:215], v[136:139], v[108:111], a[212:215]
    ds_read_b64_tr_b16 v[150:151], v7 offset:512
    v_mfma_f32_16x16x32_bf16 a[212:215], v[128:131], v[104:107], a[212:215]
    v_mfma_f32_16x16x32_bf16 a[216:219], v[128:131], v[112:115], a[216:219]
    s_add_u32 m0, s47, 77824
    ds_read_b64_tr_b16 v[156:157], v61 offset:0
    v_mfma_f32_16x16x32_bf16 a[216:219], v[136:139], v[116:119], a[216:219]
    buffer_load_dwordx4 v15, s[16:19], s59 offen nt lds
    v_mfma_f32_16x16x32_bf16 a[220:223], v[136:139], v[124:127], a[220:223]
    ds_read_b64_tr_b16 v[158:159], v61 offset:512
    v_mfma_f32_16x16x32_bf16 a[220:223], v[128:131], v[120:123], a[220:223]
    v_mfma_f32_16x16x32_bf16 a[224:227], v[132:135], v[64:67], a[224:227]
    ds_read_b128 v[64:67], v2 offset:32768
    v_mfma_f32_16x16x32_bf16 a[224:227], v[140:143], v[68:71], a[224:227]
    ds_read_b128 v[68:71], v3 offset:32768
    v_mfma_f32_16x16x32_bf16 a[228:231], v[132:135], v[72:75], a[228:231]
    ds_read_b128 v[72:75], v2 offset:34816
    v_mfma_f32_16x16x32_bf16 a[228:231], v[140:143], v[76:79], a[228:231]
    ds_read_b128 v[76:79], v3 offset:34816
    v_mfma_f32_16x16x32_bf16 a[232:235], v[132:135], v[80:83], a[232:235]
    ds_read_b128 v[80:83], v2 offset:36864
    v_mfma_f32_16x16x32_bf16 a[232:235], v[140:143], v[84:87], a[232:235]
    ds_read_b128 v[84:87], v3 offset:36864
    v_mfma_f32_16x16x32_bf16 a[236:239], v[132:135], v[88:91], a[236:239]
    ds_read_b128 v[88:91], v2 offset:38912
    v_mfma_f32_16x16x32_bf16 a[236:239], v[140:143], v[92:95], a[236:239]
    ds_read_b128 v[92:95], v3 offset:38912
    v_mfma_f32_16x16x32_bf16 a[240:243], v[132:135], v[96:99], a[240:243]
    ds_read_b128 v[96:99], v2 offset:40960
    v_mfma_f32_16x16x32_bf16 a[240:243], v[140:143], v[100:103], a[240:243]
    ds_read_b128 v[100:103], v3 offset:40960
    v_mfma_f32_16x16x32_bf16 a[244:247], v[132:135], v[104:107], a[244:247]
    ds_read_b128 v[104:107], v2 offset:43008
    v_mfma_f32_16x16x32_bf16 a[244:247], v[140:143], v[108:111], a[244:247]
    ds_read_b128 v[108:111], v3 offset:43008
    v_mfma_f32_16x16x32_bf16 a[248:251], v[132:135], v[112:115], a[248:251]
    ds_read_b128 v[112:115], v2 offset:45056
    v_mfma_f32_16x16x32_bf16 a[248:251], v[140:143], v[116:119], a[248:251]
    ds_read_b128 v[116:119], v3 offset:45056
    v_mfma_f32_16x16x32_bf16 a[252:255], v[132:135], v[120:123], a[252:255]
    ds_read_b128 v[120:123], v2 offset:47104
    v_mfma_f32_16x16x32_bf16 a[252:255], v[140:143], v[124:127], a[252:255]
    ds_read_b128 v[124:127], v3 offset:47104
    s_waitcnt lgkmcnt(15)
    v_mfma_f32_16x16x32_bf16 a[0:3], v[144:147], v[64:67], a[0:3]
    ds_read_b64_tr_b16 v[128:129], v6 offset:8192
    s_waitcnt lgkmcnt(15)
    v_mfma_f32_16x16x32_bf16 a[0:3], v[152:155], v[68:71], a[0:3]
    s_add_u32 m0, s47, 81920
    s_waitcnt lgkmcnt(14)
    s_nop 0
    v_mfma_f32_16x16x32_bf16 a[4:7], v[144:147], v[72:75], a[4:7]
    buffer_load_dwordx4 v15, s[20:23], 0 offen nt lds
    s_waitcnt lgkmcnt(13)
    v_mfma_f32_16x16x32_bf16 a[4:7], v[152:155], v[76:79], a[4:7]
    s_waitcnt lgkmcnt(12)
    v_mfma_f32_16x16x32_bf16 a[8:11], v[144:147], v[80:83], a[8:11]
    ds_read_b64_tr_b16 v[130:131], v6 offset:8704
    s_waitcnt lgkmcnt(12)
    v_mfma_f32_16x16x32_bf16 a[8:11], v[152:155], v[84:87], a[8:11]
    s_add_u32 m0, s47, 86016
    s_waitcnt lgkmcnt(11)
    v_mfma_f32_16x16x32_bf16 a[12:15], v[144:147], v[88:91], a[12:15]
    buffer_load_dwordx4 v15, s[20:23], s59 offen nt lds
    s_waitcnt lgkmcnt(10)
    v_mfma_f32_16x16x32_bf16 a[12:15], v[152:155], v[92:95], a[12:15]
    s_nop 0
    v_smfmac_f32_16x16x64_bf16 v[36:39], v[32:35], v[144:151], v56
    s_waitcnt lgkmcnt(9)
    v_mfma_f32_16x16x32_bf16 a[16:19], v[144:147], v[96:99], a[16:19]
    ds_read_b64_tr_b16 v[136:137], v60 offset:8192
    s_waitcnt lgkmcnt(9)
    v_mfma_f32_16x16x32_bf16 a[16:19], v[152:155], v[100:103], a[16:19]
    s_add_u32 m0, s47, 90112
    s_waitcnt lgkmcnt(8)
    v_mfma_f32_16x16x32_bf16 a[20:23], v[144:147], v[104:107], a[20:23]
    s_nop 0
    buffer_load_dwordx4 v10, s[24:27], 0 offen nt lds
    s_waitcnt lgkmcnt(7)
    v_mfma_f32_16x16x32_bf16 a[20:23], v[152:155], v[108:111], a[20:23]
    s_waitcnt lgkmcnt(6)
    v_mfma_f32_16x16x32_bf16 a[24:27], v[144:147], v[112:115], a[24:27]
    ds_read_b64_tr_b16 v[138:139], v60 offset:8704
    s_waitcnt lgkmcnt(6)
    v_mfma_f32_16x16x32_bf16 a[24:27], v[152:155], v[116:119], a[24:27]
    s_add_u32 m0, s47, 94208
    s_waitcnt lgkmcnt(5)
    v_mfma_f32_16x16x32_bf16 a[28:31], v[144:147], v[120:123], a[28:31]
    buffer_load_dwordx4 v10, s[24:27], s44 offen nt lds
    s_waitcnt lgkmcnt(4)
    s_nop 0
    v_mfma_f32_16x16x32_bf16 a[28:31], v[152:155], v[124:127], a[28:31]
    v_mfma_f32_16x16x32_bf16 a[32:35], v[148:151], v[64:67], a[32:35]
    ds_read_b64_tr_b16 v[132:133], v7 offset:8192
    v_mfma_f32_16x16x32_bf16 a[32:35], v[156:159], v[68:71], a[32:35]
    s_add_u32 m0, s47, 98304
    v_mfma_f32_16x16x32_bf16 a[36:39], v[156:159], v[76:79], a[36:39]
    buffer_load_dwordx4 v10, s[28:31], 0 offen nt lds
    v_mfma_f32_16x16x32_bf16 a[36:39], v[148:151], v[72:75], a[36:39]
    v_mfma_f32_16x16x32_bf16 a[40:43], v[148:151], v[80:83], a[40:43]
    ds_read_b64_tr_b16 v[134:135], v7 offset:8704
    v_mfma_f32_16x16x32_bf16 a[40:43], v[156:159], v[84:87], a[40:43]
    s_add_u32 m0, s47, 102400
    v_mfma_f32_16x16x32_bf16 a[44:47], v[156:159], v[92:95], a[44:47]
    buffer_load_dwordx4 v10, s[28:31], s44 offen nt lds
    v_mfma_f32_16x16x32_bf16 a[44:47], v[148:151], v[88:91], a[44:47]
    v_mfma_f32_16x16x32_bf16 a[48:51], v[148:151], v[96:99], a[48:51]
    ds_read_b64_tr_b16 v[140:141], v61 offset:8192
    v_mfma_f32_16x16x32_bf16 a[48:51], v[156:159], v[100:103], a[48:51]
    s_add_u32 m0, s47, 0
    v_mfma_f32_16x16x32_bf16 a[52:55], v[156:159], v[108:111], a[52:55]
    buffer_load_dwordx4 v8, s[8:11], 0 offen  lds
    s_nop 0
    v_mfma_f32_16x16x32_bf16 a[52:55], v[148:151], v[104:107], a[52:55]
    v_mfma_f32_16x16x32_bf16 a[56:59], v[148:151], v[112:115], a[56:59]
    ds_read_b64_tr_b16 v[142:143], v61 offset:8704
    v_mfma_f32_16x16x32_bf16 a[56:59], v[156:159], v[116:119], a[56:59]
    s_add_u32 m0, s47, 4096
    v_mfma_f32_16x16x32_bf16 a[60:63], v[156:159], v[124:127], a[60:63]
    buffer_load_dwordx4 v8, s[8:11], s36 offen  lds
    v_mfma_f32_16x16x32_bf16 a[60:63], v[148:151], v[120:123], a[60:63]
    s_waitcnt lgkmcnt(6)
    v_mfma_f32_16x16x32_bf16 v[192:195], v[64:67], v[128:131], v[192:195]
    ds_read_b64_tr_b16 v[144:145], v6 offset:16384
    s_waitcnt lgkmcnt(5)
    v_mfma_f32_16x16x32_bf16 v[192:195], v[68:71], v[136:139], v[192:195]
    s_add_u32 m0, s47, 8192
    v_mfma_f32_16x16x32_bf16 v[196:199], v[76:79], v[136:139], v[196:199]
    buffer_load_dwordx4 v8, s[8:11], s37 offen  lds
    v_mfma_f32_16x16x32_bf16 v[196:199], v[72:75], v[128:131], v[196:199]
    s_waitcnt vmcnt(20)
    v_perm_b32 v160, v18, v16, s72
    v_mfma_f32_16x16x32_bf16 v[200:203], v[80:83], v[128:131], v[200:203]
    s_nop 0
    ds_read_b64_tr_b16 v[146:147], v6 offset:16896
    v_mfma_f32_16x16x32_bf16 v[200:203], v[84:87], v[136:139], v[200:203]
    s_add_u32 m0, s47, 12288
    s_waitcnt vmcnt(18)
    v_perm_b32 v161, v22, v20, s72
    s_nop 0
    v_mfma_f32_16x16x32_bf16 v[204:207], v[92:95], v[136:139], v[204:207]
    buffer_load_dwordx4 v8, s[8:11], s38 offen  lds
    s_nop 0
    v_mfma_f32_16x16x32_bf16 v[204:207], v[88:91], v[128:131], v[204:207]
    s_waitcnt lgkmcnt(4)
    v_smfmac_f32_16x16x64_bf16 v[40:43], v[32:35], v[128:135], v56
    v_mfma_f32_16x16x32_bf16 v[208:211], v[96:99], v[128:131], v[208:211]
    ds_read_b64_tr_b16 v[152:153], v60 offset:16384
    v_mfma_f32_16x16x32_bf16 v[208:211], v[100:103], v[136:139], v[208:211]
    s_add_u32 m0, s47, 16384
    s_waitcnt vmcnt(17)
    v_perm_b32 v162, v26, v24, s72
    s_nop 0
    v_mfma_f32_16x16x32_bf16 v[212:215], v[108:111], v[136:139], v[212:215]
    buffer_load_dwordx4 v8, s[8:11], s39 offen  lds
    v_mfma_f32_16x16x32_bf16 v[212:215], v[104:107], v[128:131], v[212:215]
    s_waitcnt vmcnt(16)
    v_perm_b32 v163, v30, v28, s72
    s_nop 0
    v_mfma_f32_16x16x32_bf16 v[216:219], v[112:115], v[128:131], v[216:219]
    ds_read_b64_tr_b16 v[154:155], v60 offset:16896
    v_mfma_f32_16x16x32_bf16 v[216:219], v[116:119], v[136:139], v[216:219]
    s_add_u32 m0, s47, 20480
    v_perm_b32 v164, v18, v16, s73
    v_mfma_f32_16x16x32_bf16 v[220:223], v[124:127], v[136:139], v[220:223]
    buffer_load_dwordx4 v8, s[8:11], s40 offen  lds
    v_mfma_f32_16x16x32_bf16 v[220:223], v[120:123], v[128:131], v[220:223]
    v_perm_b32 v165, v22, v20, s73
    v_mfma_f32_16x16x32_bf16 v[224:227], v[64:67], v[132:135], v[224:227]
    s_nop 0
    ds_read_b64_tr_b16 v[148:149], v7 offset:16384
    s_waitcnt lgkmcnt(5)
    v_mfma_f32_16x16x32_bf16 v[224:227], v[68:71], v[140:143], v[224:227]
    s_add_u32 m0, s47, 24576
    v_perm_b32 v166, v26, v24, s73
    v_mfma_f32_16x16x32_bf16 v[228:231], v[76:79], v[140:143], v[228:231]
    buffer_load_dwordx4 v8, s[8:11], s41 offen  lds
    v_mfma_f32_16x16x32_bf16 v[228:231], v[72:75], v[132:135], v[228:231]
    v_perm_b32 v167, v30, v28, s73
    v_mfma_f32_16x16x32_bf16 v[232:235], v[80:83], v[132:135], v[232:235]
    ds_read_b64_tr_b16 v[150:151], v7 offset:16896
    v_mfma_f32_16x16x32_bf16 v[232:235], v[84:87], v[140:143], v[232:235]
    s_add_u32 m0, s47, 28672
    v_perm_b32 v168, v19, v17, s72
    v_mfma_f32_16x16x32_bf16 v[236:239], v[92:95], v[140:143], v[236:239]
    buffer_load_dwordx4 v8, s[8:11], s42 offen  lds
    v_mfma_f32_16x16x32_bf16 v[236:239], v[88:91], v[132:135], v[236:239]
    v_perm_b32 v169, v23, v21, s72
    v_mfma_f32_16x16x32_bf16 v[240:243], v[96:99], v[132:135], v[240:243]
    ds_read_b64_tr_b16 v[156:157], v61 offset:16384
    v_mfma_f32_16x16x32_bf16 v[240:243], v[100:103], v[140:143], v[240:243]
    v_perm_b32 v170, v27, v25, s72
    v_mfma_f32_16x16x32_bf16 v[244:247], v[108:111], v[140:143], v[244:247]
    buffer_load_dword v57, v12, s[4:7], 0 offen
    s_nop 0
    v_mfma_f32_16x16x32_bf16 v[244:247], v[104:107], v[132:135], v[244:247]
    s_add_u32 s101, s45, 3
    v_perm_b32 v171, v31, v29, s72
    v_mfma_f32_16x16x32_bf16 v[248:251], v[112:115], v[132:135], v[248:251]
    ds_read_b64_tr_b16 v[158:159], v61 offset:16896
    v_mfma_f32_16x16x32_bf16 v[248:251], v[116:119], v[140:143], v[248:251]
    s_and_b32 s101, s101, 15
    s_cselect_b32 s100, 1, -15
    v_perm_b32 v172, v19, v17, s73
    v_mfma_f32_16x16x32_bf16 v[252:255], v[124:127], v[140:143], v[252:255]
    v_perm_b32 v173, v23, v21, s73
    global_load_dword v57, v[62:63], off
    v_mfma_f32_16x16x32_bf16 v[252:255], v[120:123], v[132:135], v[252:255]
    s_mul_i32 s101, s100, s49
    v_perm_b32 v174, v27, v25, s73
    s_waitcnt lgkmcnt(6)
    v_mfma_f32_16x16x32_bf16 a[64:67], v[64:67], v[144:147], a[64:67]
    ds_read_b64_tr_b16 v[128:129], v6 offset:24576
    s_waitcnt lgkmcnt(5)
    v_mfma_f32_16x16x32_bf16 a[64:67], v[68:71], v[152:155], a[64:67]
    v_add_u32 v12, s101, v12
    v_mfma_f32_16x16x32_bf16 a[68:71], v[76:79], v[152:155], a[68:71]
    v_perm_b32 v175, v31, v29, s73
    v_mfma_f32_16x16x32_bf16 a[68:71], v[72:75], v[144:147], a[68:71]
    v_mfma_f32_16x16x32_bf16 a[72:75], v[80:83], v[144:147], a[72:75]
    ds_read_b64_tr_b16 v[130:131], v6 offset:25088
    v_mfma_f32_16x16x32_bf16 a[72:75], v[84:87], v[152:155], a[72:75]
    v_mfma_f32_16x16x32_bf16 a[76:79], v[92:95], v[152:155], a[76:79]
    v_mfma_f32_16x16x32_bf16 a[76:79], v[88:91], v[144:147], a[76:79]
    s_waitcnt lgkmcnt(4)
    v_smfmac_f32_16x16x64_bf16 v[44:47], v[32:35], v[144:151], v56
    v_mfma_f32_16x16x32_bf16 a[80:83], v[96:99], v[144:147], a[80:83]
    ds_read_b64_tr_b16 v[136:137], v60 offset:24576
    s_nop 0
    v_mfma_f32_16x16x32_bf16 a[80:83], v[100:103], v[152:155], a[80:83]
    v_mfma_f32_16x16x32_bf16 a[84:87], v[108:111], v[152:155], a[84:87]
    buffer_store_dwordx4 v[160:163], v14, s[64:67], 0 offen offset:0 sc1
    v_mfma_f32_16x16x32_bf16 a[84:87], v[104:107], v[144:147], a[84:87]
    v_mfma_f32_16x16x32_bf16 a[88:91], v[112:115], v[144:147], a[88:91]
    ds_read_b64_tr_b16 v[138:139], v60 offset:25088
    v_mfma_f32_16x16x32_bf16 a[88:91], v[116:119], v[152:155], a[88:91]
    v_mfma_f32_16x16x32_bf16 a[92:95], v[124:127], v[152:155], a[92:95]
    v_mfma_f32_16x16x32_bf16 a[92:95], v[120:123], v[144:147], a[92:95]
    v_mfma_f32_16x16x32_bf16 a[96:99], v[64:67], v[148:151], a[96:99]
    s_nop 0
    ds_read_b64_tr_b16 v[132:133], v7 offset:24576
    s_waitcnt lgkmcnt(5)
    v_mfma_f32_16x16x32_bf16 a[96:99], v[68:71], v[156:159], a[96:99]
    v_mfma_f32_16x16x32_bf16 a[100:103], v[76:79], v[156:159], a[100:103]
    v_mfma_f32_16x16x32_bf16 a[100:103], v[72:75], v[148:151], a[100:103]
    v_mfma_f32_16x16x32_bf16 a[104:107], v[80:83], v[148:151], a[104:107]
    ds_read_b64_tr_b16 v[134:135], v7 offset:25088
    v_mfma_f32_16x16x32_bf16 a[104:107], v[84:87], v[156:159], a[104:107]
    v_mfma_f32_16x16x32_bf16 a[108:111], v[92:95], v[156:159], a[108:111]
    buffer_store_dwordx4 v[164:167], v14, s[64:67], 0 offen offset:128 sc1
    v_mfma_f32_16x16x32_bf16 a[108:111], v[88:91], v[148:151], a[108:111]
    v_mfma_f32_16x16x32_bf16 a[112:115], v[96:99], v[148:151], a[112:115]
    ds_read_b64_tr_b16 v[140:141], v61 offset:24576
    v_mfma_f32_16x16x32_bf16 a[112:115], v[100:103], v[156:159], a[112:115]
    v_mfma_f32_16x16x32_bf16 a[116:119], v[108:111], v[156:159], a[116:119]
    v_mfma_f32_16x16x32_bf16 a[116:119], v[104:107], v[148:151], a[116:119]
    v_mfma_f32_16x16x32_bf16 a[120:123], v[112:115], v[148:151], a[120:123]
    ds_read_b64_tr_b16 v[142:143], v61 offset:25088
    v_mfma_f32_16x16x32_bf16 a[120:123], v[116:119], v[156:159], a[120:123]
    v_mfma_f32_16x16x32_bf16 a[124:127], v[124:127], v[156:159], a[124:127]
    v_mfma_f32_16x16x32_bf16 a[124:127], v[120:123], v[148:151], a[124:127]
    s_waitcnt lgkmcnt(6)
    s_nop 0
    v_mfma_f32_16x16x32_bf16 a[128:131], v[128:131], v[64:67], a[128:131]
    ds_read_b64_tr_b16 v[144:145], v6 offset:32768
    s_waitcnt lgkmcnt(5)
    v_mfma_f32_16x16x32_bf16 a[128:131], v[136:139], v[68:71], a[128:131]
    s_add_u32 s45, s45, 1
    v_mfma_f32_16x16x32_bf16 a[132:135], v[136:139], v[76:79], a[132:135]
    buffer_store_dwordx4 v[168:171], v14, s[64:67], 0 offen offset:1024 sc1
    v_mfma_f32_16x16x32_bf16 a[132:135], v[128:131], v[72:75], a[132:135]
    s_and_b32 s45, s45, 15
    s_cselect_b32 s100, 1, -15
    v_mfma_f32_16x16x32_bf16 a[136:139], v[128:131], v[80:83], a[136:139]
    ds_read_b64_tr_b16 v[146:147], v6 offset:33280
    v_mfma_f32_16x16x32_bf16 a[136:139], v[136:139], v[84:87], a[136:139]
    s_mul_i32 s101, s100, 0x80
    v_mfma_f32_16x16x32_bf16 a[140:143], v[136:139], v[92:95], a[140:143]
    v_mfma_f32_16x16x32_bf16 a[140:143], v[128:131], v[88:91], a[140:143]
    s_waitcnt lgkmcnt(4)
    v_smfmac_f32_16x16x64_bf16 v[48:51], v[32:35], v[128:135], v56
    s_nop 0
    v_mfma_f32_16x16x32_bf16 a[144:147], v[128:131], v[96:99], a[144:147]
    ds_read_b64_tr_b16 v[152:153], v60 offset:32768
    v_mfma_f32_16x16x32_bf16 a[144:147], v[136:139], v[100:103], a[144:147]
    v_add_u32_e64 v8, s101, v8
    v_mfma_f32_16x16x32_bf16 a[148:151], v[136:139], v[108:111], a[148:151]
    v_mfma_f32_16x16x32_bf16 a[148:151], v[128:131], v[104:107], a[148:151]
    s_mul_i32 s101, s100, 393216
    v_mfma_f32_16x16x32_bf16 a[152:155], v[128:131], v[112:115], a[152:155]
    ds_read_b64_tr_b16 v[154:155], v60 offset:33280
    v_mfma_f32_16x16x32_bf16 a[152:155], v[136:139], v[116:119], a[152:155]
    v_add_u32_e64 v9, s101, v9
    v_mfma_f32_16x16x32_bf16 a[156:159], v[136:139], v[124:127], a[156:159]
    buffer_store_dwordx4 v[172:175], v14, s[64:67], 0 offen offset:1152 sc1
    v_mfma_f32_16x16x32_bf16 a[156:159], v[128:131], v[120:123], a[156:159]
    s_mul_i32 s101, s100, 458752
    v_mfma_f32_16x16x32_bf16 a[160:163], v[132:135], v[64:67], a[160:163]
    ds_read_b64_tr_b16 v[148:149], v7 offset:32768
    s_waitcnt lgkmcnt(5)
    v_mfma_f32_16x16x32_bf16 a[160:163], v[140:143], v[68:71], a[160:163]
    ds_read_b64_tr_b16 v[150:151], v7 offset:33280
    v_add_u32 v10, s101, v10
    v_mfma_f32_16x16x32_bf16 a[164:167], v[140:143], v[76:79], a[164:167]
    ds_read_b64_tr_b16 v[156:157], v61 offset:32768
    v_mfma_f32_16x16x32_bf16 a[164:167], v[132:135], v[72:75], a[164:167]
    ds_read_b64_tr_b16 v[158:159], v61 offset:33280
    s_mul_i32 s101, s100, s79
    v_mfma_f32_16x16x32_bf16 a[168:171], v[132:135], v[80:83], a[168:171]
    v_mfma_f32_16x16x32_bf16 a[168:171], v[140:143], v[84:87], a[168:171]
    v_add_u32 v15, s101, v15
    v_mfma_f32_16x16x32_bf16 a[172:175], v[140:143], v[92:95], a[172:175]
    v_mfma_f32_16x16x32_bf16 a[172:175], v[132:135], v[88:91], a[172:175]
    v_add_u32_e64 v14, s58, v14
    v_mfma_f32_16x16x32_bf16 a[176:179], v[132:135], v[96:99], a[176:179]
    v_mfma_f32_16x16x32_bf16 a[176:179], v[140:143], v[100:103], a[176:179]
    v_mfma_f32_16x16x32_bf16 a[180:183], v[140:143], v[108:111], a[180:183]
    v_mfma_f32_16x16x32_bf16 a[180:183], v[132:135], v[104:107], a[180:183]
    v_mfma_f32_16x16x32_bf16 a[184:187], v[132:135], v[112:115], a[184:187]
    v_mfma_f32_16x16x32_bf16 a[184:187], v[140:143], v[116:119], a[184:187]
    v_mfma_f32_16x16x32_bf16 a[188:191], v[140:143], v[124:127], a[188:191]
    v_mfma_f32_16x16x32_bf16 a[188:191], v[132:135], v[120:123], a[188:191]
    s_waitcnt vmcnt(6) lgkmcnt(0)
    s_barrier
    v_mfma_f32_16x16x32_bf16 a[192:195], v[144:147], v[64:67], a[192:195]
    s_add_u32 m0, s47, 106496
    ds_read_b64_tr_b16 v[128:129], v4 offset:0
    v_mfma_f32_16x16x32_bf16 a[192:195], v[152:155], v[68:71], a[192:195]
    buffer_load_dwordx4 v9, s[12:15], 0 offen nt lds
    v_mfma_f32_16x16x32_bf16 a[196:199], v[152:155], v[76:79], a[196:199]
    ds_read_b64_tr_b16 v[130:131], v4 offset:512
    v_mfma_f32_16x16x32_bf16 a[196:199], v[144:147], v[72:75], a[196:199]
    v_mfma_f32_16x16x32_bf16 a[200:203], v[144:147], v[80:83], a[200:203]
    s_add_u32 m0, s47, 110592
    ds_read_b64_tr_b16 v[136:137], v58 offset:0
    v_mfma_f32_16x16x32_bf16 a[200:203], v[152:155], v[84:87], a[200:203]
    buffer_load_dwordx4 v9, s[12:15], s43 offen nt lds
    v_mfma_f32_16x16x32_bf16 a[204:207], v[152:155], v[92:95], a[204:207]
    ds_read_b64_tr_b16 v[138:139], v58 offset:512
    v_mfma_f32_16x16x32_bf16 a[204:207], v[144:147], v[88:91], a[204:207]
    v_smfmac_f32_16x16x64_bf16 v[52:55], v[32:35], v[144:151], v56
    v_mfma_f32_16x16x32_bf16 a[208:211], v[144:147], v[96:99], a[208:211]
    s_add_u32 m0, s47, 114688
    ds_read_b64_tr_b16 v[132:133], v5 offset:0
    v_mfma_f32_16x16x32_bf16 a[208:211], v[152:155], v[100:103], a[208:211]
    buffer_load_dwordx4 v15, s[16:19], 0 offen nt lds
    v_mfma_f32_16x16x32_bf16 a[212:215], v[152:155], v[108:111], a[212:215]
    ds_read_b64_tr_b16 v[134:135], v5 offset:512
    v_mfma_f32_16x16x32_bf16 a[212:215], v[144:147], v[104:107], a[212:215]
    v_mfma_f32_16x16x32_bf16 a[216:219], v[144:147], v[112:115], a[216:219]
    s_add_u32 m0, s47, 118784
    ds_read_b64_tr_b16 v[140:141], v59 offset:0
    v_mfma_f32_16x16x32_bf16 a[216:219], v[152:155], v[116:119], a[216:219]
    buffer_load_dwordx4 v15, s[16:19], s59 offen nt lds
    v_mfma_f32_16x16x32_bf16 a[220:223], v[152:155], v[124:127], a[220:223]
    ds_read_b64_tr_b16 v[142:143], v59 offset:512
    v_mfma_f32_16x16x32_bf16 a[220:223], v[144:147], v[120:123], a[220:223]
    v_mfma_f32_16x16x32_bf16 a[224:227], v[148:151], v[64:67], a[224:227]
    ds_read_b128 v[64:67], v2 offset:0
    v_mfma_f32_16x16x32_bf16 a[224:227], v[156:159], v[68:71], a[224:227]
    ds_read_b128 v[68:71], v3 offset:0
    v_mfma_f32_16x16x32_bf16 a[228:231], v[148:151], v[72:75], a[228:231]
    ds_read_b128 v[72:75], v2 offset:2048
    v_mfma_f32_16x16x32_bf16 a[228:231], v[156:159], v[76:79], a[228:231]
    ds_read_b128 v[76:79], v3 offset:2048
    v_mfma_f32_16x16x32_bf16 a[232:235], v[148:151], v[80:83], a[232:235]
    ds_read_b128 v[80:83], v2 offset:4096
    v_mfma_f32_16x16x32_bf16 a[232:235], v[156:159], v[84:87], a[232:235]
    ds_read_b128 v[84:87], v3 offset:4096
    v_mfma_f32_16x16x32_bf16 a[236:239], v[148:151], v[88:91], a[236:239]
    ds_read_b128 v[88:91], v2 offset:6144
    v_mfma_f32_16x16x32_bf16 a[236:239], v[156:159], v[92:95], a[236:239]
    ds_read_b128 v[92:95], v3 offset:6144
    v_mfma_f32_16x16x32_bf16 a[240:243], v[148:151], v[96:99], a[240:243]
    ds_read_b128 v[96:99], v2 offset:8192
    v_mfma_f32_16x16x32_bf16 a[240:243], v[156:159], v[100:103], a[240:243]
    ds_read_b128 v[100:103], v3 offset:8192
    v_mfma_f32_16x16x32_bf16 a[244:247], v[148:151], v[104:107], a[244:247]
    ds_read_b128 v[104:107], v2 offset:10240
    v_mfma_f32_16x16x32_bf16 a[244:247], v[156:159], v[108:111], a[244:247]
    ds_read_b128 v[108:111], v3 offset:10240
    v_mfma_f32_16x16x32_bf16 a[248:251], v[148:151], v[112:115], a[248:251]
    ds_read_b128 v[112:115], v2 offset:12288
    v_mfma_f32_16x16x32_bf16 a[248:251], v[156:159], v[116:119], a[248:251]
    s_sub_u32 s48, s48, 1
    ds_read_b128 v[116:119], v3 offset:12288
    v_mfma_f32_16x16x32_bf16 a[252:255], v[148:151], v[120:123], a[252:255]
    s_cmp_lg_u32 s48, 0
    ds_read_b128 v[120:123], v2 offset:14336
    v_mfma_f32_16x16x32_bf16 a[252:255], v[156:159], v[124:127], a[252:255]
    ds_read_b128 v[124:127], v3 offset:14336
    s_cbranch_scc1 L_g1_loopB
L_g1_tB:
    s_waitcnt lgkmcnt(15)
    v_mfma_f32_16x16x32_bf16 a[0:3], v[128:131], v[64:67], a[0:3]
    ds_read_b64_tr_b16 v[144:145], v4 offset:8192
    buffer_load_dword v13, off, s[68:71], 0 sc1
    s_waitcnt lgkmcnt(15)
    v_mfma_f32_16x16x32_bf16 a[0:3], v[136:139], v[68:71], a[0:3]
    s_add_u32 m0, s47, 122880
    s_waitcnt vmcnt(5)
    v_add_f32 v160, v36, v37
    v_add_f32 v161, v38, v39
    s_waitcnt lgkmcnt(14)
    v_mfma_f32_16x16x32_bf16 a[4:7], v[128:131], v[72:75], a[4:7]
    buffer_load_dwordx4 v15, s[20:23], 0 offen nt lds
    v_and_b32 v12, 15, v0
    s_waitcnt lgkmcnt(13)
    v_mfma_f32_16x16x32_bf16 a[4:7], v[136:139], v[76:79], a[4:7]
    v_lshlrev_b32 v12, 2, v12
    s_add_u32 s83, s47, 147456
    v_add_u32 v12, s83, v12
    s_waitcnt lgkmcnt(12)
    v_mfma_f32_16x16x32_bf16 a[8:11], v[128:131], v[80:83], a[8:11]
    ds_read_b64_tr_b16 v[146:147], v4 offset:8704
    v_add_f32 v162, v40, v41
    s_waitcnt lgkmcnt(12)
    v_mfma_f32_16x16x32_bf16 a[8:11], v[136:139], v[84:87], a[8:11]
    s_add_u32 m0, s47, 126976
    v_add_f32 v163, v42, v43
    v_add_f32_e64 v164, v44, v45
    s_waitcnt lgkmcnt(11)
    v_mfma_f32_16x16x32_bf16 a[12:15], v[128:131], v[88:91], a[12:15]
    buffer_load_dwordx4 v15, s[20:23], s59 offen nt lds
    v_add_f32 v165, v46, v47
    s_waitcnt lgkmcnt(10)
    v_mfma_f32_16x16x32_bf16 a[12:15], v[136:139], v[92:95], a[12:15]
    v_smfmac_f32_16x16x64_bf16 v[36:39], v[32:35], v[128:135], v56
    s_waitcnt lgkmcnt(9)
    v_mfma_f32_16x16x32_bf16 a[16:19], v[128:131], v[96:99], a[16:19]
    ds_read_b64_tr_b16 v[152:153], v58 offset:8192
    v_add_f32_e64 v166, v48, v49
    s_waitcnt lgkmcnt(9)
    v_mfma_f32_16x16x32_bf16 a[16:19], v[136:139], v[100:103], a[16:19]
    s_add_u32 m0, s47, 131072
    v_add_f32 v167, v50, v51
    v_add_f32_e64 v168, v52, v53
    s_waitcnt lgkmcnt(8)
    v_mfma_f32_16x16x32_bf16 a[20:23], v[128:131], v[104:107], a[20:23]
    buffer_load_dwordx4 v10, s[24:27], 0 offen nt lds
    v_add_f32 v169, v54, v55
    s_waitcnt lgkmcnt(7)
    v_mfma_f32_16x16x32_bf16 a[20:23], v[136:139], v[108:111], a[20:23]
    v_smfmac_f32_16x16x64_bf16 v[36:39], v[32:35], v[136:143], v56
    s_waitcnt lgkmcnt(6)
    v_mfma_f32_16x16x32_bf16 a[24:27], v[128:131], v[112:115], a[24:27]
    ds_read_b64_tr_b16 v[154:155], v58 offset:8704
    s_waitcnt lgkmcnt(6)
    v_mfma_f32_16x16x32_bf16 a[24:27], v[136:139], v[116:119], a[24:27]
    s_add_u32 m0, s47, 135168
    ds_write_b32 v12, v160 offset:4096
    s_waitcnt lgkmcnt(6)
    v_mfma_f32_16x16x32_bf16 a[28:31], v[128:131], v[120:123], a[28:31]
    buffer_load_dwordx4 v10, s[24:27], s44 offen nt lds
    s_waitcnt lgkmcnt(5)
    v_mfma_f32_16x16x32_bf16 a[28:31], v[136:139], v[124:127], a[28:31]
    ds_write_b32 v12, v161 offset:4160
    v_mfma_f32_16x16x32_bf16 a[32:35], v[132:135], v[64:67], a[32:35]
    ds_read_b64_tr_b16 v[148:149], v5 offset:8192
    v_mfma_f32_16x16x32_bf16 a[32:35], v[140:143], v[68:71], a[32:35]
    s_add_u32 m0, s47, 139264
    ds_write_b32 v12, v162 offset:4224
    v_mfma_f32_16x16x32_bf16 a[36:39], v[132:135], v[72:75], a[36:39]
    buffer_load_dwordx4 v10, s[28:31], 0 offen nt lds
    v_mfma_f32_16x16x32_bf16 a[36:39], v[140:143], v[76:79], a[36:39]
    ds_write_b32 v12, v163 offset:4288
    v_mfma_f32_16x16x32_bf16 a[40:43], v[132:135], v[80:83], a[40:43]
    ds_read_b64_tr_b16 v[150:151], v5 offset:8704
    v_mfma_f32_16x16x32_bf16 a[40:43], v[140:143], v[84:87], a[40:43]
    s_add_u32 m0, s47, 143360
    ds_write_b32 v12, v164 offset:4352
    v_mfma_f32_16x16x32_bf16 a[44:47], v[132:135], v[88:91], a[44:47]
    buffer_load_dwordx4 v10, s[28:31], s44 offen nt lds
    v_mfma_f32_16x16x32_bf16 a[44:47], v[140:143], v[92:95], a[44:47]
    ds_write_b32 v12, v165 offset:4416
    v_mfma_f32_16x16x32_bf16 a[48:51], v[132:135], v[96:99], a[48:51]
    ds_read_b64_tr_b16 v[156:157], v59 offset:8192
    v_mfma_f32_16x16x32_bf16 a[48:51], v[140:143], v[100:103], a[48:51]
    s_add_u32 m0, s47, 32768
    ds_write_b32 v12, v166 offset:4480
    v_mfma_f32_16x16x32_bf16 a[52:55], v[132:135], v[104:107], a[52:55]
    buffer_load_dwordx4 v8, s[8:11], 0 offen  lds
    v_mfma_f32_16x16x32_bf16 a[52:55], v[140:143], v[108:111], a[52:55]
    ds_write_b32 v12, v167 offset:4544
    v_mfma_f32_16x16x32_bf16 a[56:59], v[132:135], v[112:115], a[56:59]
    ds_read_b64_tr_b16 v[158:159], v59 offset:8704
    v_mfma_f32_16x16x32_bf16 a[56:59], v[140:143], v[116:119], a[56:59]
    s_add_u32 m0, s47, 36864
    ds_write_b32 v12, v168 offset:4608
    v_mfma_f32_16x16x32_bf16 a[60:63], v[132:135], v[120:123], a[60:63]
    buffer_load_dwordx4 v8, s[8:11], s36 offen  lds
    v_mfma_f32_16x16x32_bf16 a[60:63], v[140:143], v[124:127], a[60:63]
    ds_write_b32 v12, v169 offset:4672
    s_waitcnt lgkmcnt(15)
    v_mfma_f32_16x16x32_bf16 v[192:195], v[64:67], v[144:147], v[192:195]
    ds_read_b64_tr_b16 v[128:129], v4 offset:16384
    s_waitcnt lgkmcnt(15)
    v_mfma_f32_16x16x32_bf16 v[192:195], v[68:71], v[152:155], v[192:195]
    s_add_u32 m0, s47, 40960
    v_mfma_f32_16x16x32_bf16 v[196:199], v[72:75], v[144:147], v[196:199]
    buffer_load_dwordx4 v8, s[8:11], s37 offen  lds
    v_mfma_f32_16x16x32_bf16 v[196:199], v[76:79], v[152:155], v[196:199]
    v_mfma_f32_16x16x32_bf16 v[200:203], v[80:83], v[144:147], v[200:203]
    ds_read_b64_tr_b16 v[130:131], v4 offset:16896
    v_mfma_f32_16x16x32_bf16 v[200:203], v[84:87], v[152:155], v[200:203]
    s_add_u32 m0, s47, 45056
    v_mfma_f32_16x16x32_bf16 v[204:207], v[88:91], v[144:147], v[204:207]
    buffer_load_dwordx4 v8, s[8:11], s38 offen  lds
    v_mfma_f32_16x16x32_bf16 v[204:207], v[92:95], v[152:155], v[204:207]
    s_waitcnt lgkmcnt(10)
    s_nop 0
    v_smfmac_f32_16x16x64_bf16 v[40:43], v[32:35], v[144:151], v56
    v_mfma_f32_16x16x32_bf16 v[208:211], v[96:99], v[144:147], v[208:211]
    ds_read_b64_tr_b16 v[136:137], v58 offset:16384
    v_mfma_f32_16x16x32_bf16 v[208:211], v[100:103], v[152:155], v[208:211]
    s_add_u32 m0, s47, 49152
    v_mfma_f32_16x16x32_bf16 v[212:215], v[104:107], v[144:147], v[212:215]
    buffer_load_dwordx4 v8, s[8:11], s39 offen  lds
    v_mfma_f32_16x16x32_bf16 v[212:215], v[108:111], v[152:155], v[212:215]
    s_waitcnt lgkmcnt(5)
    v_smfmac_f32_16x16x64_bf16 v[40:43], v[32:35], v[152:159], v56
    v_mfma_f32_16x16x32_bf16 v[216:219], v[112:115], v[144:147], v[216:219]
    s_nop 0
    ds_read_b64_tr_b16 v[138:139], v58 offset:16896
    v_mfma_f32_16x16x32_bf16 v[216:219], v[116:119], v[152:155], v[216:219]
    s_add_u32 m0, s47, 53248
    v_mfma_f32_16x16x32_bf16 v[220:223], v[120:123], v[144:147], v[220:223]
    buffer_load_dwordx4 v8, s[8:11], s40 offen  lds
    v_mfma_f32_16x16x32_bf16 v[220:223], v[124:127], v[152:155], v[220:223]
    v_mfma_f32_16x16x32_bf16 v[224:227], v[64:67], v[148:151], v[224:227]
    ds_read_b64_tr_b16 v[132:133], v5 offset:16384
    v_mfma_f32_16x16x32_bf16 v[224:227], v[68:71], v[156:159], v[224:227]
    s_add_u32 m0, s47, 57344
    v_mfma_f32_16x16x32_bf16 v[228:231], v[72:75], v[148:151], v[228:231]
    buffer_load_dwordx4 v8, s[8:11], s41 offen  lds
    v_mfma_f32_16x16x32_bf16 v[228:231], v[76:79], v[156:159], v[228:231]
    v_mfma_f32_16x16x32_bf16 v[232:235], v[80:83], v[148:151], v[232:235]
    ds_read_b64_tr_b16 v[134:135], v5 offset:16896
    v_mfma_f32_16x16x32_bf16 v[232:235], v[84:87], v[156:159], v[232:235]
    s_add_u32 m0, s47, 61440
    v_mfma_f32_16x16x32_bf16 v[236:239], v[88:91], v[148:151], v[236:239]
    buffer_load_dwordx4 v8, s[8:11], s42 offen  lds
    v_mfma_f32_16x16x32_bf16 v[236:239], v[92:95], v[156:159], v[236:239]
    v_mfma_f32_16x16x32_bf16 v[240:243], v[96:99], v[148:151], v[240:243]
    ds_read_b64_tr_b16 v[140:141], v59 offset:16384
    s_mov_b32 s12, s84
    v_mfma_f32_16x16x32_bf16 v[240:243], v[100:103], v[156:159], v[240:243]
    s_nop 0
    s_and_b32 s13, s85, 0xffff
    v_mfma_f32_16x16x32_bf16 v[244:247], v[104:107], v[148:151], v[244:247]
    s_mov_b32 s14, 4194304
    v_mfma_f32_16x16x32_bf16 v[244:247], v[108:111], v[156:159], v[244:247]
    s_mov_b32 s15, 0x20000
    v_mfma_f32_16x16x32_bf16 v[248:251], v[112:115], v[148:151], v[248:251]
    ds_read_b64_tr_b16 v[142:143], v59 offset:16896
    v_mfma_f32_16x16x32_bf16 v[248:251], v[116:119], v[156:159], v[248:251]
    v_mfma_f32_16x16x32_bf16 v[252:255], v[120:123], v[148:151], v[252:255]
    s_waitcnt vmcnt(14)
    v_readfirstlane_b32 s84, v13
    v_mfma_f32_16x16x32_bf16 v[252:255], v[124:127], v[156:159], v[252:255]
    s_waitcnt lgkmcnt(6)
    v_mfma_f32_16x16x32_bf16 a[64:67], v[64:67], v[128:131], a[64:67]
    ds_read_b64_tr_b16 v[144:145], v4 offset:24576
    s_waitcnt lgkmcnt(5)
    v_mfma_f32_16x16x32_bf16 a[64:67], v[68:71], v[136:139], a[64:67]
    s_cmp_lt_u32 s84, 256
    v_mfma_f32_16x16x32_bf16 a[68:71], v[72:75], v[128:131], a[68:71]
    s_cbranch_scc1 L_g1_spinB
L_g1_goB:
    buffer_load_dwordx4 v[180:183], v11, s[32:35], s80 offen sc1
    v_mfma_f32_16x16x32_bf16 a[68:71], v[76:79], v[136:139], a[68:71]
    s_mov_b32 s43, s77
    s_cmp_lg_u32 s77, 0
    s_cselect_b32 s60, 2.0, s46
    v_mfma_f32_16x16x32_bf16 a[72:75], v[80:83], v[128:131], a[72:75]
    ds_read_b64_tr_b16 v[146:147], v4 offset:25088
    s_mov_b32 s74, s46
    v_mfma_f32_16x16x32_bf16 a[72:75], v[84:87], v[136:139], a[72:75]
    s_mov_b64 s[28:29], s[8:9]
    v_mfma_f32_16x16x32_bf16 a[76:79], v[88:91], v[128:131], a[76:79]
    v_mov_b32_e64 v8, v12
    s_mov_b64 s[30:31], s[10:11]
    s_and_b32 s62, s2, 7
    v_mfma_f32_16x16x32_bf16 a[76:79], v[92:95], v[136:139], a[76:79]
    s_waitcnt lgkmcnt(4)
    v_smfmac_f32_16x16x64_bf16 v[44:47], v[32:35], v[128:135], v56
    v_mfma_f32_16x16x32_bf16 a[80:83], v[96:99], v[128:131], a[80:83]
    ds_read_b64_tr_b16 v[152:153], v58 offset:24576
    s_lshl_b32 s62, s62, 2
    v_mfma_f32_16x16x32_bf16 a[80:83], v[100:103], v[136:139], a[80:83]
    v_xor_b32 v10, 2048, v12
    s_bfe_u32 s63, s2, 0x20003
    v_mfma_f32_16x16x32_bf16 a[84:87], v[104:107], v[128:131], a[84:87]
    v_lshrrev_b32_e64 v9, 4, v0
    s_add_u32 s62, s62, s63
    v_mfma_f32_16x16x32_bf16 a[84:87], v[108:111], v[136:139], a[84:87]
    s_waitcnt lgkmcnt(3)
    v_smfmac_f32_16x16x64_bf16 v[44:47], v[32:35], v[136:143], v56
    v_mfma_f32_16x16x32_bf16 a[88:91], v[112:115], v[128:131], a[88:91]
    ds_read_b64_tr_b16 v[154:155], v58 offset:25088
    s_lshr_b32 s64, s2, 5
    s_bfe_u32 s65, s2, 0x20001
    s_nop 0
    v_mfma_f32_16x16x32_bf16 a[88:91], v[116:119], v[136:139], a[88:91]
    v_lshlrev_b32 v9, 4, v9
    s_lshl_b32 s65, s65, 2
    v_mfma_f32_16x16x32_bf16 a[92:95], v[120:123], v[128:131], a[92:95]
    v_add_u32 v9, s83, v9
    s_add_u32 s65, s65, s63
    v_mfma_f32_16x16x32_bf16 a[92:95], v[124:127], v[136:139], a[92:95]
    v_add_u32 v15, s83, v11
    s_and_b32 s66, s2, 1
    v_mfma_f32_16x16x32_bf16 a[96:99], v[64:67], v[132:135], a[96:99]
    ds_read_b64_tr_b16 v[148:149], v5 offset:24576
    v_add_u32 v10, 4096, v10
    v_mfma_f32_16x16x32_bf16 a[96:99], v[68:71], v[140:143], a[96:99]
    s_lshl_b32 s66, s66, 3
    s_add_u32 s66, s66, s64
    v_mfma_f32_16x16x32_bf16 a[100:103], v[72:75], v[132:135], a[100:103]
    s_lshl_b32 s57, s43, 10
    v_mfma_f32_16x16x32_bf16 a[100:103], v[76:79], v[140:143], a[100:103]
    s_add_u32 s36, s57, 131072
    v_mfma_f32_16x16x32_bf16 a[104:107], v[80:83], v[132:135], a[104:107]
    ds_read_b64_tr_b16 v[150:151], v5 offset:25088
    s_mov_b32 s37, 0
    v_mfma_f32_16x16x32_bf16 a[104:107], v[84:87], v[140:143], a[104:107]
    s_lshl_b32 s58, s62, 17
    s_lshl_b32 s59, s64, 14
    v_mfma_f32_16x16x32_bf16 a[108:111], v[88:91], v[132:135], a[108:111]
    s_add_u32 s58, s58, s59
    v_mfma_f32_16x16x32_bf16 a[108:111], v[92:95], v[140:143], a[108:111]
    s_lshl_b32 s38, s43, 12
    v_mfma_f32_16x16x32_bf16 a[112:115], v[96:99], v[132:135], a[112:115]
    ds_read_b64_tr_b16 v[156:157], v59 offset:24576
    s_add_u32 s58, s58, s38
    v_mfma_f32_16x16x32_bf16 a[112:115], v[100:103], v[140:143], a[112:115]
    s_add_u32 s40, s58, 4194304
    s_lshl_b32 s58, s62, 18
    v_mfma_f32_16x16x32_bf16 a[116:119], v[104:107], v[132:135], a[116:119]
    s_add_u32 s58, s58, 8388608
    v_mfma_f32_16x16x32_bf16 a[116:119], v[108:111], v[140:143], a[116:119]
    s_add_u32 s8, s32, s58
    s_addc_u32 s9, s33, 0
    v_mfma_f32_16x16x32_bf16 a[120:123], v[112:115], v[132:135], a[120:123]
    ds_read_b64_tr_b16 v[158:159], v59 offset:25088
    s_and_b32 s9, s9, 0xffff
    v_mfma_f32_16x16x32_bf16 a[120:123], v[116:119], v[140:143], a[120:123]
    s_mov_b32 s10, 262144
    s_mov_b32 s11, 0x20000
    v_mfma_f32_16x16x32_bf16 a[124:127], v[120:123], v[132:135], a[124:127]
    s_mul_i32 s58, s65, 1179648
    v_mfma_f32_16x16x32_bf16 a[124:127], v[124:127], v[140:143], a[124:127]
    s_add_u32 s58, s58, 16777216
    s_waitcnt lgkmcnt(6)
    v_mfma_f32_16x16x32_bf16 a[128:131], v[144:147], v[64:67], a[128:131]
    ds_read_b64_tr_b16 v[128:129], v4 offset:32768
    s_add_u32 s16, s32, s58
    s_addc_u32 s17, s33, 0
    s_waitcnt lgkmcnt(5)
    v_mfma_f32_16x16x32_bf16 a[128:131], v[152:155], v[68:71], a[128:131]
    s_and_b32 s17, s17, 0xffff
    s_mov_b32 s18, 1179648
    v_mfma_f32_16x16x32_bf16 a[132:135], v[144:147], v[72:75], a[132:135]
    s_mov_b32 s19, 0x20000
    v_mfma_f32_16x16x32_bf16 a[132:135], v[152:155], v[76:79], a[132:135]
    s_lshr_b32 s58, s66, 1
    v_mfma_f32_16x16x32_bf16 a[136:139], v[144:147], v[80:83], a[136:139]
    ds_read_b64_tr_b16 v[130:131], v4 offset:33280
    s_mul_i32 s58, s58, 917504
    s_and_b32 s59, s66, 1
    v_mfma_f32_16x16x32_bf16 a[136:139], v[152:155], v[84:87], a[136:139]
    s_lshl_b32 s59, s59, 11
    v_mfma_f32_16x16x32_bf16 a[140:143], v[144:147], v[88:91], a[140:143]
    s_add_u32 s58, s58, s59
    s_nop 0
    v_mfma_f32_16x16x32_bf16 a[140:143], v[152:155], v[92:95], a[140:143]
    s_waitcnt lgkmcnt(4)
    v_smfmac_f32_16x16x64_bf16 v[48:51], v[32:35], v[144:151], v56
    v_mfma_f32_16x16x32_bf16 a[144:147], v[144:147], v[96:99], a[144:147]
    ds_read_b64_tr_b16 v[136:137], v58 offset:32768
    s_add_u32 s58, s58, 41943040
    v_mfma_f32_16x16x32_bf16 a[144:147], v[152:155], v[100:103], a[144:147]
    s_add_u32 s20, s32, s58
    s_addc_u32 s21, s33, 0
    s_and_b32 s21, s21, 0xffff
    v_mfma_f32_16x16x32_bf16 a[148:151], v[144:147], v[104:107], a[148:151]
    s_mov_b32 s22, 917504
    v_mfma_f32_16x16x32_bf16 a[148:151], v[152:155], v[108:111], a[148:151]
    s_waitcnt lgkmcnt(3)
    v_smfmac_f32_16x16x64_bf16 v[48:51], v[32:35], v[152:159], v56
    v_mfma_f32_16x16x32_bf16 a[152:155], v[144:147], v[112:115], a[152:155]
    ds_read_b64_tr_b16 v[138:139], v58 offset:33280
    s_mov_b32 s23, 0x20000
    v_mfma_f32_16x16x32_bf16 a[152:155], v[152:155], v[116:119], a[152:155]
    s_lshl_b32 s58, s66, 17
    v_mfma_f32_16x16x32_bf16 a[156:159], v[144:147], v[120:123], a[156:159]
    s_add_u32 s58, s58, 50331648
    s_add_u32 s24, s32, s58
    s_addc_u32 s25, s33, 0
    v_mfma_f32_16x16x32_bf16 a[156:159], v[152:155], v[124:127], a[156:159]
    s_and_b32 s25, s25, 0xffff
    v_mfma_f32_16x16x32_bf16 a[160:163], v[148:151], v[64:67], a[160:163]
    ds_read_b64_tr_b16 v[132:133], v5 offset:32768
    s_mov_b32 s26, 131072
    v_mfma_f32_16x16x32_bf16 a[160:163], v[156:159], v[68:71], a[160:163]
    ds_read_b64_tr_b16 v[134:135], v5 offset:33280
    s_mov_b32 s27, 0x20000
    v_mfma_f32_16x16x32_bf16 a[164:167], v[148:151], v[72:75], a[164:167]
    ds_read_b64_tr_b16 v[140:141], v59 offset:32768
    s_lshl_b32 s39, s43, 15
    s_lshl_b32 s58, s64, 1
    v_mfma_f32_16x16x32_bf16 a[164:167], v[156:159], v[76:79], a[164:167]
    ds_read_b64_tr_b16 v[142:143], v59 offset:33280
    s_lshr_b32 s59, s43, 1
    v_mfma_f32_16x16x32_bf16 a[168:171], v[148:151], v[80:83], a[168:171]
    s_add_u32 s58, s58, s59
    v_mfma_f32_16x16x32_bf16 a[168:171], v[156:159], v[84:87], a[168:171]
    s_mul_i32 s58, s58, 144
    v_mfma_f32_16x16x32_bf16 a[172:175], v[148:151], v[88:91], a[172:175]
    s_add_u32 s58, s58, s62
    s_add_u32 s58, s58, 112
    v_mfma_f32_16x16x32_bf16 a[172:175], v[156:159], v[92:95], a[172:175]
    s_lshl_b32 s58, s58, 2
    v_mfma_f32_16x16x32_bf16 a[176:179], v[148:151], v[96:99], a[176:179]
    s_and_b32 s59, s43, 1
    v_mfma_f32_16x16x32_bf16 a[176:179], v[156:159], v[100:103], a[176:179]
    s_add_u32 s58, s58, s59
    v_mfma_f32_16x16x32_bf16 a[180:183], v[148:151], v[104:107], a[180:183]
    s_lshl_b32 s58, s58, 11
    s_add_u32 s41, s58, 16777216
    v_mfma_f32_16x16x32_bf16 a[180:183], v[156:159], v[108:111], a[180:183]
    s_add_u32 s48, s41, 4096
    v_mfma_f32_16x16x32_bf16 a[184:187], v[148:151], v[112:115], a[184:187]
    s_lshl_b32 s58, s65, 2
    v_mfma_f32_16x16x32_bf16 a[184:187], v[156:159], v[116:119], a[184:187]
    s_add_u32 s58, s58, s43
    v_mfma_f32_16x16x32_bf16 a[188:191], v[148:151], v[120:123], a[188:191]
    s_lshl_b32 s58, s58, 16
    s_lshl_b32 s59, s66, 7
    v_mfma_f32_16x16x32_bf16 a[188:191], v[156:159], v[124:127], a[188:191]
    s_waitcnt vmcnt(1) lgkmcnt(0)
    s_barrier
    v_mfma_f32_16x16x32_bf16 a[192:195], v[128:131], v[64:67], a[192:195]
    ds_read_b64_tr_b16 v[144:145], v6 offset:0
    s_add_u32 s42, s58, s59
    v_mfma_f32_16x16x32_bf16 a[192:195], v[136:139], v[68:71], a[192:195]
    s_waitcnt vmcnt(0)
    ds_write_b128 v15, v[180:183]
    s_lshl_b32 s58, s64, 10
    v_mfma_f32_16x16x32_bf16 a[196:199], v[128:131], v[72:75], a[196:199]
    ds_read_b64_tr_b16 v[146:147], v6 offset:512
    s_add_u32 s58, s58, s62
    s_lshl_b32 s58, s58, 2
    v_mfma_f32_16x16x32_bf16 a[196:199], v[136:139], v[76:79], a[196:199]
    ds_read2_b32 v[160:161], v10 offset0:0 offset1:16
    s_add_u32 s44, s58, 54525952
    v_mfma_f32_16x16x32_bf16 a[200:203], v[128:131], v[80:83], a[200:203]
    ds_read_b64_tr_b16 v[152:153], v60 offset:0
    s_lshl_b32 s58, s65, 4
    v_mfma_f32_16x16x32_bf16 a[200:203], v[136:139], v[84:87], a[200:203]
    ds_read2_b32 v[162:163], v10 offset0:32 offset1:48
    s_add_u32 s58, s58, s66
    v_mfma_f32_16x16x32_bf16 a[204:207], v[128:131], v[88:91], a[204:207]
    ds_read_b64_tr_b16 v[154:155], v60 offset:512
    s_lshl_b32 s58, s58, 7
    s_add_u32 s45, s58, 54525952
    v_mfma_f32_16x16x32_bf16 a[204:207], v[136:139], v[92:95], a[204:207]
    v_smfmac_f32_16x16x64_bf16 v[52:55], v[32:35], v[128:135], v56
    ds_read2_b32 v[164:165], v10 offset0:64 offset1:80
    v_mfma_f32_16x16x32_bf16 a[208:211], v[128:131], v[96:99], a[208:211]
    ds_read_b64_tr_b16 v[148:149], v7 offset:0
    s_lshl_b32 s46, s64, 2
    v_mfma_f32_16x16x32_bf16 a[208:211], v[136:139], v[100:103], a[208:211]
    ds_read2_b32 v[166:167], v10 offset0:96 offset1:112
    s_bfe_u32 s58, s2, 0x30003
    v_mfma_f32_16x16x32_bf16 a[212:215], v[128:131], v[104:107], a[212:215]
    ds_read_b64_tr_b16 v[150:151], v7 offset:512
    s_lshl_b32 s58, s58, 10
    v_mfma_f32_16x16x32_bf16 a[212:215], v[136:139], v[108:111], a[212:215]
    s_nop 0
    v_smfmac_f32_16x16x64_bf16 v[52:55], v[32:35], v[136:143], v56
    ds_read2_b32 v[168:169], v10 offset0:128 offset1:144
    v_mfma_f32_16x16x32_bf16 a[216:219], v[128:131], v[112:115], a[216:219]
    ds_read_b64_tr_b16 v[156:157], v61 offset:0
    s_and_b32 s59, s62, 28
    s_add_u32 s58, s58, s59
    v_mfma_f32_16x16x32_bf16 a[216:219], v[136:139], v[116:119], a[216:219]
    s_lshr_b32 s59, s2, 6
    v_mfma_f32_16x16x32_bf16 a[220:223], v[128:131], v[120:123], a[220:223]
    ds_read_b64_tr_b16 v[158:159], v61 offset:512
    s_add_u32 s58, s58, s59
    v_mfma_f32_16x16x32_bf16 a[220:223], v[136:139], v[124:127], a[220:223]
    s_lshl_b32 s58, s58, 2
    v_mfma_f32_16x16x32_bf16 a[224:227], v[132:135], v[64:67], a[224:227]
    ds_read_b128 v[64:67], v2 offset:32768
    s_nop 0
    s_add_u32 s47, s58, 54591488
    s_add_u32 s49, s45, 65536
    v_mfma_f32_16x16x32_bf16 a[224:227], v[140:143], v[68:71], a[224:227]
    ds_read_b128 v[68:71], v3 offset:32768
    s_cmp_lg_u32 s77, 0
    s_cselect_b32 s47, 2.0, s47
    s_cselect_b32 s49, 2.0, s49
    s_cselect_b32 s61, 0, 1
    v_mfma_f32_16x16x32_bf16 a[228:231], v[132:135], v[72:75], a[228:231]
    ds_read_b128 v[72:75], v2 offset:34816
    s_lshr_b32 s58, s77, 1
    v_mfma_f32_16x16x32_bf16 a[228:231], v[140:143], v[76:79], a[228:231]
    ds_read_b128 v[76:79], v3 offset:34816
    s_nop 0
    s_mul_i32 s59, s58, 98304
    v_mfma_f32_16x16x32_bf16 a[232:235], v[132:135], v[80:83], a[232:235]
    ds_read_b128 v[80:83], v2 offset:36864
    s_add_u32 s45, s45, s59
    s_lshl_b32 s58, s58, 11
    v_mfma_f32_16x16x32_bf16 a[232:235], v[140:143], v[84:87], a[232:235]
    ds_read_b128 v[84:87], v3 offset:36864
    s_add_u32 s44, s44, s58
    v_mfma_f32_16x16x32_bf16 a[236:239], v[132:135], v[88:91], a[236:239]
    ds_read_b128 v[88:91], v2 offset:38912
    s_and_b32 s58, s77, 1
    v_mfma_f32_16x16x32_bf16 a[236:239], v[140:143], v[92:95], a[236:239]
    ds_read_b128 v[92:95], v3 offset:38912
    s_mul_i32 s58, s58, 98304
    v_mfma_f32_16x16x32_bf16 a[240:243], v[132:135], v[96:99], a[240:243]
    ds_read_b128 v[96:99], v2 offset:40960
    s_add_u32 s44, s44, s58
    s_lshr_b32 s58, s63, 1
    v_mfma_f32_16x16x32_bf16 a[240:243], v[140:143], v[100:103], a[240:243]
    ds_read_b128 v[100:103], v3 offset:40960
    s_lshl_b32 s58, s58, 3
    v_mfma_f32_16x16x32_bf16 a[244:247], v[132:135], v[104:107], a[244:247]
    ds_read_b128 v[104:107], v2 offset:43008
    s_lshl_b32 s67, 0xff0000, s58
    s_nop 0
    v_mfma_f32_16x16x32_bf16 a[244:247], v[140:143], v[108:111], a[244:247]
    ds_read_b128 v[108:111], v3 offset:43008
    s_or_b32 s67, s67, 0xff000000
    v_mfma_f32_16x16x32_bf16 a[248:251], v[132:135], v[112:115], a[248:251]
    ds_read_b128 v[112:115], v2 offset:45056
    s_add_u32 s58, s58, s64
    s_bitset1_b32 s67, s58
    v_mfma_f32_16x16x32_bf16 a[248:251], v[140:143], v[116:119], a[248:251]
    ds_read_b128 v[116:119], v3 offset:45056
    s_lshr_b32 s58, s2, 3
    v_mfma_f32_16x16x32_bf16 a[252:255], v[132:135], v[120:123], a[252:255]
    ds_read_b128 v[120:123], v2 offset:47104
    s_bitset0_b32 s67, s58
    v_mfma_f32_16x16x32_bf16 a[252:255], v[140:143], v[124:127], a[252:255]
    ds_read_b128 v[124:127], v3 offset:47104
    s_mov_b32 s66, 1
    s_waitcnt lgkmcnt(15)
    v_mfma_f32_16x16x32_bf16 a[0:3], v[144:147], v[64:67], a[0:3]
    ds_read_b64_tr_b16 v[128:129], v6 offset:8192
    s_waitcnt lgkmcnt(15)
    v_mfma_f32_16x16x32_bf16 a[0:3], v[152:155], v[68:71], a[0:3]
    ds_read2_b32 v[16:17], v8 offset0:0 offset1:16
    s_waitcnt lgkmcnt(15)
    v_mfma_f32_16x16x32_bf16 a[4:7], v[144:147], v[72:75], a[4:7]
    ds_read2_b32 v[24:25], v8 offset0:128 offset1:144
    s_waitcnt lgkmcnt(15)
    v_mfma_f32_16x16x32_bf16 a[4:7], v[152:155], v[76:79], a[4:7]
    s_waitcnt lgkmcnt(14)
    v_mfma_f32_16x16x32_bf16 a[8:11], v[144:147], v[80:83], a[8:11]
    ds_read_b64_tr_b16 v[130:131], v6 offset:8704
    s_waitcnt lgkmcnt(14)
    v_mfma_f32_16x16x32_bf16 a[8:11], v[152:155], v[84:87], a[8:11]
    ds_read2_b32 v[18:19], v8 offset0:32 offset1:48
    s_waitcnt lgkmcnt(14)
    v_mfma_f32_16x16x32_bf16 a[12:15], v[144:147], v[88:91], a[12:15]
    ds_read2_b32 v[26:27], v8 offset0:160 offset1:176
    s_waitcnt lgkmcnt(14)
    v_mfma_f32_16x16x32_bf16 a[12:15], v[152:155], v[92:95], a[12:15]
    s_nop 0
    v_smfmac_f32_16x16x64_bf16 v[36:39], v[32:35], v[144:151], v56
    s_waitcnt lgkmcnt(13)
    v_mfma_f32_16x16x32_bf16 a[16:19], v[144:147], v[96:99], a[16:19]
    ds_read_b64_tr_b16 v[136:137], v60 offset:8192
    s_waitcnt lgkmcnt(13)
    v_mfma_f32_16x16x32_bf16 a[16:19], v[152:155], v[100:103], a[16:19]
    ds_read2_b32 v[20:21], v8 offset0:64 offset1:80
    s_waitcnt lgkmcnt(13)
    v_mfma_f32_16x16x32_bf16 a[20:23], v[144:147], v[104:107], a[20:23]
    s_nop 0
    ds_read2_b32 v[28:29], v8 offset0:192 offset1:208
    s_waitcnt lgkmcnt(13)
    v_mfma_f32_16x16x32_bf16 a[20:23], v[152:155], v[108:111], a[20:23]
    v_smfmac_f32_16x16x64_bf16 v[36:39], v[32:35], v[152:159], v56
    s_waitcnt lgkmcnt(12)
    v_mfma_f32_16x16x32_bf16 a[24:27], v[144:147], v[112:115], a[24:27]
    ds_read_b64_tr_b16 v[138:139], v60 offset:8704
    s_waitcnt lgkmcnt(12)
    v_mfma_f32_16x16x32_bf16 a[24:27], v[152:155], v[116:119], a[24:27]
    s_nop 0
    ds_read2_b32 v[22:23], v8 offset0:96 offset1:112
    s_waitcnt lgkmcnt(12)
    v_mfma_f32_16x16x32_bf16 a[28:31], v[144:147], v[120:123], a[28:31]
    ds_read2_b32 v[30:31], v8 offset0:224 offset1:240
    s_waitcnt lgkmcnt(12)
    v_mfma_f32_16x16x32_bf16 a[28:31], v[152:155], v[124:127], a[28:31]
    v_mfma_f32_16x16x32_bf16 a[32:35], v[148:151], v[64:67], a[32:35]
    ds_read_b64_tr_b16 v[132:133], v7 offset:8192
    v_mfma_f32_16x16x32_bf16 a[32:35], v[156:159], v[68:71], a[32:35]
    v_add_f32 v160, v160, v36
    v_add_f32 v160, v160, v37
    v_mfma_f32_16x16x32_bf16 a[36:39], v[148:151], v[72:75], a[36:39]
    v_add_f32 v161, v161, v38
    v_add_f32 v161, v161, v39
    v_mfma_f32_16x16x32_bf16 a[36:39], v[156:159], v[76:79], a[36:39]
    ds_write_b32 v8, v160 offset:8192
    v_mfma_f32_16x16x32_bf16 a[40:43], v[148:151], v[80:83], a[40:43]
    ds_read_b64_tr_b16 v[134:135], v7 offset:8704
    v_mfma_f32_16x16x32_bf16 a[40:43], v[156:159], v[84:87], a[40:43]
    ds_write_b32 v8, v161 offset:8256
    v_mfma_f32_16x16x32_bf16 a[44:47], v[148:151], v[88:91], a[44:47]
    ds_read_b128 v[172:175], v9 offset:8192
    v_mfma_f32_16x16x32_bf16 a[44:47], v[156:159], v[92:95], a[44:47]
    ds_read_b128 v[176:179], v9 offset:8256
    v_mfma_f32_16x16x32_bf16 a[48:51], v[148:151], v[96:99], a[48:51]
    ds_read_b64_tr_b16 v[140:141], v61 offset:8192
    s_waitcnt lgkmcnt(15)
    v_mul_f32 v24, s52, v24
    v_mfma_f32_16x16x32_bf16 a[48:51], v[156:159], v[100:103], a[48:51]
    v_mul_f32 v25, s52, v25
    s_waitcnt lgkmcnt(13)
    v_mul_f32 v26, s52, v26
    v_mfma_f32_16x16x32_bf16 a[52:55], v[148:151], v[104:107], a[52:55]
    v_mul_f32 v27, s52, v27
    s_waitcnt lgkmcnt(10)
    v_mul_f32 v28, s52, v28
    v_mfma_f32_16x16x32_bf16 a[52:55], v[156:159], v[108:111], a[52:55]
    v_mul_f32 v29, s52, v29
    s_waitcnt lgkmcnt(7)
    v_mul_f32_e64 v30, s52, v30
    v_mfma_f32_16x16x32_bf16 a[56:59], v[148:151], v[112:115], a[56:59]
    ds_read_b64_tr_b16 v[142:143], v61 offset:8704
    v_mul_f32_e64 v31, s52, v31
    v_mfma_f32_16x16x32_bf16 a[56:59], v[156:159], v[116:119], a[56:59]
    v_accvgpr_read_b32 v180, a0
    v_accvgpr_read_b32 v181, a1
    v_mfma_f32_16x16x32_bf16 a[60:63], v[148:151], v[120:123], a[60:63]
    v_accvgpr_read_b32 v182, a2
    v_accvgpr_read_b32 v183, a3
    v_mfma_f32_16x16x32_bf16 a[60:63], v[156:159], v[124:127], a[60:63]
    v_accvgpr_read_b32 v184, a32
    v_accvgpr_read_b32 v185, a33
    v_mfma_f32_16x16x32_bf16 v[192:195], v[64:67], v[128:131], v[192:195]
    ds_read_b64_tr_b16 v[144:145], v6 offset:16384
    v_accvgpr_read_b32 v186, a34
    v_mfma_f32_16x16x32_bf16 v[192:195], v[68:71], v[136:139], v[192:195]
    v_accvgpr_read_b32 v187, a35
    s_waitcnt lgkmcnt(4)
    v_fmac_f32 v180, v16, v172
    v_mfma_f32_16x16x32_bf16 v[196:199], v[72:75], v[128:131], v[196:199]
    v_fmac_f32 v181, v16, v173
    v_fmac_f32 v182, v16, v174
    v_mfma_f32_16x16x32_bf16 v[196:199], v[76:79], v[136:139], v[196:199]
    v_fmac_f32 v183, v16, v175
    s_waitcnt lgkmcnt(3)
    v_fmac_f32_e64 v184, v16, v176
    v_mfma_f32_16x16x32_bf16 v[200:203], v[80:83], v[128:131], v[200:203]
    ds_read_b64_tr_b16 v[146:147], v6 offset:16896
    v_fmac_f32 v185, v16, v177
    v_mfma_f32_16x16x32_bf16 v[200:203], v[84:87], v[136:139], v[200:203]
    v_fmac_f32 v186, v16, v178
    v_fmac_f32_e64 v187, v16, v179
    v_mfma_f32_16x16x32_bf16 v[204:207], v[88:91], v[128:131], v[204:207]
    v_mul_f32 v180, v24, v180
    v_mul_f32 v181, v24, v181
    v_mfma_f32_16x16x32_bf16 v[204:207], v[92:95], v[136:139], v[204:207]
    v_smfmac_f32_16x16x64_bf16 v[40:43], v[32:35], v[128:135], v56
    v_mfma_f32_16x16x32_bf16 v[208:211], v[96:99], v[128:131], v[208:211]
    ds_read_b64_tr_b16 v[152:153], v60 offset:16384
    v_mul_f32 v182, v24, v182
    v_mfma_f32_16x16x32_bf16 v[208:211], v[100:103], v[136:139], v[208:211]
    v_mul_f32 v183, v24, v183
    v_mul_f32 v184, v24, v184
    v_mfma_f32_16x16x32_bf16 v[212:215], v[104:107], v[128:131], v[212:215]
    v_mul_f32 v185, v24, v185
    v_mul_f32 v186, v24, v186
    v_mfma_f32_16x16x32_bf16 v[212:215], v[108:111], v[136:139], v[212:215]
    s_waitcnt lgkmcnt(3)
    v_smfmac_f32_16x16x64_bf16 v[40:43], v[32:35], v[136:143], v56
    v_mfma_f32_16x16x32_bf16 v[216:219], v[112:115], v[128:131], v[216:219]
    ds_read_b64_tr_b16 v[154:155], v60 offset:16896
    v_mul_f32_e64 v187, v24, v187
    v_mfma_f32_16x16x32_bf16 v[216:219], v[116:119], v[136:139], v[216:219]
    v_cvt_pk_bf16_f32 v188, v180, v181
    v_cvt_pk_bf16_f32 v189, v182, v183
    v_mfma_f32_16x16x32_bf16 v[220:223], v[120:123], v[128:131], v[220:223]
    v_cvt_pk_bf16_f32 v190, v184, v185
    v_cvt_pk_bf16_f32 v191, v186, v187
    v_mfma_f32_16x16x32_bf16 v[220:223], v[124:127], v[136:139], v[220:223]
    buffer_store_dwordx4 v[188:191], v11, s[32:35], s50 offen offset:0 sc1
    v_accvgpr_read_b32 v180, a4
    v_mfma_f32_16x16x32_bf16 v[224:227], v[64:67], v[132:135], v[224:227]
    ds_read_b64_tr_b16 v[148:149], v7 offset:16384
    v_accvgpr_read_b32 v181, a5
    v_mfma_f32_16x16x32_bf16 v[224:227], v[68:71], v[140:143], v[224:227]
    v_add_f32 v162, v162, v40
    v_add_f32 v162, v162, v41
    v_mfma_f32_16x16x32_bf16 v[228:231], v[72:75], v[132:135], v[228:231]
    v_add_f32 v163, v163, v42
    v_add_f32 v163, v163, v43
    v_mfma_f32_16x16x32_bf16 v[228:231], v[76:79], v[140:143], v[228:231]
    ds_write_b32 v8, v162 offset:8320
    v_accvgpr_read_b32 v182, a6
    v_mfma_f32_16x16x32_bf16 v[232:235], v[80:83], v[132:135], v[232:235]
    ds_read_b64_tr_b16 v[150:151], v7 offset:16896
    v_accvgpr_read_b32 v183, a7
    v_mfma_f32_16x16x32_bf16 v[232:235], v[84:87], v[140:143], v[232:235]
    ds_write_b32 v8, v163 offset:8384
    v_accvgpr_read_b32 v184, a36
    v_mfma_f32_16x16x32_bf16 v[236:239], v[88:91], v[132:135], v[236:239]
    v_accvgpr_read_b32 v185, a37
    v_accvgpr_read_b32 v186, a38
    v_mfma_f32_16x16x32_bf16 v[236:239], v[92:95], v[140:143], v[236:239]
    v_accvgpr_read_b32 v187, a39
    v_fmac_f32_e64 v180, v17, v172
    v_mfma_f32_16x16x32_bf16 v[240:243], v[96:99], v[132:135], v[240:243]
    ds_read_b64_tr_b16 v[156:157], v61 offset:16384
    v_fmac_f32 v181, v17, v173
    v_mfma_f32_16x16x32_bf16 v[240:243], v[100:103], v[140:143], v[240:243]
    v_fmac_f32 v182, v17, v174
    v_fmac_f32_e64 v183, v17, v175
    v_mfma_f32_16x16x32_bf16 v[244:247], v[104:107], v[132:135], v[244:247]
    v_fmac_f32 v184, v17, v176
    v_fmac_f32 v185, v17, v177
    v_mfma_f32_16x16x32_bf16 v[244:247], v[108:111], v[140:143], v[244:247]
    v_fmac_f32 v186, v17, v178
    v_fmac_f32 v187, v17, v179
    v_mfma_f32_16x16x32_bf16 v[248:251], v[112:115], v[132:135], v[248:251]
    ds_read_b64_tr_b16 v[158:159], v61 offset:16896
    v_mul_f32 v180, v25, v180
    v_mfma_f32_16x16x32_bf16 v[248:251], v[116:119], v[140:143], v[248:251]
    v_mul_f32 v181, v25, v181
    v_mul_f32 v182, v25, v182
    v_mfma_f32_16x16x32_bf16 v[252:255], v[120:123], v[132:135], v[252:255]
    v_mul_f32 v183, v25, v183
    v_mul_f32 v184, v25, v184
    v_mfma_f32_16x16x32_bf16 v[252:255], v[124:127], v[140:143], v[252:255]
    v_mul_f32 v185, v25, v185
    v_mul_f32 v186, v25, v186
    s_waitcnt lgkmcnt(8)
    v_mfma_f32_16x16x32_bf16 a[64:67], v[64:67], v[144:147], a[64:67]
    ds_read_b64_tr_b16 v[128:129], v6 offset:24576
    v_mul_f32 v187, v25, v187
    s_waitcnt lgkmcnt(7)
    v_mfma_f32_16x16x32_bf16 a[64:67], v[68:71], v[152:155], a[64:67]
    v_cvt_pk_bf16_f32 v36, v180, v181
    v_cvt_pk_bf16_f32 v37, v182, v183
    v_mfma_f32_16x16x32_bf16 a[68:71], v[72:75], v[144:147], a[68:71]
    v_cvt_pk_bf16_f32 v38, v184, v185
    v_cvt_pk_bf16_f32 v39, v186, v187
    v_mfma_f32_16x16x32_bf16 a[68:71], v[76:79], v[152:155], a[68:71]
    buffer_store_dwordx4 v[36:39], v11, s[32:35], s50 offen offset:1024 sc1
    s_add_u32 s50, s50, s51
    v_accvgpr_read_b32 v180, a8
    v_mfma_f32_16x16x32_bf16 a[72:75], v[80:83], v[144:147], a[72:75]
    s_nop 0
    ds_read_b64_tr_b16 v[130:131], v6 offset:25088
    v_accvgpr_read_b32 v181, a9
    v_mfma_f32_16x16x32_bf16 a[72:75], v[84:87], v[152:155], a[72:75]
    v_accvgpr_read_b32 v182, a10
    v_accvgpr_read_b32 v183, a11
    v_mfma_f32_16x16x32_bf16 a[76:79], v[88:91], v[144:147], a[76:79]
    v_accvgpr_read_b32 v184, a40
    v_accvgpr_read_b32 v185, a41
    v_mfma_f32_16x16x32_bf16 a[76:79], v[92:95], v[152:155], a[76:79]
    s_waitcnt lgkmcnt(5)
    v_smfmac_f32_16x16x64_bf16 v[44:47], v[32:35], v[144:151], v56
    v_mfma_f32_16x16x32_bf16 a[80:83], v[96:99], v[144:147], a[80:83]
    ds_read_b64_tr_b16 v[136:137], v60 offset:24576
    s_nop 0
    v_accvgpr_read_b32 v186, a42
    v_mfma_f32_16x16x32_bf16 a[80:83], v[100:103], v[152:155], a[80:83]
    v_accvgpr_read_b32 v187, a43
    v_fmac_f32_e64 v180, v18, v172
    v_mfma_f32_16x16x32_bf16 a[84:87], v[104:107], v[144:147], a[84:87]
    v_fmac_f32 v181, v18, v173
    v_fmac_f32_e64 v182, v18, v174
    v_mfma_f32_16x16x32_bf16 a[84:87], v[108:111], v[152:155], a[84:87]
    s_waitcnt lgkmcnt(3)
    v_smfmac_f32_16x16x64_bf16 v[44:47], v[32:35], v[152:159], v56
    v_mfma_f32_16x16x32_bf16 a[88:91], v[112:115], v[144:147], a[88:91]
    ds_read_b64_tr_b16 v[138:139], v60 offset:25088
    v_fmac_f32_e64 v183, v18, v175
    v_mfma_f32_16x16x32_bf16 a[88:91], v[116:119], v[152:155], a[88:91]
    v_fmac_f32 v184, v18, v176
    v_fmac_f32 v185, v18, v177
    v_mfma_f32_16x16x32_bf16 a[92:95], v[120:123], v[144:147], a[92:95]
    v_fmac_f32 v186, v18, v178
    v_fmac_f32 v187, v18, v179
    v_mfma_f32_16x16x32_bf16 a[92:95], v[124:127], v[152:155], a[92:95]
    v_mul_f32 v180, v26, v180
    v_mul_f32 v181, v26, v181
    v_mfma_f32_16x16x32_bf16 a[96:99], v[64:67], v[148:151], a[96:99]
    ds_read_b64_tr_b16 v[132:133], v7 offset:24576
    v_mul_f32 v182, v26, v182
    v_mfma_f32_16x16x32_bf16 a[96:99], v[68:71], v[156:159], a[96:99]
    v_add_f32 v164, v164, v44
    v_add_f32 v164, v164, v45
    v_mfma_f32_16x16x32_bf16 a[100:103], v[72:75], v[148:151], a[100:103]
    v_add_f32 v165, v165, v46
    v_add_f32 v165, v165, v47
    v_mfma_f32_16x16x32_bf16 a[100:103], v[76:79], v[156:159], a[100:103]
    ds_write_b32 v8, v164 offset:8448
    v_mul_f32 v183, v26, v183
    v_mfma_f32_16x16x32_bf16 a[104:107], v[80:83], v[148:151], a[104:107]
    ds_read_b64_tr_b16 v[134:135], v7 offset:25088
    v_mul_f32_e64 v184, v26, v184
    v_mfma_f32_16x16x32_bf16 a[104:107], v[84:87], v[156:159], a[104:107]
    ds_write_b32 v8, v165 offset:8512
    v_mul_f32_e64 v185, v26, v185
    v_mfma_f32_16x16x32_bf16 a[108:111], v[88:91], v[148:151], a[108:111]
    v_mul_f32_e64 v186, v26, v186
    v_mul_f32_e64 v187, v26, v187
    v_mfma_f32_16x16x32_bf16 a[108:111], v[92:95], v[156:159], a[108:111]
    v_cvt_pk_bf16_f32 v188, v180, v181
    v_cvt_pk_bf16_f32 v189, v182, v183
    v_mfma_f32_16x16x32_bf16 a[112:115], v[96:99], v[148:151], a[112:115]
    ds_read_b64_tr_b16 v[140:141], v61 offset:24576
    v_cvt_pk_bf16_f32 v190, v184, v185
    v_mfma_f32_16x16x32_bf16 a[112:115], v[100:103], v[156:159], a[112:115]
    v_cvt_pk_bf16_f32 v191, v186, v187
    buffer_store_dwordx4 v[188:191], v11, s[32:35], s50 offen offset:0 sc1
    v_mfma_f32_16x16x32_bf16 a[116:119], v[104:107], v[148:151], a[116:119]
    v_mfma_f32_16x16x32_bf16 a[116:119], v[108:111], v[156:159], a[116:119]
    v_mfma_f32_16x16x32_bf16 a[120:123], v[112:115], v[148:151], a[120:123]
    ds_read_b64_tr_b16 v[142:143], v61 offset:25088
    v_mfma_f32_16x16x32_bf16 a[120:123], v[116:119], v[156:159], a[120:123]
    v_mfma_f32_16x16x32_bf16 a[124:127], v[120:123], v[148:151], a[124:127]
    v_mfma_f32_16x16x32_bf16 a[124:127], v[124:127], v[156:159], a[124:127]
    v_accvgpr_read_b32 v180, a12
    v_accvgpr_read_b32 v181, a13
    v_accvgpr_read_b32 v182, a14
    v_accvgpr_read_b32 v183, a15
    v_accvgpr_read_b32 v184, a44
    v_accvgpr_read_b32 v185, a45
    v_accvgpr_read_b32 v186, a46
    v_accvgpr_read_b32 v187, a47
    v_pk_fma_f32 v[180:181], v[18:19], v[172:173], v[180:181] op_sel:[1,0,0] op_sel_hi:[1,1,1]
    v_pk_fma_f32 v[182:183], v[18:19], v[174:175], v[182:183] op_sel:[1,0,0] op_sel_hi:[1,1,1]
    v_pk_fma_f32 v[184:185], v[18:19], v[176:177], v[184:185] op_sel:[1,0,0] op_sel_hi:[1,1,1]
    v_pk_fma_f32 v[186:187], v[18:19], v[178:179], v[186:187] op_sel:[1,0,0] op_sel_hi:[1,1,1]
    v_pk_mul_f32 v[180:181], v[180:181], v[26:27] op_sel:[0,1] op_sel_hi:[1,1]
    v_pk_mul_f32 v[182:183], v[182:183], v[26:27] op_sel:[0,1] op_sel_hi:[1,1]
    v_pk_mul_f32 v[184:185], v[184:185], v[26:27] op_sel:[0,1] op_sel_hi:[1,1]
    v_pk_mul_f32 v[186:187], v[186:187], v[26:27] op_sel:[0,1] op_sel_hi:[1,1]
    v_cvt_pk_bf16_f32 v36, v180, v181
    v_cvt_pk_bf16_f32 v37, v182, v183
    v_cvt_pk_bf16_f32 v38, v184, v185
    v_cvt_pk_bf16_f32 v39, v186, v187
    buffer_store_dwordx4 v[36:39], v11, s[32:35], s50 offen offset:1024 sc1
    s_add_u32 s50, s50, s51
    v_accvgpr_read_b32 v180, a16
    s_nop 0
    v_accvgpr_read_b32 v181, a17
    v_accvgpr_read_b32 v182, a18
    v_accvgpr_read_b32 v183, a19
    v_accvgpr_read_b32 v184, a48
    v_accvgpr_read_b32 v185, a49
    v_accvgpr_read_b32 v186, a50
    v_accvgpr_read_b32 v187, a51
    v_pk_fma_f32 v[180:181], v[20:21], v[172:173], v[180:181] op_sel:[0,0,0] op_sel_hi:[0,1,1]
    v_pk_fma_f32 v[182:183], v[20:21], v[174:175], v[182:183] op_sel:[0,0,0] op_sel_hi:[0,1,1]
    v_pk_fma_f32 v[184:185], v[20:21], v[176:177], v[184:185] op_sel:[0,0,0] op_sel_hi:[0,1,1]
    v_pk_fma_f32 v[186:187], v[20:21], v[178:179], v[186:187] op_sel:[0,0,0] op_sel_hi:[0,1,1]
    v_pk_mul_f32 v[180:181], v[180:181], v[28:29] op_sel:[0,0] op_sel_hi:[1,0]
    v_pk_mul_f32 v[182:183], v[182:183], v[28:29] op_sel:[0,0] op_sel_hi:[1,0]
    v_pk_mul_f32 v[184:185], v[184:185], v[28:29] op_sel:[0,0] op_sel_hi:[1,0]
    v_pk_mul_f32 v[186:187], v[186:187], v[28:29] op_sel:[0,0] op_sel_hi:[1,0]
    v_cvt_pk_bf16_f32 v188, v180, v181
    v_cvt_pk_bf16_f32 v189, v182, v183
    v_cvt_pk_bf16_f32 v190, v184, v185
    v_cvt_pk_bf16_f32 v191, v186, v187
    buffer_store_dwordx4 v[188:191], v11, s[32:35], s50 offen offset:0 sc1
    v_accvgpr_read_b32 v180, a20
    v_accvgpr_read_b32 v181, a21
    v_accvgpr_read_b32 v182, a22
    v_accvgpr_read_b32 v183, a23
    v_accvgpr_read_b32 v184, a52
    v_accvgpr_read_b32 v185, a53
    v_accvgpr_read_b32 v186, a54
    v_accvgpr_read_b32 v187, a55
    v_pk_fma_f32 v[180:181], v[20:21], v[172:173], v[180:181] op_sel:[1,0,0] op_sel_hi:[1,1,1]
    v_pk_fma_f32 v[182:183], v[20:21], v[174:175], v[182:183] op_sel:[1,0,0] op_sel_hi:[1,1,1]
    v_pk_fma_f32 v[184:185], v[20:21], v[176:177], v[184:185] op_sel:[1,0,0] op_sel_hi:[1,1,1]
    v_pk_fma_f32 v[186:187], v[20:21], v[178:179], v[186:187] op_sel:[1,0,0] op_sel_hi:[1,1,1]
    v_pk_mul_f32 v[180:181], v[180:181], v[28:29] op_sel:[0,1] op_sel_hi:[1,1]
    v_pk_mul_f32 v[182:183], v[182:183], v[28:29] op_sel:[0,1] op_sel_hi:[1,1]
    v_pk_mul_f32 v[184:185], v[184:185], v[28:29] op_sel:[0,1] op_sel_hi:[1,1]
    v_pk_mul_f32 v[186:187], v[186:187], v[28:29] op_sel:[0,1] op_sel_hi:[1,1]
    v_cvt_pk_bf16_f32 v36, v180, v181
    v_cvt_pk_bf16_f32 v37, v182, v183
    v_cvt_pk_bf16_f32 v38, v184, v185
    v_cvt_pk_bf16_f32 v39, v186, v187
    buffer_store_dwordx4 v[36:39], v11, s[32:35], s50 offen offset:1024 sc1
    s_add_u32 s50, s50, s51
    v_accvgpr_read_b32 v180, a24
    v_accvgpr_read_b32 v181, a25
    v_accvgpr_read_b32 v182, a26
    s_nop 0
    v_accvgpr_read_b32 v183, a27
    v_accvgpr_read_b32 v184, a56
    v_accvgpr_read_b32 v185, a57
    v_accvgpr_read_b32 v186, a58
    v_accvgpr_read_b32 v187, a59
    v_pk_fma_f32 v[180:181], v[22:23], v[172:173], v[180:181] op_sel:[0,0,0] op_sel_hi:[0,1,1]
    v_pk_fma_f32 v[182:183], v[22:23], v[174:175], v[182:183] op_sel:[0,0,0] op_sel_hi:[0,1,1]
    v_pk_fma_f32 v[184:185], v[22:23], v[176:177], v[184:185] op_sel:[0,0,0] op_sel_hi:[0,1,1]
    v_pk_fma_f32 v[186:187], v[22:23], v[178:179], v[186:187] op_sel:[0,0,0] op_sel_hi:[0,1,1]
    v_pk_mul_f32 v[180:181], v[180:181], v[30:31] op_sel:[0,0] op_sel_hi:[1,0]
    v_pk_mul_f32 v[182:183], v[182:183], v[30:31] op_sel:[0,0] op_sel_hi:[1,0]
    v_pk_mul_f32 v[184:185], v[184:185], v[30:31] op_sel:[0,0] op_sel_hi:[1,0]
    v_pk_mul_f32 v[186:187], v[186:187], v[30:31] op_sel:[0,0] op_sel_hi:[1,0]
    v_cvt_pk_bf16_f32 v188, v180, v181
    v_cvt_pk_bf16_f32 v189, v182, v183
    v_cvt_pk_bf16_f32 v190, v184, v185
    v_cvt_pk_bf16_f32 v191, v186, v187
    buffer_store_dwordx4 v[188:191], v11, s[32:35], s50 offen offset:0 sc1
    v_accvgpr_read_b32 v180, a28
    v_accvgpr_read_b32 v181, a29
    v_accvgpr_read_b32 v182, a30
    v_accvgpr_read_b32 v183, a31
    v_accvgpr_read_b32 v184, a60
    v_accvgpr_read_b32 v185, a61
    v_accvgpr_read_b32 v186, a62
    v_accvgpr_read_b32 v187, a63
    v_pk_fma_f32 v[180:181], v[22:23], v[172:173], v[180:181] op_sel:[1,0,0] op_sel_hi:[1,1,1]
    v_pk_fma_f32 v[182:183], v[22:23], v[174:175], v[182:183] op_sel:[1,0,0] op_sel_hi:[1,1,1]
    v_pk_fma_f32 v[184:185], v[22:23], v[176:177], v[184:185] op_sel:[1,0,0] op_sel_hi:[1,1,1]
    v_pk_fma_f32 v[186:187], v[22:23], v[178:179], v[186:187] op_sel:[1,0,0] op_sel_hi:[1,1,1]
    v_pk_mul_f32 v[180:181], v[180:181], v[30:31] op_sel:[0,1] op_sel_hi:[1,1]
    v_pk_mul_f32 v[182:183], v[182:183], v[30:31] op_sel:[0,1] op_sel_hi:[1,1]
    v_pk_mul_f32 v[184:185], v[184:185], v[30:31] op_sel:[0,1] op_sel_hi:[1,1]
    v_pk_mul_f32 v[186:187], v[186:187], v[30:31] op_sel:[0,1] op_sel_hi:[1,1]
    v_cvt_pk_bf16_f32 v36, v180, v181
    v_cvt_pk_bf16_f32 v37, v182, v183
    v_cvt_pk_bf16_f32 v38, v184, v185
    v_cvt_pk_bf16_f32 v39, v186, v187
    buffer_store_dwordx4 v[36:39], v11, s[32:35], s50 offen offset:1024 sc1
    s_add_u32 s50, s50, s51
    s_nop 0
    ds_read_b128 v[172:175], v9 offset:0
    ds_read_b128 v[176:179], v9 offset:512
    ds_read_b128 v[180:183], v9 offset:64
    ds_read_b128 v[184:187], v9 offset:576
    ds_read_b128 v[16:19], v9 offset:128
    ds_read_b128 v[20:23], v9 offset:640
    ds_read_b128 v[24:27], v9 offset:192
    ds_read_b128 v[28:31], v9 offset:704
    s_waitcnt lgkmcnt(15)
    v_mfma_f32_16x16x32_bf16 a[128:131], v[128:131], v[64:67], a[128:131]
    ds_read_b64_tr_b16 v[144:145], v6 offset:32768
    s_waitcnt lgkmcnt(15)
    v_mfma_f32_16x16x32_bf16 a[128:131], v[136:139], v[68:71], a[128:131]
    s_waitcnt lgkmcnt(8)
    v_pk_fma_f32 v[192:193], v[162:163], v[172:173], v[192:193] op_sel:[0,0,0] op_sel_hi:[0,1,1]
    v_pk_fma_f32 v[194:195], v[162:163], v[174:175], v[194:195] op_sel:[0,0,0] op_sel_hi:[0,1,1]
    s_waitcnt lgkmcnt(6)
    v_pk_fma_f32 v[196:197], v[162:163], v[180:181], v[196:197] op_sel:[0,0,0] op_sel_hi:[0,1,1]
    v_pk_fma_f32 v[198:199], v[162:163], v[182:183], v[198:199] op_sel:[0,0,0] op_sel_hi:[0,1,1]
    v_pk_mul_f32 v[192:193], v[192:193], v[176:177]
    s_nop 0
    v_pk_mul_f32 v[194:195], v[194:195], v[178:179]
    s_waitcnt lgkmcnt(5)
    v_pk_mul_f32 v[196:197], v[196:197], v[184:185]
    v_pk_mul_f32 v[198:199], v[198:199], v[186:187]
    v_cvt_pk_bf16_f32 v188, v192, v193
    v_cvt_pk_bf16_f32 v189, v194, v195
    v_cvt_pk_bf16_f32 v190, v196, v197
    v_cvt_pk_bf16_f32 v191, v198, v199
    buffer_store_dwordx4 v[188:191], v11, s[32:35], s55 offen offset:2048 sc1
    v_pk_fma_f32 v[224:225], v[162:163], v[172:173], v[224:225] op_sel:[1,0,0] op_sel_hi:[1,1,1]
    v_pk_fma_f32 v[226:227], v[162:163], v[174:175], v[226:227] op_sel:[1,0,0] op_sel_hi:[1,1,1]
    v_pk_fma_f32 v[228:229], v[162:163], v[180:181], v[228:229] op_sel:[1,0,0] op_sel_hi:[1,1,1]
    v_pk_fma_f32 v[230:231], v[162:163], v[182:183], v[230:231] op_sel:[1,0,0] op_sel_hi:[1,1,1]
    v_pk_mul_f32 v[224:225], v[224:225], v[176:177]
    v_pk_mul_f32 v[226:227], v[226:227], v[178:179]
    v_pk_mul_f32 v[228:229], v[228:229], v[184:185]
    v_pk_mul_f32 v[230:231], v[230:231], v[186:187]
    v_cvt_pk_bf16_f32 v36, v224, v225
    v_cvt_pk_bf16_f32 v37, v226, v227
    v_cvt_pk_bf16_f32 v38, v228, v229
    v_cvt_pk_bf16_f32 v39, v230, v231
    buffer_store_dwordx4 v[36:39], v11, s[32:35], s55 offen offset:3072 sc1
    s_add_u32 s55, s55, 4096
    v_accvgpr_read_b32 v192, a64
    v_accvgpr_read_b32 v193, a65
    v_accvgpr_read_b32 v194, a66
    v_accvgpr_read_b32 v195, a67
    v_accvgpr_read_b32 v196, a68
    v_accvgpr_read_b32 v197, a69
    v_accvgpr_read_b32 v198, a70
    v_accvgpr_read_b32 v199, a71
    v_pk_fma_f32 v[192:193], v[164:165], v[172:173], v[192:193] op_sel:[0,0,0] op_sel_hi:[0,1,1]
    v_pk_fma_f32 v[194:195], v[164:165], v[174:175], v[194:195] op_sel:[0,0,0] op_sel_hi:[0,1,1]
    v_pk_fma_f32 v[196:197], v[164:165], v[180:181], v[196:197] op_sel:[0,0,0] op_sel_hi:[0,1,1]
    v_pk_fma_f32 v[198:199], v[164:165], v[182:183], v[198:199] op_sel:[0,0,0] op_sel_hi:[0,1,1]
    v_pk_mul_f32 v[192:193], v[192:193], v[176:177]
    v_pk_mul_f32 v[194:195], v[194:195], v[178:179]
    v_pk_mul_f32 v[196:197], v[196:197], v[184:185]
    v_pk_mul_f32 v[198:199], v[198:199], v[186:187]
    v_cvt_pk_bf16_f32 v188, v192, v193
    v_cvt_pk_bf16_f32 v189, v194, v195
    v_cvt_pk_bf16_f32 v190, v196, v197
    v_cvt_pk_bf16_f32 v191, v198, v199
    buffer_store_dwordx4 v[188:191], v11, s[32:35], s56 offen offset:2048 sc1
    v_accvgpr_read_b32 v224, a96
    v_accvgpr_read_b32 v225, a97
    v_accvgpr_read_b32 v226, a98
    v_accvgpr_read_b32 v227, a99
    v_accvgpr_read_b32 v228, a100
    v_accvgpr_read_b32 v229, a101
    v_accvgpr_read_b32 v230, a102
    v_accvgpr_read_b32 v231, a103
    v_pk_fma_f32 v[224:225], v[164:165], v[172:173], v[224:225] op_sel:[1,0,0] op_sel_hi:[1,1,1]
    v_pk_fma_f32 v[226:227], v[164:165], v[174:175], v[226:227] op_sel:[1,0,0] op_sel_hi:[1,1,1]
    v_pk_fma_f32 v[228:229], v[164:165], v[180:181], v[228:229] op_sel:[1,0,0] op_sel_hi:[1,1,1]
    v_pk_fma_f32 v[230:231], v[164:165], v[182:183], v[230:231] op_sel:[1,0,0] op_sel_hi:[1,1,1]
    v_pk_mul_f32 v[224:225], v[224:225], v[176:177]
    v_pk_mul_f32 v[226:227], v[226:227], v[178:179]
    v_pk_mul_f32 v[228:229], v[228:229], v[184:185]
    v_pk_mul_f32 v[230:231], v[230:231], v[186:187]
    ds_read_b128 v[172:175], v9 offset:256
    ds_read_b128 v[176:179], v9 offset:768
    ds_read_b128 v[180:183], v9 offset:320
    ds_read_b128 v[184:187], v9 offset:832
    v_cvt_pk_bf16_f32 v36, v224, v225
    v_cvt_pk_bf16_f32 v37, v226, v227
    v_cvt_pk_bf16_f32 v38, v228, v229
    v_cvt_pk_bf16_f32 v39, v230, v231
    buffer_store_dwordx4 v[36:39], v11, s[32:35], s56 offen offset:3072 sc1
    s_add_u32 s56, s56, 4096
    s_waitcnt lgkmcnt(8)
    v_pk_fma_f32 v[200:201], v[162:163], v[16:17], v[200:201] op_sel:[0,0,0] op_sel_hi:[0,1,1]
    v_pk_fma_f32 v[202:203], v[162:163], v[18:19], v[202:203] op_sel:[0,0,0] op_sel_hi:[0,1,1]
    s_waitcnt lgkmcnt(6)
    v_pk_fma_f32 v[204:205], v[162:163], v[24:25], v[204:205] op_sel:[0,0,0] op_sel_hi:[0,1,1]
    v_pk_fma_f32 v[206:207], v[162:163], v[26:27], v[206:207] op_sel:[0,0,0] op_sel_hi:[0,1,1]
    v_pk_mul_f32 v[200:201], v[200:201], v[20:21]
    v_pk_mul_f32 v[202:203], v[202:203], v[22:23]
    s_waitcnt lgkmcnt(5)
    s_nop 0
    v_pk_mul_f32 v[204:205], v[204:205], v[28:29]
    v_pk_mul_f32 v[206:207], v[206:207], v[30:31]
    v_cvt_pk_bf16_f32 v188, v200, v201
    v_cvt_pk_bf16_f32 v189, v202, v203
    v_cvt_pk_bf16_f32 v190, v204, v205
    v_cvt_pk_bf16_f32 v191, v206, v207
    buffer_store_dwordx4 v[188:191], v11, s[32:35], s55 offen offset:2048 sc1
    v_pk_fma_f32 v[232:233], v[162:163], v[16:17], v[232:233] op_sel:[1,0,0] op_sel_hi:[1,1,1]
    v_pk_fma_f32 v[234:235], v[162:163], v[18:19], v[234:235] op_sel:[1,0,0] op_sel_hi:[1,1,1]
    v_pk_fma_f32 v[236:237], v[162:163], v[24:25], v[236:237] op_sel:[1,0,0] op_sel_hi:[1,1,1]
    v_pk_fma_f32 v[238:239], v[162:163], v[26:27], v[238:239] op_sel:[1,0,0] op_sel_hi:[1,1,1]
    v_pk_mul_f32 v[232:233], v[232:233], v[20:21]
    v_pk_mul_f32 v[234:235], v[234:235], v[22:23]
    v_pk_mul_f32 v[236:237], v[236:237], v[28:29]
    v_pk_mul_f32 v[238:239], v[238:239], v[30:31]
    v_cvt_pk_bf16_f32 v36, v232, v233
    v_cvt_pk_bf16_f32 v37, v234, v235
    v_cvt_pk_bf16_f32 v38, v236, v237
    v_cvt_pk_bf16_f32 v39, v238, v239
    buffer_store_dwordx4 v[36:39], v11, s[32:35], s55 offen offset:3072 sc1
    s_add_u32 s55, s55, 4096
    v_accvgpr_read_b32 v200, a72
    v_accvgpr_read_b32 v201, a73
    v_accvgpr_read_b32 v202, a74
    v_accvgpr_read_b32 v203, a75
    v_accvgpr_read_b32 v204, a76
    v_accvgpr_read_b32 v205, a77
    v_accvgpr_read_b32 v206, a78
    v_accvgpr_read_b32 v207, a79
    v_pk_fma_f32 v[200:201], v[164:165], v[16:17], v[200:201] op_sel:[0,0,0] op_sel_hi:[0,1,1]
    v_pk_fma_f32 v[202:203], v[164:165], v[18:19], v[202:203] op_sel:[0,0,0] op_sel_hi:[0,1,1]
    v_pk_fma_f32 v[204:205], v[164:165], v[24:25], v[204:205] op_sel:[0,0,0] op_sel_hi:[0,1,1]
    v_pk_fma_f32 v[206:207], v[164:165], v[26:27], v[206:207] op_sel:[0,0,0] op_sel_hi:[0,1,1]
    v_pk_mul_f32 v[200:201], v[200:201], v[20:21]
    v_pk_mul_f32 v[202:203], v[202:203], v[22:23]
    v_pk_mul_f32 v[204:205], v[204:205], v[28:29]
    v_pk_mul_f32 v[206:207], v[206:207], v[30:31]
    v_cvt_pk_bf16_f32 v188, v200, v201
    v_cvt_pk_bf16_f32 v189, v202, v203
    v_cvt_pk_bf16_f32 v190, v204, v205
    v_cvt_pk_bf16_f32 v191, v206, v207
    buffer_store_dwordx4 v[188:191], v11, s[32:35], s56 offen offset:2048 sc1
    v_accvgpr_read_b32 v232, a104
    v_accvgpr_read_b32 v233, a105
    v_accvgpr_read_b32 v234, a106
    v_accvgpr_read_b32 v235, a107
    v_accvgpr_read_b32 v236, a108
    v_accvgpr_read_b32 v237, a109
    v_accvgpr_read_b32 v238, a110
    v_accvgpr_read_b32 v239, a111
    v_pk_fma_f32 v[232:233], v[164:165], v[16:17], v[232:233] op_sel:[1,0,0] op_sel_hi:[1,1,1]
    v_pk_fma_f32 v[234:235], v[164:165], v[18:19], v[234:235] op_sel:[1,0,0] op_sel_hi:[1,1,1]
    v_pk_fma_f32 v[236:237], v[164:165], v[24:25], v[236:237] op_sel:[1,0,0] op_sel_hi:[1,1,1]
    v_pk_fma_f32 v[238:239], v[164:165], v[26:27], v[238:239] op_sel:[1,0,0] op_sel_hi:[1,1,1]
    v_pk_mul_f32 v[232:233], v[232:233], v[20:21]
    v_pk_mul_f32 v[234:235], v[234:235], v[22:23]
    v_pk_mul_f32 v[236:237], v[236:237], v[28:29]
    v_pk_mul_f32 v[238:239], v[238:239], v[30:31]
    ds_read_b128 v[16:19], v9 offset:384
    ds_read_b128 v[20:23], v9 offset:896
    ds_read_b128 v[24:27], v9 offset:448
    ds_read_b128 v[28:31], v9 offset:960
    v_cvt_pk_bf16_f32 v36, v232, v233
    v_cvt_pk_bf16_f32 v37, v234, v235
    v_cvt_pk_bf16_f32 v38, v236, v237
    v_cvt_pk_bf16_f32 v39, v238, v239
    buffer_store_dwordx4 v[36:39], v11, s[32:35], s56 offen offset:3072 sc1
    s_add_u32 s56, s56, 4096
    s_waitcnt lgkmcnt(7)
    v_pk_fma_f32 v[208:209], v[162:163], v[172:173], v[208:209] op_sel:[0,0,0] op_sel_hi:[0,1,1]
    v_pk_fma_f32 v[210:211], v[162:163], v[174:175], v[210:211] op_sel:[0,0,0] op_sel_hi:[0,1,1]
    s_waitcnt lgkmcnt(5)
    v_pk_fma_f32 v[212:213], v[162:163], v[180:181], v[212:213] op_sel:[0,0,0] op_sel_hi:[0,1,1]
    v_pk_fma_f32 v[214:215], v[162:163], v[182:183], v[214:215] op_sel:[0,0,0] op_sel_hi:[0,1,1]
    v_pk_mul_f32 v[208:209], v[208:209], v[176:177]
    s_nop 0
    v_pk_mul_f32 v[210:211], v[210:211], v[178:179]
    s_waitcnt lgkmcnt(4)
    v_pk_mul_f32 v[212:213], v[212:213], v[184:185]
    v_pk_mul_f32 v[214:215], v[214:215], v[186:187]
    v_cvt_pk_bf16_f32 v188, v208, v209
    v_cvt_pk_bf16_f32 v189, v210, v211
    v_cvt_pk_bf16_f32 v190, v212, v213
    v_cvt_pk_bf16_f32 v191, v214, v215
    buffer_store_dwordx4 v[188:191], v11, s[32:35], s55 offen offset:2048 sc1
    v_pk_fma_f32 v[240:241], v[162:163], v[172:173], v[240:241] op_sel:[1,0,0] op_sel_hi:[1,1,1]
    v_pk_fma_f32 v[242:243], v[162:163], v[174:175], v[242:243] op_sel:[1,0,0] op_sel_hi:[1,1,1]
    v_pk_fma_f32 v[244:245], v[162:163], v[180:181], v[244:245] op_sel:[1,0,0] op_sel_hi:[1,1,1]
    v_pk_fma_f32 v[246:247], v[162:163], v[182:183], v[246:247] op_sel:[1,0,0] op_sel_hi:[1,1,1]
    v_pk_mul_f32 v[240:241], v[240:241], v[176:177]
    v_pk_mul_f32 v[242:243], v[242:243], v[178:179]
    v_pk_mul_f32 v[244:245], v[244:245], v[184:185]
    v_pk_mul_f32 v[246:247], v[246:247], v[186:187]
    v_cvt_pk_bf16_f32 v36, v240, v241
    v_cvt_pk_bf16_f32 v37, v242, v243
    v_cvt_pk_bf16_f32 v38, v244, v245
    v_cvt_pk_bf16_f32 v39, v246, v247
    buffer_store_dwordx4 v[36:39], v11, s[32:35], s55 offen offset:3072 sc1
    s_add_u32 s55, s55, 4096
    v_accvgpr_read_b32 v208, a80
    v_accvgpr_read_b32 v209, a81
    v_accvgpr_read_b32 v210, a82
    v_accvgpr_read_b32 v211, a83
    v_accvgpr_read_b32 v212, a84
    v_accvgpr_read_b32 v213, a85
    v_accvgpr_read_b32 v214, a86
    v_accvgpr_read_b32 v215, a87
    v_pk_fma_f32 v[208:209], v[164:165], v[172:173], v[208:209] op_sel:[0,0,0] op_sel_hi:[0,1,1]
    v_pk_fma_f32 v[210:211], v[164:165], v[174:175], v[210:211] op_sel:[0,0,0] op_sel_hi:[0,1,1]
    v_pk_fma_f32 v[212:213], v[164:165], v[180:181], v[212:213] op_sel:[0,0,0] op_sel_hi:[0,1,1]
    v_pk_fma_f32 v[214:215], v[164:165], v[182:183], v[214:215] op_sel:[0,0,0] op_sel_hi:[0,1,1]
    v_pk_mul_f32 v[208:209], v[208:209], v[176:177]
    v_pk_mul_f32 v[210:211], v[210:211], v[178:179]
    v_pk_mul_f32 v[212:213], v[212:213], v[184:185]
    v_pk_mul_f32 v[214:215], v[214:215], v[186:187]
    v_cvt_pk_bf16_f32 v188, v208, v209
    v_cvt_pk_bf16_f32 v189, v210, v211
    v_cvt_pk_bf16_f32 v190, v212, v213
    v_cvt_pk_bf16_f32 v191, v214, v215
    buffer_store_dwordx4 v[188:191], v11, s[32:35], s56 offen offset:2048 sc1
    v_accvgpr_read_b32 v240, a112
    v_accvgpr_read_b32 v241, a113
    v_accvgpr_read_b32 v242, a114
    v_accvgpr_read_b32 v243, a115
    v_accvgpr_read_b32 v244, a116
    v_accvgpr_read_b32 v245, a117
    v_accvgpr_read_b32 v246, a118
    v_accvgpr_read_b32 v247, a119
    v_pk_fma_f32 v[240:241], v[164:165], v[172:173], v[240:241] op_sel:[1,0,0] op_sel_hi:[1,1,1]
    v_pk_fma_f32 v[242:243], v[164:165], v[174:175], v[242:243] op_sel:[1,0,0] op_sel_hi:[1,1,1]
    v_pk_fma_f32 v[244:245], v[164:165], v[180:181], v[244:245] op_sel:[1,0,0] op_sel_hi:[1,1,1]
    v_pk_fma_f32 v[246:247], v[164:165], v[182:183], v[246:247] op_sel:[1,0,0] op_sel_hi:[1,1,1]
    v_pk_mul_f32 v[240:241], v[240:241], v[176:177]
    v_pk_mul_f32 v[242:243], v[242:243], v[178:179]
    v_pk_mul_f32 v[244:245], v[244:245], v[184:185]
    v_pk_mul_f32 v[246:247], v[246:247], v[186:187]
    v_cvt_pk_bf16_f32 v36, v240, v241
    v_cvt_pk_bf16_f32 v37, v242, v243
    v_cvt_pk_bf16_f32 v38, v244, v245
    v_cvt_pk_bf16_f32 v39, v246, v247
    buffer_store_dwordx4 v[36:39], v11, s[32:35], s56 offen offset:3072 sc1
    s_add_u32 s56, s56, 4096
    s_waitcnt lgkmcnt(3)
    v_pk_fma_f32 v[216:217], v[162:163], v[16:17], v[216:217] op_sel:[0,0,0] op_sel_hi:[0,1,1]
    v_pk_fma_f32 v[218:219], v[162:163], v[18:19], v[218:219] op_sel:[0,0,0] op_sel_hi:[0,1,1]
    s_waitcnt lgkmcnt(1)
    v_pk_fma_f32 v[220:221], v[162:163], v[24:25], v[220:221] op_sel:[0,0,0] op_sel_hi:[0,1,1]
    v_pk_fma_f32 v[222:223], v[162:163], v[26:27], v[222:223] op_sel:[0,0,0] op_sel_hi:[0,1,1]
    v_pk_mul_f32 v[216:217], v[216:217], v[20:21]
    s_nop 0
    v_pk_mul_f32 v[218:219], v[218:219], v[22:23]
    s_waitcnt lgkmcnt(0)
    v_pk_mul_f32 v[220:221], v[220:221], v[28:29]
    v_pk_mul_f32 v[222:223], v[222:223], v[30:31]
    v_cvt_pk_bf16_f32 v188, v216, v217
    v_cvt_pk_bf16_f32 v189, v218, v219
    v_cvt_pk_bf16_f32 v190, v220, v221
    v_cvt_pk_bf16_f32 v191, v222, v223
    buffer_store_dwordx4 v[188:191], v11, s[32:35], s55 offen offset:2048 sc1
    v_pk_fma_f32 v[248:249], v[162:163], v[16:17], v[248:249] op_sel:[1,0,0] op_sel_hi:[1,1,1]
    v_pk_fma_f32 v[250:251], v[162:163], v[18:19], v[250:251] op_sel:[1,0,0] op_sel_hi:[1,1,1]
    v_pk_fma_f32 v[252:253], v[162:163], v[24:25], v[252:253] op_sel:[1,0,0] op_sel_hi:[1,1,1]
    v_pk_fma_f32 v[254:255], v[162:163], v[26:27], v[254:255] op_sel:[1,0,0] op_sel_hi:[1,1,1]
    v_pk_mul_f32 v[248:249], v[248:249], v[20:21]
    v_pk_mul_f32 v[250:251], v[250:251], v[22:23]
    v_pk_mul_f32 v[252:253], v[252:253], v[28:29]
    v_pk_mul_f32 v[254:255], v[254:255], v[30:31]
    v_cvt_pk_bf16_f32 v36, v248, v249
    v_cvt_pk_bf16_f32 v37, v250, v251
    v_cvt_pk_bf16_f32 v38, v252, v253
    v_cvt_pk_bf16_f32 v39, v254, v255
    buffer_store_dwordx4 v[36:39], v11, s[32:35], s55 offen offset:3072 sc1
    s_add_u32 s55, s55, 4096
    v_accvgpr_read_b32 v216, a88
    v_accvgpr_read_b32 v217, a89
    v_accvgpr_read_b32 v218, a90
    v_accvgpr_read_b32 v219, a91
    v_accvgpr_read_b32 v220, a92
    v_accvgpr_read_b32 v221, a93
    v_accvgpr_read_b32 v222, a94
    v_accvgpr_read_b32 v223, a95
    v_pk_fma_f32 v[216:217], v[164:165], v[16:17], v[216:217] op_sel:[0,0,0] op_sel_hi:[0,1,1]
    v_pk_fma_f32 v[218:219], v[164:165], v[18:19], v[218:219] op_sel:[0,0,0] op_sel_hi:[0,1,1]
    v_pk_fma_f32 v[220:221], v[164:165], v[24:25], v[220:221] op_sel:[0,0,0] op_sel_hi:[0,1,1]
    v_pk_fma_f32 v[222:223], v[164:165], v[26:27], v[222:223] op_sel:[0,0,0] op_sel_hi:[0,1,1]
    v_pk_mul_f32 v[216:217], v[216:217], v[20:21]
    v_pk_mul_f32 v[218:219], v[218:219], v[22:23]
    v_pk_mul_f32 v[220:221], v[220:221], v[28:29]
    v_pk_mul_f32 v[222:223], v[222:223], v[30:31]
    v_cvt_pk_bf16_f32 v188, v216, v217
    v_cvt_pk_bf16_f32 v189, v218, v219
    v_cvt_pk_bf16_f32 v190, v220, v221
    v_cvt_pk_bf16_f32 v191, v222, v223
    buffer_store_dwordx4 v[188:191], v11, s[32:35], s56 offen offset:2048 sc1
    v_accvgpr_read_b32 v248, a120
    v_accvgpr_read_b32 v249, a121
    v_accvgpr_read_b32 v250, a122
    v_accvgpr_read_b32 v251, a123
    v_accvgpr_read_b32 v252, a124
    v_accvgpr_read_b32 v253, a125
    v_accvgpr_read_b32 v254, a126
    v_accvgpr_read_b32 v255, a127
    v_pk_fma_f32 v[248:249], v[164:165], v[16:17], v[248:249] op_sel:[1,0,0] op_sel_hi:[1,1,1]
    v_pk_fma_f32 v[250:251], v[164:165], v[18:19], v[250:251] op_sel:[1,0,0] op_sel_hi:[1,1,1]
    v_pk_fma_f32 v[252:253], v[164:165], v[24:25], v[252:253] op_sel:[1,0,0] op_sel_hi:[1,1,1]
    v_pk_fma_f32 v[254:255], v[164:165], v[26:27], v[254:255] op_sel:[1,0,0] op_sel_hi:[1,1,1]
    v_pk_mul_f32 v[248:249], v[248:249], v[20:21]
    v_pk_mul_f32 v[250:251], v[250:251], v[22:23]
    v_pk_mul_f32 v[252:253], v[252:253], v[28:29]
    v_pk_mul_f32 v[254:255], v[254:255], v[30:31]
    v_cvt_pk_bf16_f32 v36, v248, v249
    v_cvt_pk_bf16_f32 v37, v250, v251
    v_cvt_pk_bf16_f32 v38, v252, v253
    v_cvt_pk_bf16_f32 v39, v254, v255
    buffer_store_dwordx4 v[36:39], v11, s[32:35], s56 offen offset:3072 sc1
    s_add_u32 s56, s56, 4096
    v_mfma_f32_16x16x32_bf16 a[132:135], v[128:131], v[72:75], a[132:135]
    v_mfma_f32_16x16x32_bf16 a[132:135], v[136:139], v[76:79], a[132:135]
    ds_read2_b32 v[16:17], v8 offset0:0 offset1:16
    v_mfma_f32_16x16x32_bf16 a[136:139], v[128:131], v[80:83], a[136:139]
    ds_read_b64_tr_b16 v[146:147], v6 offset:33280
    v_mfma_f32_16x16x32_bf16 a[136:139], v[136:139], v[84:87], a[136:139]
    ds_read2_b32 v[18:19], v8 offset0:32 offset1:48
    v_mfma_f32_16x16x32_bf16 a[140:143], v[128:131], v[88:91], a[140:143]
    ds_read2_b32 v[20:21], v8 offset0:64 offset1:80
    v_mfma_f32_16x16x32_bf16 a[140:143], v[136:139], v[92:95], a[140:143]
    v_smfmac_f32_16x16x64_bf16 v[48:51], v[32:35], v[128:135], v56
    v_mfma_f32_16x16x32_bf16 a[144:147], v[128:131], v[96:99], a[144:147]
    ds_read_b64_tr_b16 v[152:153], v60 offset:32768
    v_mfma_f32_16x16x32_bf16 a[144:147], v[136:139], v[100:103], a[144:147]
    ds_read2_b32 v[22:23], v8 offset0:96 offset1:112
    v_mfma_f32_16x16x32_bf16 a[148:151], v[128:131], v[104:107], a[148:151]
    ds_read2_b32 v[24:25], v8 offset0:128 offset1:144
    v_mfma_f32_16x16x32_bf16 a[148:151], v[136:139], v[108:111], a[148:151]
    v_smfmac_f32_16x16x64_bf16 v[48:51], v[32:35], v[136:143], v56
    v_mfma_f32_16x16x32_bf16 a[152:155], v[128:131], v[112:115], a[152:155]
    ds_read_b64_tr_b16 v[154:155], v60 offset:33280
    v_mfma_f32_16x16x32_bf16 a[152:155], v[136:139], v[116:119], a[152:155]
    ds_read2_b32 v[26:27], v8 offset0:160 offset1:176
    v_mfma_f32_16x16x32_bf16 a[156:159], v[128:131], v[120:123], a[156:159]
    ds_read2_b32 v[28:29], v8 offset0:192 offset1:208
    v_mfma_f32_16x16x32_bf16 a[156:159], v[136:139], v[124:127], a[156:159]
    ds_read2_b32 v[30:31], v8 offset0:224 offset1:240
    v_mfma_f32_16x16x32_bf16 a[160:163], v[132:135], v[64:67], a[160:163]
    ds_read_b64_tr_b16 v[148:149], v7 offset:32768
    v_mfma_f32_16x16x32_bf16 a[160:163], v[140:143], v[68:71], a[160:163]
    ds_read_b64_tr_b16 v[150:151], v7 offset:33280
    v_add_f32_e64 v166, v166, v48
    v_add_f32_e64 v166, v166, v49
    v_mfma_f32_16x16x32_bf16 a[164:167], v[132:135], v[72:75], a[164:167]
    ds_read_b64_tr_b16 v[156:157], v61 offset:32768
    v_add_f32_e64 v167, v167, v50
    v_add_f32_e64 v167, v167, v51
    v_mfma_f32_16x16x32_bf16 a[164:167], v[140:143], v[76:79], a[164:167]
    ds_read_b64_tr_b16 v[158:159], v61 offset:33280
    ds_write_b32 v8, v166 offset:8576
    v_mfma_f32_16x16x32_bf16 a[168:171], v[132:135], v[80:83], a[168:171]
    v_mfma_f32_16x16x32_bf16 a[168:171], v[140:143], v[84:87], a[168:171]
    ds_write_b32 v8, v167 offset:8640
    v_mfma_f32_16x16x32_bf16 a[172:175], v[132:135], v[88:91], a[172:175]
    v_mfma_f32_16x16x32_bf16 a[172:175], v[140:143], v[92:95], a[172:175]
    v_mfma_f32_16x16x32_bf16 a[176:179], v[132:135], v[96:99], a[176:179]
    v_mfma_f32_16x16x32_bf16 a[176:179], v[140:143], v[100:103], a[176:179]
    v_mfma_f32_16x16x32_bf16 a[180:183], v[132:135], v[104:107], a[180:183]
    v_mfma_f32_16x16x32_bf16 a[180:183], v[140:143], v[108:111], a[180:183]
    v_mfma_f32_16x16x32_bf16 a[184:187], v[132:135], v[112:115], a[184:187]
    v_mfma_f32_16x16x32_bf16 a[184:187], v[140:143], v[116:119], a[184:187]
    v_mfma_f32_16x16x32_bf16 a[188:191], v[132:135], v[120:123], a[188:191]
    v_mfma_f32_16x16x32_bf16 a[188:191], v[140:143], v[124:127], a[188:191]
    s_waitcnt lgkmcnt(15)
    v_mfma_f32_16x16x32_bf16 a[192:195], v[144:147], v[64:67], a[192:195]
    s_waitcnt lgkmcnt(9)
    v_mfma_f32_16x16x32_bf16 a[192:195], v[152:155], v[68:71], a[192:195]
    v_mfma_f32_16x16x32_bf16 a[196:199], v[144:147], v[72:75], a[196:199]
    ds_read_b128 v[128:131], v9 offset:8576
    v_mfma_f32_16x16x32_bf16 a[196:199], v[152:155], v[76:79], a[196:199]
    v_mfma_f32_16x16x32_bf16 a[200:203], v[144:147], v[80:83], a[200:203]
    ds_read_b128 v[132:135], v9 offset:8640
    v_mfma_f32_16x16x32_bf16 a[200:203], v[152:155], v[84:87], a[200:203]
    v_mfma_f32_16x16x32_bf16 a[204:207], v[144:147], v[88:91], a[204:207]
    v_mfma_f32_16x16x32_bf16 a[204:207], v[152:155], v[92:95], a[204:207]
    s_waitcnt lgkmcnt(6)
    v_smfmac_f32_16x16x64_bf16 v[52:55], v[32:35], v[144:151], v56
    v_mov_b32 v3, 1
    v_lshlrev_b32 v2, 7, v0
    s_cmp_lg_u32 s77, 0
    s_cselect_b32 s78, 2.0, s78
    s_waitcnt vmcnt(0)
    s_waitcnt lgkmcnt(0)
    s_barrier
    s_mov_b32 exec_hi, 0
    buffer_store_dword v3, v2, s[32:35], s78 offen sc1
    s_mov_b32 exec_hi, -1
    v_mfma_f32_16x16x32_bf16 a[208:211], v[144:147], v[96:99], a[208:211]
    v_mfma_f32_16x16x32_bf16 a[208:211], v[152:155], v[100:103], a[208:211]
    v_mfma_f32_16x16x32_bf16 a[212:215], v[144:147], v[104:107], a[212:215]
    v_mfma_f32_16x16x32_bf16 a[212:215], v[152:155], v[108:111], a[212:215]
    s_waitcnt lgkmcnt(4)
    s_nop 0
    v_smfmac_f32_16x16x64_bf16 v[52:55], v[32:35], v[152:159], v56
    v_mfma_f32_16x16x32_bf16 a[216:219], v[144:147], v[112:115], a[216:219]
    v_mfma_f32_16x16x32_bf16 a[216:219], v[152:155], v[116:119], a[216:219]
    v_mfma_f32_16x16x32_bf16 a[220:223], v[144:147], v[120:123], a[220:223]
    v_mfma_f32_16x16x32_bf16 a[220:223], v[152:155], v[124:127], a[220:223]
    v_mfma_f32_16x16x32_bf16 a[224:227], v[148:151], v[64:67], a[224:227]
    v_mfma_f32_16x16x32_bf16 a[224:227], v[156:159], v[68:71], a[224:227]
    v_add_f32 v168, v168, v52
    v_add_f32 v168, v168, v53
    v_mfma_f32_16x16x32_bf16 a[228:231], v[148:151], v[72:75], a[228:231]
    v_add_f32 v169, v169, v54
    v_add_f32 v169, v169, v55
    v_mfma_f32_16x16x32_bf16 a[228:231], v[156:159], v[76:79], a[228:231]
    ds_write_b32 v8, v168 offset:8704
    v_mfma_f32_16x16x32_bf16 a[232:235], v[148:151], v[80:83], a[232:235]
    v_mfma_f32_16x16x32_bf16 a[232:235], v[156:159], v[84:87], a[232:235]
    ds_write_b32 v8, v169 offset:8768
    v_mfma_f32_16x16x32_bf16 a[236:239], v[148:151], v[88:91], a[236:239]
    v_mfma_f32_16x16x32_bf16 a[236:239], v[156:159], v[92:95], a[236:239]
    v_mfma_f32_16x16x32_bf16 a[240:243], v[148:151], v[96:99], a[240:243]
    ds_read_b128 v[136:139], v9 offset:8704
    v_mfma_f32_16x16x32_bf16 a[240:243], v[156:159], v[100:103], a[240:243]
    ds_read_b128 v[140:143], v9 offset:8768
    v_mfma_f32_16x16x32_bf16 a[244:247], v[148:151], v[104:107], a[244:247]
    v_mfma_f32_16x16x32_bf16 a[244:247], v[156:159], v[108:111], a[244:247]
    v_mfma_f32_16x16x32_bf16 a[248:251], v[148:151], v[112:115], a[248:251]
    v_mfma_f32_16x16x32_bf16 a[248:251], v[156:159], v[116:119], a[248:251]
    v_mfma_f32_16x16x32_bf16 a[252:255], v[148:151], v[120:123], a[252:255]
    v_mfma_f32_16x16x32_bf16 a[252:255], v[156:159], v[124:127], a[252:255]
    s_mov_b32 s70, s53
    s_mov_b32 s71, 2.0
    v_accvgpr_read_b32 v172, a128
    v_accvgpr_read_b32 v173, a129
    v_accvgpr_read_b32 v174, a130
    v_accvgpr_read_b32 v175, a131
    v_accvgpr_read_b32 v176, a160
    v_accvgpr_read_b32 v177, a161
    v_accvgpr_read_b32 v178, a162
    v_accvgpr_read_b32 v179, a163
    v_accvgpr_read_b32 v180, a192
    v_accvgpr_read_b32 v181, a193
    v_accvgpr_read_b32 v182, a194
    v_accvgpr_read_b32 v183, a195
    v_accvgpr_read_b32 v184, a224
    v_accvgpr_read_b32 v185, a225
    v_accvgpr_read_b32 v186, a226
    v_accvgpr_read_b32 v187, a227
    s_waitcnt lgkmcnt(5)
    v_pk_fma_f32 v[172:173], v[16:17], v[128:129], v[172:173] op_sel:[0,0,0] op_sel_hi:[0,1,1]
    v_pk_fma_f32 v[174:175], v[16:17], v[130:131], v[174:175] op_sel:[0,0,0] op_sel_hi:[0,1,1]
    s_waitcnt lgkmcnt(4)
    v_pk_fma_f32 v[176:177], v[16:17], v[132:133], v[176:177] op_sel:[0,0,0] op_sel_hi:[0,1,1]
    v_pk_fma_f32 v[178:179], v[16:17], v[134:135], v[178:179] op_sel:[0,0,0] op_sel_hi:[0,1,1]
    s_waitcnt lgkmcnt(1)
    v_pk_fma_f32 v[180:181], v[16:17], v[136:137], v[180:181] op_sel:[0,0,0] op_sel_hi:[0,1,1]
    v_pk_fma_f32 v[182:183], v[16:17], v[138:139], v[182:183] op_sel:[0,0,0] op_sel_hi:[0,1,1]
    s_waitcnt lgkmcnt(0)
    v_pk_fma_f32 v[184:185], v[16:17], v[140:141], v[184:185] op_sel:[0,0,0] op_sel_hi:[0,1,1]
    v_pk_fma_f32 v[186:187], v[16:17], v[142:143], v[186:187] op_sel:[0,0,0] op_sel_hi:[0,1,1]
    v_pk_mul_f32 v[172:173], v[172:173], v[180:181]
    v_pk_mul_f32 v[174:175], v[174:175], v[182:183]
    v_pk_mul_f32 v[176:177], v[176:177], v[184:185]
    v_pk_mul_f32 v[178:179], v[178:179], v[186:187]
    v_pk_mul_f32 v[24:25], v[24:25], v[24:25]
    v_pk_mul_f32 v[26:27], v[26:27], v[26:27]
    v_pk_mul_f32 v[28:29], v[28:29], v[28:29]
    v_pk_mul_f32 v[30:31], v[30:31], v[30:31]
    v_pk_mul_f32 v[172:173], v[172:173], v[24:25] op_sel:[0,0] op_sel_hi:[1,0]
    v_pk_mul_f32 v[174:175], v[174:175], v[24:25] op_sel:[0,0] op_sel_hi:[1,0]
    v_pk_mul_f32 v[176:177], v[176:177], v[24:25] op_sel:[0,0] op_sel_hi:[1,0]
    v_pk_mul_f32 v[178:179], v[178:179], v[24:25] op_sel:[0,0] op_sel_hi:[1,0]
    v_lshlrev_b32_e64 v61, 2, v0
    v_and_b32 v61, 0x7c, v61
    v_bfe_u32 v12, v0, 3, 1
    v_lshlrev_b32 v12, 10, v12
    v_lshrrev_b32 v13, 5, v0
    v_lshl_add_u32 v12, v13, 8, v12
    v_bfe_u32 v14, v0, 4, 1
    v_lshl_add_u32 v12, v14, 7, v12
    v_and_b32 v15, 7, v0
    v_lshl_add_u32 v10, v15, 4, v12
    v_lshlrev_b32 v12, 10, v14
    v_lshl_add_u32 v12, v13, 8, v12
    v_and_b32_e64 v15, 15, v0
    v_lshl_add_u32 v3, v15, 4, v12
    v_lshlrev_b32_e64 v9, 4, v0
    v_add_u32_e64 v4, s57, v9
    v_cvt_pk_bf16_f32 v192, v172, v173
    v_cvt_pk_bf16_f32 v193, v174, v175
    v_cvt_pk_bf16_f32 v194, v176, v177
    v_cvt_pk_bf16_f32 v195, v178, v179
    v_accvgpr_read_b32 v172, a132
    v_accvgpr_read_b32 v173, a133
    v_accvgpr_read_b32 v174, a134
    v_accvgpr_read_b32 v175, a135
    v_accvgpr_read_b32 v176, a164
    v_accvgpr_read_b32 v177, a165
    v_accvgpr_read_b32 v178, a166
    v_accvgpr_read_b32 v179, a167
    v_accvgpr_read_b32 v180, a196
    v_accvgpr_read_b32 v181, a197
    v_accvgpr_read_b32 v182, a198
    v_accvgpr_read_b32 v183, a199
    v_accvgpr_read_b32 v184, a228
    v_accvgpr_read_b32 v185, a229
    v_accvgpr_read_b32 v186, a230
    v_accvgpr_read_b32 v187, a231
    v_pk_fma_f32 v[172:173], v[16:17], v[128:129], v[172:173] op_sel:[1,0,0] op_sel_hi:[1,1,1]
    v_pk_fma_f32 v[174:175], v[16:17], v[130:131], v[174:175] op_sel:[1,0,0] op_sel_hi:[1,1,1]
    v_pk_fma_f32 v[176:177], v[16:17], v[132:133], v[176:177] op_sel:[1,0,0] op_sel_hi:[1,1,1]
    v_pk_fma_f32 v[178:179], v[16:17], v[134:135], v[178:179] op_sel:[1,0,0] op_sel_hi:[1,1,1]
    v_pk_fma_f32 v[180:181], v[16:17], v[136:137], v[180:181] op_sel:[1,0,0] op_sel_hi:[1,1,1]
    v_pk_fma_f32 v[182:183], v[16:17], v[138:139], v[182:183] op_sel:[1,0,0] op_sel_hi:[1,1,1]
    v_pk_fma_f32 v[184:185], v[16:17], v[140:141], v[184:185] op_sel:[1,0,0] op_sel_hi:[1,1,1]
    v_pk_fma_f32 v[186:187], v[16:17], v[142:143], v[186:187] op_sel:[1,0,0] op_sel_hi:[1,1,1]
    v_pk_mul_f32 v[172:173], v[172:173], v[180:181]
    v_pk_mul_f32 v[174:175], v[174:175], v[182:183]
    v_pk_mul_f32 v[176:177], v[176:177], v[184:185]
    v_pk_mul_f32 v[178:179], v[178:179], v[186:187]
    v_pk_mul_f32 v[172:173], v[172:173], v[24:25] op_sel:[0,1] op_sel_hi:[1,1]
    v_pk_mul_f32 v[174:175], v[174:175], v[24:25] op_sel:[0,1] op_sel_hi:[1,1]
    v_pk_mul_f32 v[176:177], v[176:177], v[24:25] op_sel:[0,1] op_sel_hi:[1,1]
    v_pk_mul_f32 v[178:179], v[178:179], v[24:25] op_sel:[0,1] op_sel_hi:[1,1]
    s_cmp_eq_u32 s66, 0
    s_cbranch_scc1 L_lateB
    buffer_load_dword v60, v61, s[32:35], s60 offen sc1
L_lateB:
    v_cvt_pk_bf16_f32 v196, v172, v173
    v_cvt_pk_bf16_f32 v197, v174, v175
    v_cvt_pk_bf16_f32 v198, v176, v177
    v_cvt_pk_bf16_f32 v199, v178, v179
    v_accvgpr_read_b32 v172, a136
    v_accvgpr_read_b32 v173, a137
    v_accvgpr_read_b32 v174, a138
    v_accvgpr_read_b32 v175, a139
    v_accvgpr_read_b32 v176, a168
    v_accvgpr_read_b32 v177, a169
    v_accvgpr_read_b32 v178, a170
    v_accvgpr_read_b32 v179, a171
    v_accvgpr_read_b32 v180, a200
    v_accvgpr_read_b32 v181, a201
    v_accvgpr_read_b32 v182, a202
    v_accvgpr_read_b32 v183, a203
    v_accvgpr_read_b32 v184, a232
    v_accvgpr_read_b32 v185, a233
    v_accvgpr_read_b32 v186, a234
    v_accvgpr_read_b32 v187, a235
    v_pk_fma_f32 v[172:173], v[18:19], v[128:129], v[172:173] op_sel:[0,0,0] op_sel_hi:[0,1,1]
    v_pk_fma_f32 v[174:175], v[18:19], v[130:131], v[174:175] op_sel:[0,0,0] op_sel_hi:[0,1,1]
    v_pk_fma_f32 v[176:177], v[18:19], v[132:133], v[176:177] op_sel:[0,0,0] op_sel_hi:[0,1,1]
    v_pk_fma_f32 v[178:179], v[18:19], v[134:135], v[178:179] op_sel:[0,0,0] op_sel_hi:[0,1,1]
    v_pk_fma_f32 v[180:181], v[18:19], v[136:137], v[180:181] op_sel:[0,0,0] op_sel_hi:[0,1,1]
    v_pk_fma_f32 v[182:183], v[18:19], v[138:139], v[182:183] op_sel:[0,0,0] op_sel_hi:[0,1,1]
    v_pk_fma_f32 v[184:185], v[18:19], v[140:141], v[184:185] op_sel:[0,0,0] op_sel_hi:[0,1,1]
    v_pk_fma_f32 v[186:187], v[18:19], v[142:143], v[186:187] op_sel:[0,0,0] op_sel_hi:[0,1,1]
    v_pk_mul_f32 v[172:173], v[172:173], v[180:181]
    v_pk_mul_f32 v[174:175], v[174:175], v[182:183]
    v_pk_mul_f32 v[176:177], v[176:177], v[184:185]
    v_pk_mul_f32 v[178:179], v[178:179], v[186:187]
    v_pk_mul_f32 v[172:173], v[172:173], v[26:27] op_sel:[0,0] op_sel_hi:[1,0]
    v_pk_mul_f32 v[174:175], v[174:175], v[26:27] op_sel:[0,0] op_sel_hi:[1,0]
    v_pk_mul_f32 v[176:177], v[176:177], v[26:27] op_sel:[0,0] op_sel_hi:[1,0]
    v_pk_mul_f32 v[178:179], v[178:179], v[26:27] op_sel:[0,0] op_sel_hi:[1,0]
    v_cvt_pk_bf16_f32 v200, v172, v173
    v_cvt_pk_bf16_f32 v201, v174, v175
    v_cvt_pk_bf16_f32 v202, v176, v177
    v_cvt_pk_bf16_f32 v203, v178, v179
    v_accvgpr_read_b32 v172, a140
    v_accvgpr_read_b32 v173, a141
    v_accvgpr_read_b32 v174, a142
    v_accvgpr_read_b32 v175, a143
    v_accvgpr_read_b32 v176, a172
    v_accvgpr_read_b32 v177, a173
    v_accvgpr_read_b32 v178, a174
    v_accvgpr_read_b32 v179, a175
    v_accvgpr_read_b32 v180, a204
    v_accvgpr_read_b32 v181, a205
    v_accvgpr_read_b32 v182, a206
    v_accvgpr_read_b32 v183, a207
    v_accvgpr_read_b32 v184, a236
    v_accvgpr_read_b32 v185, a237
    v_accvgpr_read_b32 v186, a238
    v_accvgpr_read_b32 v187, a239
    v_pk_fma_f32 v[172:173], v[18:19], v[128:129], v[172:173] op_sel:[1,0,0] op_sel_hi:[1,1,1]
    v_pk_fma_f32 v[174:175], v[18:19], v[130:131], v[174:175] op_sel:[1,0,0] op_sel_hi:[1,1,1]
    v_pk_fma_f32 v[176:177], v[18:19], v[132:133], v[176:177] op_sel:[1,0,0] op_sel_hi:[1,1,1]
    v_pk_fma_f32 v[178:179], v[18:19], v[134:135], v[178:179] op_sel:[1,0,0] op_sel_hi:[1,1,1]
    v_pk_fma_f32 v[180:181], v[18:19], v[136:137], v[180:181] op_sel:[1,0,0] op_sel_hi:[1,1,1]
    v_pk_fma_f32 v[182:183], v[18:19], v[138:139], v[182:183] op_sel:[1,0,0] op_sel_hi:[1,1,1]
    v_pk_fma_f32 v[184:185], v[18:19], v[140:141], v[184:185] op_sel:[1,0,0] op_sel_hi:[1,1,1]
    v_pk_fma_f32 v[186:187], v[18:19], v[142:143], v[186:187] op_sel:[1,0,0] op_sel_hi:[1,1,1]
    v_pk_mul_f32 v[172:173], v[172:173], v[180:181]
    v_pk_mul_f32 v[174:175], v[174:175], v[182:183]
    v_pk_mul_f32 v[176:177], v[176:177], v[184:185]
    v_pk_mul_f32 v[178:179], v[178:179], v[186:187]
    v_pk_mul_f32 v[172:173], v[172:173], v[26:27] op_sel:[0,1] op_sel_hi:[1,1]
    v_pk_mul_f32 v[174:175], v[174:175], v[26:27] op_sel:[0,1] op_sel_hi:[1,1]
    v_pk_mul_f32 v[176:177], v[176:177], v[26:27] op_sel:[0,1] op_sel_hi:[1,1]
    v_pk_mul_f32 v[178:179], v[178:179], v[26:27] op_sel:[0,1] op_sel_hi:[1,1]
    v_cvt_pk_bf16_f32 v204, v172, v173
    v_cvt_pk_bf16_f32 v205, v174, v175
    v_cvt_pk_bf16_f32 v206, v176, v177
    v_cvt_pk_bf16_f32 v207, v178, v179
    v_accvgpr_read_b32 v172, a144
    v_accvgpr_read_b32 v173, a145
    v_accvgpr_read_b32 v174, a146
    v_accvgpr_read_b32 v175, a147
    v_accvgpr_read_b32 v176, a176
    v_accvgpr_read_b32 v177, a177
    v_accvgpr_read_b32 v178, a178
    v_accvgpr_read_b32 v179, a179
    v_accvgpr_read_b32 v180, a208
    v_accvgpr_read_b32 v181, a209
    v_accvgpr_read_b32 v182, a210
    v_accvgpr_read_b32 v183, a211
    v_accvgpr_read_b32 v184, a240
    v_accvgpr_read_b32 v185, a241
    v_accvgpr_read_b32 v186, a242
    v_accvgpr_read_b32 v187, a243
    v_pk_fma_f32 v[172:173], v[20:21], v[128:129], v[172:173] op_sel:[0,0,0] op_sel_hi:[0,1,1]
    v_pk_fma_f32 v[174:175], v[20:21], v[130:131], v[174:175] op_sel:[0,0,0] op_sel_hi:[0,1,1]
    v_pk_fma_f32 v[176:177], v[20:21], v[132:133], v[176:177] op_sel:[0,0,0] op_sel_hi:[0,1,1]
    v_pk_fma_f32 v[178:179], v[20:21], v[134:135], v[178:179] op_sel:[0,0,0] op_sel_hi:[0,1,1]
    v_pk_fma_f32 v[180:181], v[20:21], v[136:137], v[180:181] op_sel:[0,0,0] op_sel_hi:[0,1,1]
    v_pk_fma_f32 v[182:183], v[20:21], v[138:139], v[182:183] op_sel:[0,0,0] op_sel_hi:[0,1,1]
    v_pk_fma_f32 v[184:185], v[20:21], v[140:141], v[184:185] op_sel:[0,0,0] op_sel_hi:[0,1,1]
    v_pk_fma_f32 v[186:187], v[20:21], v[142:143], v[186:187] op_sel:[0,0,0] op_sel_hi:[0,1,1]
    v_pk_mul_f32 v[172:173], v[172:173], v[180:181]
    v_pk_mul_f32 v[174:175], v[174:175], v[182:183]
    v_pk_mul_f32 v[176:177], v[176:177], v[184:185]
    v_pk_mul_f32 v[178:179], v[178:179], v[186:187]
    v_pk_mul_f32 v[172:173], v[172:173], v[28:29] op_sel:[0,0] op_sel_hi:[1,0]
    v_pk_mul_f32 v[174:175], v[174:175], v[28:29] op_sel:[0,0] op_sel_hi:[1,0]
    v_pk_mul_f32 v[176:177], v[176:177], v[28:29] op_sel:[0,0] op_sel_hi:[1,0]
    v_pk_mul_f32 v[178:179], v[178:179], v[28:29] op_sel:[0,0] op_sel_hi:[1,0]
    v_cvt_pk_bf16_f32 v208, v172, v173
    v_cvt_pk_bf16_f32 v209, v174, v175
    v_cvt_pk_bf16_f32 v210, v176, v177
    v_cvt_pk_bf16_f32 v211, v178, v179
    v_accvgpr_read_b32 v172, a148
    v_accvgpr_read_b32 v173, a149
    v_accvgpr_read_b32 v174, a150
    v_accvgpr_read_b32 v175, a151
    v_accvgpr_read_b32 v176, a180
    v_accvgpr_read_b32 v177, a181
    v_accvgpr_read_b32 v178, a182
    v_accvgpr_read_b32 v179, a183
    v_accvgpr_read_b32 v180, a212
    v_accvgpr_read_b32 v181, a213
    v_accvgpr_read_b32 v182, a214
    v_accvgpr_read_b32 v183, a215
    v_accvgpr_read_b32 v184, a244
    v_accvgpr_read_b32 v185, a245
    v_accvgpr_read_b32 v186, a246
    v_accvgpr_read_b32 v187, a247
    v_pk_fma_f32 v[172:173], v[20:21], v[128:129], v[172:173] op_sel:[1,0,0] op_sel_hi:[1,1,1]
    v_pk_fma_f32 v[174:175], v[20:21], v[130:131], v[174:175] op_sel:[1,0,0] op_sel_hi:[1,1,1]
    v_pk_fma_f32 v[176:177], v[20:21], v[132:133], v[176:177] op_sel:[1,0,0] op_sel_hi:[1,1,1]
    v_pk_fma_f32 v[178:179], v[20:21], v[134:135], v[178:179] op_sel:[1,0,0] op_sel_hi:[1,1,1]
    v_pk_fma_f32 v[180:181], v[20:21], v[136:137], v[180:181] op_sel:[1,0,0] op_sel_hi:[1,1,1]
    v_pk_fma_f32 v[182:183], v[20:21], v[138:139], v[182:183] op_sel:[1,0,0] op_sel_hi:[1,1,1]
    v_pk_fma_f32 v[184:185], v[20:21], v[140:141], v[184:185] op_sel:[1,0,0] op_sel_hi:[1,1,1]
    v_pk_fma_f32 v[186:187], v[20:21], v[142:143], v[186:187] op_sel:[1,0,0] op_sel_hi:[1,1,1]
    v_pk_mul_f32 v[172:173], v[172:173], v[180:181]
    v_pk_mul_f32 v[174:175], v[174:175], v[182:183]
    v_pk_mul_f32 v[176:177], v[176:177], v[184:185]
    v_pk_mul_f32 v[178:179], v[178:179], v[186:187]
    v_pk_mul_f32 v[172:173], v[172:173], v[28:29] op_sel:[0,1] op_sel_hi:[1,1]
    v_pk_mul_f32 v[174:175], v[174:175], v[28:29] op_sel:[0,1] op_sel_hi:[1,1]
    v_pk_mul_f32 v[176:177], v[176:177], v[28:29] op_sel:[0,1] op_sel_hi:[1,1]
    v_pk_mul_f32 v[178:179], v[178:179], v[28:29] op_sel:[0,1] op_sel_hi:[1,1]
    v_cvt_pk_bf16_f32 v212, v172, v173
    v_cvt_pk_bf16_f32 v213, v174, v175
    v_cvt_pk_bf16_f32 v214, v176, v177
    v_cvt_pk_bf16_f32 v215, v178, v179
    v_accvgpr_read_b32 v172, a152
    v_accvgpr_read_b32 v173, a153
    v_accvgpr_read_b32 v174, a154
    v_accvgpr_read_b32 v175, a155
    v_accvgpr_read_b32 v176, a184
    v_accvgpr_read_b32 v177, a185
    v_accvgpr_read_b32 v178, a186
    v_accvgpr_read_b32 v179, a187
    v_accvgpr_read_b32 v180, a216
    v_accvgpr_read_b32 v181, a217
    v_accvgpr_read_b32 v182, a218
    v_accvgpr_read_b32 v183, a219
    v_accvgpr_read_b32 v184, a248
    v_accvgpr_read_b32 v185, a249
    v_accvgpr_read_b32 v186, a250
    v_accvgpr_read_b32 v187, a251
    v_pk_fma_f32 v[172:173], v[22:23], v[128:129], v[172:173] op_sel:[0,0,0] op_sel_hi:[0,1,1]
    v_pk_fma_f32 v[174:175], v[22:23], v[130:131], v[174:175] op_sel:[0,0,0] op_sel_hi:[0,1,1]
    v_pk_fma_f32 v[176:177], v[22:23], v[132:133], v[176:177] op_sel:[0,0,0] op_sel_hi:[0,1,1]
    v_pk_fma_f32 v[178:179], v[22:23], v[134:135], v[178:179] op_sel:[0,0,0] op_sel_hi:[0,1,1]
    v_pk_fma_f32 v[180:181], v[22:23], v[136:137], v[180:181] op_sel:[0,0,0] op_sel_hi:[0,1,1]
    v_pk_fma_f32 v[182:183], v[22:23], v[138:139], v[182:183] op_sel:[0,0,0] op_sel_hi:[0,1,1]
    v_pk_fma_f32 v[184:185], v[22:23], v[140:141], v[184:185] op_sel:[0,0,0] op_sel_hi:[0,1,1]
    v_pk_fma_f32 v[186:187], v[22:23], v[142:143], v[186:187] op_sel:[0,0,0] op_sel_hi:[0,1,1]
    v_pk_mul_f32 v[172:173], v[172:173], v[180:181]
    v_pk_mul_f32 v[174:175], v[174:175], v[182:183]
    v_pk_mul_f32 v[176:177], v[176:177], v[184:185]
    v_pk_mul_f32 v[178:179], v[178:179], v[186:187]
    v_pk_mul_f32 v[172:173], v[172:173], v[30:31] op_sel:[0,0] op_sel_hi:[1,0]
    v_pk_mul_f32 v[174:175], v[174:175], v[30:31] op_sel:[0,0] op_sel_hi:[1,0]
    v_pk_mul_f32 v[176:177], v[176:177], v[30:31] op_sel:[0,0] op_sel_hi:[1,0]
    v_pk_mul_f32 v[178:179], v[178:179], v[30:31] op_sel:[0,0] op_sel_hi:[1,0]
    v_cvt_pk_bf16_f32 v216, v172, v173
    v_cvt_pk_bf16_f32 v217, v174, v175
    v_cvt_pk_bf16_f32 v218, v176, v177
    v_cvt_pk_bf16_f32 v219, v178, v179
    v_accvgpr_read_b32 v172, a156
    v_accvgpr_read_b32 v173, a157
    v_accvgpr_read_b32 v174, a158
    v_accvgpr_read_b32 v175, a159
    v_accvgpr_read_b32 v176, a188
    v_accvgpr_read_b32 v177, a189
    v_accvgpr_read_b32 v178, a190
    v_accvgpr_read_b32 v179, a191
    v_accvgpr_read_b32 v180, a220
    v_accvgpr_read_b32 v181, a221
    v_accvgpr_read_b32 v182, a222
    v_accvgpr_read_b32 v183, a223
    v_accvgpr_read_b32 v184, a252
    v_accvgpr_read_b32 v185, a253
    v_accvgpr_read_b32 v186, a254
    v_accvgpr_read_b32 v187, a255
    v_pk_fma_f32 v[172:173], v[22:23], v[128:129], v[172:173] op_sel:[1,0,0] op_sel_hi:[1,1,1]
    v_pk_fma_f32 v[174:175], v[22:23], v[130:131], v[174:175] op_sel:[1,0,0] op_sel_hi:[1,1,1]
    v_pk_fma_f32 v[176:177], v[22:23], v[132:133], v[176:177] op_sel:[1,0,0] op_sel_hi:[1,1,1]
    v_pk_fma_f32 v[178:179], v[22:23], v[134:135], v[178:179] op_sel:[1,0,0] op_sel_hi:[1,1,1]
    v_pk_fma_f32 v[180:181], v[22:23], v[136:137], v[180:181] op_sel:[1,0,0] op_sel_hi:[1,1,1]
    v_pk_fma_f32 v[182:183], v[22:23], v[138:139], v[182:183] op_sel:[1,0,0] op_sel_hi:[1,1,1]
    v_pk_fma_f32 v[184:185], v[22:23], v[140:141], v[184:185] op_sel:[1,0,0] op_sel_hi:[1,1,1]
    v_pk_fma_f32 v[186:187], v[22:23], v[142:143], v[186:187] op_sel:[1,0,0] op_sel_hi:[1,1,1]
    v_pk_mul_f32 v[172:173], v[172:173], v[180:181]
    v_pk_mul_f32 v[174:175], v[174:175], v[182:183]
    v_pk_mul_f32 v[176:177], v[176:177], v[184:185]
    v_pk_mul_f32 v[178:179], v[178:179], v[186:187]
    v_pk_mul_f32 v[172:173], v[172:173], v[30:31] op_sel:[0,1] op_sel_hi:[1,1]
    v_pk_mul_f32 v[174:175], v[174:175], v[30:31] op_sel:[0,1] op_sel_hi:[1,1]
    v_pk_mul_f32 v[176:177], v[176:177], v[30:31] op_sel:[0,1] op_sel_hi:[1,1]
    v_pk_mul_f32 v[178:179], v[178:179], v[30:31] op_sel:[0,1] op_sel_hi:[1,1]
    v_cvt_pk_bf16_f32 v220, v172, v173
    v_cvt_pk_bf16_f32 v221, v174, v175
    v_cvt_pk_bf16_f32 v222, v176, v177
    v_cvt_pk_bf16_f32 v223, v178, v179
    s_branch L_p2
L_g1_spinB:
    s_mov_b32 s85, 0
L_g1_spB:
    buffer_load_dword v13, off, s[68:71], 0 sc1
    s_add_u32 s85, s85, 1
    s_cmp_gt_u32 s85, 400000
    s_cbranch_scc1 L_g1_goB
    s_waitcnt vmcnt(0)
    v_readfirstlane_b32 s84, v13
    s_cmp_lt_u32 s84, 256
    s_cbranch_scc1 L_g1_spB
    s_branch L_g1_goB
L_g1_eB:
L_p2:
    s_mov_b32 s58, 0
    s_cmp_eq_u32 s66, 0
    s_cbranch_scc1 L_p2_goq
    s_branch L_p2_chq
L_p2_spq:
    buffer_load_dword v60, v61, s[32:35], s60 offen sc1
    s_add_u32 s58, s58, 1
    s_cmp_gt_u32 s58, 400000
    s_cbranch_scc1 L_p2_goq
L_p2_chq:
    s_waitcnt vmcnt(0)
    v_cmp_ne_u32 vcc, s61, v60
    s_nop 3
    s_and_b32 s59, vcc_lo, s67
    s_cbranch_scc1 L_p2_spq
L_p2_goq:
    s_barrier
    s_cmp_eq_u32 s66, 0
    s_cbranch_scc1 L_p2_ld
    buffer_load_dwordx4 v[32:35], v3, s[32:35], s40 offen offset:0 sc1
    buffer_load_dwordx4 v[36:39], v3, s[32:35], s40 offen offset:512 sc1
    buffer_load_dwordx4 v[40:43], v3, s[32:35], s40 offen offset:2048 sc1
    buffer_load_dwordx4 v[44:47], v3, s[32:35], s40 offen offset:2560 sc1
    buffer_load_dwordx4 v[48:51], v10, s[8:11], 0 offen sc1
    buffer_load_dwordx4 v[52:55], v10, s[8:11], 0 offen offset:512 sc1
L_p2_ld:
    s_add_u32 m0, s36, 0
    s_nop 0
    buffer_load_dwordx4 v4, s[8:11], s37 offen sc1 lds
    s_add_u32 s37, s37, 4096
    s_add_u32 m0, s36, 4096
    s_nop 0
    buffer_load_dwordx4 v4, s[8:11], s37 offen sc1 lds
    s_add_u32 s37, s37, 4096
    s_add_u32 m0, s36, 8192
    s_nop 0
    buffer_load_dwordx4 v4, s[8:11], s37 offen sc1 lds
    s_add_u32 s37, s37, 4096
    v_lshrrev_b32 v12, 3, v0
    v_and_b32 v15, 7, v0
    v_xor_b32 v15, v12, v15
    v_lshlrev_b32 v15, 4, v15
    v_lshl_add_u32 v8, v12, 11, v15
    s_add_u32 s59, s39, 28672
    v_and_b32 v168, 31, v0
    v_lshrrev_b32 v169, 5, v0
    v_and_b32 v170, 7, v0
    v_lshlrev_b32 v169, 2, v169
    v_xor_b32 v169, v169, v170
    v_lshlrev_b32 v169, 4, v169
    v_lshl_add_u32 v168, v168, 7, v169
    v_add_u32 v168, s59, v168
    v_xor_b32 v172, 16, v168
    v_xor_b32 v176, 32, v168
    v_xor_b32 v180, 48, v168
    v_add_u32 v2, 131072, v10
    v_add_u32 v5, 1024, v4
    v_and_b32 v5, 0xfff, v5
    v_add_u32 v6, 2048, v4
    v_and_b32 v6, 0xfff, v6
    v_add_u32 v7, 3072, v4
    v_and_b32 v7, 0xfff, v7
    v_bfe_u32 v15, v0, 2, 1
    v_cmp_eq_u32 vcc, 0, v15
    v_mov_b32 v12, 0x3f803f80
    s_nop 0
    v_cndmask_b32 v20, 0, v12, vcc
    v_sub_u32 v22, v12, v20
    v_cndmask_b32 v21, 0, v12, vcc
    v_sub_u32 v23, v12, v21
    v_add_u32 v11, s46, v0
    v_and_b32 v11, 31, v11
    v_lshlrev_b32 v11, 2, v11
    v_and_b32 v3, 1, v0
    v_mul_u32_u24 v3, 0xaaaa, v3
    v_add_u32 v3, 0x4444, v3
    buffer_store_dwordx4 v[192:195], v1, s[32:35], s70 offen offset:0 sc1
    v_mov_b32 v128, 0
    v_mov_b32 v129, 0
    v_mov_b32 v130, 0
    v_mov_b32 v131, 0
    v_mov_b32 v132, 0
    v_mov_b32 v133, 0
    v_mov_b32 v134, 0
    v_mov_b32 v135, 0
    v_mov_b32 v136, 0
    v_mov_b32 v137, 0
    v_mov_b32 v138, 0
    v_mov_b32 v139, 0
    v_mov_b32 v140, 0
    v_mov_b32 v141, 0
    v_mov_b32 v142, 0
    v_mov_b32 v143, 0
    v_mov_b32 v144, 0
    v_mov_b32 v145, 0
    v_mov_b32 v146, 0
    v_mov_b32 v147, 0
    v_mov_b32 v148, 0
    v_mov_b32 v149, 0
    v_mov_b32 v150, 0
    v_mov_b32 v151, 0
    v_mov_b32 v152, 0
    v_mov_b32 v153, 0
    v_mov_b32 v154, 0
    v_mov_b32 v155, 0
    buffer_store_dwordx4 v[224:227], v1, s[32:35], s71 offen offset:0 sc1
    v_mov_b32 v156, 0
    v_mov_b32 v157, 0
    v_mov_b32 v158, 0
    v_mov_b32 v159, 0
    v_mov_b32 v160, 0
    v_mov_b32 v161, 0
    v_mov_b32 v162, 0
    v_mov_b32 v163, 0
    v_mov_b32 v164, 0
    v_mov_b32 v165, 0
    v_mov_b32 v166, 0
    v_mov_b32 v167, 0
    v_mov_b32 v24, 0
    v_mov_b32 v25, 0
    v_mov_b32 v26, 0
    v_mov_b32 v27, 0
    v_mov_b32 v28, 0
    v_mov_b32 v29, 0
    v_mov_b32 v30, 0
    v_mov_b32 v31, 0
    v_mov_b32 v56, 0
    v_mov_b32 v57, 0
    v_mov_b32 v58, 0
    v_mov_b32 v59, 0
    v_mov_b32 v60, 0
    v_mov_b32 v61, 0
    v_mov_b32_e64 v62, 0
    v_mov_b32_e64 v63, 0
    v_mov_b32_e64 v18, 0
    v_mov_b32 v19, 0
    s_waitcnt vmcnt(5)
    v_mfma_f32_32x32x16_bf16 v[64:79], v[48:51], v[32:35], 0
    v_mfma_f32_32x32x16_bf16 v[64:79], v[52:55], v[36:39], v[64:79]
    v_mfma_f32_32x32x16_bf16 v[80:95], v[48:51], v[40:43], 0
    v_mfma_f32_32x32x16_bf16 v[80:95], v[52:55], v[44:47], v[80:95]
    s_add_u32 m0, s36, 12288
    s_nop 0
    s_nop 0
    buffer_load_dwordx4 v4, s[8:11], s37 offen sc1 lds
    s_add_u32 s37, s37, 4096
    buffer_store_dwordx4 v[196:199], v1, s[32:35], s70 offen offset:256 sc1
    s_nop 9
    v_max3_f32 v12, v64, v65, v66
    s_nop 0
    v_max3_f32 v12, v12, v67, v68
    v_max3_f32 v12, v12, v69, v70
    v_max3_f32 v12, v12, v71, v72
    v_max3_f32 v12, v12, v73, v74
    v_max3_f32 v12, v12, v75, v76
    v_max3_f32 v12, v12, v77, v78
    v_max3_f32 v12, v12, v79, v79
    s_add_u32 m0, s36, 16384
    s_nop 0
    buffer_load_dwordx4 v4, s[8:11], s37 offen sc1 lds
    s_add_u32 s37, s37, 4096
    buffer_store_dwordx4 v[228:231], v1, s[32:35], s71 offen offset:256 sc1
    s_nop 1
    v_max3_f32 v13, v80, v81, v82
    v_max3_f32 v13, v13, v83, v84
    v_max3_f32 v13, v13, v85, v86
    v_max3_f32 v13, v13, v87, v88
    v_max3_f32 v13, v13, v89, v90
    v_max3_f32 v13, v13, v91, v92
    v_max3_f32 v13, v13, v93, v94
    v_max3_f32 v13, v13, v95, v95
    s_add_u32 m0, s36, 20480
    s_nop 0
    buffer_load_dwordx4 v4, s[8:11], s37 offen sc1 lds
    s_add_u32 s37, s37, 4096
    v_mov_b32 v14, v12
    v_mov_b32 v15, v13
    s_nop 1
    v_permlane32_swap_b32 v12, v14
    v_permlane32_swap_b32 v13, v15
    s_nop 1
    v_max_f32 v12, v12, v14
    v_max_f32 v13, v13, v15
    v_sub_f32 v96, 0, v12
    v_sub_f32 v97, 0, v12
    v_sub_f32 v98, 0, v12
    v_sub_f32 v99, 0, v12
    v_sub_f32 v100, 0, v12
    v_sub_f32 v101, 0, v12
    v_sub_f32 v102, 0, v12
    v_sub_f32 v103, 0, v12
    v_sub_f32 v104, 0, v12
    v_sub_f32 v105, 0, v12
    v_sub_f32 v106, 0, v12
    v_sub_f32 v107, 0, v12
    v_sub_f32 v108, 0, v12
    v_sub_f32 v109, 0, v12
    v_sub_f32 v110, 0, v12
    v_sub_f32 v111, 0, v12
    v_sub_f32 v112, 0, v13
    v_sub_f32 v113, 0, v13
    v_sub_f32 v114, 0, v13
    v_sub_f32 v115, 0, v13
    v_sub_f32 v116, 0, v13
    v_sub_f32 v117, 0, v13
    v_sub_f32 v118, 0, v13
    v_sub_f32 v119, 0, v13
    v_sub_f32 v120, 0, v13
    v_sub_f32 v121, 0, v13
    v_sub_f32 v122, 0, v13
    v_sub_f32 v123, 0, v13
    v_sub_f32 v124, 0, v13
    v_sub_f32 v125, 0, v13
    v_sub_f32 v126, 0, v13
    v_sub_f32_e64 v127, 0, v13
    v_mfma_f32_32x32x16_bf16 v[64:79], v[48:51], v[32:35], v[96:111]
    v_mfma_f32_32x32x16_bf16 v[64:79], v[52:55], v[36:39], v[64:79]
    s_waitcnt vmcnt(7)
    s_barrier
    s_nop 7
    s_nop 1
    v_mfma_f32_32x32x16_bf16 v[144:159], v[56:59], v[24:27], v[144:159]
    ds_read_b128 v[56:59], v2 offset:2048
    v_cvt_pk_bf16_f32 v31, v18, v19
    v_exp_f32 v12, v64
    v_exp_f32 v13, v65
    v_exp_f32 v14, v66
    v_mfma_f32_32x32x16_bf16 v[144:159], v[60:63], v[28:31], v[144:159]
    ds_read_b128 v[60:63], v2 offset:2560
    v_exp_f32 v15, v67
    v_exp_f32 v16, v68
    v_exp_f32 v17, v69
    v_smfmac_f32_16x16x64_bf16 v[164:167], v[20:23], v[24:31], v3
    buffer_store_dwordx4 v[200:203], v1, s[32:35], s70 offen offset:1024 sc1
    v_cvt_pk_bf16_f32 v24, v12, v13
    v_cvt_pk_bf16_f32 v25, v14, v15
    v_mfma_f32_32x32x16_bf16 v[80:95], v[48:51], v[40:43], v[112:127]
    ds_read_b128 v[48:51], v2 offset:4096
    v_exp_f32 v18, v70
    v_exp_f32 v19, v71
    v_cvt_pk_bf16_f32 v26, v16, v17
    v_exp_f32 v12, v72
    v_mfma_f32_32x32x16_bf16 v[80:95], v[52:55], v[44:47], v[80:95]
    ds_read_b128 v[52:55], v2 offset:4608
    v_cvt_pk_bf16_f32 v27, v18, v19
    v_exp_f32 v13, v73
    v_exp_f32 v14, v74
    v_cvt_pk_bf16_f32 v28, v12, v13
    v_exp_f32 v15, v75
    v_exp_f32 v16, v76
    v_cvt_pk_bf16_f32 v29, v14, v15
    v_exp_f32 v17, v77
    v_exp_f32 v18, v78
    v_cvt_pk_bf16_f32 v30, v16, v17
    s_add_u32 m0, s36, 24576
    s_waitcnt lgkmcnt(2)
    v_exp_f32_e64 v19, v79
    v_mfma_f32_32x32x16_bf16 v[128:143], v[56:59], v[24:27], v[128:143]
    buffer_load_dwordx4 v4, s[8:11], s37 offen sc1 lds
    v_cvt_pk_bf16_f32 v31, v18, v19
    v_exp_f32 v12, v80
    v_exp_f32 v13, v81
    v_exp_f32 v14, v82
    v_mfma_f32_32x32x16_bf16 v[128:143], v[60:63], v[28:31], v[128:143]
    s_add_u32 s37, s37, 4096
    v_exp_f32 v15, v83
    v_exp_f32_e64 v16, v84
    v_exp_f32 v17, v85
    v_smfmac_f32_16x16x64_bf16 v[160:163], v[20:23], v[24:31], v3
    s_waitcnt lgkmcnt(0)
    v_cvt_pk_bf16_f32 v24, v12, v13
    v_cvt_pk_bf16_f32 v25, v14, v15
    v_mfma_f32_32x32x16_bf16 v[64:79], v[48:51], v[32:35], v[96:111]
    buffer_store_dwordx4 v[232:235], v1, s[32:35], s71 offen offset:1024 sc1
    v_exp_f32 v18, v86
    v_exp_f32 v19, v87
    v_cvt_pk_bf16_f32 v26, v16, v17
    v_exp_f32 v12, v88
    v_mfma_f32_32x32x16_bf16 v[64:79], v[52:55], v[36:39], v[64:79]
    v_cvt_pk_bf16_f32 v27, v18, v19
    v_exp_f32 v13, v89
    v_exp_f32_e64 v14, v90
    v_cvt_pk_bf16_f32 v28, v12, v13
    v_exp_f32 v15, v91
    v_exp_f32 v16, v92
    v_cvt_pk_bf16_f32 v29, v14, v15
    v_exp_f32 v17, v93
    v_exp_f32 v18, v94
    v_cvt_pk_bf16_f32 v30, v16, v17
    v_exp_f32_e64 v19, v95
    v_mfma_f32_32x32x16_bf16 v[144:159], v[56:59], v[24:27], v[144:159]
    ds_read_b128 v[56:59], v2 offset:6144
    v_cvt_pk_bf16_f32 v31, v18, v19
    v_exp_f32 v12, v64
    v_exp_f32 v13, v65
    v_exp_f32_e64 v14, v66
    v_mfma_f32_32x32x16_bf16 v[144:159], v[60:63], v[28:31], v[144:159]
    ds_read_b128 v[60:63], v2 offset:6656
    v_exp_f32 v15, v67
    v_exp_f32 v16, v68
    v_exp_f32_e64 v17, v69
    v_smfmac_f32_16x16x64_bf16 v[164:167], v[20:23], v[24:31], v3
    buffer_store_dwordx4 v[204:207], v1, s[32:35], s70 offen offset:1280 sc1
    v_cvt_pk_bf16_f32 v24, v12, v13
    v_cvt_pk_bf16_f32 v25, v14, v15
    v_mfma_f32_32x32x16_bf16 v[80:95], v[48:51], v[40:43], v[112:127]
    ds_read_b128 v[48:51], v2 offset:8192
    v_exp_f32 v18, v70
    v_exp_f32 v19, v71
    v_cvt_pk_bf16_f32 v26, v16, v17
    v_exp_f32_e64 v12, v72
    v_mfma_f32_32x32x16_bf16 v[80:95], v[52:55], v[44:47], v[80:95]
    ds_read_b128 v[52:55], v2 offset:8704
    v_cvt_pk_bf16_f32 v27, v18, v19
    v_exp_f32 v13, v73
    v_exp_f32 v14, v74
    v_cvt_pk_bf16_f32 v28, v12, v13
    v_exp_f32 v15, v75
    v_exp_f32 v16, v76
    v_cvt_pk_bf16_f32 v29, v14, v15
    v_exp_f32 v17, v77
    v_exp_f32 v18, v78
    v_cvt_pk_bf16_f32 v30, v16, v17
    s_add_u32 m0, s36, 28672
    s_waitcnt lgkmcnt(2)
    v_exp_f32 v19, v79
    v_mfma_f32_32x32x16_bf16 v[128:143], v[56:59], v[24:27], v[128:143]
    buffer_load_dwordx4 v4, s[8:11], s37 offen sc1 lds
    v_cvt_pk_bf16_f32 v31, v18, v19
    v_exp_f32 v12, v80
    v_exp_f32 v13, v81
    v_exp_f32_e64 v14, v82
    v_mfma_f32_32x32x16_bf16 v[128:143], v[60:63], v[28:31], v[128:143]
    s_add_u32 s37, s37, 4096
    v_exp_f32_e64 v15, v83
    v_exp_f32_e64 v16, v84
    v_exp_f32 v17, v85
    v_smfmac_f32_16x16x64_bf16 v[160:163], v[20:23], v[24:31], v3
    s_waitcnt lgkmcnt(0)
    v_cvt_pk_bf16_f32 v24, v12, v13
    v_cvt_pk_bf16_f32 v25, v14, v15
    v_mfma_f32_32x32x16_bf16 v[64:79], v[48:51], v[32:35], v[96:111]
    buffer_store_dwordx4 v[236:239], v1, s[32:35], s71 offen offset:1280 sc1
    v_exp_f32 v18, v86
    v_exp_f32 v19, v87
    v_cvt_pk_bf16_f32 v26, v16, v17
    v_exp_f32 v12, v88
    v_mfma_f32_32x32x16_bf16 v[64:79], v[52:55], v[36:39], v[64:79]
    v_cvt_pk_bf16_f32 v27, v18, v19
    v_exp_f32 v13, v89
    v_exp_f32_e64 v14, v90
    v_cvt_pk_bf16_f32 v28, v12, v13
    v_exp_f32 v15, v91
    s_waitcnt vmcnt(8)
    v_exp_f32 v16, v92
    v_cvt_pk_bf16_f32 v29, v14, v15
    v_exp_f32 v17, v93
    s_barrier
    v_exp_f32 v18, v94
    v_cvt_pk_bf16_f32 v30, v16, v17
    v_exp_f32_e64 v19, v95
    v_mfma_f32_32x32x16_bf16 v[144:159], v[56:59], v[24:27], v[144:159]
    ds_read_b128 v[56:59], v2 offset:10240
    v_cvt_pk_bf16_f32 v31, v18, v19
    v_exp_f32 v12, v64
    v_exp_f32 v13, v65
    v_exp_f32_e64 v14, v66
    v_mfma_f32_32x32x16_bf16 v[144:159], v[60:63], v[28:31], v[144:159]
    ds_read_b128 v[60:63], v2 offset:10752
    v_exp_f32 v15, v67
    v_exp_f32 v16, v68
    v_exp_f32_e64 v17, v69
    v_smfmac_f32_16x16x64_bf16 v[164:167], v[20:23], v[24:31], v3
    buffer_store_dwordx4 v[208:211], v1, s[32:35], s70 offen offset:2048 sc1
    v_cvt_pk_bf16_f32 v24, v12, v13
    v_cvt_pk_bf16_f32 v25, v14, v15
    v_mfma_f32_32x32x16_bf16 v[80:95], v[48:51], v[40:43], v[112:127]
    ds_read_b128 v[48:51], v2 offset:12288
    v_exp_f32 v18, v70
    v_exp_f32 v19, v71
    v_cvt_pk_bf16_f32 v26, v16, v17
    v_exp_f32 v12, v72
    v_mfma_f32_32x32x16_bf16 v[80:95], v[52:55], v[44:47], v[80:95]
    ds_read_b128 v[52:55], v2 offset:12800
    v_cvt_pk_bf16_f32 v27, v18, v19
    v_exp_f32 v13, v73
    v_exp_f32 v14, v74
    v_cvt_pk_bf16_f32 v28, v12, v13
    v_exp_f32 v15, v75
    v_exp_f32 v16, v76
    v_cvt_pk_bf16_f32 v29, v14, v15
    v_exp_f32 v17, v77
    v_exp_f32 v18, v78
    v_cvt_pk_bf16_f32 v30, v16, v17
    s_add_u32 m0, s36, 0
    s_waitcnt lgkmcnt(2)
    v_exp_f32 v19, v79
    v_mfma_f32_32x32x16_bf16 v[128:143], v[56:59], v[24:27], v[128:143]
    buffer_load_dwordx4 v4, s[8:11], s37 offen sc1 lds
    v_cvt_pk_bf16_f32 v31, v18, v19
    v_exp_f32 v12, v80
    v_exp_f32 v13, v81
    v_exp_f32_e64 v14, v82
    v_mfma_f32_32x32x16_bf16 v[128:143], v[60:63], v[28:31], v[128:143]
    s_add_u32 s37, s37, 4096
    s_mov_b32 m0, s39
    v_exp_f32 v15, v83
    v_exp_f32_e64 v16, v84
    v_exp_f32 v17, v85
    v_smfmac_f32_16x16x64_bf16 v[160:163], v[20:23], v[24:31], v3
    s_waitcnt lgkmcnt(0)
    v_cvt_pk_bf16_f32 v24, v12, v13
    v_cvt_pk_bf16_f32 v25, v14, v15
    v_mfma_f32_32x32x16_bf16 v[64:79], v[48:51], v[32:35], v[96:111]
    buffer_store_dwordx4 v[240:243], v1, s[32:35], s71 offen offset:2048 sc1
    v_exp_f32 v18, v86
    v_exp_f32 v19, v87
    v_cvt_pk_bf16_f32 v26, v16, v17
    v_exp_f32 v12, v88
    v_mfma_f32_32x32x16_bf16 v[64:79], v[52:55], v[36:39], v[64:79]
    v_cvt_pk_bf16_f32 v27, v18, v19
    v_exp_f32 v13, v89
    v_exp_f32_e64 v14, v90
    v_cvt_pk_bf16_f32 v28, v12, v13
    v_exp_f32 v15, v91
    v_exp_f32 v16, v92
    v_cvt_pk_bf16_f32 v29, v14, v15
    v_exp_f32_e64 v17, v93
    buffer_load_dwordx4 v9, s[24:27], m0 offen offset:0 sc1 lds
    v_exp_f32 v18, v94
    v_cvt_pk_bf16_f32 v30, v16, v17
    v_exp_f32 v19, v95
    v_mfma_f32_32x32x16_bf16 v[144:159], v[56:59], v[24:27], v[144:159]
    ds_read_b128 v[56:59], v2 offset:14336
    v_cvt_pk_bf16_f32 v31, v18, v19
    v_exp_f32 v12, v64
    v_exp_f32 v13, v65
    v_exp_f32_e64 v14, v66
    v_mfma_f32_32x32x16_bf16 v[144:159], v[60:63], v[28:31], v[144:159]
    ds_read_b128 v[60:63], v2 offset:14848
    v_exp_f32 v15, v67
    v_exp_f32 v16, v68
    v_exp_f32_e64 v17, v69
    v_smfmac_f32_16x16x64_bf16 v[164:167], v[20:23], v[24:31], v3
    buffer_store_dwordx4 v[212:215], v1, s[32:35], s70 offen offset:2304 sc1
    v_cvt_pk_bf16_f32 v24, v12, v13
    v_cvt_pk_bf16_f32 v25, v14, v15
    v_mfma_f32_32x32x16_bf16 v[80:95], v[48:51], v[40:43], v[112:127]
    ds_read_b128 v[48:51], v2 offset:16384
    v_exp_f32 v18, v70
    v_exp_f32 v19, v71
    v_cvt_pk_bf16_f32 v26, v16, v17
    v_exp_f32 v12, v72
    v_mfma_f32_32x32x16_bf16 v[80:95], v[52:55], v[44:47], v[80:95]
    ds_read_b128 v[52:55], v2 offset:16896
    v_cvt_pk_bf16_f32 v27, v18, v19
    v_exp_f32 v13, v73
    v_exp_f32 v14, v74
    v_cvt_pk_bf16_f32 v28, v12, v13
    v_exp_f32 v15, v75
    v_exp_f32 v16, v76
    v_cvt_pk_bf16_f32 v29, v14, v15
    v_exp_f32 v17, v77
    v_exp_f32 v18, v78
    v_cvt_pk_bf16_f32 v30, v16, v17
    s_add_u32 m0, s36, 4096
    s_waitcnt lgkmcnt(2)
    v_exp_f32_e64 v19, v79
    v_mfma_f32_32x32x16_bf16 v[128:143], v[56:59], v[24:27], v[128:143]
    buffer_load_dwordx4 v4, s[8:11], s37 offen sc1 lds
    v_cvt_pk_bf16_f32 v31, v18, v19
    v_exp_f32 v12, v80
    v_exp_f32 v13, v81
    v_exp_f32 v14, v82
    v_mfma_f32_32x32x16_bf16 v[128:143], v[60:63], v[28:31], v[128:143]
    s_add_u32 s37, s37, 4096
    s_mov_b32 m0, s39
    v_exp_f32 v15, v83
    v_exp_f32 v16, v84
    v_exp_f32 v17, v85
    v_smfmac_f32_16x16x64_bf16 v[160:163], v[20:23], v[24:31], v3
    s_waitcnt lgkmcnt(0)
    v_cvt_pk_bf16_f32 v24, v12, v13
    v_cvt_pk_bf16_f32 v25, v14, v15
    v_mfma_f32_32x32x16_bf16 v[64:79], v[48:51], v[32:35], v[96:111]
    buffer_store_dwordx4 v[244:247], v1, s[32:35], s71 offen offset:2304 sc1
    v_exp_f32 v18, v86
    v_exp_f32 v19, v87
    v_cvt_pk_bf16_f32 v26, v16, v17
    v_exp_f32 v12, v88
    v_mfma_f32_32x32x16_bf16 v[64:79], v[52:55], v[36:39], v[64:79]
    v_cvt_pk_bf16_f32 v27, v18, v19
    v_exp_f32 v13, v89
    v_exp_f32_e64 v14, v90
    v_cvt_pk_bf16_f32 v28, v12, v13
    v_exp_f32 v15, v91
    s_waitcnt vmcnt(11)
    v_exp_f32 v16, v92
    v_cvt_pk_bf16_f32 v29, v14, v15
    v_exp_f32 v17, v93
    buffer_load_dwordx4 v9, s[24:27], m0 offen offset:1024 sc1 lds
    s_barrier
    v_exp_f32 v18, v94
    v_cvt_pk_bf16_f32 v30, v16, v17
    v_exp_f32_e64 v19, v95
    v_mfma_f32_32x32x16_bf16 v[144:159], v[56:59], v[24:27], v[144:159]
    ds_read_b128 v[56:59], v2 offset:18432
    v_cvt_pk_bf16_f32 v31, v18, v19
    v_exp_f32 v12, v64
    v_exp_f32 v13, v65
    v_exp_f32 v14, v66
    v_mfma_f32_32x32x16_bf16 v[144:159], v[60:63], v[28:31], v[144:159]
    ds_read_b128 v[60:63], v2 offset:18944
    v_exp_f32 v15, v67
    v_exp_f32 v16, v68
    v_exp_f32 v17, v69
    v_smfmac_f32_16x16x64_bf16 v[164:167], v[20:23], v[24:31], v3
    buffer_store_dwordx4 v[216:219], v1, s[32:35], s70 offen offset:3072 sc1
    v_cvt_pk_bf16_f32 v24, v12, v13
    v_cvt_pk_bf16_f32 v25, v14, v15
    v_mfma_f32_32x32x16_bf16 v[80:95], v[48:51], v[40:43], v[112:127]
    ds_read_b128 v[48:51], v2 offset:20480
    v_exp_f32 v18, v70
    v_exp_f32 v19, v71
    v_cvt_pk_bf16_f32 v26, v16, v17
    v_exp_f32 v12, v72
    v_mfma_f32_32x32x16_bf16 v[80:95], v[52:55], v[44:47], v[80:95]
    ds_read_b128 v[52:55], v2 offset:20992
    v_cvt_pk_bf16_f32 v27, v18, v19
    v_exp_f32 v13, v73
    v_exp_f32 v14, v74
    v_cvt_pk_bf16_f32 v28, v12, v13
    v_exp_f32 v15, v75
    v_exp_f32 v16, v76
    v_cvt_pk_bf16_f32 v29, v14, v15
    v_exp_f32 v17, v77
    v_exp_f32 v18, v78
    v_cvt_pk_bf16_f32 v30, v16, v17
    s_add_u32 m0, s36, 8192
    s_waitcnt lgkmcnt(2)
    v_exp_f32_e64 v19, v79
    v_mfma_f32_32x32x16_bf16 v[128:143], v[56:59], v[24:27], v[128:143]
    buffer_load_dwordx4 v4, s[8:11], s37 offen sc1 lds
    v_cvt_pk_bf16_f32 v31, v18, v19
    v_exp_f32 v12, v80
    v_exp_f32 v13, v81
    v_exp_f32 v14, v82
    v_mfma_f32_32x32x16_bf16 v[128:143], v[60:63], v[28:31], v[128:143]
    s_add_u32 s37, s37, 4096
    s_mov_b32 m0, s39
    v_exp_f32 v15, v83
    v_exp_f32 v16, v84
    v_exp_f32 v17, v85
    v_smfmac_f32_16x16x64_bf16 v[160:163], v[20:23], v[24:31], v3
    s_waitcnt lgkmcnt(0)
    v_cvt_pk_bf16_f32 v24, v12, v13
    v_cvt_pk_bf16_f32 v25, v14, v15
    v_mfma_f32_32x32x16_bf16 v[64:79], v[48:51], v[32:35], v[96:111]
    buffer_store_dwordx4 v[248:251], v1, s[32:35], s71 offen offset:3072 sc1
    v_exp_f32 v18, v86
    v_exp_f32 v19, v87
    v_cvt_pk_bf16_f32 v26, v16, v17
    v_exp_f32 v12, v88
    v_mfma_f32_32x32x16_bf16 v[64:79], v[52:55], v[36:39], v[64:79]
    v_cvt_pk_bf16_f32 v27, v18, v19
    v_exp_f32 v13, v89
    v_exp_f32_e64 v14, v90
    v_cvt_pk_bf16_f32 v28, v12, v13
    v_exp_f32 v15, v91
    v_exp_f32 v16, v92
    v_cvt_pk_bf16_f32 v29, v14, v15
    v_exp_f32_e64 v17, v93
    buffer_load_dwordx4 v9, s[24:27], m0 offen offset:2048 sc1 lds
    v_exp_f32 v18, v94
    v_cvt_pk_bf16_f32 v30, v16, v17
    v_exp_f32 v19, v95
    v_mfma_f32_32x32x16_bf16 v[144:159], v[56:59], v[24:27], v[144:159]
    ds_read_b128 v[56:59], v2 offset:22528
    v_cvt_pk_bf16_f32 v31, v18, v19
    v_exp_f32 v12, v64
    v_exp_f32 v13, v65
    v_exp_f32_e64 v14, v66
    v_mfma_f32_32x32x16_bf16 v[144:159], v[60:63], v[28:31], v[144:159]
    ds_read_b128 v[60:63], v2 offset:23040
    v_exp_f32 v15, v67
    v_exp_f32 v16, v68
    v_exp_f32_e64 v17, v69
    v_smfmac_f32_16x16x64_bf16 v[164:167], v[20:23], v[24:31], v3
    buffer_store_dwordx4 v[220:223], v1, s[32:35], s70 offen offset:3328 sc1
    v_cvt_pk_bf16_f32 v24, v12, v13
    v_cvt_pk_bf16_f32 v25, v14, v15
    v_mfma_f32_32x32x16_bf16 v[80:95], v[48:51], v[40:43], v[112:127]
    ds_read_b128 v[48:51], v2 offset:24576
    v_exp_f32 v18, v70
    v_exp_f32 v19, v71
    v_cvt_pk_bf16_f32 v26, v16, v17
    v_exp_f32 v12, v72
    v_mfma_f32_32x32x16_bf16 v[80:95], v[52:55], v[44:47], v[80:95]
    ds_read_b128 v[52:55], v2 offset:25088
    v_cvt_pk_bf16_f32 v27, v18, v19
    v_exp_f32 v13, v73
    v_exp_f32 v14, v74
    v_cvt_pk_bf16_f32 v28, v12, v13
    v_exp_f32 v15, v75
    v_exp_f32 v16, v76
    v_cvt_pk_bf16_f32 v29, v14, v15
    v_exp_f32 v17, v77
    v_exp_f32 v18, v78
    v_cvt_pk_bf16_f32 v30, v16, v17
    s_add_u32 m0, s36, 12288
    s_waitcnt lgkmcnt(2)
    v_exp_f32_e64 v19, v79
    v_mfma_f32_32x32x16_bf16 v[128:143], v[56:59], v[24:27], v[128:143]
    buffer_load_dwordx4 v4, s[8:11], s37 offen sc1 lds
    v_cvt_pk_bf16_f32 v31, v18, v19
    v_exp_f32 v12, v80
    v_exp_f32 v13, v81
    v_exp_f32 v14, v82
    v_mfma_f32_32x32x16_bf16 v[128:143], v[60:63], v[28:31], v[128:143]
    s_add_u32 s37, s37, 4096
    s_mov_b32 m0, s39
    v_exp_f32 v15, v83
    v_exp_f32 v16, v84
    v_exp_f32 v17, v85
    v_smfmac_f32_16x16x64_bf16 v[160:163], v[20:23], v[24:31], v3
    s_waitcnt lgkmcnt(0)
    v_cvt_pk_bf16_f32 v24, v12, v13
    v_cvt_pk_bf16_f32 v25, v14, v15
    v_mfma_f32_32x32x16_bf16 v[64:79], v[48:51], v[32:35], v[96:111]
    buffer_store_dwordx4 v[252:255], v1, s[32:35], s71 offen offset:3328 sc1
    v_exp_f32 v18, v86
    v_exp_f32 v19, v87
    v_cvt_pk_bf16_f32 v26, v16, v17
    v_exp_f32 v12, v88
    v_mfma_f32_32x32x16_bf16 v[64:79], v[52:55], v[36:39], v[64:79]
    v_cvt_pk_bf16_f32 v27, v18, v19
    v_exp_f32 v13, v89
    v_exp_f32_e64 v14, v90
    v_cvt_pk_bf16_f32 v28, v12, v13
    v_exp_f32 v15, v91
    s_waitcnt vmcnt(13)
    v_exp_f32 v16, v92
    v_cvt_pk_bf16_f32 v29, v14, v15
    v_exp_f32 v17, v93
    buffer_load_dwordx4 v9, s[24:27], m0 offen offset:3072 sc1 lds
    s_add_u32 s39, s39, 4096
    s_barrier
    v_exp_f32 v18, v94
    v_cvt_pk_bf16_f32 v30, v16, v17
    v_exp_f32 v19, v95
    v_mfma_f32_32x32x16_bf16 v[144:159], v[56:59], v[24:27], v[144:159]
    ds_read_b128 v[56:59], v2 offset:26624
    v_cvt_pk_bf16_f32 v31, v18, v19
    v_exp_f32 v12, v64
    v_exp_f32 v13, v65
    v_exp_f32 v14, v66
    v_mfma_f32_32x32x16_bf16 v[144:159], v[60:63], v[28:31], v[144:159]
    ds_read_b128 v[60:63], v2 offset:27136
    v_exp_f32 v15, v67
    v_exp_f32 v16, v68
    v_exp_f32_e64 v17, v69
    v_smfmac_f32_16x16x64_bf16 v[164:167], v[20:23], v[24:31], v3
    s_add_u32 s58, s38, 16384
    buffer_load_dwordx4 a[128:131], v9, s[20:23], s58 offen offset:0 sc1
    v_cvt_pk_bf16_f32 v24, v12, v13
    v_cvt_pk_bf16_f32 v25, v14, v15
    v_mfma_f32_32x32x16_bf16 v[80:95], v[48:51], v[40:43], v[112:127]
    ds_read_b128 v[48:51], v2 offset:28672
    v_exp_f32 v18, v70
    v_exp_f32 v19, v71
    v_cvt_pk_bf16_f32 v26, v16, v17
    v_exp_f32_e64 v12, v72
    v_mfma_f32_32x32x16_bf16 v[80:95], v[52:55], v[44:47], v[80:95]
    ds_read_b128 v[52:55], v2 offset:29184
    v_cvt_pk_bf16_f32 v27, v18, v19
    v_exp_f32 v13, v73
    buffer_load_dwordx4 a[132:135], v9, s[20:23], s58 offen offset:1024 sc1
    v_exp_f32 v14, v74
    v_cvt_pk_bf16_f32 v28, v12, v13
    v_exp_f32 v15, v75
    v_exp_f32 v16, v76
    v_cvt_pk_bf16_f32 v29, v14, v15
    v_exp_f32 v17, v77
    v_exp_f32 v18, v78
    v_cvt_pk_bf16_f32 v30, v16, v17
    s_add_u32 m0, s36, 16384
    s_waitcnt lgkmcnt(2)
    v_exp_f32 v19, v79
    v_mfma_f32_32x32x16_bf16 v[128:143], v[56:59], v[24:27], v[128:143]
    buffer_load_dwordx4 v4, s[8:11], s37 offen sc1 lds
    v_cvt_pk_bf16_f32 v31, v18, v19
    v_exp_f32 v12, v80
    v_exp_f32 v13, v81
    v_exp_f32_e64 v14, v82
    v_mfma_f32_32x32x16_bf16 v[128:143], v[60:63], v[28:31], v[128:143]
    s_add_u32 s37, s37, 4096
    v_exp_f32_e64 v15, v83
    v_exp_f32_e64 v16, v84
    v_exp_f32 v17, v85
    v_smfmac_f32_16x16x64_bf16 v[160:163], v[20:23], v[24:31], v3
    s_waitcnt lgkmcnt(0)
    v_cvt_pk_bf16_f32 v24, v12, v13
    v_cvt_pk_bf16_f32 v25, v14, v15
    v_mfma_f32_32x32x16_bf16 v[64:79], v[48:51], v[32:35], v[96:111]
    s_add_u32 s58, s38, 32768
    buffer_load_dwordx4 a[152:155], v9, s[20:23], s58 offen offset:0 sc1
    v_exp_f32 v18, v86
    v_exp_f32 v19, v87
    v_cvt_pk_bf16_f32 v26, v16, v17
    v_exp_f32_e64 v12, v88
    v_mfma_f32_32x32x16_bf16 v[64:79], v[52:55], v[36:39], v[64:79]
    buffer_load_dwordx4 a[156:159], v9, s[20:23], s58 offen offset:1024 sc1
    v_cvt_pk_bf16_f32 v27, v18, v19
    v_exp_f32 v13, v89
    v_exp_f32 v14, v90
    v_cvt_pk_bf16_f32 v28, v12, v13
    v_exp_f32 v15, v91
    s_waitcnt vmcnt(6)
    v_exp_f32 v16, v92
    v_cvt_pk_bf16_f32 v29, v14, v15
    v_exp_f32 v17, v93
    s_barrier
    v_exp_f32 v18, v94
    v_cvt_pk_bf16_f32 v30, v16, v17
    v_mov_b32 v192, 1
    v_lshlrev_b32 v193, 7, v0
    s_mov_b32 exec_hi, 0
    buffer_store_dword v192, v193, s[32:35], s47 offen sc1
    s_mov_b32 exec_hi, -1
    v_exp_f32_e64 v19, v95
    v_mfma_f32_32x32x16_bf16 v[144:159], v[56:59], v[24:27], v[144:159]
    ds_read_b128 v[56:59], v2 offset:30720
    v_cvt_pk_bf16_f32 v31, v18, v19
    v_exp_f32 v12, v64
    v_exp_f32 v13, v65
    v_exp_f32 v14, v66
    v_mfma_f32_32x32x16_bf16 v[144:159], v[60:63], v[28:31], v[144:159]
    ds_read_b128 v[60:63], v2 offset:31232
    v_exp_f32 v15, v67
    v_exp_f32 v16, v68
    v_exp_f32 v17, v69
    v_smfmac_f32_16x16x64_bf16 v[164:167], v[20:23], v[24:31], v3
    v_cvt_pk_bf16_f32 v24, v12, v13
    v_cvt_pk_bf16_f32 v25, v14, v15
    v_mfma_f32_32x32x16_bf16 v[80:95], v[48:51], v[40:43], v[112:127]
    ds_read_b128 v[48:51], v2 offset:0
    v_exp_f32 v18, v70
    v_exp_f32 v19, v71
    v_cvt_pk_bf16_f32 v26, v16, v17
    v_exp_f32_e64 v12, v72
    v_mfma_f32_32x32x16_bf16 v[80:95], v[52:55], v[44:47], v[80:95]
    ds_read_b128 v[52:55], v2 offset:512
    v_cvt_pk_bf16_f32 v27, v18, v19
    v_exp_f32 v13, v73
    v_exp_f32 v14, v74
    v_cvt_pk_bf16_f32 v28, v12, v13
    v_exp_f32 v15, v75
    v_exp_f32 v16, v76
    v_cvt_pk_bf16_f32 v29, v14, v15
    v_exp_f32 v17, v77
    v_exp_f32 v18, v78
    v_cvt_pk_bf16_f32 v30, v16, v17
    s_add_u32 m0, s36, 20480
    s_waitcnt lgkmcnt(2)
    v_exp_f32 v19, v79
    v_mfma_f32_32x32x16_bf16 v[128:143], v[56:59], v[24:27], v[128:143]
    buffer_load_dwordx4 v4, s[8:11], s37 offen sc1 lds
    v_cvt_pk_bf16_f32 v31, v18, v19
    v_exp_f32 v12, v80
    v_exp_f32 v13, v81
    v_exp_f32_e64 v14, v82
    v_mfma_f32_32x32x16_bf16 v[128:143], v[60:63], v[28:31], v[128:143]
    s_add_u32 s37, s37, 4096
    s_mov_b32 m0, s39
    v_exp_f32 v15, v83
    v_exp_f32_e64 v16, v84
    v_exp_f32 v17, v85
    v_smfmac_f32_16x16x64_bf16 v[160:163], v[20:23], v[24:31], v3
    s_waitcnt lgkmcnt(0)
    v_cvt_pk_bf16_f32 v24, v12, v13
    v_cvt_pk_bf16_f32 v25, v14, v15
    v_mfma_f32_32x32x16_bf16 v[64:79], v[48:51], v[32:35], v[96:111]
    v_exp_f32 v18, v86
    v_exp_f32 v19, v87
    v_cvt_pk_bf16_f32 v26, v16, v17
    v_exp_f32_e64 v12, v88
    v_mfma_f32_32x32x16_bf16 v[64:79], v[52:55], v[36:39], v[64:79]
    v_cvt_pk_bf16_f32 v27, v18, v19
    v_exp_f32 v13, v89
    v_exp_f32 v14, v90
    v_cvt_pk_bf16_f32 v28, v12, v13
    v_exp_f32 v15, v91
    s_waitcnt vmcnt(8)
    v_exp_f32 v16, v92
    v_cvt_pk_bf16_f32 v29, v14, v15
    v_exp_f32 v17, v93
    buffer_load_dwordx4 v9, s[24:27], m0 offen offset:0 sc1 lds
    s_barrier
    v_exp_f32 v18, v94
    v_cvt_pk_bf16_f32 v30, v16, v17
    v_exp_f32_e64 v19, v95
    v_mfma_f32_32x32x16_bf16 v[144:159], v[56:59], v[24:27], v[144:159]
    ds_read_b128 v[56:59], v2 offset:2048
    v_cvt_pk_bf16_f32 v31, v18, v19
    v_exp_f32 v12, v64
    v_exp_f32 v13, v65
    v_exp_f32_e64 v14, v66
    v_mfma_f32_32x32x16_bf16 v[144:159], v[60:63], v[28:31], v[144:159]
    ds_read_b128 v[60:63], v2 offset:2560
    v_exp_f32 v15, v67
    v_exp_f32 v16, v68
    v_exp_f32_e64 v17, v69
    v_smfmac_f32_16x16x64_bf16 v[164:167], v[20:23], v[24:31], v3
    s_add_u32 s58, s38, 49152
    buffer_load_dwordx4 a[176:179], v9, s[20:23], s58 offen offset:0 sc1
    v_cvt_pk_bf16_f32 v24, v12, v13
    v_cvt_pk_bf16_f32 v25, v14, v15
    v_mfma_f32_32x32x16_bf16 v[80:95], v[48:51], v[40:43], v[112:127]
    ds_read_b128 v[48:51], v2 offset:4096
    v_exp_f32 v18, v70
    v_exp_f32 v19, v71
    v_cvt_pk_bf16_f32 v26, v16, v17
    v_exp_f32_e64 v12, v72
    v_mfma_f32_32x32x16_bf16 v[80:95], v[52:55], v[44:47], v[80:95]
    ds_read_b128 v[52:55], v2 offset:4608
    v_cvt_pk_bf16_f32 v27, v18, v19
    v_exp_f32 v13, v73
    buffer_load_dwordx4 a[180:183], v9, s[20:23], s58 offen offset:1024 sc1
    v_exp_f32 v14, v74
    v_cvt_pk_bf16_f32 v28, v12, v13
    v_exp_f32 v15, v75
    v_exp_f32 v16, v76
    v_cvt_pk_bf16_f32 v29, v14, v15
    v_exp_f32 v17, v77
    v_exp_f32 v18, v78
    v_cvt_pk_bf16_f32 v30, v16, v17
    s_add_u32 m0, s36, 24576
    s_waitcnt lgkmcnt(2)
    v_exp_f32 v19, v79
    v_mfma_f32_32x32x16_bf16 v[128:143], v[56:59], v[24:27], v[128:143]
    buffer_load_dwordx4 v4, s[8:11], s37 offen sc1 lds
    v_cvt_pk_bf16_f32 v31, v18, v19
    v_exp_f32_e64 v12, v80
    v_exp_f32_e64 v13, v81
    v_exp_f32_e64 v14, v82
    v_mfma_f32_32x32x16_bf16 v[128:143], v[60:63], v[28:31], v[128:143]
    s_add_u32 s37, s37, 4096
    s_mov_b32 m0, s39
    v_exp_f32 v15, v83
    v_exp_f32_e64 v16, v84
    v_exp_f32 v17, v85
    v_smfmac_f32_16x16x64_bf16 v[160:163], v[20:23], v[24:31], v3
    s_waitcnt lgkmcnt(0)
    v_cvt_pk_bf16_f32 v24, v12, v13
    v_cvt_pk_bf16_f32 v25, v14, v15
    v_mfma_f32_32x32x16_bf16 v[64:79], v[48:51], v[32:35], v[96:111]
    s_add_u32 s58, s38, 65536
    buffer_load_dwordx4 a[200:203], v9, s[20:23], s58 offen offset:0 sc1
    v_exp_f32 v18, v86
    v_exp_f32 v19, v87
    v_cvt_pk_bf16_f32 v26, v16, v17
    v_exp_f32_e64 v12, v88
    v_mfma_f32_32x32x16_bf16 v[64:79], v[52:55], v[36:39], v[64:79]
    buffer_load_dwordx4 a[204:207], v9, s[20:23], s58 offen offset:1024 sc1
    v_cvt_pk_bf16_f32 v27, v18, v19
    v_exp_f32 v13, v89
    v_exp_f32 v14, v90
    v_cvt_pk_bf16_f32 v28, v12, v13
    v_exp_f32 v15, v91
    v_exp_f32 v16, v92
    v_cvt_pk_bf16_f32 v29, v14, v15
    v_exp_f32 v17, v93
    buffer_load_dwordx4 v9, s[24:27], m0 offen offset:1024 sc1 lds
    v_exp_f32 v18, v94
    v_cvt_pk_bf16_f32 v30, v16, v17
    v_exp_f32 v19, v95
    v_mfma_f32_32x32x16_bf16 v[144:159], v[56:59], v[24:27], v[144:159]
    ds_read_b128 v[56:59], v2 offset:6144
    v_cvt_pk_bf16_f32 v31, v18, v19
    v_exp_f32 v12, v64
    v_exp_f32 v13, v65
    v_exp_f32 v14, v66
    v_mfma_f32_32x32x16_bf16 v[144:159], v[60:63], v[28:31], v[144:159]
    ds_read_b128 v[60:63], v2 offset:6656
    v_exp_f32 v15, v67
    v_exp_f32 v16, v68
    v_exp_f32_e64 v17, v69
    v_smfmac_f32_16x16x64_bf16 v[164:167], v[20:23], v[24:31], v3
    s_add_u32 s58, s38, 81920
    buffer_load_dwordx4 a[224:227], v9, s[20:23], s58 offen offset:0 sc1
    v_cvt_pk_bf16_f32 v24, v12, v13
    v_cvt_pk_bf16_f32 v25, v14, v15
    v_mfma_f32_32x32x16_bf16 v[80:95], v[48:51], v[40:43], v[112:127]
    ds_read_b128 v[48:51], v2 offset:8192
    v_exp_f32 v18, v70
    v_exp_f32 v19, v71
    v_cvt_pk_bf16_f32 v26, v16, v17
    v_exp_f32_e64 v12, v72
    v_mfma_f32_32x32x16_bf16 v[80:95], v[52:55], v[44:47], v[80:95]
    ds_read_b128 v[52:55], v2 offset:8704
    v_cvt_pk_bf16_f32 v27, v18, v19
    v_exp_f32 v13, v73
    buffer_load_dwordx4 a[228:231], v9, s[20:23], s58 offen offset:1024 sc1
    v_exp_f32 v14, v74
    v_cvt_pk_bf16_f32 v28, v12, v13
    v_exp_f32 v15, v75
    v_exp_f32 v16, v76
    v_cvt_pk_bf16_f32 v29, v14, v15
    v_exp_f32 v17, v77
    v_exp_f32 v18, v78
    v_cvt_pk_bf16_f32 v30, v16, v17
    s_add_u32 m0, s36, 28672
    s_waitcnt lgkmcnt(2)
    v_exp_f32 v19, v79
    v_mfma_f32_32x32x16_bf16 v[128:143], v[56:59], v[24:27], v[128:143]
    buffer_load_dwordx4 v4, s[8:11], s37 offen sc1 lds
    v_cvt_pk_bf16_f32 v31, v18, v19
    v_exp_f32 v12, v80
    v_exp_f32 v13, v81
    v_exp_f32_e64 v14, v82
    v_mfma_f32_32x32x16_bf16 v[128:143], v[60:63], v[28:31], v[128:143]
    s_add_u32 s37, s37, 4096
    s_mov_b32 m0, s39
    s_mov_b32 m0, s39
    v_exp_f32 v15, v83
    v_exp_f32 v16, v84
    v_exp_f32 v17, v85
    v_smfmac_f32_16x16x64_bf16 v[160:163], v[20:23], v[24:31], v3
    s_waitcnt lgkmcnt(0)
    v_cvt_pk_bf16_f32 v24, v12, v13
    v_cvt_pk_bf16_f32 v25, v14, v15
    v_mfma_f32_32x32x16_bf16 v[64:79], v[48:51], v[32:35], v[96:111]
    s_add_u32 s58, s38, 98304
    buffer_load_dwordx4 v[184:187], v9, s[20:23], s58 offen offset:0 sc1
    v_exp_f32 v18, v86
    v_exp_f32 v19, v87
    v_cvt_pk_bf16_f32 v26, v16, v17
    v_exp_f32_e64 v12, v88
    v_mfma_f32_32x32x16_bf16 v[64:79], v[52:55], v[36:39], v[64:79]
    buffer_load_dwordx4 v[188:191], v9, s[20:23], s58 offen offset:1024 sc1
    v_cvt_pk_bf16_f32 v27, v18, v19
    v_exp_f32 v13, v89
    v_exp_f32 v14, v90
    v_cvt_pk_bf16_f32 v28, v12, v13
    v_exp_f32 v15, v91
    s_waitcnt vmcnt(16)
    v_exp_f32 v16, v92
    v_cvt_pk_bf16_f32 v29, v14, v15
    v_exp_f32 v17, v93
    buffer_load_dwordx4 v9, s[24:27], m0 offen offset:2048 sc1 lds
    buffer_load_dwordx4 v9, s[24:27], m0 offen offset:3072 sc1 lds
    s_add_u32 s39, s39, 4096
    s_barrier
    v_exp_f32 v18, v94
    v_cvt_pk_bf16_f32 v30, v16, v17
    v_exp_f32_e64 v19, v95
    v_mfma_f32_32x32x16_bf16 v[144:159], v[56:59], v[24:27], v[144:159]
    ds_read_b128 v[56:59], v2 offset:10240
    v_cvt_pk_bf16_f32 v31, v18, v19
    v_exp_f32 v12, v64
    v_exp_f32 v13, v65
    v_exp_f32_e64 v14, v66
    v_mfma_f32_32x32x16_bf16 v[144:159], v[60:63], v[28:31], v[144:159]
    ds_read_b128 v[60:63], v2 offset:10752
    s_add_u32 m0, s59, 0
    s_add_u32 s74, s42, 0
    buffer_load_dwordx4 v8, s[28:31], s74 offen lds
    v_exp_f32 v15, v67
    v_exp_f32 v16, v68
    v_exp_f32_e64 v17, v69
    v_smfmac_f32_16x16x64_bf16 v[164:167], v[20:23], v[24:31], v3
    s_add_u32 s58, s38, 114688
    buffer_load_dwordx4 v[208:211], v9, s[20:23], s58 offen offset:0 sc1
    v_cvt_pk_bf16_f32 v24, v12, v13
    v_cvt_pk_bf16_f32 v25, v14, v15
    v_mfma_f32_32x32x16_bf16 v[80:95], v[48:51], v[40:43], v[112:127]
    ds_read_b128 v[48:51], v2 offset:12288
    v_exp_f32 v18, v70
    v_exp_f32 v19, v71
    v_cvt_pk_bf16_f32 v26, v16, v17
    v_exp_f32 v12, v72
    v_mfma_f32_32x32x16_bf16 v[80:95], v[52:55], v[44:47], v[80:95]
    ds_read_b128 v[52:55], v2 offset:12800
    v_cvt_pk_bf16_f32 v27, v18, v19
    v_exp_f32 v13, v73
    v_exp_f32 v14, v74
    v_cvt_pk_bf16_f32 v28, v12, v13
    v_exp_f32 v15, v75
    v_exp_f32 v16, v76
    v_cvt_pk_bf16_f32 v29, v14, v15
    v_exp_f32 v17, v77
    s_add_u32 m0, s59, 1024
    s_add_u32 s74, s42, 16384
    buffer_load_dwordx4 v8, s[28:31], s74 offen lds
    v_exp_f32_e64 v18, v78
    v_cvt_pk_bf16_f32 v30, v16, v17
    s_add_u32 m0, s36, 0
    s_waitcnt lgkmcnt(2)
    v_exp_f32_e64 v19, v79
    v_mfma_f32_32x32x16_bf16 v[128:143], v[56:59], v[24:27], v[128:143]
    buffer_load_dwordx4 v4, s[8:11], s37 offen sc1 lds
    v_cvt_pk_bf16_f32 v31, v18, v19
    v_exp_f32 v12, v80
    v_exp_f32 v13, v81
    v_exp_f32_e64 v14, v82
    v_mfma_f32_32x32x16_bf16 v[128:143], v[60:63], v[28:31], v[128:143]
    s_add_u32 s37, s37, 4096
    v_exp_f32_e64 v15, v83
    v_exp_f32_e64 v16, v84
    v_exp_f32 v17, v85
    v_smfmac_f32_16x16x64_bf16 v[160:163], v[20:23], v[24:31], v3
    s_waitcnt lgkmcnt(0)
    v_cvt_pk_bf16_f32 v24, v12, v13
    v_cvt_pk_bf16_f32 v25, v14, v15
    v_mfma_f32_32x32x16_bf16 v[64:79], v[48:51], v[32:35], v[96:111]
    buffer_load_dwordx4 v[212:215], v9, s[20:23], s58 offen offset:1024 sc1
    v_exp_f32 v18, v86
    v_exp_f32 v19, v87
    v_cvt_pk_bf16_f32 v26, v16, v17
    v_exp_f32 v12, v88
    v_mfma_f32_32x32x16_bf16 v[64:79], v[52:55], v[36:39], v[64:79]
    v_cvt_pk_bf16_f32 v27, v18, v19
    v_exp_f32 v13, v89
    v_exp_f32_e64 v14, v90
    v_cvt_pk_bf16_f32 v28, v12, v13
    v_exp_f32 v15, v91
    v_exp_f32 v16, v92
    v_cvt_pk_bf16_f32 v29, v14, v15
    v_exp_f32 v17, v93
    v_exp_f32 v18, v94
    v_cvt_pk_bf16_f32 v30, v16, v17
    buffer_load_dword v1, v11, s[32:35], s49 offen sc1
    v_exp_f32_e64 v19, v95
    v_mfma_f32_32x32x16_bf16 v[144:159], v[56:59], v[24:27], v[144:159]
    ds_read_b128 v[56:59], v2 offset:14336
    v_cvt_pk_bf16_f32 v31, v18, v19
    v_exp_f32 v12, v64
    v_exp_f32 v13, v65
    v_exp_f32_e64 v14, v66
    v_mfma_f32_32x32x16_bf16 v[144:159], v[60:63], v[28:31], v[144:159]
    ds_read_b128 v[60:63], v2 offset:14848
    s_add_u32 m0, s59, 2048
    s_add_u32 s74, s42, 32768
    buffer_load_dwordx4 v8, s[28:31], s74 offen lds
    v_exp_f32 v15, v67
    v_exp_f32 v16, v68
    v_exp_f32 v17, v69
    v_smfmac_f32_16x16x64_bf16 v[164:167], v[20:23], v[24:31], v3
    s_add_u32 s58, s38, 0
    buffer_load_dwordx4 v[232:235], v9, s[20:23], s58 offen offset:0 sc1
    v_cvt_pk_bf16_f32 v24, v12, v13
    v_cvt_pk_bf16_f32 v25, v14, v15
    v_mfma_f32_32x32x16_bf16 v[80:95], v[48:51], v[40:43], v[112:127]
    ds_read_b128 v[48:51], v2 offset:16384
    v_exp_f32 v18, v70
    v_exp_f32 v19, v71
    v_cvt_pk_bf16_f32 v26, v16, v17
    v_exp_f32_e64 v12, v72
    v_mfma_f32_32x32x16_bf16 v[80:95], v[52:55], v[44:47], v[80:95]
    ds_read_b128 v[52:55], v2 offset:16896
    v_cvt_pk_bf16_f32 v27, v18, v19
    v_exp_f32 v13, v73
    v_exp_f32 v14, v74
    v_cvt_pk_bf16_f32 v28, v12, v13
    v_exp_f32 v15, v75
    v_exp_f32 v16, v76
    v_cvt_pk_bf16_f32 v29, v14, v15
    v_exp_f32_e64 v17, v77
    s_add_u32 m0, s59, 3072
    s_add_u32 s74, s42, 49152
    buffer_load_dwordx4 v8, s[28:31], s74 offen lds
    v_exp_f32_e64 v18, v78
    v_cvt_pk_bf16_f32 v30, v16, v17
    s_add_u32 m0, s36, 4096
    s_waitcnt lgkmcnt(2)
    v_exp_f32 v19, v79
    v_mfma_f32_32x32x16_bf16 v[128:143], v[56:59], v[24:27], v[128:143]
    buffer_load_dwordx4 v4, s[8:11], s37 offen sc1 lds
    v_cvt_pk_bf16_f32 v31, v18, v19
    v_exp_f32 v12, v80
    v_exp_f32 v13, v81
    v_exp_f32_e64 v14, v82
    v_mfma_f32_32x32x16_bf16 v[128:143], v[60:63], v[28:31], v[128:143]
    s_add_u32 s37, s37, 4096
    v_exp_f32_e64 v15, v83
    v_exp_f32_e64 v16, v84
    v_exp_f32 v17, v85
    v_smfmac_f32_16x16x64_bf16 v[160:163], v[20:23], v[24:31], v3
    s_waitcnt lgkmcnt(0)
    v_cvt_pk_bf16_f32 v24, v12, v13
    v_cvt_pk_bf16_f32 v25, v14, v15
    v_mfma_f32_32x32x16_bf16 v[64:79], v[48:51], v[32:35], v[96:111]
    buffer_load_dwordx4 v[236:239], v9, s[20:23], s58 offen offset:1024 sc1
    v_exp_f32 v18, v86
    v_exp_f32 v19, v87
    v_cvt_pk_bf16_f32 v26, v16, v17
    v_exp_f32 v12, v88
    v_mfma_f32_32x32x16_bf16 v[64:79], v[52:55], v[36:39], v[64:79]
    v_cvt_pk_bf16_f32 v27, v18, v19
    v_exp_f32 v13, v89
    s_waitcnt vmcnt(5)
    v_cmp_ne_u32 vcc, s61, v1
    v_exp_f32 v14, v90
    v_cvt_pk_bf16_f32 v28, v12, v13
    v_exp_f32 v15, v91
    s_waitcnt vmcnt(5)
    v_exp_f32 v16, v92
    v_cvt_pk_bf16_f32 v29, v14, v15
    v_exp_f32 v17, v93
    s_cbranch_vccnz L_p2_spinh
L_p2_goh:
    s_barrier
    v_exp_f32 v18, v94
    v_cvt_pk_bf16_f32 v30, v16, v17
    v_exp_f32_e64 v19, v95
    v_mfma_f32_32x32x16_bf16 v[144:159], v[56:59], v[24:27], v[144:159]
    ds_read_b128 v[56:59], v2 offset:18432
    v_cvt_pk_bf16_f32 v31, v18, v19
    v_exp_f32 v12, v64
    v_exp_f32 v13, v65
    v_exp_f32 v14, v66
    v_mfma_f32_32x32x16_bf16 v[144:159], v[60:63], v[28:31], v[144:159]
    ds_read_b128 v[60:63], v2 offset:18944
    v_exp_f32 v15, v67
    v_exp_f32 v16, v68
    v_exp_f32 v17, v69
    v_smfmac_f32_16x16x64_bf16 v[164:167], v[20:23], v[24:31], v3
    buffer_load_dwordx4 v[240:243], v4, s[16:19], s38 offen sc1
    buffer_load_dwordx4 v[244:247], v5, s[16:19], s38 offen sc1
    v_cvt_pk_bf16_f32 v24, v12, v13
    v_cvt_pk_bf16_f32 v25, v14, v15
    v_mfma_f32_32x32x16_bf16 v[80:95], v[48:51], v[40:43], v[112:127]
    ds_read_b128 v[48:51], v2 offset:20480
    v_exp_f32 v18, v70
    v_exp_f32 v19, v71
    v_cvt_pk_bf16_f32 v26, v16, v17
    v_exp_f32_e64 v12, v72
    v_mfma_f32_32x32x16_bf16 v[80:95], v[52:55], v[44:47], v[80:95]
    ds_read_b128 v[52:55], v2 offset:20992
    v_cvt_pk_bf16_f32 v27, v18, v19
    v_exp_f32 v13, v73
    buffer_load_dwordx4 v[248:251], v6, s[16:19], s38 offen sc1
    v_exp_f32 v14, v74
    v_cvt_pk_bf16_f32 v28, v12, v13
    v_exp_f32 v15, v75
    buffer_load_dwordx4 v[252:255], v7, s[16:19], s38 offen sc1
    s_add_u32 s38, s38, 16384
    v_exp_f32 v16, v76
    v_cvt_pk_bf16_f32 v29, v14, v15
    v_exp_f32 v17, v77
    v_exp_f32 v18, v78
    v_cvt_pk_bf16_f32 v30, v16, v17
    s_add_u32 m0, s36, 8192
    s_waitcnt lgkmcnt(2)
    v_exp_f32 v19, v79
    v_mfma_f32_32x32x16_bf16 v[128:143], v[56:59], v[24:27], v[128:143]
    buffer_load_dwordx4 v4, s[8:11], s37 offen sc1 lds
    v_cvt_pk_bf16_f32 v31, v18, v19
    v_exp_f32 v12, v80
    v_exp_f32 v13, v81
    v_exp_f32 v14, v82
    v_mfma_f32_32x32x16_bf16 v[128:143], v[60:63], v[28:31], v[128:143]
    s_add_u32 s37, s37, 4096
    v_exp_f32 v15, v83
    v_exp_f32_e64 v16, v84
    v_exp_f32 v17, v85
    v_smfmac_f32_16x16x64_bf16 v[160:163], v[20:23], v[24:31], v3
    s_waitcnt lgkmcnt(0)
    v_cvt_pk_bf16_f32 v24, v12, v13
    v_cvt_pk_bf16_f32 v25, v14, v15
    v_mfma_f32_32x32x16_bf16 v[64:79], v[48:51], v[32:35], v[96:111]
    buffer_load_dwordx4 a[136:139], v4, s[16:19], s38 offen sc1
    buffer_load_dwordx4 a[140:143], v5, s[16:19], s38 offen sc1
    v_exp_f32 v18, v86
    v_exp_f32 v19, v87
    v_cvt_pk_bf16_f32 v26, v16, v17
    v_exp_f32_e64 v12, v88
    v_mfma_f32_32x32x16_bf16 v[64:79], v[52:55], v[36:39], v[64:79]
    buffer_load_dwordx4 a[144:147], v6, s[16:19], s38 offen sc1
    v_cvt_pk_bf16_f32 v27, v18, v19
    v_exp_f32 v13, v89
    buffer_load_dwordx4 a[148:151], v7, s[16:19], s38 offen sc1
    s_add_u32 s38, s38, 16384
    v_exp_f32 v14, v90
    v_cvt_pk_bf16_f32 v28, v12, v13
    v_exp_f32 v15, v91
    v_exp_f32 v16, v92
    v_cvt_pk_bf16_f32 v29, v14, v15
    v_exp_f32 v17, v93
    v_exp_f32 v18, v94
    v_cvt_pk_bf16_f32 v30, v16, v17
    v_exp_f32_e64 v19, v95
    v_mfma_f32_32x32x16_bf16 v[144:159], v[56:59], v[24:27], v[144:159]
    ds_read_b128 v[56:59], v2 offset:22528
    v_cvt_pk_bf16_f32 v31, v18, v19
    v_exp_f32 v12, v64
    v_exp_f32 v13, v65
    v_exp_f32_e64 v14, v66
    v_mfma_f32_32x32x16_bf16 v[144:159], v[60:63], v[28:31], v[144:159]
    ds_read_b128 v[60:63], v2 offset:23040
    v_exp_f32 v15, v67
    v_exp_f32 v16, v68
    v_exp_f32_e64 v17, v69
    v_smfmac_f32_16x16x64_bf16 v[164:167], v[20:23], v[24:31], v3
    buffer_load_dwordx4 a[160:163], v4, s[16:19], s38 offen sc1
    buffer_load_dwordx4 a[164:167], v5, s[16:19], s38 offen sc1
    v_cvt_pk_bf16_f32 v24, v12, v13
    v_cvt_pk_bf16_f32 v25, v14, v15
    v_mfma_f32_32x32x16_bf16 v[80:95], v[48:51], v[40:43], v[112:127]
    ds_read_b128 v[48:51], v2 offset:24576
    v_exp_f32 v18, v70
    v_exp_f32 v19, v71
    v_cvt_pk_bf16_f32 v26, v16, v17
    v_exp_f32 v12, v72
    v_mfma_f32_32x32x16_bf16 v[80:95], v[52:55], v[44:47], v[80:95]
    ds_read_b128 v[52:55], v2 offset:25088
    v_cvt_pk_bf16_f32 v27, v18, v19
    v_exp_f32 v13, v73
    buffer_load_dwordx4 a[168:171], v6, s[16:19], s38 offen sc1
    v_exp_f32 v14, v74
    v_cvt_pk_bf16_f32 v28, v12, v13
    v_exp_f32 v15, v75
    buffer_load_dwordx4 a[172:175], v7, s[16:19], s38 offen sc1
    s_add_u32 s38, s38, 16384
    v_exp_f32 v16, v76
    v_cvt_pk_bf16_f32 v29, v14, v15
    v_exp_f32 v17, v77
    v_exp_f32_e64 v18, v78
    v_cvt_pk_bf16_f32 v30, v16, v17
    s_add_u32 m0, s36, 12288
    s_waitcnt lgkmcnt(2)
    v_exp_f32 v19, v79
    v_mfma_f32_32x32x16_bf16 v[128:143], v[56:59], v[24:27], v[128:143]
    buffer_load_dwordx4 v4, s[8:11], s37 offen sc1 lds
    v_cvt_pk_bf16_f32 v31, v18, v19
    v_exp_f32 v12, v80
    v_exp_f32 v13, v81
    v_exp_f32_e64 v14, v82
    v_mfma_f32_32x32x16_bf16 v[128:143], v[60:63], v[28:31], v[128:143]
    s_add_u32 s37, s37, 4096
    v_exp_f32 v15, v83
    v_exp_f32 v16, v84
    v_exp_f32_e64 v17, v85
    v_smfmac_f32_16x16x64_bf16 v[160:163], v[20:23], v[24:31], v3
    s_waitcnt lgkmcnt(0)
    s_waitcnt vmcnt(16)
    v_cvt_pk_bf16_f32 v24, v12, v13
    v_cvt_pk_bf16_f32 v25, v14, v15
    v_mfma_f32_32x32x16_bf16 v[64:79], v[48:51], v[32:35], v[96:111]
    ds_read_b128 v[168:171], v168
    buffer_load_dwordx4 a[184:187], v4, s[16:19], s38 offen sc1
    buffer_load_dwordx4 a[188:191], v5, s[16:19], s38 offen sc1
    v_exp_f32 v18, v86
    v_exp_f32 v19, v87
    v_cvt_pk_bf16_f32 v26, v16, v17
    v_exp_f32_e64 v12, v88
    v_mfma_f32_32x32x16_bf16 v[64:79], v[52:55], v[36:39], v[64:79]
    ds_read_b128 v[172:175], v172
    buffer_load_dwordx4 a[192:195], v6, s[16:19], s38 offen sc1
    v_cvt_pk_bf16_f32 v27, v18, v19
    v_exp_f32_e64 v13, v89
    ds_read_b128 v[176:179], v176
    buffer_load_dwordx4 a[196:199], v7, s[16:19], s38 offen sc1
    s_add_u32 s38, s38, 16384
    v_exp_f32_e64 v14, v90
    v_cvt_pk_bf16_f32 v28, v12, v13
    v_exp_f32 v15, v91
    ds_read_b128 v[180:183], v180
    s_waitcnt vmcnt(20)
    v_exp_f32_e64 v16, v92
    v_cvt_pk_bf16_f32 v29, v14, v15
    v_exp_f32 v17, v93
    s_barrier
    v_exp_f32 v18, v94
    v_cvt_pk_bf16_f32 v30, v16, v17
    v_exp_f32 v19, v95
    v_mfma_f32_32x32x16_bf16 v[144:159], v[56:59], v[24:27], v[144:159]
    ds_read_b128 v[56:59], v2 offset:26624
    v_cvt_pk_bf16_f32 v31, v18, v19
    v_exp_f32 v12, v64
    v_exp_f32 v13, v65
    v_exp_f32 v14, v66
    v_mfma_f32_32x32x16_bf16 v[144:159], v[60:63], v[28:31], v[144:159]
    ds_read_b128 v[60:63], v2 offset:27136
    v_exp_f32 v15, v67
    v_exp_f32 v16, v68
    v_exp_f32 v17, v69
    v_smfmac_f32_16x16x64_bf16 v[164:167], v[20:23], v[24:31], v3
    buffer_load_dwordx4 a[208:211], v4, s[16:19], s38 offen sc1
    buffer_load_dwordx4 a[212:215], v5, s[16:19], s38 offen sc1
    v_cvt_pk_bf16_f32 v24, v12, v13
    v_cvt_pk_bf16_f32 v25, v14, v15
    v_mfma_f32_32x32x16_bf16 v[80:95], v[48:51], v[40:43], v[112:127]
    ds_read_b128 v[48:51], v2 offset:28672
    v_exp_f32 v18, v70
    v_exp_f32 v19, v71
    v_cvt_pk_bf16_f32 v26, v16, v17
    v_exp_f32_e64 v12, v72
    v_mfma_f32_32x32x16_bf16 v[80:95], v[52:55], v[44:47], v[80:95]
    ds_read_b128 v[52:55], v2 offset:29184
    v_cvt_pk_bf16_f32 v27, v18, v19
    v_exp_f32 v13, v73
    buffer_load_dwordx4 a[216:219], v6, s[16:19], s38 offen sc1
    v_exp_f32 v14, v74
    v_cvt_pk_bf16_f32 v28, v12, v13
    v_exp_f32 v15, v75
    buffer_load_dwordx4 a[220:223], v7, s[16:19], s38 offen sc1
    s_add_u32 s38, s38, 16384
    v_exp_f32 v16, v76
    v_cvt_pk_bf16_f32 v29, v14, v15
    v_exp_f32 v17, v77
    s_sub_u32 s72, s8, 163840
    s_subb_u32 s73, s9, 0
    s_mov_b32 s74, 425984
    s_mov_b32 s75, 0x20000
    v_exp_f32 v18, v78
    v_cvt_pk_bf16_f32 v30, v16, v17
    s_add_u32 m0, s36, 16384
    s_waitcnt lgkmcnt(2)
    v_exp_f32_e64 v19, v79
    v_mfma_f32_32x32x16_bf16 v[128:143], v[56:59], v[24:27], v[128:143]
    buffer_load_dwordx4 v4, s[8:11], s37 offen sc1 lds
    v_cvt_pk_bf16_f32 v31, v18, v19
    v_exp_f32 v12, v80
    v_exp_f32 v13, v81
    v_exp_f32 v14, v82
    v_mfma_f32_32x32x16_bf16 v[128:143], v[60:63], v[28:31], v[128:143]
    s_add_u32 s37, s37, 4096
    v_exp_f32 v15, v83
    v_exp_f32_e64 v16, v84
    v_exp_f32 v17, v85
    v_smfmac_f32_16x16x64_bf16 v[160:163], v[20:23], v[24:31], v3
    s_waitcnt lgkmcnt(0)
    v_cvt_pk_bf16_f32 v24, v12, v13
    v_cvt_pk_bf16_f32 v25, v14, v15
    v_mfma_f32_32x32x16_bf16 v[64:79], v[48:51], v[32:35], v[96:111]
    buffer_load_dwordx4 a[232:235], v4, s[16:19], s38 offen sc1
    buffer_load_dwordx4 a[236:239], v5, s[16:19], s38 offen sc1
    v_exp_f32 v18, v86
    v_exp_f32 v19, v87
    v_cvt_pk_bf16_f32 v26, v16, v17
    v_exp_f32_e64 v12, v88
    v_mfma_f32_32x32x16_bf16 v[64:79], v[52:55], v[36:39], v[64:79]
    buffer_load_dwordx4 a[240:243], v6, s[16:19], s38 offen sc1
    v_cvt_pk_bf16_f32 v27, v18, v19
    v_exp_f32 v13, v89
    s_sub_u32 s76, 229376, s36
    v_add_u32 v10, s76, v4
    buffer_load_dwordx4 a[244:247], v7, s[16:19], s38 offen sc1
    s_add_u32 s38, s38, 16384
    v_exp_f32 v14, v90
    v_cvt_pk_bf16_f32 v28, v12, v13
    v_exp_f32 v15, v91
    v_exp_f32_e64 v16, v92
    v_cvt_pk_bf16_f32 v29, v14, v15
    v_exp_f32 v17, v93
    v_exp_f32 v18, v94
    v_cvt_pk_bf16_f32 v30, v16, v17
    v_exp_f32_e64 v19, v95
    v_mfma_f32_32x32x16_bf16 v[144:159], v[56:59], v[24:27], v[144:159]
    ds_read_b128 v[56:59], v2 offset:30720
    v_cvt_pk_bf16_f32 v31, v18, v19
    v_exp_f32 v12, v64
    v_exp_f32 v13, v65
    v_mfma_f32_32x32x16_bf16 v[144:159], v[60:63], v[28:31], v[144:159]
    ds_read_b128 v[60:63], v2 offset:31232
    v_exp_f32 v14, v66
    v_exp_f32 v15, v67
    v_smfmac_f32_16x16x64_bf16 v[164:167], v[20:23], v[24:31], v3
    buffer_load_dwordx4 v[192:195], v4, s[16:19], s38 offen sc1
    buffer_load_dwordx4 v[196:199], v5, s[16:19], s38 offen sc1
    v_cvt_pk_bf16_f32 v24, v12, v13
    v_mfma_f32_32x32x16_bf16 v[80:95], v[48:51], v[40:43], v[112:127]
    ds_read_b128 v[48:51], v2 offset:0
    v_exp_f32 v16, v68
    v_exp_f32 v17, v69
    v_cvt_pk_bf16_f32 v25, v14, v15
    v_mfma_f32_32x32x16_bf16 v[80:95], v[52:55], v[44:47], v[80:95]
    ds_read_b128 v[52:55], v2 offset:512
    s_waitcnt vmcnt(25)
    v_exp_f32 v18, v70
    v_exp_f32_e64 v19, v71
    v_cvt_pk_bf16_f32 v26, v16, v17
    v_mfma_f32_32x32x16_bf16 a[0:15], v[232:235], v[240:243], 0
    buffer_load_dwordx4 v[200:203], v6, s[16:19], s38 offen sc1
    v_exp_f32 v12, v72
    v_exp_f32 v13, v73
    v_cvt_pk_bf16_f32 v27, v18, v19
    v_mfma_f32_32x32x16_bf16 a[16:31], v[236:239], v[240:243], 0
    buffer_load_dwordx4 v[204:207], v7, s[16:19], s38 offen sc1
    s_add_u32 s38, s38, 16384
    v_exp_f32 v14, v74
    v_exp_f32 v15, v75
    v_cvt_pk_bf16_f32 v28, v12, v13
    v_mfma_f32_32x32x16_bf16 a[32:47], v[232:235], v[244:247], 0
    v_exp_f32 v16, v76
    v_exp_f32 v17, v77
    v_cvt_pk_bf16_f32 v29, v14, v15
    v_mfma_f32_32x32x16_bf16 a[48:63], v[236:239], v[244:247], 0
    s_add_u32 m0, s36, 20480
    s_waitcnt lgkmcnt(2)
    v_exp_f32 v18, v78
    v_exp_f32_e64 v19, v79
    v_cvt_pk_bf16_f32 v30, v16, v17
    v_mfma_f32_32x32x16_bf16 v[128:143], v[56:59], v[24:27], v[128:143]
    buffer_load_dwordx4 v4, s[8:11], s37 offen sc1 lds
    v_cvt_pk_bf16_f32 v31, v18, v19
    v_exp_f32 v12, v80
    v_exp_f32 v13, v81
    v_mfma_f32_32x32x16_bf16 v[128:143], v[60:63], v[28:31], v[128:143]
    s_add_u32 s37, s37, 4096
    v_exp_f32_e64 v14, v82
    v_exp_f32 v15, v83
    v_smfmac_f32_16x16x64_bf16 v[160:163], v[20:23], v[24:31], v3
    s_waitcnt lgkmcnt(0)
    v_cvt_pk_bf16_f32 v24, v12, v13
    v_mfma_f32_32x32x16_bf16 v[64:79], v[48:51], v[32:35], v[96:111]
    buffer_load_dwordx4 v[216:219], v4, s[16:19], s38 offen sc1
    buffer_load_dwordx4 v[220:223], v5, s[16:19], s38 offen sc1
    v_exp_f32 v16, v84
    v_exp_f32 v17, v85
    v_cvt_pk_bf16_f32 v25, v14, v15
    v_mfma_f32_32x32x16_bf16 v[64:79], v[52:55], v[36:39], v[64:79]
    buffer_load_dwordx4 v[224:227], v6, s[16:19], s38 offen sc1
    v_exp_f32 v18, v86
    v_exp_f32 v19, v87
    v_cvt_pk_bf16_f32 v26, v16, v17
    v_mfma_f32_32x32x16_bf16 a[64:79], v[232:235], v[248:251], 0
    buffer_load_dwordx4 v[228:231], v7, s[16:19], s38 offen sc1
    s_add_u32 s38, s38, 16384
    v_exp_f32 v12, v88
    v_exp_f32 v13, v89
    v_cvt_pk_bf16_f32 v27, v18, v19
    v_mfma_f32_32x32x16_bf16 a[80:95], v[236:239], v[248:251], 0
    s_waitcnt vmcnt(23)
    v_exp_f32 v14, v90
    v_exp_f32_e64 v15, v91
    v_cvt_pk_bf16_f32 v28, v12, v13
    v_mfma_f32_32x32x16_bf16 a[96:111], v[232:235], v[252:255], 0
    s_barrier
    v_exp_f32 v16, v92
    v_exp_f32_e64 v17, v93
    v_cvt_pk_bf16_f32 v29, v14, v15
    v_mfma_f32_32x32x16_bf16 a[112:127], v[236:239], v[252:255], 0
    v_exp_f32 v18, v94
    v_exp_f32 v19, v95
    v_cvt_pk_bf16_f32 v30, v16, v17
    s_mov_b32 vcc_lo, 0x3f
    s_mov_b32 vcc_hi, 0
.p2align 6
L_p2_loop:
    v_mfma_f32_32x32x16_bf16 v[144:159], v[56:59], v[24:27], v[144:159]
    ds_read_b128 v[56:59], v2 offset:2048
    v_cvt_pk_bf16_f32 v31, v18, v19
    v_exp_f32 v12, v64
    v_exp_f32 v13, v65
    v_mfma_f32_32x32x16_bf16 v[144:159], v[60:63], v[28:31], v[144:159]
    ds_read_b128 v[60:63], v2 offset:2560
    v_exp_f32 v14, v66
    v_exp_f32 v15, v67
    v_smfmac_f32_16x16x64_bf16 v[164:167], v[20:23], v[24:31], v3
    buffer_load_dwordx4 v[232:235], v9, s[20:23], s38 offen offset:0 sc1
    v_cvt_pk_bf16_f32 v24, v12, v13
    v_mfma_f32_32x32x16_bf16 v[80:95], v[48:51], v[40:43], v[112:127]
    ds_read_b128 v[48:51], v2 offset:4096
    v_exp_f32 v16, v68
    v_exp_f32 v17, v69
    v_cvt_pk_bf16_f32 v25, v14, v15
    v_mfma_f32_32x32x16_bf16 v[80:95], v[52:55], v[44:47], v[80:95]
    ds_read_b128 v[52:55], v2 offset:4608
    v_exp_f32 v18, v70
    v_exp_f32 v19, v71
    v_cvt_pk_bf16_f32 v26, v16, v17
    v_mfma_f32_32x32x16_bf16 a[0:15], a[128:131], a[136:139], a[0:15]
    buffer_load_dwordx4 v[240:243], v4, s[16:19], s38 offen sc1
    v_exp_f32 v12, v72
    v_exp_f32 v13, v73
    v_cvt_pk_bf16_f32 v27, v18, v19
    v_mfma_f32_32x32x16_bf16 a[16:31], a[132:135], a[136:139], a[16:31]
    buffer_load_dwordx4 v[236:239], v9, s[20:23], s38 offen offset:1024 sc1
    v_exp_f32 v14, v74
    v_exp_f32 v15, v75
    v_cvt_pk_bf16_f32 v28, v12, v13
    v_mfma_f32_32x32x16_bf16 a[32:47], a[128:131], a[140:143], a[32:47]
    v_exp_f32 v16, v76
    v_exp_f32 v17, v77
    v_cvt_pk_bf16_f32 v29, v14, v15
    v_mfma_f32_32x32x16_bf16 a[48:63], a[132:135], a[140:143], a[48:63]
    s_add_u32 m0, s36, 24576
    s_waitcnt lgkmcnt(2)
    v_exp_f32 v18, v78
    v_exp_f32_e64 v19, v79
    v_cvt_pk_bf16_f32 v30, v16, v17
    v_mfma_f32_32x32x16_bf16 v[128:143], v[56:59], v[24:27], v[128:143]
    buffer_load_dwordx4 v10, s[72:75], m0 offen sc1 lds
    v_cvt_pk_bf16_f32 v31, v18, v19
    v_exp_f32 v12, v80
    v_exp_f32 v13, v81
    v_mfma_f32_32x32x16_bf16 v[128:143], v[60:63], v[28:31], v[128:143]
    s_mov_b32 m0, s39
    v_exp_f32 v14, v82
    v_exp_f32 v15, v83
    v_smfmac_f32_16x16x64_bf16 v[160:163], v[20:23], v[24:31], v3
    s_waitcnt lgkmcnt(0)
    v_cvt_pk_bf16_f32 v24, v12, v13
    v_mfma_f32_32x32x16_bf16 v[64:79], v[48:51], v[32:35], v[96:111]
    buffer_load_dwordx4 v[244:247], v5, s[16:19], s38 offen sc1
    v_exp_f32 v16, v84
    v_exp_f32 v17, v85
    v_cvt_pk_bf16_f32 v25, v14, v15
    v_mfma_f32_32x32x16_bf16 v[64:79], v[52:55], v[36:39], v[64:79]
    buffer_load_dwordx4 v[248:251], v6, s[16:19], s38 offen sc1
    v_exp_f32 v18, v86
    v_exp_f32 v19, v87
    v_cvt_pk_bf16_f32 v26, v16, v17
    v_mfma_f32_32x32x16_bf16 a[64:79], a[128:131], a[144:147], a[64:79]
    buffer_load_dwordx4 v[252:255], v7, s[16:19], s38 offen sc1
    v_exp_f32 v12, v88
    v_exp_f32 v13, v89
    v_cvt_pk_bf16_f32 v27, v18, v19
    v_mfma_f32_32x32x16_bf16 a[80:95], a[132:135], a[144:147], a[80:95]
    v_exp_f32 v14, v90
    v_exp_f32 v15, v91
    v_cvt_pk_bf16_f32 v28, v12, v13
    v_mfma_f32_32x32x16_bf16 a[96:111], a[128:131], a[148:151], a[96:111]
    buffer_load_dwordx4 v9, s[24:27], m0 offen offset:0 sc1 lds
    v_exp_f32 v16, v92
    v_exp_f32 v17, v93
    v_cvt_pk_bf16_f32 v29, v14, v15
    v_mfma_f32_32x32x16_bf16 a[112:127], a[132:135], a[148:151], a[112:127]
    s_add_u32 s38, s38, 16384
    v_exp_f32 v18, v94
    v_exp_f32 v19, v95
    v_cvt_pk_bf16_f32 v30, v16, v17
    v_mfma_f32_32x32x16_bf16 v[144:159], v[56:59], v[24:27], v[144:159]
    ds_read_b128 v[56:59], v2 offset:6144
    v_cvt_pk_bf16_f32 v31, v18, v19
    v_exp_f32 v12, v64
    v_exp_f32 v13, v65
    v_mfma_f32_32x32x16_bf16 v[144:159], v[60:63], v[28:31], v[144:159]
    ds_read_b128 v[60:63], v2 offset:6656
    v_exp_f32 v14, v66
    v_exp_f32 v15, v67
    v_smfmac_f32_16x16x64_bf16 v[164:167], v[20:23], v[24:31], v3
    buffer_load_dwordx4 a[128:131], v9, s[20:23], s38 offen offset:0 sc1
    v_cvt_pk_bf16_f32 v24, v12, v13
    v_mfma_f32_32x32x16_bf16 v[80:95], v[48:51], v[40:43], v[112:127]
    ds_read_b128 v[48:51], v2 offset:8192
    v_exp_f32 v16, v68
    v_exp_f32 v17, v69
    v_cvt_pk_bf16_f32 v25, v14, v15
    v_mfma_f32_32x32x16_bf16 v[80:95], v[52:55], v[44:47], v[80:95]
    ds_read_b128 v[52:55], v2 offset:8704
    v_exp_f32 v18, v70
    v_exp_f32 v19, v71
    v_cvt_pk_bf16_f32 v26, v16, v17
    v_mfma_f32_32x32x16_bf16 a[0:15], a[152:155], a[160:163], a[0:15]
    buffer_load_dwordx4 a[136:139], v4, s[16:19], s38 offen sc1
    v_exp_f32 v12, v72
    v_exp_f32 v13, v73
    v_cvt_pk_bf16_f32 v27, v18, v19
    v_mfma_f32_32x32x16_bf16 a[16:31], a[156:159], a[160:163], a[16:31]
    buffer_load_dwordx4 a[132:135], v9, s[20:23], s38 offen offset:1024 sc1
    v_exp_f32 v14, v74
    v_exp_f32 v15, v75
    v_cvt_pk_bf16_f32 v28, v12, v13
    v_mfma_f32_32x32x16_bf16 a[32:47], a[152:155], a[164:167], a[32:47]
    v_exp_f32 v16, v76
    v_exp_f32 v17, v77
    v_cvt_pk_bf16_f32 v29, v14, v15
    v_mfma_f32_32x32x16_bf16 a[48:63], a[156:159], a[164:167], a[48:63]
    s_add_u32 m0, s36, 28672
    s_waitcnt lgkmcnt(2)
    v_exp_f32 v18, v78
    v_exp_f32_e64 v19, v79
    v_cvt_pk_bf16_f32 v30, v16, v17
    v_mfma_f32_32x32x16_bf16 v[128:143], v[56:59], v[24:27], v[128:143]
    buffer_load_dwordx4 v10, s[72:75], m0 offen sc1 lds
    v_cvt_pk_bf16_f32 v31, v18, v19
    v_exp_f32 v12, v80
    v_exp_f32 v13, v81
    v_mfma_f32_32x32x16_bf16 v[128:143], v[60:63], v[28:31], v[128:143]
    v_exp_f32 v14, v82
    v_exp_f32_e64 v15, v83
    v_smfmac_f32_16x16x64_bf16 v[160:163], v[20:23], v[24:31], v3
    s_waitcnt lgkmcnt(0)
    v_cvt_pk_bf16_f32 v24, v12, v13
    v_mfma_f32_32x32x16_bf16 v[64:79], v[48:51], v[32:35], v[96:111]
    buffer_load_dwordx4 a[140:143], v5, s[16:19], s38 offen sc1
    v_exp_f32 v16, v84
    v_exp_f32 v17, v85
    v_cvt_pk_bf16_f32 v25, v14, v15
    v_mfma_f32_32x32x16_bf16 v[64:79], v[52:55], v[36:39], v[64:79]
    buffer_load_dwordx4 a[144:147], v6, s[16:19], s38 offen sc1
    v_exp_f32 v18, v86
    v_exp_f32 v19, v87
    v_cvt_pk_bf16_f32 v26, v16, v17
    v_mfma_f32_32x32x16_bf16 a[64:79], a[152:155], a[168:171], a[64:79]
    buffer_load_dwordx4 a[148:151], v7, s[16:19], s38 offen sc1
    v_exp_f32 v12, v88
    v_exp_f32 v13, v89
    v_cvt_pk_bf16_f32 v27, v18, v19
    v_mfma_f32_32x32x16_bf16 a[80:95], a[156:159], a[168:171], a[80:95]
    s_waitcnt vmcnt(27)
    v_exp_f32 v14, v90
    v_exp_f32_e64 v15, v91
    v_cvt_pk_bf16_f32 v28, v12, v13
    v_mfma_f32_32x32x16_bf16 a[96:111], a[152:155], a[172:175], a[96:111]
    s_barrier
    v_exp_f32 v16, v92
    v_exp_f32_e64 v17, v93
    v_cvt_pk_bf16_f32 v29, v14, v15
    v_mfma_f32_32x32x16_bf16 a[112:127], a[156:159], a[172:175], a[112:127]
    s_add_u32 s38, s38, 16384
    v_exp_f32 v18, v94
    v_exp_f32 v19, v95
    v_cvt_pk_bf16_f32 v30, v16, v17
    v_mfma_f32_32x32x16_bf16 v[144:159], v[56:59], v[24:27], v[144:159]
    ds_read_b128 v[56:59], v2 offset:10240
    v_cvt_pk_bf16_f32 v31, v18, v19
    v_exp_f32 v12, v64
    v_exp_f32 v13, v65
    v_mfma_f32_32x32x16_bf16 v[144:159], v[60:63], v[28:31], v[144:159]
    ds_read_b128 v[60:63], v2 offset:10752
    v_exp_f32 v14, v66
    v_exp_f32 v15, v67
    v_smfmac_f32_16x16x64_bf16 v[164:167], v[20:23], v[24:31], v3
    buffer_load_dwordx4 a[152:155], v9, s[20:23], s38 offen offset:0 sc1
    v_cvt_pk_bf16_f32 v24, v12, v13
    v_mfma_f32_32x32x16_bf16 v[80:95], v[48:51], v[40:43], v[112:127]
    ds_read_b128 v[48:51], v2 offset:12288
    v_exp_f32 v16, v68
    v_exp_f32 v17, v69
    v_cvt_pk_bf16_f32 v25, v14, v15
    v_mfma_f32_32x32x16_bf16 v[80:95], v[52:55], v[44:47], v[80:95]
    ds_read_b128 v[52:55], v2 offset:12800
    v_exp_f32 v18, v70
    v_exp_f32 v19, v71
    v_cvt_pk_bf16_f32 v26, v16, v17
    v_mfma_f32_32x32x16_bf16 a[0:15], a[176:179], a[184:187], a[0:15]
    buffer_load_dwordx4 a[160:163], v4, s[16:19], s38 offen sc1
    v_exp_f32 v12, v72
    v_exp_f32 v13, v73
    v_cvt_pk_bf16_f32 v27, v18, v19
    v_mfma_f32_32x32x16_bf16 a[16:31], a[180:183], a[184:187], a[16:31]
    buffer_load_dwordx4 a[156:159], v9, s[20:23], s38 offen offset:1024 sc1
    v_exp_f32 v14, v74
    v_exp_f32 v15, v75
    v_cvt_pk_bf16_f32 v28, v12, v13
    v_mfma_f32_32x32x16_bf16 a[32:47], a[176:179], a[188:191], a[32:47]
    v_add_u32 v10, 0x8000, v10
    v_exp_f32 v16, v76
    v_exp_f32 v17, v77
    v_cvt_pk_bf16_f32 v29, v14, v15
    v_mfma_f32_32x32x16_bf16 a[48:63], a[180:183], a[188:191], a[48:63]
    s_add_u32 m0, s36, 0
    s_waitcnt lgkmcnt(2)
    v_exp_f32 v18, v78
    v_exp_f32 v19, v79
    v_cvt_pk_bf16_f32 v30, v16, v17
    v_mfma_f32_32x32x16_bf16 v[128:143], v[56:59], v[24:27], v[128:143]
    buffer_load_dwordx4 v10, s[72:75], m0 offen sc1 lds
    v_cvt_pk_bf16_f32 v31, v18, v19
    v_exp_f32 v12, v80
    v_exp_f32 v13, v81
    v_mfma_f32_32x32x16_bf16 v[128:143], v[60:63], v[28:31], v[128:143]
    s_mov_b32 m0, s39
    v_exp_f32 v14, v82
    v_exp_f32 v15, v83
    v_smfmac_f32_16x16x64_bf16 v[160:163], v[20:23], v[24:31], v3
    s_waitcnt lgkmcnt(0)
    v_cvt_pk_bf16_f32 v24, v12, v13
    v_mfma_f32_32x32x16_bf16 v[64:79], v[48:51], v[32:35], v[96:111]
    buffer_load_dwordx4 a[164:167], v5, s[16:19], s38 offen sc1
    v_exp_f32 v16, v84
    v_exp_f32 v17, v85
    v_cvt_pk_bf16_f32 v25, v14, v15
    v_mfma_f32_32x32x16_bf16 v[64:79], v[52:55], v[36:39], v[64:79]
    buffer_load_dwordx4 a[168:171], v6, s[16:19], s38 offen sc1
    v_exp_f32 v18, v86
    v_exp_f32 v19, v87
    v_cvt_pk_bf16_f32 v26, v16, v17
    v_mfma_f32_32x32x16_bf16 a[64:79], a[176:179], a[192:195], a[64:79]
    buffer_load_dwordx4 a[172:175], v7, s[16:19], s38 offen sc1
    v_exp_f32 v12, v88
    v_exp_f32 v13, v89
    v_cvt_pk_bf16_f32 v27, v18, v19
    v_mfma_f32_32x32x16_bf16 a[80:95], a[180:183], a[192:195], a[80:95]
    v_exp_f32 v14, v90
    v_exp_f32 v15, v91
    v_cvt_pk_bf16_f32 v28, v12, v13
    v_mfma_f32_32x32x16_bf16 a[96:111], a[176:179], a[196:199], a[96:111]
    buffer_load_dwordx4 v9, s[24:27], m0 offen offset:1024 sc1 lds
    v_exp_f32 v16, v92
    v_exp_f32 v17, v93
    v_cvt_pk_bf16_f32 v29, v14, v15
    v_mfma_f32_32x32x16_bf16 a[112:127], a[180:183], a[196:199], a[112:127]
    s_add_u32 s38, s38, 16384
    v_exp_f32 v18, v94
    v_exp_f32 v19, v95
    v_cvt_pk_bf16_f32 v30, v16, v17
    v_mfma_f32_32x32x16_bf16 v[144:159], v[56:59], v[24:27], v[144:159]
    ds_read_b128 v[56:59], v2 offset:14336
    v_cvt_pk_bf16_f32 v31, v18, v19
    v_exp_f32 v12, v64
    v_exp_f32 v13, v65
    v_mfma_f32_32x32x16_bf16 v[144:159], v[60:63], v[28:31], v[144:159]
    ds_read_b128 v[60:63], v2 offset:14848
    v_exp_f32 v14, v66
    v_exp_f32 v15, v67
    v_smfmac_f32_16x16x64_bf16 v[164:167], v[20:23], v[24:31], v3
    buffer_load_dwordx4 a[176:179], v9, s[20:23], s38 offen offset:0 sc1
    v_cvt_pk_bf16_f32 v24, v12, v13
    v_mfma_f32_32x32x16_bf16 v[80:95], v[48:51], v[40:43], v[112:127]
    ds_read_b128 v[48:51], v2 offset:16384
    v_exp_f32 v16, v68
    v_exp_f32 v17, v69
    v_cvt_pk_bf16_f32 v25, v14, v15
    v_mfma_f32_32x32x16_bf16 v[80:95], v[52:55], v[44:47], v[80:95]
    ds_read_b128 v[52:55], v2 offset:16896
    v_exp_f32 v18, v70
    v_exp_f32 v19, v71
    v_cvt_pk_bf16_f32 v26, v16, v17
    v_mfma_f32_32x32x16_bf16 a[0:15], a[200:203], a[208:211], a[0:15]
    buffer_load_dwordx4 a[184:187], v4, s[16:19], s38 offen sc1
    v_exp_f32 v12, v72
    v_exp_f32 v13, v73
    v_cvt_pk_bf16_f32 v27, v18, v19
    v_mfma_f32_32x32x16_bf16 a[16:31], a[204:207], a[208:211], a[16:31]
    buffer_load_dwordx4 a[180:183], v9, s[20:23], s38 offen offset:1024 sc1
    v_exp_f32 v14, v74
    v_exp_f32 v15, v75
    v_cvt_pk_bf16_f32 v28, v12, v13
    v_mfma_f32_32x32x16_bf16 a[32:47], a[200:203], a[212:215], a[32:47]
    v_exp_f32 v16, v76
    v_exp_f32 v17, v77
    v_cvt_pk_bf16_f32 v29, v14, v15
    v_mfma_f32_32x32x16_bf16 a[48:63], a[204:207], a[212:215], a[48:63]
    s_add_u32 m0, s36, 4096
    s_waitcnt lgkmcnt(2)
    v_exp_f32 v18, v78
    v_exp_f32_e64 v19, v79
    v_cvt_pk_bf16_f32 v30, v16, v17
    v_mfma_f32_32x32x16_bf16 v[128:143], v[56:59], v[24:27], v[128:143]
    buffer_load_dwordx4 v10, s[72:75], m0 offen sc1 lds
    v_cvt_pk_bf16_f32 v31, v18, v19
    v_exp_f32 v12, v80
    v_exp_f32 v13, v81
    v_mfma_f32_32x32x16_bf16 v[128:143], v[60:63], v[28:31], v[128:143]
    v_exp_f32 v14, v82
    v_exp_f32 v15, v83
    v_smfmac_f32_16x16x64_bf16 v[160:163], v[20:23], v[24:31], v3
    s_waitcnt lgkmcnt(0)
    v_cvt_pk_bf16_f32 v24, v12, v13
    v_mfma_f32_32x32x16_bf16 v[64:79], v[48:51], v[32:35], v[96:111]
    buffer_load_dwordx4 a[188:191], v5, s[16:19], s38 offen sc1
    v_exp_f32 v16, v84
    v_exp_f32 v17, v85
    v_cvt_pk_bf16_f32 v25, v14, v15
    v_mfma_f32_32x32x16_bf16 v[64:79], v[52:55], v[36:39], v[64:79]
    buffer_load_dwordx4 a[192:195], v6, s[16:19], s38 offen sc1
    v_exp_f32 v18, v86
    v_exp_f32 v19, v87
    v_cvt_pk_bf16_f32 v26, v16, v17
    v_mfma_f32_32x32x16_bf16 a[64:79], a[200:203], a[216:219], a[64:79]
    buffer_load_dwordx4 a[196:199], v7, s[16:19], s38 offen sc1
    v_exp_f32 v12, v88
    v_exp_f32 v13, v89
    v_cvt_pk_bf16_f32 v27, v18, v19
    v_mfma_f32_32x32x16_bf16 a[80:95], a[204:207], a[216:219], a[80:95]
    s_waitcnt vmcnt(26)
    v_exp_f32 v14, v90
    v_exp_f32 v15, v91
    v_cvt_pk_bf16_f32 v28, v12, v13
    v_mfma_f32_32x32x16_bf16 a[96:111], a[200:203], a[220:223], a[96:111]
    s_barrier
    v_exp_f32 v16, v92
    v_exp_f32_e64 v17, v93
    v_cvt_pk_bf16_f32 v29, v14, v15
    v_mfma_f32_32x32x16_bf16 a[112:127], a[204:207], a[220:223], a[112:127]
    s_add_u32 s38, s38, 16384
    v_exp_f32 v18, v94
    v_exp_f32 v19, v95
    v_cvt_pk_bf16_f32 v30, v16, v17
    v_mfma_f32_32x32x16_bf16 v[144:159], v[56:59], v[24:27], v[144:159]
    ds_read_b128 v[56:59], v2 offset:18432
    v_cvt_pk_bf16_f32 v31, v18, v19
    v_exp_f32 v12, v64
    v_exp_f32 v13, v65
    v_mfma_f32_32x32x16_bf16 v[144:159], v[60:63], v[28:31], v[144:159]
    ds_read_b128 v[60:63], v2 offset:18944
    v_exp_f32 v14, v66
    v_exp_f32 v15, v67
    v_smfmac_f32_16x16x64_bf16 v[164:167], v[20:23], v[24:31], v3
    buffer_load_dwordx4 a[200:203], v9, s[20:23], s38 offen offset:0 sc1
    v_cvt_pk_bf16_f32 v24, v12, v13
    v_mfma_f32_32x32x16_bf16 v[80:95], v[48:51], v[40:43], v[112:127]
    ds_read_b128 v[48:51], v2 offset:20480
    v_exp_f32 v16, v68
    v_exp_f32 v17, v69
    v_cvt_pk_bf16_f32 v25, v14, v15
    v_mfma_f32_32x32x16_bf16 v[80:95], v[52:55], v[44:47], v[80:95]
    ds_read_b128 v[52:55], v2 offset:20992
    v_exp_f32 v18, v70
    v_exp_f32 v19, v71
    v_cvt_pk_bf16_f32 v26, v16, v17
    v_mfma_f32_32x32x16_bf16 a[0:15], a[224:227], a[232:235], a[0:15]
    buffer_load_dwordx4 a[208:211], v4, s[16:19], s38 offen sc1
    v_exp_f32 v12, v72
    v_exp_f32 v13, v73
    v_cvt_pk_bf16_f32 v27, v18, v19
    v_mfma_f32_32x32x16_bf16 a[16:31], a[228:231], a[232:235], a[16:31]
    buffer_load_dwordx4 a[204:207], v9, s[20:23], s38 offen offset:1024 sc1
    v_exp_f32 v14, v74
    v_exp_f32 v15, v75
    v_cvt_pk_bf16_f32 v28, v12, v13
    v_mfma_f32_32x32x16_bf16 a[32:47], a[224:227], a[236:239], a[32:47]
    v_exp_f32 v16, v76
    v_exp_f32 v17, v77
    v_cvt_pk_bf16_f32 v29, v14, v15
    v_mfma_f32_32x32x16_bf16 a[48:63], a[228:231], a[236:239], a[48:63]
    s_add_u32 m0, s36, 8192
    s_waitcnt lgkmcnt(2)
    v_exp_f32 v18, v78
    v_exp_f32_e64 v19, v79
    v_cvt_pk_bf16_f32 v30, v16, v17
    v_mfma_f32_32x32x16_bf16 v[128:143], v[56:59], v[24:27], v[128:143]
    buffer_load_dwordx4 v10, s[72:75], m0 offen sc1 lds
    v_cvt_pk_bf16_f32 v31, v18, v19
    v_exp_f32 v12, v80
    v_exp_f32 v13, v81
    v_mfma_f32_32x32x16_bf16 v[128:143], v[60:63], v[28:31], v[128:143]
    s_mov_b32 m0, s39
    v_exp_f32 v14, v82
    v_exp_f32 v15, v83
    v_smfmac_f32_16x16x64_bf16 v[160:163], v[20:23], v[24:31], v3
    s_waitcnt lgkmcnt(0)
    v_cvt_pk_bf16_f32 v24, v12, v13
    v_mfma_f32_32x32x16_bf16 v[64:79], v[48:51], v[32:35], v[96:111]
    buffer_load_dwordx4 a[212:215], v5, s[16:19], s38 offen sc1
    v_exp_f32 v16, v84
    v_exp_f32 v17, v85
    v_cvt_pk_bf16_f32 v25, v14, v15
    v_mfma_f32_32x32x16_bf16 v[64:79], v[52:55], v[36:39], v[64:79]
    buffer_load_dwordx4 a[216:219], v6, s[16:19], s38 offen sc1
    v_exp_f32 v18, v86
    v_exp_f32 v19, v87
    v_cvt_pk_bf16_f32 v26, v16, v17
    v_mfma_f32_32x32x16_bf16 a[64:79], a[224:227], a[240:243], a[64:79]
    buffer_load_dwordx4 a[220:223], v7, s[16:19], s38 offen sc1
    v_exp_f32 v12, v88
    v_exp_f32 v13, v89
    v_cvt_pk_bf16_f32 v27, v18, v19
    v_mfma_f32_32x32x16_bf16 a[80:95], a[228:231], a[240:243], a[80:95]
    v_exp_f32 v14, v90
    v_exp_f32 v15, v91
    v_cvt_pk_bf16_f32 v28, v12, v13
    v_mfma_f32_32x32x16_bf16 a[96:111], a[224:227], a[244:247], a[96:111]
    buffer_load_dwordx4 v9, s[24:27], m0 offen offset:2048 sc1 lds
    v_exp_f32 v16, v92
    v_exp_f32 v17, v93
    v_cvt_pk_bf16_f32 v29, v14, v15
    v_mfma_f32_32x32x16_bf16 a[112:127], a[228:231], a[244:247], a[112:127]
    s_add_u32 s38, s38, 16384
    v_exp_f32 v18, v94
    v_exp_f32 v19, v95
    v_cvt_pk_bf16_f32 v30, v16, v17
    v_mfma_f32_32x32x16_bf16 v[144:159], v[56:59], v[24:27], v[144:159]
    ds_read_b128 v[56:59], v2 offset:22528
    v_cvt_pk_bf16_f32 v31, v18, v19
    v_exp_f32 v12, v64
    v_exp_f32 v13, v65
    v_mfma_f32_32x32x16_bf16 v[144:159], v[60:63], v[28:31], v[144:159]
    ds_read_b128 v[60:63], v2 offset:23040
    v_exp_f32 v14, v66
    v_exp_f32 v15, v67
    v_smfmac_f32_16x16x64_bf16 v[164:167], v[20:23], v[24:31], v3
    buffer_load_dwordx4 a[224:227], v9, s[20:23], s38 offen offset:0 sc1
    v_cvt_pk_bf16_f32 v24, v12, v13
    v_mfma_f32_32x32x16_bf16 v[80:95], v[48:51], v[40:43], v[112:127]
    ds_read_b128 v[48:51], v2 offset:24576
    v_exp_f32 v16, v68
    v_exp_f32 v17, v69
    v_cvt_pk_bf16_f32 v25, v14, v15
    v_mfma_f32_32x32x16_bf16 v[80:95], v[52:55], v[44:47], v[80:95]
    ds_read_b128 v[52:55], v2 offset:25088
    v_exp_f32 v18, v70
    v_exp_f32 v19, v71
    v_cvt_pk_bf16_f32 v26, v16, v17
    v_mfma_f32_32x32x16_bf16 a[0:15], v[184:187], v[192:195], a[0:15]
    buffer_load_dwordx4 a[232:235], v4, s[16:19], s38 offen sc1
    v_exp_f32 v12, v72
    v_exp_f32 v13, v73
    v_cvt_pk_bf16_f32 v27, v18, v19
    v_mfma_f32_32x32x16_bf16 a[16:31], v[188:191], v[192:195], a[16:31]
    buffer_load_dwordx4 a[228:231], v9, s[20:23], s38 offen offset:1024 sc1
    v_exp_f32 v14, v74
    v_exp_f32 v15, v75
    v_cvt_pk_bf16_f32 v28, v12, v13
    v_mfma_f32_32x32x16_bf16 a[32:47], v[184:187], v[196:199], a[32:47]
    v_exp_f32 v16, v76
    v_exp_f32 v17, v77
    v_cvt_pk_bf16_f32 v29, v14, v15
    v_mfma_f32_32x32x16_bf16 a[48:63], v[188:191], v[196:199], a[48:63]
    s_add_u32 m0, s36, 12288
    s_waitcnt lgkmcnt(2)
    v_exp_f32 v18, v78
    v_exp_f32_e64 v19, v79
    v_cvt_pk_bf16_f32 v30, v16, v17
    v_mfma_f32_32x32x16_bf16 v[128:143], v[56:59], v[24:27], v[128:143]
    buffer_load_dwordx4 v10, s[72:75], m0 offen sc1 lds
    v_cvt_pk_bf16_f32 v31, v18, v19
    v_exp_f32 v12, v80
    v_exp_f32 v13, v81
    v_mfma_f32_32x32x16_bf16 v[128:143], v[60:63], v[28:31], v[128:143]
    v_exp_f32 v14, v82
    v_exp_f32 v15, v83
    v_smfmac_f32_16x16x64_bf16 v[160:163], v[20:23], v[24:31], v3
    s_waitcnt lgkmcnt(0)
    v_cvt_pk_bf16_f32 v24, v12, v13
    v_mfma_f32_32x32x16_bf16 v[64:79], v[48:51], v[32:35], v[96:111]
    buffer_load_dwordx4 a[236:239], v5, s[16:19], s38 offen sc1
    v_exp_f32 v16, v84
    v_exp_f32 v17, v85
    v_cvt_pk_bf16_f32 v25, v14, v15
    v_mfma_f32_32x32x16_bf16 v[64:79], v[52:55], v[36:39], v[64:79]
    buffer_load_dwordx4 a[240:243], v6, s[16:19], s38 offen sc1
    v_exp_f32 v18, v86
    v_exp_f32 v19, v87
    v_cvt_pk_bf16_f32 v26, v16, v17
    v_mfma_f32_32x32x16_bf16 a[64:79], v[184:187], v[200:203], a[64:79]
    buffer_load_dwordx4 a[244:247], v7, s[16:19], s38 offen sc1
    v_exp_f32 v12, v88
    v_exp_f32 v13, v89
    v_cvt_pk_bf16_f32 v27, v18, v19
    v_mfma_f32_32x32x16_bf16 a[80:95], v[188:191], v[200:203], a[80:95]
    s_waitcnt vmcnt(26)
    v_exp_f32 v14, v90
    v_exp_f32 v15, v91
    v_cvt_pk_bf16_f32 v28, v12, v13
    v_mfma_f32_32x32x16_bf16 a[96:111], v[184:187], v[204:207], a[96:111]
    s_barrier
    v_exp_f32 v16, v92
    v_exp_f32_e64 v17, v93
    v_cvt_pk_bf16_f32 v29, v14, v15
    v_mfma_f32_32x32x16_bf16 a[112:127], v[188:191], v[204:207], a[112:127]
    s_add_u32 s38, s38, 16384
    v_exp_f32 v18, v94
    v_exp_f32 v19, v95
    v_cvt_pk_bf16_f32 v30, v16, v17
    v_mfma_f32_32x32x16_bf16 v[144:159], v[56:59], v[24:27], v[144:159]
    ds_read_b128 v[56:59], v2 offset:26624
    v_cvt_pk_bf16_f32 v31, v18, v19
    v_exp_f32 v12, v64
    v_exp_f32 v13, v65
    v_mfma_f32_32x32x16_bf16 v[144:159], v[60:63], v[28:31], v[144:159]
    ds_read_b128 v[60:63], v2 offset:27136
    v_exp_f32 v14, v66
    v_exp_f32 v15, v67
    v_smfmac_f32_16x16x64_bf16 v[164:167], v[20:23], v[24:31], v3
    buffer_load_dwordx4 v[184:187], v9, s[20:23], s38 offen offset:0 sc1
    v_cvt_pk_bf16_f32 v24, v12, v13
    v_mfma_f32_32x32x16_bf16 v[80:95], v[48:51], v[40:43], v[112:127]
    ds_read_b128 v[48:51], v2 offset:28672
    v_exp_f32 v16, v68
    v_exp_f32 v17, v69
    v_cvt_pk_bf16_f32 v25, v14, v15
    v_mfma_f32_32x32x16_bf16 v[80:95], v[52:55], v[44:47], v[80:95]
    ds_read_b128 v[52:55], v2 offset:29184
    v_exp_f32 v18, v70
    v_exp_f32 v19, v71
    v_cvt_pk_bf16_f32 v26, v16, v17
    v_mfma_f32_32x32x16_bf16 a[0:15], v[208:211], v[216:219], a[0:15]
    buffer_load_dwordx4 v[192:195], v4, s[16:19], s38 offen sc1
    v_exp_f32 v12, v72
    v_exp_f32 v13, v73
    v_cvt_pk_bf16_f32 v27, v18, v19
    v_mfma_f32_32x32x16_bf16 a[16:31], v[212:215], v[216:219], a[16:31]
    buffer_load_dwordx4 v[188:191], v9, s[20:23], s38 offen offset:1024 sc1
    v_exp_f32 v14, v74
    v_exp_f32 v15, v75
    v_cvt_pk_bf16_f32 v28, v12, v13
    v_mfma_f32_32x32x16_bf16 a[32:47], v[208:211], v[220:223], a[32:47]
    v_exp_f32 v16, v76
    v_exp_f32 v17, v77
    v_cvt_pk_bf16_f32 v29, v14, v15
    v_mfma_f32_32x32x16_bf16 a[48:63], v[212:215], v[220:223], a[48:63]
    s_add_u32 m0, s36, 16384
    s_waitcnt lgkmcnt(2)
    v_exp_f32 v18, v78
    v_exp_f32_e64 v19, v79
    v_cvt_pk_bf16_f32 v30, v16, v17
    v_mfma_f32_32x32x16_bf16 v[128:143], v[56:59], v[24:27], v[128:143]
    buffer_load_dwordx4 v10, s[72:75], m0 offen sc1 lds
    v_cvt_pk_bf16_f32 v31, v18, v19
    v_exp_f32 v12, v80
    v_exp_f32 v13, v81
    v_mfma_f32_32x32x16_bf16 v[128:143], v[60:63], v[28:31], v[128:143]
    s_mov_b32 m0, s39
    v_exp_f32 v14, v82
    v_exp_f32 v15, v83
    v_smfmac_f32_16x16x64_bf16 v[160:163], v[20:23], v[24:31], v3
    s_waitcnt lgkmcnt(0)
    v_cvt_pk_bf16_f32 v24, v12, v13
    v_mfma_f32_32x32x16_bf16 v[64:79], v[48:51], v[32:35], v[96:111]
    buffer_load_dwordx4 v[196:199], v5, s[16:19], s38 offen sc1
    v_exp_f32 v16, v84
    v_exp_f32 v17, v85
    v_cvt_pk_bf16_f32 v25, v14, v15
    v_mfma_f32_32x32x16_bf16 v[64:79], v[52:55], v[36:39], v[64:79]
    buffer_load_dwordx4 v[200:203], v6, s[16:19], s38 offen sc1
    v_exp_f32 v18, v86
    v_exp_f32 v19, v87
    v_cvt_pk_bf16_f32 v26, v16, v17
    v_mfma_f32_32x32x16_bf16 a[64:79], v[208:211], v[224:227], a[64:79]
    buffer_load_dwordx4 v[204:207], v7, s[16:19], s38 offen sc1
    v_exp_f32 v12, v88
    v_exp_f32 v13, v89
    v_cvt_pk_bf16_f32 v27, v18, v19
    v_mfma_f32_32x32x16_bf16 a[80:95], v[212:215], v[224:227], a[80:95]
    v_exp_f32 v14, v90
    v_exp_f32 v15, v91
    v_cvt_pk_bf16_f32 v28, v12, v13
    v_mfma_f32_32x32x16_bf16 a[96:111], v[208:211], v[228:231], a[96:111]
    buffer_load_dwordx4 v9, s[24:27], m0 offen offset:3072 sc1 lds
    s_add_u32 s39, s39, 4096
    v_exp_f32 v16, v92
    v_exp_f32 v17, v93
    v_cvt_pk_bf16_f32 v29, v14, v15
    v_mfma_f32_32x32x16_bf16 a[112:127], v[212:215], v[228:231], a[112:127]
    s_add_u32 s38, s38, 16384
    v_exp_f32 v18, v94
    v_exp_f32 v19, v95
    v_cvt_pk_bf16_f32 v30, v16, v17
    v_mfma_f32_32x32x16_bf16 v[144:159], v[56:59], v[24:27], v[144:159]
    ds_read_b128 v[56:59], v2 offset:30720
    v_cvt_pk_bf16_f32 v31, v18, v19
    v_exp_f32 v12, v64
    v_exp_f32 v13, v65
    v_mfma_f32_32x32x16_bf16 v[144:159], v[60:63], v[28:31], v[144:159]
    ds_read_b128 v[60:63], v2 offset:31232
    v_exp_f32 v14, v66
    v_exp_f32 v15, v67
    v_smfmac_f32_16x16x64_bf16 v[164:167], v[20:23], v[24:31], v3
    buffer_load_dwordx4 v[208:211], v9, s[20:23], s38 offen offset:0 sc1
    v_cvt_pk_bf16_f32 v24, v12, v13
    v_mfma_f32_32x32x16_bf16 v[80:95], v[48:51], v[40:43], v[112:127]
    ds_read_b128 v[48:51], v2 offset:0
    v_exp_f32 v16, v68
    v_exp_f32 v17, v69
    v_cvt_pk_bf16_f32 v25, v14, v15
    v_mfma_f32_32x32x16_bf16 v[80:95], v[52:55], v[44:47], v[80:95]
    ds_read_b128 v[52:55], v2 offset:512
    v_exp_f32 v18, v70
    v_exp_f32 v19, v71
    v_cvt_pk_bf16_f32 v26, v16, v17
    v_mfma_f32_32x32x16_bf16 a[0:15], v[232:235], v[240:243], a[0:15]
    buffer_load_dwordx4 v[216:219], v4, s[16:19], s38 offen sc1
    v_exp_f32 v12, v72
    v_exp_f32 v13, v73
    v_cvt_pk_bf16_f32 v27, v18, v19
    v_mfma_f32_32x32x16_bf16 a[16:31], v[236:239], v[240:243], a[16:31]
    buffer_load_dwordx4 v[212:215], v9, s[20:23], s38 offen offset:1024 sc1
    v_exp_f32 v14, v74
    v_exp_f32 v15, v75
    v_cvt_pk_bf16_f32 v28, v12, v13
    v_mfma_f32_32x32x16_bf16 a[32:47], v[232:235], v[244:247], a[32:47]
    buffer_load_dword v1, v11, s[32:35], s45 offen sc1
    v_exp_f32 v16, v76
    v_exp_f32 v17, v77
    v_cvt_pk_bf16_f32 v29, v14, v15
    v_mfma_f32_32x32x16_bf16 a[48:63], v[236:239], v[244:247], a[48:63]
    s_add_u32 m0, s36, 20480
    s_waitcnt lgkmcnt(2)
    v_exp_f32 v18, v78
    v_exp_f32_e64 v19, v79
    v_cvt_pk_bf16_f32 v30, v16, v17
    v_mfma_f32_32x32x16_bf16 v[128:143], v[56:59], v[24:27], v[128:143]
    buffer_load_dwordx4 v10, s[72:75], m0 offen sc1 lds
    v_cvt_pk_bf16_f32 v31, v18, v19
    v_exp_f32 v12, v80
    v_exp_f32 v13, v81
    v_mfma_f32_32x32x16_bf16 v[128:143], v[60:63], v[28:31], v[128:143]
    s_lshr_b32 vcc_lo, vcc_lo, 1
    v_exp_f32 v14, v82
    v_exp_f32 v15, v83
    v_smfmac_f32_16x16x64_bf16 v[160:163], v[20:23], v[24:31], v3
    s_waitcnt lgkmcnt(0)
    v_cvt_pk_bf16_f32 v24, v12, v13
    v_mfma_f32_32x32x16_bf16 v[64:79], v[48:51], v[32:35], v[96:111]
    buffer_load_dwordx4 v[220:223], v5, s[16:19], s38 offen sc1
    v_exp_f32 v16, v84
    v_exp_f32 v17, v85
    v_cvt_pk_bf16_f32 v25, v14, v15
    v_mfma_f32_32x32x16_bf16 v[64:79], v[52:55], v[36:39], v[64:79]
    buffer_load_dwordx4 v[224:227], v6, s[16:19], s38 offen sc1
    v_exp_f32 v18, v86
    v_exp_f32 v19, v87
    v_cvt_pk_bf16_f32 v26, v16, v17
    v_mfma_f32_32x32x16_bf16 a[64:79], v[232:235], v[248:251], a[64:79]
    buffer_load_dwordx4 v[228:231], v7, s[16:19], s38 offen sc1
    v_exp_f32_e64 v12, v88
    v_exp_f32_e64 v13, v89
    v_cvt_pk_bf16_f32 v27, v18, v19
    v_mfma_f32_32x32x16_bf16 a[80:95], v[236:239], v[248:251], a[80:95]
    s_waitcnt vmcnt(27)
    v_exp_f32 v14, v90
    v_exp_f32_e64 v15, v91
    v_cvt_pk_bf16_f32 v28, v12, v13
    v_mfma_f32_32x32x16_bf16 a[96:111], v[232:235], v[252:255], a[96:111]
    s_barrier
    v_exp_f32 v16, v92
    v_exp_f32_e64 v17, v93
    v_cvt_pk_bf16_f32 v29, v14, v15
    v_mfma_f32_32x32x16_bf16 a[112:127], v[236:239], v[252:255], a[112:127]
    s_add_u32 s38, s38, 16384
    v_exp_f32_e64 v18, v94
    v_exp_f32_e64 v19, v95
    v_cvt_pk_bf16_f32 v30, v16, v17
    s_cbranch_vccnz L_p2_loop
    v_cvt_pk_bf16_f32 v31, v18, v19
    s_nop 0
    v_mfma_f32_32x32x16_bf16 v[144:159], v[56:59], v[24:27], v[144:159]
    v_mfma_f32_32x32x16_bf16 v[144:159], v[60:63], v[28:31], v[144:159]
    v_smfmac_f32_16x16x64_bf16 v[164:167], v[20:23], v[24:31], v3
    v_mfma_f32_32x32x16_bf16 a[32:47], a[128:131], a[140:143], a[32:47]
    s_mov_b32 s53, 0
    s_mov_b32 s59, 917504
    v_mfma_f32_32x32x16_bf16 a[48:63], a[132:135], a[140:143], a[48:63]
    v_add_f32 v160, v160, v161
    v_rcp_f32 v12, v160
    s_nop 0
    v_mul_f32 v128, v12, v128
    v_mul_f32 v129, v12, v129
    v_mul_f32 v130, v12, v130
    v_mul_f32 v131, v12, v131
    v_mfma_f32_32x32x16_bf16 a[32:47], a[152:155], a[164:167], a[32:47]
    v_mul_f32 v132, v12, v132
    v_mul_f32 v133, v12, v133
    v_mul_f32 v134, v12, v134
    v_mul_f32 v135, v12, v135
    v_cvt_pk_bf16_f32 v64, v128, v129
    v_cvt_pk_bf16_f32 v65, v130, v131
    v_mfma_f32_32x32x16_bf16 a[48:63], a[156:159], a[164:167], a[48:63]
    v_cvt_pk_bf16_f32 v66, v132, v133
    v_cvt_pk_bf16_f32 v67, v134, v135
    buffer_store_dwordx4 v[64:67], v9, s[32:35], s41 offen offset:0 sc1
    v_mul_f32 v136, v12, v136
    v_mul_f32 v137, v12, v137
    v_mul_f32 v138, v12, v138
    v_mfma_f32_32x32x16_bf16 a[32:47], a[176:179], a[188:191], a[32:47]
    v_mul_f32 v139, v12, v139
    v_mul_f32 v140, v12, v140
    v_mul_f32 v141, v12, v141
    v_mul_f32 v142, v12, v142
    v_mul_f32 v143, v12, v143
    v_cvt_pk_bf16_f32 v68, v136, v137
    v_mfma_f32_32x32x16_bf16 a[48:63], a[180:183], a[188:191], a[48:63]
    s_waitcnt vmcnt(5)
    v_cmp_eq_u32 vcc, 1, v1
    v_cvt_pk_bf16_f32 v69, v138, v139
    v_cvt_pk_bf16_f32 v70, v140, v141
    v_cvt_pk_bf16_f32 v71, v142, v143
    buffer_store_dwordx4 v[68:71], v9, s[32:35], s48 offen offset:0 sc1
    v_add_f32 v164, v164, v165
    v_rcp_f32 v14, v164
    v_mfma_f32_32x32x16_bf16 a[32:47], a[200:203], a[212:215], a[32:47]
    s_lshr_b32 s56, vcc_lo, 1
    s_and_b32 s56, s56, vcc_lo
    s_lshr_b32 s57, s56, 2
    s_and_b32 s56, s56, s57
    s_and_b32 s56, s56, 0x11111111
    s_andn2_b32 s52, s56, s53
    s_nop 0
    v_mul_f32 v144, v14, v144
    v_mul_f32 v145, v14, v145
    v_mul_f32 v146, v14, v146
    v_mul_f32 v147, v14, v147
    v_mul_f32 v148, v14, v148
    v_mul_f32 v149, v14, v149
    v_mfma_f32_32x32x16_bf16 a[48:63], a[204:207], a[212:215], a[48:63]
    s_nop 0
    s_bcnt1_i32_b32 s56, s52
    s_cmp_ge_u32 s56, 0
    s_cselect_b32 s52, s52, 0
    s_cselect_b32 s54, s59, 2.0
    v_mul_f32 v150, v14, v150
    v_mul_f32_e64 v151, v14, v151
    v_cvt_pk_bf16_f32 v72, v144, v145
    v_cvt_pk_bf16_f32 v73, v146, v147
    v_cvt_pk_bf16_f32 v74, v148, v149
    v_cvt_pk_bf16_f32 v75, v150, v151
    v_mfma_f32_32x32x16_bf16 a[32:47], a[224:227], a[236:239], a[32:47]
    buffer_store_dwordx4 v[72:75], v9, s[32:35], s41 offen offset:1024 sc1
    v_mul_f32 v152, v14, v152
    v_mul_f32 v153, v14, v153
    v_mul_f32 v154, v14, v154
    v_mul_f32 v155, v14, v155
    v_mul_f32 v156, v14, v156
    v_mfma_f32_32x32x16_bf16 a[48:63], a[228:231], a[236:239], a[48:63]
    v_mul_f32 v157, v14, v157
    v_mul_f32 v158, v14, v158
    v_mul_f32 v159, v14, v159
    v_cvt_pk_bf16_f32 v76, v152, v153
    v_cvt_pk_bf16_f32 v77, v154, v155
    v_cvt_pk_bf16_f32 v78, v156, v157
    v_mfma_f32_32x32x16_bf16 a[32:47], v[184:187], v[196:199], a[32:47]
    v_cvt_pk_bf16_f32 v79, v158, v159
    buffer_store_dwordx4 v[76:79], v9, s[32:35], s48 offen offset:1024 sc1
    v_add_f32 v128, v128, v132
    v_add_f32 v129, v129, v133
    v_add_f32 v130, v130, v134
    v_add_f32 v131, v131, v135
    v_mfma_f32_32x32x16_bf16 a[48:63], v[188:191], v[196:199], a[48:63]
    v_add_f32 v128, v128, v136
    v_add_f32 v129, v129, v137
    v_add_f32 v130, v130, v138
    v_add_f32 v131, v131, v139
    v_add_f32 v128, v128, v140
    v_add_f32 v129, v129, v141
    s_waitcnt vmcnt(6)
    v_mfma_f32_32x32x16_bf16 a[32:47], v[208:211], v[220:223], a[32:47]
    v_add_f32 v130, v130, v142
    v_add_f32 v131, v131, v143
    v_add_f32 v128, v128, v144
    v_add_f32 v129, v129, v145
    v_add_f32 v130, v130, v146
    v_add_f32 v131, v131, v147
    v_mfma_f32_32x32x16_bf16 a[48:63], v[212:215], v[220:223], a[48:63]
    v_add_f32 v128, v128, v148
    v_add_f32 v129, v129, v149
    v_add_f32 v130, v130, v150
    v_add_f32 v131, v131, v151
    v_add_f32 v128, v128, v152
    v_add_f32 v129, v129, v153
    v_mfma_f32_32x32x16_bf16 a[64:79], a[128:131], a[144:147], a[64:79]
    v_add_f32 v130, v130, v154
    v_add_f32 v131, v131, v155
    v_add_f32 v128, v128, v156
    v_add_f32 v129, v129, v157
    v_add_f32 v130, v130, v158
    v_add_f32 v131, v131, v159
    v_mfma_f32_32x32x16_bf16 a[80:95], a[132:135], a[144:147], a[80:95]
    v_add_f32 v128, v128, v129
    v_add_f32 v130, v130, v131
    v_max_f32 v16, v160, v164
    v_add_f32 v128, v128, v130
    v_fmac_f32 v16, 0, v128
    v_cmp_nge_f32 vcc, 0x53800000, v16
    v_mfma_f32_32x32x16_bf16 a[64:79], a[152:155], a[168:171], a[64:79]
    v_mfma_f32_32x32x16_bf16 a[80:95], a[156:159], a[168:171], a[80:95]
    v_mfma_f32_32x32x16_bf16 a[64:79], a[176:179], a[192:195], a[64:79]
    s_cbranch_vccnz L_p2_fallback
L_p2_ok:
    v_and_b32 v24, 0xc00, v4
    v_lshl_add_u32 v24, v24, 2, v9
    v_add_u32 v24, 131072, v24
    s_nop 0
    v_and_b32 v25, 0xc00, v5
    v_lshl_add_u32 v25, v25, 2, v9
    v_add_u32 v25, 131072, v25
    v_mfma_f32_32x32x16_bf16 a[80:95], a[180:183], a[192:195], a[80:95]
    v_and_b32 v26, 0xc00, v6
    v_lshl_add_u32 v26, v26, 2, v9
    v_add_u32 v26, 131072, v26
    v_and_b32 v27, 0xc00, v7
    v_lshl_add_u32 v27, v27, 2, v9
    v_add_u32 v27, 131072, v27
    v_mfma_f32_32x32x16_bf16 a[64:79], a[200:203], a[216:219], a[64:79]
    v_mov_b32 v10, 1
    v_lshlrev_b32 v30, 7, v0
    s_waitcnt lgkmcnt(0)
    s_barrier
    v_mfma_f32_32x32x16_bf16 a[80:95], a[204:207], a[216:219], a[80:95]
    ds_write_b128 v25, a[32:35] offset:0
    v_lshlrev_b32_e64 v128, 16, v168
    v_and_b32 v132, 0xffff0000, v168
    v_lshlrev_b32 v144, 16, v169
    v_and_b32 v148, 0xffff0000, v169
    v_mfma_f32_32x32x16_bf16 a[64:79], a[224:227], a[240:243], a[64:79]
    v_lshlrev_b32 v129, 16, v170
    v_and_b32 v133, 0xffff0000, v170
    v_lshlrev_b32 v145, 16, v171
    v_and_b32 v149, 0xffff0000, v171
    v_lshlrev_b32 v130, 16, v172
    v_mfma_f32_32x32x16_bf16 a[80:95], a[228:231], a[240:243], a[80:95]
    ds_write_b128 v25, a[36:39] offset:1024
    v_and_b32 v134, 0xffff0000, v172
    v_lshlrev_b32 v146, 16, v173
    v_and_b32 v150, 0xffff0000, v173
    v_lshlrev_b32 v131, 16, v174
    v_mfma_f32_32x32x16_bf16 a[64:79], v[184:187], v[200:203], a[64:79]
    v_and_b32 v135, 0xffff0000, v174
    v_lshlrev_b32 v147, 16, v175
    v_and_b32 v151, 0xffff0000, v175
    v_lshlrev_b32 v136, 16, v176
    v_and_b32 v140, 0xffff0000, v176
    v_mfma_f32_32x32x16_bf16 a[80:95], v[188:191], v[200:203], a[80:95]
    ds_write_b128 v25, a[40:43] offset:2048
    v_lshlrev_b32_e64 v152, 16, v177
    v_and_b32 v156, 0xffff0000, v177
    v_lshlrev_b32 v137, 16, v178
    v_and_b32 v141, 0xffff0000, v178
    s_waitcnt vmcnt(5)
    v_mfma_f32_32x32x16_bf16 a[64:79], v[208:211], v[224:227], a[64:79]
    s_waitcnt vmcnt(0)
    s_mov_b64 exec, 0xffff
    buffer_store_dword v10, v30, s[32:35], s44 offen sc1
    s_mov_b64 exec, -1
    v_lshlrev_b32_e64 v153, 16, v179
    v_and_b32 v157, 0xffff0000, v179
    v_lshlrev_b32 v138, 16, v180
    v_and_b32 v142, 0xffff0000, v180
    v_lshlrev_b32 v154, 16, v181
    v_mfma_f32_32x32x16_bf16 a[80:95], v[212:215], v[224:227], a[80:95]
    s_cmp_eq_u32 s52, 0
    s_cbranch_scc1 L_p2_acq0
L_p2_got0:
    ds_write_b128 v25, a[44:47] offset:3072
    v_and_b32 v158, 0xffff0000, v181
    v_lshlrev_b32_e64 v139, 16, v182
    v_and_b32 v143, 0xffff0000, v182
    v_mfma_f32_32x32x16_bf16 a[96:111], a[128:131], a[148:151], a[96:111]
    s_ff1_i32_b32 s56, s52
    s_bitset0_b32 s52, s56
    s_bitset1_b32 s53, s56
    s_add_u32 s56, s56, s46
    v_lshlrev_b32 v155, 16, v183
    v_and_b32 v159, 0xffff0000, v183
    v_mfma_f32_32x32x16_bf16 a[112:127], a[132:135], a[148:151], a[112:127]
    s_and_b32 s56, s56, 28
    s_lshl_b32 s62, s56, 12
    s_lshl_b32 s56, s56, 13
    s_add_u32 s55, s56, 917504
    s_cmp_eq_u32 s52, 0
    s_cselect_b32 s57, s45, 2.0
    buffer_load_dword v1, v11, s[32:35], s57 offen sc1
    v_mfma_f32_32x32x16_bf16 a[96:111], a[152:155], a[172:175], a[96:111]
    buffer_load_dwordx4 v[232:235], v4, s[16:19], s55 offen sc1
    v_mfma_f32_32x32x16_bf16 a[112:127], a[156:159], a[172:175], a[112:127]
    s_add_u32 s55, s55, 4096
    s_waitcnt lgkmcnt(0)
    s_barrier
    v_mfma_f32_32x32x16_bf16 a[96:111], a[176:179], a[196:199], a[96:111]
    buffer_load_dwordx4 v[236:239], v4, s[16:19], s55 offen sc1
    ds_write_b128 v25, a[48:51] offset:16384
    v_mfma_f32_32x32x16_bf16 a[112:127], a[180:183], a[196:199], a[112:127]
    ds_read_b128 v[32:35], v24 offset:0
    s_add_u32 s55, s55, 4096
    v_mfma_f32_32x32x16_bf16 a[96:111], a[200:203], a[220:223], a[96:111]
    buffer_load_dwordx4 v[240:243], v4, s[16:19], s55 offen sc1
    ds_write_b128 v25, a[52:55] offset:17408
    v_mfma_f32_32x32x16_bf16 a[112:127], a[204:207], a[220:223], a[112:127]
    ds_read_b128 v[36:39], v24 offset:1024
    s_add_u32 s55, s55, 4096
    v_mfma_f32_32x32x16_bf16 a[96:111], a[224:227], a[244:247], a[96:111]
    buffer_load_dwordx4 v[244:247], v4, s[16:19], s55 offen sc1
    ds_write_b128 v25, a[56:59] offset:18432
    v_mfma_f32_32x32x16_bf16 a[112:127], a[228:231], a[244:247], a[112:127]
    ds_read_b128 v[40:43], v24 offset:2048
    s_add_u32 s55, s55, 4096
    v_mfma_f32_32x32x16_bf16 a[96:111], v[184:187], v[204:207], a[96:111]
    buffer_load_dwordx4 v[248:251], v4, s[16:19], s55 offen sc1
    ds_write_b128 v25, a[60:63] offset:19456
    v_mfma_f32_32x32x16_bf16 a[112:127], v[188:191], v[204:207], a[112:127]
    ds_read_b128 v[44:47], v24 offset:3072
    s_add_u32 s55, s55, 4096
    v_mfma_f32_32x32x16_bf16 a[96:111], v[208:211], v[228:231], a[96:111]
    buffer_load_dwordx4 v[252:255], v4, s[16:19], s55 offen sc1
    v_mfma_f32_32x32x16_bf16 a[112:127], v[212:215], v[228:231], a[112:127]
    s_add_u32 s55, s55, 4096
    v_mfma_f32_32x32x16_bf16 a[0:15], a[128:131], a[136:139], a[0:15]
    buffer_load_dwordx4 a[248:251], v4, s[16:19], s55 offen sc1
    s_waitcnt lgkmcnt(0)
    s_barrier
    v_mfma_f32_32x32x16_bf16 a[16:31], a[132:135], a[136:139], a[16:31]
    s_add_u32 s55, s55, 4096
    ds_write_b128 v26, a[64:67] offset:0
    v_add_f32 v128, v128, v32
    v_add_f32 v129, v129, v33
    v_add_f32 v130, v130, v34
    v_add_f32 v131, v131, v35
    v_mfma_f32_32x32x16_bf16 a[0:15], a[152:155], a[160:163], a[0:15]
    ds_read_b128 v[48:51], v24 offset:16384
    buffer_load_dwordx4 a[252:255], v4, s[16:19], s55 offen sc1
    s_cmp_eq_u32 s52, 0
    s_cbranch_scc1 L_p2_acq1
L_p2_got1:
    v_add_f32 v132, v132, v36
    v_add_f32 v133, v133, v37
    v_mfma_f32_32x32x16_bf16 a[16:31], a[156:159], a[160:163], a[16:31]
    s_ff1_i32_b32 s56, s52
    s_bitset0_b32 s52, s56
    s_bitset1_b32 s53, s56
    s_add_u32 s56, s56, s46
    ds_write_b128 v26, a[68:71] offset:1024
    v_add_f32 v134, v134, v38
    v_add_f32 v135, v135, v39
    v_add_f32 v136, v136, v40
    v_add_f32 v137, v137, v41
    v_mfma_f32_32x32x16_bf16 a[0:15], a[176:179], a[184:187], a[0:15]
    ds_read_b128 v[52:55], v24 offset:17408
    s_and_b32 s56, s56, 28
    s_lshl_b32 s63, s56, 12
    s_lshl_b32 s56, s56, 13
    s_add_u32 s55, s56, 917504
    s_cmp_eq_u32 s52, 0
    s_cselect_b32 s57, s45, 2.0
    buffer_load_dword v1, v11, s[32:35], s57 offen sc1
    v_add_f32 v138, v138, v42
    v_add_f32 v139, v139, v43
    v_add_f32 v140, v140, v44
    v_mfma_f32_32x32x16_bf16 a[16:31], a[180:183], a[184:187], a[16:31]
    buffer_load_dwordx4 a[140:143], v4, s[16:19], s55 offen sc1
    ds_write_b128 v26, a[72:75] offset:2048
    v_add_f32 v141, v141, v45
    v_add_f32 v142, v142, v46
    v_add_f32_e64 v143, v143, v47
    v_mfma_f32_32x32x16_bf16 a[0:15], a[200:203], a[208:211], a[0:15]
    ds_read_b128 v[56:59], v24 offset:18432
    v_add_u32_e64 v28, s62, v9
    s_add_u32 s55, s55, 4096
    v_mfma_f32_32x32x16_bf16 a[16:31], a[204:207], a[208:211], a[16:31]
    buffer_load_dwordx4 a[164:167], v4, s[16:19], s55 offen sc1
    ds_write_b128 v26, a[76:79] offset:3072
    v_mfma_f32_32x32x16_bf16 a[0:15], a[224:227], a[232:235], a[0:15]
    ds_read_b128 v[60:63], v24 offset:19456
    ds_read_b128 v[64:67], v28 offset:0
    s_add_u32 s55, s55, 4096
    v_mfma_f32_32x32x16_bf16 a[16:31], a[228:231], a[232:235], a[16:31]
    ds_read_b128 v[68:71], v28 offset:1024
    buffer_load_dwordx4 a[188:191], v4, s[16:19], s55 offen sc1
    v_mfma_f32_32x32x16_bf16 a[0:15], v[184:187], v[192:195], a[0:15]
    ds_read_b128 v[72:75], v28 offset:2048
    s_add_u32 s55, s55, 4096
    v_mfma_f32_32x32x16_bf16 a[16:31], v[188:191], v[192:195], a[16:31]
    ds_read_b128 v[76:79], v28 offset:3072
    buffer_load_dwordx4 a[212:215], v4, s[16:19], s55 offen sc1
    s_waitcnt lgkmcnt(4)
    s_barrier
    v_mfma_f32_32x32x16_bf16 a[0:15], v[208:211], v[216:219], a[0:15]
    ds_read_b128 v[80:83], v28 offset:4096
    s_add_u32 s55, s55, 4096
    ds_write_b128 v26, a[80:83] offset:16384
    v_add_f32 v144, v144, v48
    v_add_f32 v145, v145, v49
    v_add_f32_e64 v146, v146, v50
    v_mfma_f32_32x32x16_bf16 a[16:31], v[212:215], v[216:219], a[16:31]
    ds_read_b128 v[32:35], v24 offset:0
    ds_read_b128 v[84:87], v28 offset:5120
    buffer_load_dwordx4 a[236:239], v4, s[16:19], s55 offen sc1
    v_add_f32 v147, v147, v51
    v_add_f32 v148, v148, v52
    s_waitcnt vmcnt(13) lgkmcnt(7)
    v_mfma_f32_32x32x16_bf16 v[96:111], v[64:67], v[232:235], 0
    ds_read_b128 v[88:91], v28 offset:6144
    s_add_u32 s55, s55, 4096
    v_add_f32 v149, v149, v53
    v_add_f32 v150, v150, v54
    v_add_f32 v151, v151, v55
    v_add_f32 v152, v152, v56
    s_waitcnt lgkmcnt(7)
    v_mfma_f32_32x32x16_bf16 v[112:127], v[68:71], v[232:235], 0
    ds_read_b128 v[92:95], v28 offset:7168
    buffer_load_dwordx4 v[196:199], v4, s[16:19], s55 offen sc1
    v_add_f32 v153, v153, v57
    v_add_f32 v154, v154, v58
    v_add_f32 v155, v155, v59
    s_waitcnt vmcnt(13) lgkmcnt(7)
    v_mfma_f32_32x32x16_bf16 v[96:111], v[72:75], v[236:239], v[96:111]
    ds_read_b128 v[64:67], v28 offset:8192
    s_add_u32 s55, s55, 4096
    v_add_f32 v156, v156, v60
    v_add_f32 v157, v157, v61
    v_add_f32_e64 v158, v158, v62
    v_add_f32 v159, v159, v63
    s_waitcnt lgkmcnt(7)
    v_mfma_f32_32x32x16_bf16 v[112:127], v[76:79], v[236:239], v[112:127]
    ds_read_b128 v[68:71], v28 offset:9216
    buffer_load_dwordx4 v[220:223], v4, s[16:19], s55 offen sc1
    s_waitcnt vmcnt(13) lgkmcnt(7)
    v_mfma_f32_32x32x16_bf16 v[96:111], v[80:83], v[240:243], v[96:111]
    ds_read_b128 v[72:75], v28 offset:10240
    s_add_u32 s55, s55, 4096
    s_waitcnt lgkmcnt(5)
    v_mfma_f32_32x32x16_bf16 v[112:127], v[84:87], v[240:243], v[112:127]
    ds_read_b128 v[76:79], v28 offset:11264
    buffer_load_dwordx4 a[144:147], v4, s[16:19], s55 offen sc1
    s_cmp_eq_u32 s52, 0
    s_cbranch_scc1 L_p2_acq2
L_p2_got2:
    s_waitcnt vmcnt(13) lgkmcnt(5)
    v_mfma_f32_32x32x16_bf16 v[96:111], v[88:91], v[244:247], v[96:111]
    ds_read_b128 v[80:83], v28 offset:12288
    s_ff1_i32_b32 s56, s52
    s_bitset0_b32 s52, s56
    s_bitset1_b32 s53, s56
    s_add_u32 s56, s56, s46
    ds_write_b128 v26, a[84:87] offset:17408
    s_waitcnt lgkmcnt(6)
    v_mfma_f32_32x32x16_bf16 v[112:127], v[92:95], v[244:247], v[112:127]
    ds_read_b128 v[36:39], v24 offset:1024
    ds_read_b128 v[84:87], v28 offset:13312
    s_and_b32 s56, s56, 28
    s_lshl_b32 s64, s56, 12
    s_lshl_b32 s56, s56, 13
    s_add_u32 s55, s56, 917504
    s_cmp_eq_u32 s52, 0
    s_cselect_b32 s57, s45, 2.0
    buffer_load_dword v1, v11, s[32:35], s57 offen sc1
    s_waitcnt vmcnt(13) lgkmcnt(7)
    v_mfma_f32_32x32x16_bf16 v[96:111], v[64:67], v[248:251], v[96:111]
    ds_read_b128 v[88:91], v28 offset:14336
    v_add_u32 v29, s63, v9
    buffer_load_dwordx4 a[168:171], v4, s[16:19], s55 offen sc1
    s_waitcnt lgkmcnt(7)
    v_mfma_f32_32x32x16_bf16 v[112:127], v[68:71], v[248:251], v[112:127]
    ds_read_b128 v[92:95], v28 offset:15360
    s_add_u32 s55, s55, 4096
    s_waitcnt vmcnt(13) lgkmcnt(7)
    v_mfma_f32_32x32x16_bf16 v[96:111], v[72:75], v[252:255], v[96:111]
    ds_read_b128 v[64:67], v29 offset:0
    buffer_load_dwordx4 a[192:195], v4, s[16:19], s55 offen sc1
    s_waitcnt lgkmcnt(7)
    v_mfma_f32_32x32x16_bf16 v[112:127], v[76:79], v[252:255], v[112:127]
    ds_read_b128 v[68:71], v29 offset:1024
    s_add_u32 s55, s55, 4096
    s_waitcnt vmcnt(13) lgkmcnt(7)
    v_mfma_f32_32x32x16_bf16 v[96:111], v[80:83], a[248:251], v[96:111]
    ds_read_b128 v[72:75], v29 offset:2048
    buffer_load_dwordx4 a[216:219], v4, s[16:19], s55 offen sc1
    s_waitcnt lgkmcnt(5)
    v_mfma_f32_32x32x16_bf16 v[112:127], v[84:87], a[248:251], v[112:127]
    ds_read_b128 v[76:79], v29 offset:3072
    s_add_u32 s55, s55, 4096
    s_waitcnt vmcnt(13) lgkmcnt(5)
    v_mfma_f32_32x32x16_bf16 v[96:111], v[88:91], a[252:255], v[96:111]
    ds_read_b128 v[80:83], v29 offset:4096
    buffer_load_dwordx4 a[240:243], v4, s[16:19], s55 offen sc1
    ds_write_b128 v26, a[88:91] offset:18432
    s_waitcnt lgkmcnt(6)
    v_mfma_f32_32x32x16_bf16 v[112:127], v[92:95], a[252:255], v[112:127]
    ds_read_b128 v[40:43], v24 offset:2048
    ds_read_b128 v[84:87], v29 offset:5120
    s_add_u32 s55, s55, 4096
    s_waitcnt vmcnt(12) lgkmcnt(7)
    v_mfma_f32_32x32x16_bf16 v[96:111], v[64:67], a[140:143], v[96:111]
    ds_read_b128 v[88:91], v29 offset:6144
    buffer_load_dwordx4 v[200:203], v4, s[16:19], s55 offen sc1
    s_waitcnt lgkmcnt(7)
    v_mfma_f32_32x32x16_bf16 v[112:127], v[68:71], a[140:143], v[112:127]
    ds_read_b128 v[92:95], v29 offset:7168
    s_add_u32 s55, s55, 4096
    s_waitcnt vmcnt(12) lgkmcnt(7)
    v_mfma_f32_32x32x16_bf16 v[96:111], v[72:75], a[164:167], v[96:111]
    ds_read_b128 v[64:67], v29 offset:8192
    buffer_load_dwordx4 v[224:227], v4, s[16:19], s55 offen sc1
    s_waitcnt lgkmcnt(7)
    v_mfma_f32_32x32x16_bf16 v[112:127], v[76:79], a[164:167], v[112:127]
    ds_read_b128 v[68:71], v29 offset:9216
    s_add_u32 s55, s55, 4096
    s_waitcnt vmcnt(12) lgkmcnt(7)
    v_mfma_f32_32x32x16_bf16 v[96:111], v[80:83], a[188:191], v[96:111]
    ds_read_b128 v[72:75], v29 offset:10240
    buffer_load_dwordx4 a[148:151], v4, s[16:19], s55 offen sc1
    s_waitcnt lgkmcnt(5)
    v_mfma_f32_32x32x16_bf16 v[112:127], v[84:87], a[188:191], v[112:127]
    ds_read_b128 v[76:79], v29 offset:11264
    s_add_u32 s55, s55, 4096
    s_waitcnt vmcnt(12) lgkmcnt(5)
    v_mfma_f32_32x32x16_bf16 v[96:111], v[88:91], a[212:215], v[96:111]
    ds_read_b128 v[80:83], v29 offset:12288
    buffer_load_dwordx4 a[172:175], v4, s[16:19], s55 offen sc1
    s_cmp_eq_u32 s52, 0
    s_cbranch_scc1 L_p2_acq3
L_p2_got3:
    ds_write_b128 v26, a[92:95] offset:19456
    s_waitcnt lgkmcnt(6)
    v_mfma_f32_32x32x16_bf16 v[112:127], v[92:95], a[212:215], v[112:127]
    ds_read_b128 v[44:47], v24 offset:3072
    ds_read_b128 v[84:87], v29 offset:13312
    s_ff1_i32_b32 s56, s52
    s_bitset0_b32 s52, s56
    s_bitset1_b32 s53, s56
    s_add_u32 s56, s56, s46
    s_waitcnt vmcnt(12) lgkmcnt(7)
    v_mfma_f32_32x32x16_bf16 v[96:111], v[64:67], a[236:239], v[96:111]
    ds_read_b128 v[88:91], v29 offset:14336
    v_add_u32_e64 v28, s64, v9
    s_and_b32 s56, s56, 28
    s_lshl_b32 s65, s56, 12
    s_lshl_b32 s56, s56, 13
    s_add_u32 s55, s56, 917504
    s_cmp_eq_u32 s52, 0
    s_cselect_b32 s57, s45, 2.0
    buffer_load_dword v1, v11, s[32:35], s57 offen sc1
    s_waitcnt lgkmcnt(7)
    v_mfma_f32_32x32x16_bf16 v[112:127], v[68:71], a[236:239], v[112:127]
    ds_read_b128 v[92:95], v29 offset:15360
    buffer_load_dwordx4 a[196:199], v4, s[16:19], s55 offen sc1
    s_waitcnt lgkmcnt(3)
    s_barrier
    s_waitcnt vmcnt(13)
    v_mfma_f32_32x32x16_bf16 v[96:111], v[72:75], v[196:199], v[96:111]
    ds_read_b128 v[64:67], v28 offset:0
    s_add_u32 s55, s55, 4096
    ds_write_b128 v27, a[96:99] offset:0
    v_add_f32 v128, v128, v32
    v_add_f32 v129, v129, v33
    v_add_f32_e64 v130, v130, v34
    v_mfma_f32_32x32x16_bf16 v[112:127], v[76:79], v[196:199], v[112:127]
    ds_read_b128 v[48:51], v24 offset:16384
    ds_read_b128 v[68:71], v28 offset:1024
    buffer_load_dwordx4 a[220:223], v4, s[16:19], s55 offen sc1
    v_add_f32 v131, v131, v35
    v_add_f32 v132, v132, v36
    s_waitcnt vmcnt(13)
    v_mfma_f32_32x32x16_bf16 v[96:111], v[80:83], v[220:223], v[96:111]
    ds_read_b128 v[72:75], v28 offset:2048
    s_add_u32 s55, s55, 4096
    v_add_f32 v133, v133, v37
    v_add_f32 v134, v134, v38
    v_add_f32 v135, v135, v39
    v_add_f32 v136, v136, v40
    s_waitcnt lgkmcnt(7)
    v_mfma_f32_32x32x16_bf16 v[112:127], v[84:87], v[220:223], v[112:127]
    ds_read_b128 v[76:79], v28 offset:3072
    buffer_load_dwordx4 a[244:247], v4, s[16:19], s55 offen sc1
    v_add_f32 v137, v137, v41
    v_add_f32 v138, v138, v42
    v_add_f32 v139, v139, v43
    s_waitcnt vmcnt(13) lgkmcnt(7)
    v_mfma_f32_32x32x16_bf16 v[96:111], v[88:91], a[144:147], v[96:111]
    ds_read_b128 v[80:83], v28 offset:4096
    s_add_u32 s55, s55, 4096
    v_add_f32 v140, v140, v44
    v_add_f32 v141, v141, v45
    v_add_f32_e64 v142, v142, v46
    v_add_f32 v143, v143, v47
    s_waitcnt lgkmcnt(7)
    v_mfma_f32_32x32x16_bf16 v[112:127], v[92:95], a[144:147], v[112:127]
    ds_read_b128 v[84:87], v28 offset:5120
    buffer_load_dwordx4 v[204:207], v4, s[16:19], s55 offen sc1
    s_waitcnt vmcnt(12) lgkmcnt(7)
    v_mfma_f32_32x32x16_bf16 v[96:111], v[64:67], a[168:171], v[96:111]
    ds_read_b128 v[88:91], v28 offset:6144
    s_add_u32 s55, s55, 4096
    s_waitcnt lgkmcnt(5)
    v_mfma_f32_32x32x16_bf16 v[112:127], v[68:71], a[168:171], v[112:127]
    ds_read_b128 v[92:95], v28 offset:7168
    buffer_load_dwordx4 v[228:231], v4, s[16:19], s55 offen sc1
    s_waitcnt vmcnt(12) lgkmcnt(5)
    v_mfma_f32_32x32x16_bf16 v[96:111], v[72:75], a[192:195], v[96:111]
    ds_read_b128 v[64:67], v28 offset:8192
    s_add_u32 s55, s55, 4096
    ds_write_b128 v27, a[100:103] offset:1024
    s_waitcnt lgkmcnt(6)
    v_mfma_f32_32x32x16_bf16 v[112:127], v[76:79], a[192:195], v[112:127]
    ds_read_b128 v[52:55], v24 offset:17408
    ds_read_b128 v[68:71], v28 offset:9216
    buffer_load_dwordx4 a[136:139], v4, s[16:19], s55 offen sc1
    s_waitcnt vmcnt(12) lgkmcnt(7)
    v_mfma_f32_32x32x16_bf16 v[96:111], v[80:83], a[216:219], v[96:111]
    ds_read_b128 v[72:75], v28 offset:10240
    s_add_u32 s55, s55, 4096
    s_waitcnt lgkmcnt(7)
    v_mfma_f32_32x32x16_bf16 v[112:127], v[84:87], a[216:219], v[112:127]
    ds_read_b128 v[76:79], v28 offset:11264
    buffer_load_dwordx4 a[160:163], v4, s[16:19], s55 offen sc1
    s_waitcnt vmcnt(12) lgkmcnt(7)
    v_mfma_f32_32x32x16_bf16 v[96:111], v[88:91], a[240:243], v[96:111]
    ds_read_b128 v[80:83], v28 offset:12288
    s_add_u32 s55, s55, 4096
    s_waitcnt lgkmcnt(7)
    v_mfma_f32_32x32x16_bf16 v[112:127], v[92:95], a[240:243], v[112:127]
    ds_read_b128 v[84:87], v28 offset:13312
    s_nop 0
    buffer_load_dwordx4 a[184:187], v4, s[16:19], s55 offen sc1
    s_cmp_eq_u32 s52, 0
    s_cbranch_scc1 L_p2_acq4
L_p2_got4:
    s_waitcnt vmcnt(12) lgkmcnt(7)
    v_mfma_f32_32x32x16_bf16 v[96:111], v[64:67], v[200:203], v[96:111]
    ds_read_b128 v[88:91], v28 offset:14336
    v_add_u32 v29, s65, v9
    s_ff1_i32_b32 s56, s52
    s_bitset0_b32 s52, s56
    s_bitset1_b32 s53, s56
    s_add_u32 s56, s56, s46
    s_waitcnt lgkmcnt(5)
    v_mfma_f32_32x32x16_bf16 v[112:127], v[68:71], v[200:203], v[112:127]
    ds_read_b128 v[92:95], v28 offset:15360
    s_and_b32 s56, s56, 28
    s_lshl_b32 s66, s56, 12
    s_lshl_b32 s56, s56, 13
    s_add_u32 s55, s56, 917504
    s_cmp_eq_u32 s52, 0
    s_cselect_b32 s57, s45, 2.0
    buffer_load_dword v1, v11, s[32:35], s57 offen sc1
    s_waitcnt vmcnt(12) lgkmcnt(5)
    v_mfma_f32_32x32x16_bf16 v[96:111], v[72:75], v[224:227], v[96:111]
    ds_read_b128 v[64:67], v29 offset:0
    buffer_load_dwordx4 a[208:211], v4, s[16:19], s55 offen sc1
    ds_write_b128 v27, a[104:107] offset:2048
    s_waitcnt lgkmcnt(6)
    v_mfma_f32_32x32x16_bf16 v[112:127], v[76:79], v[224:227], v[112:127]
    ds_read_b128 v[56:59], v24 offset:18432
    ds_read_b128 v[68:71], v29 offset:1024
    s_add_u32 s55, s55, 4096
    s_waitcnt vmcnt(12) lgkmcnt(7)
    v_mfma_f32_32x32x16_bf16 v[96:111], v[80:83], a[148:151], v[96:111]
    ds_read_b128 v[72:75], v29 offset:2048
    buffer_load_dwordx4 a[232:235], v4, s[16:19], s55 offen sc1
    s_waitcnt lgkmcnt(7)
    v_mfma_f32_32x32x16_bf16 v[112:127], v[84:87], a[148:151], v[112:127]
    ds_read_b128 v[76:79], v29 offset:3072
    s_add_u32 s55, s55, 4096
    s_waitcnt vmcnt(12) lgkmcnt(7)
    v_mfma_f32_32x32x16_bf16 v[96:111], v[88:91], a[172:175], v[96:111]
    ds_read_b128 v[80:83], v29 offset:4096
    buffer_load_dwordx4 v[192:195], v4, s[16:19], s55 offen sc1
    s_waitcnt lgkmcnt(7)
    v_mfma_f32_32x32x16_bf16 v[112:127], v[92:95], a[172:175], v[112:127]
    ds_read_b128 v[84:87], v29 offset:5120
    s_add_u32 s55, s55, 4096
    s_waitcnt vmcnt(11) lgkmcnt(7)
    v_mfma_f32_32x32x16_bf16 v[96:111], v[64:67], a[196:199], v[96:111]
    ds_read_b128 v[88:91], v29 offset:6144
    buffer_load_dwordx4 v[216:219], v4, s[16:19], s55 offen sc1
    s_waitcnt lgkmcnt(5)
    s_nop 0
    v_mfma_f32_32x32x16_bf16 v[112:127], v[68:71], a[196:199], v[112:127]
    ds_read_b128 v[92:95], v29 offset:7168
    s_add_u32 s55, s55, 4096
    s_waitcnt vmcnt(11) lgkmcnt(5)
    v_mfma_f32_32x32x16_bf16 v[96:111], v[72:75], a[220:223], v[96:111]
    s_nop 0
    ds_read_b128 v[64:67], v29 offset:8192
    buffer_load_dwordx4 a[128:131], v4, s[16:19], s55 offen sc1
    s_nop 0
    ds_write_b128 v27, a[108:111] offset:3072
    s_waitcnt lgkmcnt(6)
    v_mfma_f32_32x32x16_bf16 v[112:127], v[76:79], a[220:223], v[112:127]
    ds_read_b128 v[60:63], v24 offset:19456
    ds_read_b128 v[68:71], v29 offset:9216
    s_add_u32 s55, s55, 4096
    s_waitcnt vmcnt(11) lgkmcnt(7)
    v_mfma_f32_32x32x16_bf16 v[96:111], v[80:83], a[244:247], v[96:111]
    ds_read_b128 v[72:75], v29 offset:10240
    buffer_load_dwordx4 a[132:135], v4, s[16:19], s55 offen sc1
    s_waitcnt lgkmcnt(7)
    v_mfma_f32_32x32x16_bf16 v[112:127], v[84:87], a[244:247], v[112:127]
    ds_read_b128 v[76:79], v29 offset:11264
    s_add_u32 s55, s55, 4096
    s_waitcnt lgkmcnt(3)
    s_barrier
    s_waitcnt vmcnt(11)
    v_mfma_f32_32x32x16_bf16 v[96:111], v[88:91], v[204:207], v[96:111]
    ds_read_b128 v[80:83], v29 offset:12288
    s_nop 0
    buffer_load_dwordx4 a[152:155], v4, s[16:19], s55 offen sc1
    ds_write_b128 v27, a[112:115] offset:16384
    v_add_f32 v144, v144, v48
    v_add_f32 v145, v145, v49
    v_mfma_f32_32x32x16_bf16 v[112:127], v[92:95], v[204:207], v[112:127]
    ds_read_b128 v[32:35], v24 offset:0
    ds_read_b128 v[84:87], v29 offset:13312
    s_add_u32 s55, s55, 4096
    v_add_f32 v146, v146, v50
    v_add_f32 v147, v147, v51
    v_add_f32 v148, v148, v52
    s_waitcnt vmcnt(11)
    v_mfma_f32_32x32x16_bf16 v[96:111], v[64:67], v[228:231], v[96:111]
    ds_read_b128 v[88:91], v29 offset:14336
    v_add_u32 v28, s66, v9
    buffer_load_dwordx4 a[156:159], v4, s[16:19], s55 offen sc1
    s_cmp_eq_u32 s52, 0
    s_cbranch_scc1 L_p2_acq5
L_p2_got5:
    v_add_f32 v149, v149, v53
    s_waitcnt lgkmcnt(7)
    v_mfma_f32_32x32x16_bf16 v[112:127], v[68:71], v[228:231], v[112:127]
    ds_read_b128 v[92:95], v29 offset:15360
    s_ff1_i32_b32 s56, s52
    s_bitset0_b32 s52, s56
    s_bitset1_b32 s53, s56
    s_add_u32 s56, s56, s46
    v_add_f32 v150, v150, v54
    v_add_f32_e64 v151, v151, v55
    v_add_f32_e64 v152, v152, v56
    v_add_f32_e64 v153, v153, v57
    s_waitcnt vmcnt(11) lgkmcnt(7)
    v_mfma_f32_32x32x16_bf16 v[96:111], v[72:75], a[136:139], v[96:111]
    ds_read_b128 v[64:67], v28 offset:0
    s_and_b32 s56, s56, 28
    s_lshl_b32 s67, s56, 12
    s_lshl_b32 s56, s56, 13
    s_add_u32 s55, s56, 917504
    s_cmp_eq_u32 s52, 0
    s_cselect_b32 s57, s45, 2.0
    buffer_load_dword v1, v11, s[32:35], s57 offen sc1
    v_add_f32 v154, v154, v58
    v_add_f32_e64 v155, v155, v59
    v_add_f32_e64 v156, v156, v60
    s_waitcnt lgkmcnt(7)
    v_mfma_f32_32x32x16_bf16 v[112:127], v[76:79], a[136:139], v[112:127]
    ds_read_b128 v[68:71], v28 offset:1024
    buffer_load_dwordx4 a[176:179], v4, s[16:19], s55 offen sc1
    v_add_f32_e64 v157, v157, v61
    v_add_f32_e64 v158, v158, v62
    v_add_f32 v159, v159, v63
    s_waitcnt vmcnt(12) lgkmcnt(7)
    v_mfma_f32_32x32x16_bf16 v[96:111], v[80:83], a[160:163], v[96:111]
    ds_read_b128 v[72:75], v28 offset:2048
    s_add_u32 s55, s55, 4096
    s_waitcnt lgkmcnt(5)
    v_mfma_f32_32x32x16_bf16 v[112:127], v[84:87], a[160:163], v[112:127]
    ds_read_b128 v[76:79], v28 offset:3072
    buffer_load_dwordx4 a[180:183], v4, s[16:19], s55 offen sc1
    s_waitcnt vmcnt(12) lgkmcnt(5)
    v_mfma_f32_32x32x16_bf16 v[96:111], v[88:91], a[184:187], v[96:111]
    ds_read_b128 v[80:83], v28 offset:4096
    s_add_u32 s55, s55, 4096
    ds_write_b128 v27, a[116:119] offset:17408
    s_waitcnt lgkmcnt(6)
    v_mfma_f32_32x32x16_bf16 v[112:127], v[92:95], a[184:187], v[112:127]
    ds_read_b128 v[36:39], v24 offset:1024
    ds_read_b128 v[84:87], v28 offset:5120
    buffer_load_dwordx4 a[200:203], v4, s[16:19], s55 offen sc1
    s_waitcnt vmcnt(11) lgkmcnt(7)
    v_mfma_f32_32x32x16_bf16 v[96:111], v[64:67], a[208:211], v[96:111]
    ds_read_b128 v[88:91], v28 offset:6144
    s_add_u32 s55, s55, 4096
    s_waitcnt lgkmcnt(7)
    v_mfma_f32_32x32x16_bf16 v[112:127], v[68:71], a[208:211], v[112:127]
    ds_read_b128 v[92:95], v28 offset:7168
    buffer_load_dwordx4 a[204:207], v4, s[16:19], s55 offen sc1
    s_waitcnt vmcnt(11) lgkmcnt(7)
    v_mfma_f32_32x32x16_bf16 v[96:111], v[72:75], a[232:235], v[96:111]
    ds_read_b128 v[64:67], v28 offset:8192
    s_add_u32 s55, s55, 4096
    s_waitcnt lgkmcnt(7)
    v_mfma_f32_32x32x16_bf16 v[112:127], v[76:79], a[232:235], v[112:127]
    ds_read_b128 v[68:71], v28 offset:9216
    buffer_load_dwordx4 a[224:227], v4, s[16:19], s55 offen sc1
    s_waitcnt vmcnt(11) lgkmcnt(7)
    v_mfma_f32_32x32x16_bf16 v[96:111], v[80:83], v[192:195], v[96:111]
    ds_read_b128 v[72:75], v28 offset:10240
    s_add_u32 s55, s55, 4096
    s_waitcnt lgkmcnt(5)
    s_nop 0
    v_mfma_f32_32x32x16_bf16 v[112:127], v[84:87], v[192:195], v[112:127]
    ds_read_b128 v[76:79], v28 offset:11264
    buffer_load_dwordx4 a[228:231], v4, s[16:19], s55 offen sc1
    s_waitcnt vmcnt(11) lgkmcnt(5)
    v_mfma_f32_32x32x16_bf16 v[96:111], v[88:91], v[216:219], v[96:111]
    s_nop 0
    ds_read_b128 v[80:83], v28 offset:12288
    s_add_u32 s55, s55, 4096
    s_nop 0
    ds_write_b128 v27, a[120:123] offset:18432
    s_waitcnt lgkmcnt(6)
    v_mfma_f32_32x32x16_bf16 v[112:127], v[92:95], v[216:219], v[112:127]
    ds_read_b128 v[40:43], v24 offset:2048
    ds_read_b128 v[84:87], v28 offset:13312
    buffer_load_dwordx4 v[184:187], v4, s[16:19], s55 offen sc1
    s_waitcnt vmcnt(11) lgkmcnt(7)
    v_mfma_f32_32x32x16_bf16 v[96:111], v[64:67], a[128:131], v[96:111]
    ds_read_b128 v[88:91], v28 offset:14336
    v_add_u32 v29, s67, v9
    s_add_u32 s55, s55, 4096
    s_waitcnt lgkmcnt(7)
    v_mfma_f32_32x32x16_bf16 v[112:127], v[68:71], a[128:131], v[112:127]
    ds_read_b128 v[92:95], v28 offset:15360
    buffer_load_dwordx4 v[188:191], v4, s[16:19], s55 offen sc1
    s_cmp_eq_u32 s52, 0
    s_cbranch_scc1 L_p2_acq6
L_p2_got6:
    s_waitcnt vmcnt(11) lgkmcnt(7)
    v_mfma_f32_32x32x16_bf16 v[96:111], v[72:75], a[132:135], v[96:111]
    ds_read_b128 v[64:67], v29 offset:0
    s_ff1_i32_b32 s56, s52
    s_bitset0_b32 s52, s56
    s_bitset1_b32 s53, s56
    s_add_u32 s56, s56, s46
    s_waitcnt lgkmcnt(7)
    v_mfma_f32_32x32x16_bf16 v[112:127], v[76:79], a[132:135], v[112:127]
    ds_read_b128 v[68:71], v29 offset:1024
    s_and_b32 s56, s56, 28
    s_lshl_b32 s62, s56, 12
    s_lshl_b32 s56, s56, 13
    s_add_u32 s55, s56, 917504
    s_cmp_eq_u32 s52, 0
    s_cselect_b32 s57, s45, 2.0
    buffer_load_dword v1, v11, s[32:35], s57 offen sc1
    s_waitcnt vmcnt(11) lgkmcnt(7)
    v_mfma_f32_32x32x16_bf16 v[96:111], v[80:83], a[152:155], v[96:111]
    ds_read_b128 v[72:75], v29 offset:2048
    buffer_load_dwordx4 v[232:235], v4, s[16:19], s55 offen sc1
    s_waitcnt lgkmcnt(5)
    v_mfma_f32_32x32x16_bf16 v[112:127], v[84:87], a[152:155], v[112:127]
    ds_read_b128 v[76:79], v29 offset:3072
    s_add_u32 s55, s55, 4096
    s_waitcnt vmcnt(11) lgkmcnt(5)
    v_mfma_f32_32x32x16_bf16 v[96:111], v[88:91], a[156:159], v[96:111]
    ds_read_b128 v[80:83], v29 offset:4096
    buffer_load_dwordx4 v[236:239], v4, s[16:19], s55 offen sc1
    ds_write_b128 v27, a[124:127] offset:19456
    s_waitcnt lgkmcnt(6)
    v_mfma_f32_32x32x16_bf16 v[112:127], v[92:95], a[156:159], v[112:127]
    ds_read_b128 v[44:47], v24 offset:3072
    ds_read_b128 v[84:87], v29 offset:5120
    s_add_u32 s55, s55, 4096
    s_waitcnt vmcnt(10) lgkmcnt(7)
    v_mfma_f32_32x32x16_bf16 v[96:111], v[64:67], a[176:179], v[96:111]
    ds_read_b128 v[88:91], v29 offset:6144
    buffer_load_dwordx4 v[240:243], v4, s[16:19], s55 offen sc1
    s_waitcnt lgkmcnt(7)
    v_mfma_f32_32x32x16_bf16 v[112:127], v[68:71], a[176:179], v[112:127]
    ds_read_b128 v[92:95], v29 offset:7168
    s_add_u32 s55, s55, 4096
    s_waitcnt lgkmcnt(3)
    s_barrier
    s_waitcnt vmcnt(10)
    v_mfma_f32_32x32x16_bf16 v[96:111], v[72:75], a[180:183], v[96:111]
    ds_read_b128 v[64:67], v29 offset:8192
    buffer_load_dwordx4 v[244:247], v4, s[16:19], s55 offen sc1
    v_add_f32 v128, v128, v32
    v_add_f32 v129, v129, v33
    v_add_f32 v130, v130, v34
    v_mfma_f32_32x32x16_bf16 v[112:127], v[76:79], a[180:183], v[112:127]
    ds_read_b128 v[48:51], v24 offset:16384
    ds_read_b128 v[68:71], v29 offset:9216
    s_add_u32 s55, s55, 4096
    v_add_f32 v131, v131, v35
    v_add_f32 v132, v132, v36
    v_add_f32 v133, v133, v37
    s_waitcnt vmcnt(10)
    v_mfma_f32_32x32x16_bf16 v[96:111], v[80:83], a[200:203], v[96:111]
    ds_read_b128 v[72:75], v29 offset:10240
    buffer_load_dwordx4 v[248:251], v4, s[16:19], s55 offen sc1
    v_add_f32 v134, v134, v38
    v_add_f32 v135, v135, v39
    v_add_f32 v136, v136, v40
    s_waitcnt lgkmcnt(6)
    v_mfma_f32_32x32x16_bf16 v[112:127], v[84:87], a[200:203], v[112:127]
    ds_read_b128 v[76:79], v29 offset:11264
    s_add_u32 s55, s55, 4096
    v_add_f32 v137, v137, v41
    v_add_f32 v138, v138, v42
    v_add_f32 v139, v139, v43
    v_add_f32_e64 v140, v140, v44
    s_waitcnt vmcnt(10) lgkmcnt(6)
    v_mfma_f32_32x32x16_bf16 v[96:111], v[88:91], a[204:207], v[96:111]
    ds_read_b128 v[52:55], v24 offset:17408
    ds_read_b128 v[80:83], v29 offset:12288
    buffer_load_dwordx4 v[252:255], v4, s[16:19], s55 offen sc1
    v_add_f32 v141, v141, v45
    v_add_f32_e64 v142, v142, v46
    s_waitcnt lgkmcnt(7)
    v_mfma_f32_32x32x16_bf16 v[112:127], v[92:95], a[204:207], v[112:127]
    ds_read_b128 v[84:87], v29 offset:13312
    s_add_u32 s55, s55, 4096
    v_add_f32 v143, v143, v47
    s_waitcnt vmcnt(10) lgkmcnt(7)
    v_mfma_f32_32x32x16_bf16 v[96:111], v[64:67], a[224:227], v[96:111]
    ds_read_b128 v[88:91], v29 offset:14336
    v_add_u32 v28, s62, v9
    buffer_load_dwordx4 a[248:251], v4, s[16:19], s55 offen sc1
    s_waitcnt lgkmcnt(6)
    v_mfma_f32_32x32x16_bf16 v[112:127], v[68:71], a[224:227], v[112:127]
    ds_read_b128 v[56:59], v24 offset:18432
    ds_read_b128 v[92:95], v29 offset:15360
    s_add_u32 s55, s55, 4096
    s_waitcnt vmcnt(10) lgkmcnt(7)
    v_mfma_f32_32x32x16_bf16 v[96:111], v[72:75], a[228:231], v[96:111]
    ds_read_b128 v[64:67], v28 offset:0
    buffer_load_dwordx4 a[252:255], v4, s[16:19], s55 offen sc1
    s_cmp_eq_u32 s52, 0
    s_cbranch_scc1 L_p2_acq7
L_p2_got7:
    s_waitcnt lgkmcnt(7)
    v_mfma_f32_32x32x16_bf16 v[112:127], v[76:79], a[228:231], v[112:127]
    ds_read_b128 v[68:71], v28 offset:1024
    s_ff1_i32_b32 s56, s52
    s_bitset0_b32 s52, s56
    s_bitset1_b32 s53, s56
    s_add_u32 s56, s56, s46
    s_cmp_eq_u32 s54, 2.0
    s_cbranch_scc1 L_p2_late
    s_waitcnt vmcnt(10) lgkmcnt(6)
    v_mfma_f32_32x32x16_bf16 v[96:111], v[80:83], v[184:187], v[96:111]
    ds_read_b128 v[60:63], v24 offset:19456
    ds_read_b128 v[72:75], v28 offset:2048
    s_and_b32 s56, s56, 28
    s_lshl_b32 s63, s56, 12
    s_lshl_b32 s56, s56, 13
    s_add_u32 s55, s56, 917504
    s_waitcnt lgkmcnt(7)
    v_mfma_f32_32x32x16_bf16 v[112:127], v[84:87], v[184:187], v[112:127]
    ds_read_b128 v[76:79], v28 offset:3072
    buffer_load_dwordx4 a[140:143], v4, s[16:19], s55 offen sc1
    s_waitcnt vmcnt(10) lgkmcnt(7)
    v_mfma_f32_32x32x16_bf16 v[96:111], v[88:91], v[188:191], v[96:111]
    ds_read_b128 v[80:83], v28 offset:4096
    s_add_u32 s55, s55, 4096
    v_add_f32 v144, v144, v48
    v_add_f32 v145, v145, v49
    v_add_f32 v146, v146, v50
    v_add_f32_e64 v147, v147, v51
    s_waitcnt lgkmcnt(6)
    v_mfma_f32_32x32x16_bf16 v[112:127], v[92:95], v[188:191], v[112:127]
    ds_read_b128 v[84:87], v28 offset:5120
    buffer_load_dwordx4 a[164:167], v4, s[16:19], s55 offen sc1
    v_add_f32 v148, v148, v52
    v_add_f32 v149, v149, v53
    v_add_f32 v150, v150, v54
    s_waitcnt vmcnt(9) lgkmcnt(6)
    v_mfma_f32_32x32x16_bf16 v[96:111], v[64:67], v[232:235], v[96:111]
    ds_read_b128 v[88:91], v28 offset:6144
    s_add_u32 s55, s55, 4096
    v_add_f32 v151, v151, v55
    v_add_f32 v152, v152, v56
    v_add_f32 v153, v153, v57
    v_add_f32 v154, v154, v58
    s_waitcnt lgkmcnt(6)
    v_mfma_f32_32x32x16_bf16 v[112:127], v[68:71], v[232:235], v[112:127]
    ds_read_b128 v[92:95], v28 offset:7168
    buffer_load_dwordx4 a[188:191], v4, s[16:19], s55 offen sc1
    v_add_f32 v155, v155, v59
    s_waitcnt lgkmcnt(6)
    v_add_f32 v156, v156, v60
    v_add_f32 v157, v157, v61
    s_waitcnt vmcnt(9) lgkmcnt(5)
    v_mfma_f32_32x32x16_bf16 v[96:111], v[72:75], v[236:239], v[96:111]
    ds_read_b128 v[64:67], v28 offset:8192
    s_add_u32 s55, s55, 4096
    v_add_f32 v158, v158, v62
    v_add_f32_e64 v159, v159, v63
    s_waitcnt lgkmcnt(5)
    v_mfma_f32_32x32x16_bf16 v[112:127], v[76:79], v[236:239], v[112:127]
    ds_read_b128 v[68:71], v28 offset:9216
    buffer_load_dwordx4 a[212:215], v4, s[16:19], s55 offen sc1
    v_accvgpr_read_b32 v160, a0
    v_accvgpr_read_b32 v161, a1
    v_accvgpr_read_b32 v162, a2
    s_waitcnt vmcnt(9) lgkmcnt(5)
    v_mfma_f32_32x32x16_bf16 v[96:111], v[80:83], v[240:243], v[96:111]
    s_nop 0
    ds_read_b128 v[72:75], v28 offset:10240
    s_add_u32 s55, s55, 4096
    v_accvgpr_read_b32 v163, a3
    v_accvgpr_read_b32 v164, a4
    v_accvgpr_read_b32 v165, a5
    v_accvgpr_read_b32 v166, a6
    s_waitcnt lgkmcnt(5)
    v_mfma_f32_32x32x16_bf16 v[112:127], v[84:87], v[240:243], v[112:127]
    s_nop 0
    ds_read_b128 v[76:79], v28 offset:11264
    buffer_load_dwordx4 a[236:239], v4, s[16:19], s55 offen sc1
    v_accvgpr_read_b32 v167, a7
    v_add_f32 v128, v128, v160
    v_add_f32_e64 v129, v129, v161
    s_waitcnt vmcnt(9) lgkmcnt(5)
    v_mfma_f32_32x32x16_bf16 v[96:111], v[88:91], v[244:247], v[96:111]
    ds_read_b128 v[80:83], v28 offset:12288
    s_add_u32 s55, s55, 4096
    v_add_f32 v130, v130, v162
    v_add_f32 v131, v131, v163
    v_add_f32 v132, v132, v164
    v_add_f32_e64 v133, v133, v165
    s_waitcnt lgkmcnt(5)
    v_mfma_f32_32x32x16_bf16 v[112:127], v[92:95], v[244:247], v[112:127]
    ds_read_b128 v[84:87], v28 offset:13312
    buffer_load_dwordx4 v[196:199], v4, s[16:19], s55 offen sc1
    v_add_f32 v134, v134, v166
    v_add_f32_e64 v135, v135, v167
    v_accvgpr_read_b32 v160, a8
    s_waitcnt vmcnt(9) lgkmcnt(5)
    v_mfma_f32_32x32x16_bf16 v[96:111], v[64:67], v[248:251], v[96:111]
    ds_read_b128 v[88:91], v28 offset:14336
    v_add_u32_e64 v29, s63, v9
    s_add_u32 s55, s55, 4096
    v_accvgpr_read_b32 v161, a9
    v_accvgpr_read_b32 v162, a10
    s_nop 0
    v_accvgpr_read_b32 v163, a11
    s_waitcnt lgkmcnt(5)
    v_mfma_f32_32x32x16_bf16 v[112:127], v[68:71], v[248:251], v[112:127]
    ds_read_b128 v[92:95], v28 offset:15360
    buffer_load_dwordx4 v[220:223], v4, s[16:19], s55 offen sc1
    v_accvgpr_read_b32 v164, a12
    v_accvgpr_read_b32 v165, a13
    v_accvgpr_read_b32 v166, a14
    s_waitcnt vmcnt(9) lgkmcnt(5)
    s_nop 0
    v_mfma_f32_32x32x16_bf16 v[96:111], v[72:75], v[252:255], v[96:111]
    ds_read_b128 v[64:67], v29 offset:0
    s_add_u32 s55, s55, 4096
    v_accvgpr_read_b32 v167, a15
    v_add_f32 v136, v136, v160
    v_add_f32 v137, v137, v161
    v_add_f32 v138, v138, v162
    s_waitcnt lgkmcnt(5)
    v_mfma_f32_32x32x16_bf16 v[112:127], v[76:79], v[252:255], v[112:127]
    ds_read_b128 v[68:71], v29 offset:1024
    buffer_load_dwordx4 a[144:147], v4, s[16:19], s55 offen sc1
    v_add_f32 v139, v139, v163
    v_add_f32 v140, v140, v164
    v_add_f32 v141, v141, v165
    s_waitcnt vmcnt(9) lgkmcnt(5)
    v_mfma_f32_32x32x16_bf16 v[96:111], v[80:83], a[248:251], v[96:111]
    ds_read_b128 v[72:75], v29 offset:2048
    v_add_f32 v142, v142, v166
    v_add_f32_e64 v143, v143, v167
    v_accvgpr_read_b32 v160, a16
    v_accvgpr_read_b32 v161, a17
    s_waitcnt lgkmcnt(5)
    v_mfma_f32_32x32x16_bf16 v[112:127], v[84:87], a[248:251], v[112:127]
    ds_read_b128 v[76:79], v29 offset:3072
    v_accvgpr_read_b32 v162, a18
    v_accvgpr_read_b32 v163, a19
    v_accvgpr_read_b32 v164, a20
    v_accvgpr_read_b32 v165, a21
    s_waitcnt vmcnt(8) lgkmcnt(5)
    s_nop 0
    v_mfma_f32_32x32x16_bf16 v[96:111], v[88:91], a[252:255], v[96:111]
    ds_read_b128 v[80:83], v29 offset:4096
    v_accvgpr_read_b32 v166, a22
    v_accvgpr_read_b32 v167, a23
    v_add_f32 v144, v144, v160
    v_add_f32 v145, v145, v161
    s_waitcnt lgkmcnt(5)
    v_mfma_f32_32x32x16_bf16 v[112:127], v[92:95], a[252:255], v[112:127]
    ds_read_b128 v[84:87], v29 offset:5120
    v_add_f32 v146, v146, v162
    v_add_f32 v147, v147, v163
    v_add_f32 v148, v148, v164
    v_add_f32 v149, v149, v165
    s_waitcnt vmcnt(7) lgkmcnt(5)
    v_mfma_f32_32x32x16_bf16 v[96:111], v[64:67], a[140:143], v[96:111]
    ds_read_b128 v[88:91], v29 offset:6144
    v_add_f32_e64 v150, v150, v166
    v_add_f32 v151, v151, v167
    v_accvgpr_read_b32 v160, a24
    v_accvgpr_read_b32 v161, a25
    s_waitcnt lgkmcnt(5)
    v_mfma_f32_32x32x16_bf16 v[112:127], v[68:71], a[140:143], v[112:127]
    ds_read_b128 v[92:95], v29 offset:7168
    v_accvgpr_read_b32 v162, a26
    v_accvgpr_read_b32 v163, a27
    v_accvgpr_read_b32 v164, a28
    v_accvgpr_read_b32 v165, a29
    s_waitcnt vmcnt(6) lgkmcnt(5)
    v_mfma_f32_32x32x16_bf16 v[96:111], v[72:75], a[164:167], v[96:111]
    s_nop 0
    ds_read_b128 v[64:67], v29 offset:8192
    v_accvgpr_read_b32 v166, a30
    v_accvgpr_read_b32 v167, a31
    v_add_f32 v152, v152, v160
    v_add_f32_e64 v153, v153, v161
    s_waitcnt lgkmcnt(5)
    v_mfma_f32_32x32x16_bf16 v[112:127], v[76:79], a[164:167], v[112:127]
    ds_read_b128 v[68:71], v29 offset:9216
    v_add_f32 v154, v154, v162
    v_add_f32 v155, v155, v163
    v_add_f32 v156, v156, v164
    v_add_f32 v157, v157, v165
    s_waitcnt vmcnt(5) lgkmcnt(5)
    v_mfma_f32_32x32x16_bf16 v[96:111], v[80:83], a[188:191], v[96:111]
    ds_read_b128 v[72:75], v29 offset:10240
    v_add_f32 v158, v158, v166
    v_add_f32 v159, v159, v167
    v_subrev_u32 v16, v9, v24
    v_and_b32 v12, 31, v0
    s_waitcnt lgkmcnt(5)
    v_mfma_f32_32x32x16_bf16 v[112:127], v[84:87], a[188:191], v[112:127]
    ds_read_b128 v[76:79], v29 offset:11264
    v_lshrrev_b32_e64 v13, 5, v0
    v_and_b32 v14, 7, v0
    v_lshlrev_b32_e64 v13, 2, v13
    v_xor_b32_e64 v13, v13, v14
    s_waitcnt vmcnt(4) lgkmcnt(5)
    v_mfma_f32_32x32x16_bf16 v[96:111], v[88:91], a[212:215], v[96:111]
    ds_read_b128 v[80:83], v29 offset:12288
    v_lshlrev_b32_e64 v13, 4, v13
    v_lshl_add_u32 v12, v12, 7, v13
    v_add_u32_e64 v12, v16, v12
    v_xor_b32 v13, 16, v12
    s_waitcnt lgkmcnt(5)
    v_mfma_f32_32x32x16_bf16 v[112:127], v[92:95], a[212:215], v[112:127]
    ds_read_b128 v[84:87], v29 offset:13312
    v_xor_b32_e64 v14, 32, v12
    v_xor_b32_e64 v15, 48, v12
    s_waitcnt vmcnt(3) lgkmcnt(5)
    v_mfma_f32_32x32x16_bf16 v[96:111], v[64:67], a[236:239], v[96:111]
    ds_read_b128 v[88:91], v29 offset:14336
    s_waitcnt lgkmcnt(5)
    v_mfma_f32_32x32x16_bf16 v[112:127], v[68:71], a[236:239], v[112:127]
    ds_read_b128 v[92:95], v29 offset:15360
    s_waitcnt vmcnt(2) lgkmcnt(5)
    v_mfma_f32_32x32x16_bf16 v[96:111], v[72:75], v[196:199], v[96:111]
    s_waitcnt lgkmcnt(4)
    v_mfma_f32_32x32x16_bf16 v[112:127], v[76:79], v[196:199], v[112:127]
    s_waitcnt vmcnt(1) lgkmcnt(3)
    v_mfma_f32_32x32x16_bf16 v[96:111], v[80:83], v[220:223], v[96:111]
    s_waitcnt lgkmcnt(2)
    v_mfma_f32_32x32x16_bf16 v[112:127], v[84:87], v[220:223], v[112:127]
    s_waitcnt vmcnt(0) lgkmcnt(1)
    v_mfma_f32_32x32x16_bf16 v[96:111], v[88:91], a[144:147], v[96:111]
    s_waitcnt lgkmcnt(0)
    v_mfma_f32_32x32x16_bf16 v[112:127], v[92:95], a[144:147], v[112:127]
L_p2_fin:
    s_nop 7
    s_nop 3
    v_pk_add_f32 v[96:97], v[96:97], v[128:129]
    v_pk_add_f32 v[100:101], v[100:101], v[132:133]
    v_cvt_pk_bf16_f32 v168, v96, v100
    v_pk_add_f32 v[112:113], v[112:113], v[144:145]
    v_pk_add_f32 v[116:117], v[116:117], v[148:149]
    v_cvt_pk_bf16_f32 v169, v112, v116
    v_cvt_pk_bf16_f32 v170, v97, v101
    v_cvt_pk_bf16_f32 v171, v113, v117
    ds_write_b128 v12, v[168:171]
    v_pk_add_f32 v[98:99], v[98:99], v[130:131]
    v_pk_add_f32 v[102:103], v[102:103], v[134:135]
    v_cvt_pk_bf16_f32 v172, v98, v102
    v_pk_add_f32 v[114:115], v[114:115], v[146:147]
    v_pk_add_f32 v[118:119], v[118:119], v[150:151]
    v_cvt_pk_bf16_f32 v173, v114, v118
    v_cvt_pk_bf16_f32 v174, v99, v103
    v_cvt_pk_bf16_f32 v175, v115, v119
    ds_write_b128 v13, v[172:175]
    v_pk_add_f32 v[104:105], v[104:105], v[136:137]
    v_pk_add_f32 v[108:109], v[108:109], v[140:141]
    v_cvt_pk_bf16_f32 v176, v104, v108
    v_pk_add_f32 v[120:121], v[120:121], v[152:153]
    v_pk_add_f32 v[124:125], v[124:125], v[156:157]
    v_cvt_pk_bf16_f32 v177, v120, v124
    v_cvt_pk_bf16_f32 v178, v105, v109
    v_cvt_pk_bf16_f32 v179, v121, v125
    ds_write_b128 v14, v[176:179]
    v_pk_add_f32 v[106:107], v[106:107], v[138:139]
    v_pk_add_f32 v[110:111], v[110:111], v[142:143]
    v_cvt_pk_bf16_f32 v180, v106, v110
    v_pk_add_f32 v[122:123], v[122:123], v[154:155]
    v_pk_add_f32 v[126:127], v[126:127], v[158:159]
    v_cvt_pk_bf16_f32 v181, v122, v126
    v_cvt_pk_bf16_f32 v182, v107, v111
    v_cvt_pk_bf16_f32 v183, v123, v127
    ds_write_b128 v15, v[180:183]
    ds_read_b128 v[32:35], v24 offset:0
    ds_read_b128 v[36:39], v24 offset:1024
    ds_read_b128 v[40:43], v24 offset:2048
    ds_read_b128 v[44:47], v24 offset:3072
    s_waitcnt lgkmcnt(3)
    buffer_store_dwordx4 v[32:35], v8, s[12:15], s42 offen nt
    s_add_u32 s42, s42, 16384
    s_waitcnt lgkmcnt(2)
    buffer_store_dwordx4 v[36:39], v8, s[12:15], s42 offen nt
    s_add_u32 s42, s42, 16384
    s_waitcnt lgkmcnt(1)
    buffer_store_dwordx4 v[40:43], v8, s[12:15], s42 offen nt
    s_add_u32 s42, s42, 16384
    s_waitcnt lgkmcnt(0)
    buffer_store_dwordx4 v[44:47], v8, s[12:15], s42 offen nt
L_p2_exit:
    s_endpgm
L_p2_late:
    s_waitcnt vmcnt(10) lgkmcnt(6)
    v_mfma_f32_32x32x16_bf16 v[96:111], v[80:83], v[184:187], v[96:111]
    ds_read_b128 v[60:63], v24 offset:19456
    ds_read_b128 v[72:75], v28 offset:2048
    s_and_b32 s56, s56, 28
    s_lshl_b32 s63, s56, 12
    s_lshl_b32 s56, s56, 13
    s_add_u32 s55, s56, 917504
    s_waitcnt lgkmcnt(7)
    v_mfma_f32_32x32x16_bf16 v[112:127], v[84:87], v[184:187], v[112:127]
    ds_read_b128 v[76:79], v28 offset:3072
    s_nop 0
    buffer_load_dwordx4 a[140:143], v4, s[16:19], s55 offen sc1
    s_waitcnt vmcnt(10) lgkmcnt(7)
    v_mfma_f32_32x32x16_bf16 v[96:111], v[88:91], v[188:191], v[96:111]
    ds_read_b128 v[80:83], v28 offset:4096
    s_add_u32 s55, s55, 4096
    v_add_f32 v144, v144, v48
    v_add_f32 v145, v145, v49
    v_add_f32 v146, v146, v50
    v_add_f32_e64 v147, v147, v51
    s_waitcnt lgkmcnt(6)
    v_mfma_f32_32x32x16_bf16 v[112:127], v[92:95], v[188:191], v[112:127]
    ds_read_b128 v[84:87], v28 offset:5120
    buffer_load_dwordx4 a[164:167], v4, s[16:19], s55 offen sc1
    v_add_f32 v148, v148, v52
    v_add_f32 v149, v149, v53
    v_add_f32 v150, v150, v54
    s_waitcnt vmcnt(9) lgkmcnt(6)
    v_mfma_f32_32x32x16_bf16 v[96:111], v[64:67], v[232:235], v[96:111]
    ds_read_b128 v[88:91], v28 offset:6144
    s_add_u32 s55, s55, 4096
    v_add_f32 v151, v151, v55
    v_add_f32 v152, v152, v56
    v_add_f32 v153, v153, v57
    v_add_f32 v154, v154, v58
    s_waitcnt lgkmcnt(6)
    v_mfma_f32_32x32x16_bf16 v[112:127], v[68:71], v[232:235], v[112:127]
    ds_read_b128 v[92:95], v28 offset:7168
    buffer_load_dwordx4 a[188:191], v4, s[16:19], s55 offen sc1
    v_add_f32 v155, v155, v59
    s_waitcnt lgkmcnt(6)
    v_add_f32 v156, v156, v60
    v_add_f32 v157, v157, v61
    s_waitcnt vmcnt(9) lgkmcnt(5)
    v_mfma_f32_32x32x16_bf16 v[96:111], v[72:75], v[236:239], v[96:111]
    ds_read_b128 v[64:67], v28 offset:8192
    s_add_u32 s55, s55, 4096
    v_add_f32 v158, v158, v62
    v_add_f32_e64 v159, v159, v63
    s_waitcnt lgkmcnt(5)
    v_mfma_f32_32x32x16_bf16 v[112:127], v[76:79], v[236:239], v[112:127]
    ds_read_b128 v[68:71], v28 offset:9216
    buffer_load_dwordx4 a[212:215], v4, s[16:19], s55 offen sc1
    v_accvgpr_read_b32 v160, a0
    v_accvgpr_read_b32 v161, a1
    v_accvgpr_read_b32 v162, a2
    s_waitcnt vmcnt(9) lgkmcnt(5)
    v_mfma_f32_32x32x16_bf16 v[96:111], v[80:83], v[240:243], v[96:111]
    ds_read_b128 v[72:75], v28 offset:10240
    s_nop 0
    s_add_u32 s55, s55, 4096
    v_accvgpr_read_b32 v163, a3
    v_accvgpr_read_b32 v164, a4
    v_accvgpr_read_b32 v165, a5
    v_accvgpr_read_b32 v166, a6
    s_waitcnt lgkmcnt(5)
    v_mfma_f32_32x32x16_bf16 v[112:127], v[84:87], v[240:243], v[112:127]
    ds_read_b128 v[76:79], v28 offset:11264
    s_nop 0
    buffer_load_dwordx4 a[236:239], v4, s[16:19], s55 offen sc1
    v_accvgpr_read_b32 v167, a7
    v_add_f32 v128, v128, v160
    v_add_f32_e64 v129, v129, v161
    s_waitcnt vmcnt(9) lgkmcnt(5)
    v_mfma_f32_32x32x16_bf16 v[96:111], v[88:91], v[244:247], v[96:111]
    ds_read_b128 v[80:83], v28 offset:12288
    s_add_u32 s55, s55, 4096
    v_add_f32 v130, v130, v162
    v_add_f32 v131, v131, v163
    v_add_f32 v132, v132, v164
    v_add_f32_e64 v133, v133, v165
    s_waitcnt lgkmcnt(5)
    v_mfma_f32_32x32x16_bf16 v[112:127], v[92:95], v[244:247], v[112:127]
    ds_read_b128 v[84:87], v28 offset:13312
    buffer_load_dwordx4 v[196:199], v4, s[16:19], s55 offen sc1
    v_add_f32 v134, v134, v166
    v_add_f32_e64 v135, v135, v167
    v_accvgpr_read_b32 v160, a8
    s_waitcnt vmcnt(9) lgkmcnt(5)
    v_mfma_f32_32x32x16_bf16 v[96:111], v[64:67], v[248:251], v[96:111]
    ds_read_b128 v[88:91], v28 offset:14336
    v_add_u32_e64 v29, s63, v9
    s_add_u32 s55, s55, 4096
    v_accvgpr_read_b32 v161, a9
    v_accvgpr_read_b32 v162, a10
    v_accvgpr_read_b32 v163, a11
    s_waitcnt lgkmcnt(5)
    s_nop 0
    v_mfma_f32_32x32x16_bf16 v[112:127], v[68:71], v[248:251], v[112:127]
    ds_read_b128 v[92:95], v28 offset:15360
    buffer_load_dwordx4 v[220:223], v4, s[16:19], s55 offen sc1
    v_accvgpr_read_b32 v164, a12
    v_accvgpr_read_b32 v165, a13
    v_accvgpr_read_b32 v166, a14
    s_waitcnt vmcnt(9) lgkmcnt(5)
    v_mfma_f32_32x32x16_bf16 v[96:111], v[72:75], v[252:255], v[96:111]
    s_nop 0
    ds_read_b128 v[64:67], v29 offset:0
    s_add_u32 s55, s55, 4096
    v_accvgpr_read_b32 v167, a15
    v_add_f32 v136, v136, v160
    v_add_f32 v137, v137, v161
    v_add_f32 v138, v138, v162
    s_waitcnt lgkmcnt(5)
    v_mfma_f32_32x32x16_bf16 v[112:127], v[76:79], v[252:255], v[112:127]
    ds_read_b128 v[68:71], v29 offset:1024
    buffer_load_dwordx4 a[144:147], v4, s[16:19], s55 offen sc1
    v_add_f32 v139, v139, v163
    v_add_f32 v140, v140, v164
    v_add_f32 v141, v141, v165
    s_waitcnt vmcnt(9) lgkmcnt(5)
    v_mfma_f32_32x32x16_bf16 v[96:111], v[80:83], a[248:251], v[96:111]
    ds_read_b128 v[72:75], v29 offset:2048
    v_add_f32 v142, v142, v166
    v_add_f32_e64 v143, v143, v167
    v_accvgpr_read_b32 v160, a16
    v_accvgpr_read_b32 v161, a17
    s_waitcnt lgkmcnt(5)
    v_mfma_f32_32x32x16_bf16 v[112:127], v[84:87], a[248:251], v[112:127]
    ds_read_b128 v[76:79], v29 offset:3072
    v_accvgpr_read_b32 v162, a18
    v_accvgpr_read_b32 v163, a19
    v_accvgpr_read_b32 v164, a20
    v_accvgpr_read_b32 v165, a21
    s_waitcnt vmcnt(8) lgkmcnt(5)
    v_mfma_f32_32x32x16_bf16 v[96:111], v[88:91], a[252:255], v[96:111]
    s_nop 0
    ds_read_b128 v[80:83], v29 offset:4096
    v_accvgpr_read_b32 v166, a22
    v_accvgpr_read_b32 v167, a23
    v_add_f32 v144, v144, v160
    v_add_f32 v145, v145, v161
    s_waitcnt lgkmcnt(5)
    v_mfma_f32_32x32x16_bf16 v[112:127], v[92:95], a[252:255], v[112:127]
    ds_read_b128 v[84:87], v29 offset:5120
    v_add_f32 v146, v146, v162
    v_add_f32 v147, v147, v163
    v_add_f32 v148, v148, v164
    v_add_f32 v149, v149, v165
    s_waitcnt vmcnt(7) lgkmcnt(5)
    v_mfma_f32_32x32x16_bf16 v[96:111], v[64:67], a[140:143], v[96:111]
    ds_read_b128 v[88:91], v29 offset:6144
    v_add_f32_e64 v150, v150, v166
    v_add_f32 v151, v151, v167
    v_accvgpr_read_b32 v160, a24
    v_accvgpr_read_b32 v161, a25
    s_waitcnt lgkmcnt(5)
    v_mfma_f32_32x32x16_bf16 v[112:127], v[68:71], a[140:143], v[112:127]
    ds_read_b128 v[92:95], v29 offset:7168
    v_accvgpr_read_b32 v162, a26
    v_accvgpr_read_b32 v163, a27
    v_accvgpr_read_b32 v164, a28
    v_accvgpr_read_b32 v165, a29
    s_waitcnt vmcnt(6) lgkmcnt(5)
    v_mfma_f32_32x32x16_bf16 v[96:111], v[72:75], a[164:167], v[96:111]
    ds_read_b128 v[64:67], v29 offset:8192
    s_nop 0
    v_accvgpr_read_b32 v166, a30
    v_accvgpr_read_b32 v167, a31
    v_add_f32 v152, v152, v160
    v_add_f32_e64 v153, v153, v161
    s_waitcnt lgkmcnt(5)
    v_mfma_f32_32x32x16_bf16 v[112:127], v[76:79], a[164:167], v[112:127]
    ds_read_b128 v[68:71], v29 offset:9216
    v_add_f32 v154, v154, v162
    v_add_f32 v155, v155, v163
    v_add_f32 v156, v156, v164
    v_add_f32 v157, v157, v165
    s_waitcnt vmcnt(5) lgkmcnt(5)
    v_mfma_f32_32x32x16_bf16 v[96:111], v[80:83], a[188:191], v[96:111]
    ds_read_b128 v[72:75], v29 offset:10240
    v_add_f32 v158, v158, v166
    v_add_f32 v159, v159, v167
    v_subrev_u32 v16, v9, v24
    v_and_b32 v12, 31, v0
    s_waitcnt lgkmcnt(5)
    v_mfma_f32_32x32x16_bf16 v[112:127], v[84:87], a[188:191], v[112:127]
    ds_read_b128 v[76:79], v29 offset:11264
    v_lshrrev_b32_e64 v13, 5, v0
    v_and_b32 v14, 7, v0
    v_lshlrev_b32_e64 v13, 2, v13
    v_xor_b32_e64 v13, v13, v14
    s_waitcnt vmcnt(4) lgkmcnt(5)
    v_mfma_f32_32x32x16_bf16 v[96:111], v[88:91], a[212:215], v[96:111]
    ds_read_b128 v[80:83], v29 offset:12288
    v_lshlrev_b32_e64 v13, 4, v13
    v_lshl_add_u32 v12, v12, 7, v13
    v_add_u32_e64 v12, v16, v12
    v_xor_b32 v13, 16, v12
    s_waitcnt lgkmcnt(5)
    v_mfma_f32_32x32x16_bf16 v[112:127], v[92:95], a[212:215], v[112:127]
    ds_read_b128 v[84:87], v29 offset:13312
    v_xor_b32_e64 v14, 32, v12
    v_xor_b32_e64 v15, 48, v12
    s_waitcnt vmcnt(3) lgkmcnt(5)
    v_mfma_f32_32x32x16_bf16 v[96:111], v[64:67], a[236:239], v[96:111]
    ds_read_b128 v[88:91], v29 offset:14336
    s_waitcnt lgkmcnt(5)
    v_mfma_f32_32x32x16_bf16 v[112:127], v[68:71], a[236:239], v[112:127]
    ds_read_b128 v[92:95], v29 offset:15360
    s_waitcnt vmcnt(2) lgkmcnt(5)
    v_mfma_f32_32x32x16_bf16 v[96:111], v[72:75], v[196:199], v[96:111]
    s_waitcnt lgkmcnt(4)
    v_mfma_f32_32x32x16_bf16 v[112:127], v[76:79], v[196:199], v[112:127]
    s_waitcnt vmcnt(1) lgkmcnt(3)
    v_mfma_f32_32x32x16_bf16 v[96:111], v[80:83], v[220:223], v[96:111]
    s_waitcnt lgkmcnt(2)
    v_mfma_f32_32x32x16_bf16 v[112:127], v[84:87], v[220:223], v[112:127]
    s_waitcnt vmcnt(0) lgkmcnt(1)
    v_mfma_f32_32x32x16_bf16 v[96:111], v[88:91], a[144:147], v[96:111]
    s_waitcnt lgkmcnt(0)
    v_mfma_f32_32x32x16_bf16 v[112:127], v[92:95], a[144:147], v[112:127]
    s_branch L_p2_fin
L_p2_acq0:
    s_mov_b32 s58, 0
L_p2_aq0:
    v_cmp_eq_u32 vcc, 1, v1
    s_add_u32 s58, s58, 1
    s_cmp_gt_u32 s58, 400000
    s_cbranch_scc1 L_p2_got0
    s_nop 1
    s_lshr_b32 s56, vcc_lo, 1
    s_and_b32 s56, s56, vcc_lo
    s_lshr_b32 s57, s56, 2
    s_and_b32 s56, s56, s57
    s_and_b32 s56, s56, 0x11111111
    s_andn2_b32 s52, s56, s53
    s_cbranch_scc0 L_p2_ar0
    s_nop 0
    s_branch L_p2_got0
L_p2_ar0:
    buffer_load_dword v1, v11, s[32:35], s45 offen sc1
    s_waitcnt vmcnt(0)
    s_branch L_p2_aq0
L_p2_acq1:
    s_mov_b32 s58, 0
    s_waitcnt vmcnt(8)
L_p2_aq1:
    v_cmp_eq_u32 vcc, 1, v1
    s_add_u32 s58, s58, 1
    s_cmp_gt_u32 s58, 400000
    s_cbranch_scc1 L_p2_got1
    s_nop 1
    s_lshr_b32 s56, vcc_lo, 1
    s_and_b32 s56, s56, vcc_lo
    s_lshr_b32 s57, s56, 2
    s_and_b32 s56, s56, s57
    s_and_b32 s56, s56, 0x11111111
    s_andn2_b32 s52, s56, s53
    s_cbranch_scc0 L_p2_ar1
    s_nop 0
    s_branch L_p2_got1
L_p2_ar1:
    buffer_load_dword v1, v11, s[32:35], s45 offen sc1
    s_waitcnt vmcnt(0)
    s_branch L_p2_aq1
L_p2_acq2:
    s_mov_b32 s58, 0
    s_waitcnt vmcnt(8)
L_p2_aq2:
    v_cmp_eq_u32 vcc, 1, v1
    s_add_u32 s58, s58, 1
    s_cmp_gt_u32 s58, 400000
    s_cbranch_scc1 L_p2_got2
    s_nop 1
    s_lshr_b32 s56, vcc_lo, 1
    s_and_b32 s56, s56, vcc_lo
    s_lshr_b32 s57, s56, 2
    s_and_b32 s56, s56, s57
    s_and_b32 s56, s56, 0x11111111
    s_andn2_b32 s52, s56, s53
    s_cbranch_scc0 L_p2_ar2
    s_nop 0
    s_branch L_p2_got2
L_p2_ar2:
    buffer_load_dword v1, v11, s[32:35], s45 offen sc1
    s_waitcnt vmcnt(0)
    s_branch L_p2_aq2
L_p2_acq3:
    s_mov_b32 s58, 0
    s_waitcnt vmcnt(8)
L_p2_aq3:
    v_cmp_eq_u32 vcc, 1, v1
    s_add_u32 s58, s58, 1
    s_cmp_gt_u32 s58, 400000
    s_cbranch_scc1 L_p2_got3
    s_nop 1
    s_lshr_b32 s56, vcc_lo, 1
    s_and_b32 s56, s56, vcc_lo
    s_lshr_b32 s57, s56, 2
    s_and_b32 s56, s56, s57
    s_and_b32 s56, s56, 0x11111111
    s_andn2_b32 s52, s56, s53
    s_cbranch_scc0 L_p2_ar3
    s_nop 0
    s_branch L_p2_got3
L_p2_ar3:
    buffer_load_dword v1, v11, s[32:35], s45 offen sc1
    s_waitcnt vmcnt(0)
    s_branch L_p2_aq3
L_p2_acq4:
    s_mov_b32 s58, 0
    s_waitcnt vmcnt(8)
L_p2_aq4:
    v_cmp_eq_u32 vcc, 1, v1
    s_add_u32 s58, s58, 1
    s_cmp_gt_u32 s58, 400000
    s_cbranch_scc1 L_p2_got4
    s_nop 1
    s_lshr_b32 s56, vcc_lo, 1
    s_and_b32 s56, s56, vcc_lo
    s_lshr_b32 s57, s56, 2
    s_and_b32 s56, s56, s57
    s_and_b32 s56, s56, 0x11111111
    s_andn2_b32 s52, s56, s53
    s_cbranch_scc0 L_p2_ar4
    s_nop 0
    s_branch L_p2_got4
L_p2_ar4:
    buffer_load_dword v1, v11, s[32:35], s45 offen sc1
    s_waitcnt vmcnt(0)
    s_branch L_p2_aq4
L_p2_acq5:
    s_mov_b32 s58, 0
    s_waitcnt vmcnt(8)
L_p2_aq5:
    v_cmp_eq_u32 vcc, 1, v1
    s_add_u32 s58, s58, 1
    s_cmp_gt_u32 s58, 400000
    s_cbranch_scc1 L_p2_got5
    s_nop 1
    s_lshr_b32 s56, vcc_lo, 1
    s_and_b32 s56, s56, vcc_lo
    s_lshr_b32 s57, s56, 2
    s_and_b32 s56, s56, s57
    s_and_b32 s56, s56, 0x11111111
    s_andn2_b32 s52, s56, s53
    s_cbranch_scc0 L_p2_ar5
    s_nop 0
    s_branch L_p2_got5
L_p2_ar5:
    buffer_load_dword v1, v11, s[32:35], s45 offen sc1
    s_waitcnt vmcnt(0)
    s_branch L_p2_aq5
L_p2_acq6:
    s_mov_b32 s58, 0
    s_waitcnt vmcnt(8)
L_p2_aq6:
    v_cmp_eq_u32 vcc, 1, v1
    s_add_u32 s58, s58, 1
    s_cmp_gt_u32 s58, 400000
    s_cbranch_scc1 L_p2_got6
    s_nop 1
    s_lshr_b32 s56, vcc_lo, 1
    s_and_b32 s56, s56, vcc_lo
    s_lshr_b32 s57, s56, 2
    s_and_b32 s56, s56, s57
    s_and_b32 s56, s56, 0x11111111
    s_andn2_b32 s52, s56, s53
    s_cbranch_scc0 L_p2_ar6
    s_nop 0
    s_branch L_p2_got6
L_p2_ar6:
    buffer_load_dword v1, v11, s[32:35], s45 offen sc1
    s_waitcnt vmcnt(0)
    s_branch L_p2_aq6
L_p2_acq7:
    s_mov_b32 s58, 0
    s_waitcnt vmcnt(8)
L_p2_aq7:
    v_cmp_eq_u32 vcc, 1, v1
    s_add_u32 s58, s58, 1
    s_cmp_gt_u32 s58, 400000
    s_cbranch_scc1 L_p2_got7
    s_nop 1
    s_lshr_b32 s56, vcc_lo, 1
    s_and_b32 s56, s56, vcc_lo
    s_lshr_b32 s57, s56, 2
    s_and_b32 s56, s56, s57
    s_and_b32 s56, s56, 0x11111111
    s_andn2_b32 s52, s56, s53
    s_cbranch_scc0 L_p2_ar7
    s_nop 0
    s_branch L_p2_got7
L_p2_ar7:
    buffer_load_dword v1, v11, s[32:35], s45 offen sc1
    s_waitcnt vmcnt(0)
    s_branch L_p2_aq7
L_p2_end:
L_p2_fallback:
    v_subrev_u32 v10, 131072, v2
    s_mov_b32 s49, 0
    v_mov_b32 v12, 0xff800000
    v_mov_b32 v13, 0xff800000
    s_waitcnt vmcnt(0)
L_p2_fb1:
    buffer_load_dwordx4 v[48:51], v10, s[8:11], s49 offen offset:0 sc1
    buffer_load_dwordx4 v[52:55], v10, s[8:11], s49 offen offset:512 sc1
    s_waitcnt vmcnt(0)
    v_mfma_f32_32x32x16_bf16 v[64:79], v[48:51], v[32:35], 0
    s_nop 0
    v_mfma_f32_32x32x16_bf16 v[64:79], v[52:55], v[36:39], v[64:79]
    v_mfma_f32_32x32x16_bf16 v[80:95], v[48:51], v[40:43], 0
    v_mfma_f32_32x32x16_bf16 v[80:95], v[52:55], v[44:47], v[80:95]
    s_nop 9
    v_max3_f32 v12, v12, v64, v65
    s_nop 0
    v_max3_f32 v12, v12, v66, v67
    v_max3_f32 v12, v12, v68, v69
    v_max3_f32 v12, v12, v70, v71
    v_max3_f32 v12, v12, v72, v73
    v_max3_f32 v12, v12, v74, v75
    v_max3_f32 v12, v12, v76, v77
    v_max3_f32 v12, v12, v78, v79
    s_nop 1
    s_nop 0
    v_max3_f32 v13, v13, v80, v81
    v_max3_f32 v13, v13, v82, v83
    v_max3_f32 v13, v13, v84, v85
    v_max3_f32 v13, v13, v86, v87
    v_max3_f32 v13, v13, v88, v89
    v_max3_f32 v13, v13, v90, v91
    v_max3_f32 v13, v13, v92, v93
    v_max3_f32 v13, v13, v94, v95
    s_add_u32 s49, s49, 4096
    s_cmp_lt_u32 s49, 262144
    s_cbranch_scc1 L_p2_fb1
    v_mov_b32 v14, v12
    v_mov_b32 v15, v13
    s_nop 1
    v_permlane32_swap_b32 v12, v14
    v_permlane32_swap_b32 v13, v15
    s_nop 1
    v_max_f32 v12, v12, v14
    v_max_f32 v13, v13, v15
    v_sub_f32 v96, 0, v12
    v_sub_f32 v97, 0, v12
    v_sub_f32 v98, 0, v12
    v_sub_f32 v99, 0, v12
    v_sub_f32 v100, 0, v12
    v_sub_f32 v101, 0, v12
    v_sub_f32 v102, 0, v12
    v_sub_f32 v103, 0, v12
    v_sub_f32 v104, 0, v12
    v_sub_f32 v105, 0, v12
    v_sub_f32 v106, 0, v12
    v_sub_f32 v107, 0, v12
    v_sub_f32 v108, 0, v12
    v_sub_f32 v109, 0, v12
    v_sub_f32 v110, 0, v12
    v_sub_f32 v111, 0, v12
    v_sub_f32 v112, 0, v13
    v_sub_f32 v113, 0, v13
    v_sub_f32 v114, 0, v13
    v_sub_f32 v115, 0, v13
    v_sub_f32 v116, 0, v13
    v_sub_f32 v117, 0, v13
    v_sub_f32 v118, 0, v13
    v_sub_f32 v119, 0, v13
    v_sub_f32 v120, 0, v13
    v_sub_f32 v121, 0, v13
    v_sub_f32 v122, 0, v13
    v_sub_f32 v123, 0, v13
    v_sub_f32 v124, 0, v13
    v_sub_f32 v125, 0, v13
    v_sub_f32 v126, 0, v13
    v_sub_f32 v127, 0, v13
    v_mov_b32 v128, 0
    v_mov_b32 v129, 0
    v_mov_b32 v130, 0
    v_mov_b32 v131, 0
    v_mov_b32 v132, 0
    v_mov_b32 v133, 0
    v_mov_b32 v134, 0
    v_mov_b32 v135, 0
    v_mov_b32 v136, 0
    v_mov_b32 v137, 0
    v_mov_b32 v138, 0
    v_mov_b32 v139, 0
    v_mov_b32 v140, 0
    v_mov_b32 v141, 0
    v_mov_b32 v142, 0
    v_mov_b32 v143, 0
    v_mov_b32 v144, 0
    v_mov_b32 v145, 0
    v_mov_b32 v146, 0
    v_mov_b32 v147, 0
    v_mov_b32 v148, 0
    v_mov_b32 v149, 0
    v_mov_b32 v150, 0
    v_mov_b32 v151, 0
    v_mov_b32 v152, 0
    v_mov_b32 v153, 0
    v_mov_b32 v154, 0
    v_mov_b32 v155, 0
    v_mov_b32 v156, 0
    v_mov_b32 v157, 0
    v_mov_b32 v158, 0
    v_mov_b32 v159, 0
    v_mov_b32 v160, 0
    v_mov_b32 v161, 0
    v_mov_b32 v162, 0
    v_mov_b32 v163, 0
    v_mov_b32 v164, 0
    v_mov_b32 v165, 0
    v_mov_b32_e64 v166, 0
    v_mov_b32_e64 v167, 0
    s_mov_b32 s49, 0
L_p2_fb2:
    buffer_load_dwordx4 v[48:51], v10, s[8:11], s49 offen offset:0 sc1
    buffer_load_dwordx4 v[52:55], v10, s[8:11], s49 offen offset:512 sc1
    buffer_load_dwordx4 v[56:59], v10, s[8:11], s49 offen offset:2048 sc1
    buffer_load_dwordx4 v[60:63], v10, s[8:11], s49 offen offset:2560 sc1
    s_waitcnt vmcnt(0)
    v_mfma_f32_32x32x16_bf16 v[64:79], v[48:51], v[32:35], v[96:111]
    v_mfma_f32_32x32x16_bf16 v[64:79], v[52:55], v[36:39], v[64:79]
    s_nop 7
    s_nop 7
    s_nop 3
    v_exp_f32 v64, v64
    v_exp_f32 v65, v65
    v_exp_f32 v66, v66
    v_exp_f32 v67, v67
    v_exp_f32 v68, v68
    v_exp_f32 v69, v69
    v_exp_f32 v70, v70
    v_exp_f32 v71, v71
    v_exp_f32 v72, v72
    v_exp_f32 v73, v73
    v_exp_f32 v74, v74
    v_exp_f32 v75, v75
    v_exp_f32 v76, v76
    v_exp_f32 v77, v77
    v_exp_f32_e64 v78, v78
    v_exp_f32 v79, v79
    s_nop 0
    v_cvt_pk_bf16_f32 v24, v64, v65
    v_cvt_pk_bf16_f32 v25, v66, v67
    v_cvt_pk_bf16_f32 v26, v68, v69
    v_cvt_pk_bf16_f32 v27, v70, v71
    v_cvt_pk_bf16_f32 v28, v72, v73
    v_cvt_pk_bf16_f32 v29, v74, v75
    v_cvt_pk_bf16_f32 v30, v76, v77
    v_cvt_pk_bf16_f32 v31, v78, v79
    s_nop 1
    v_mfma_f32_32x32x16_bf16 v[128:143], v[56:59], v[24:27], v[128:143]
    v_mfma_f32_32x32x16_bf16 v[128:143], v[60:63], v[28:31], v[128:143]
    s_nop 0
    v_smfmac_f32_16x16x64_bf16 v[160:163], v[20:23], v[24:31], v3
    v_mfma_f32_32x32x16_bf16 v[80:95], v[48:51], v[40:43], v[112:127]
    v_mfma_f32_32x32x16_bf16 v[80:95], v[52:55], v[44:47], v[80:95]
    s_nop 7
    s_nop 7
    s_nop 3
    v_exp_f32 v80, v80
    v_exp_f32 v81, v81
    v_exp_f32 v82, v82
    v_exp_f32 v83, v83
    v_exp_f32 v84, v84
    v_exp_f32 v85, v85
    v_exp_f32 v86, v86
    v_exp_f32 v87, v87
    v_exp_f32 v88, v88
    v_exp_f32 v89, v89
    v_exp_f32 v90, v90
    v_exp_f32 v91, v91
    v_exp_f32 v92, v92
    v_exp_f32 v93, v93
    v_exp_f32 v94, v94
    v_exp_f32 v95, v95
    s_nop 0
    v_cvt_pk_bf16_f32 v24, v80, v81
    v_cvt_pk_bf16_f32 v25, v82, v83
    v_cvt_pk_bf16_f32 v26, v84, v85
    v_cvt_pk_bf16_f32 v27, v86, v87
    v_cvt_pk_bf16_f32 v28, v88, v89
    v_cvt_pk_bf16_f32 v29, v90, v91
    v_cvt_pk_bf16_f32 v30, v92, v93
    v_cvt_pk_bf16_f32 v31, v94, v95
    s_nop 1
    v_mfma_f32_32x32x16_bf16 v[144:159], v[56:59], v[24:27], v[144:159]
    v_mfma_f32_32x32x16_bf16 v[144:159], v[60:63], v[28:31], v[144:159]
    s_nop 0
    v_smfmac_f32_16x16x64_bf16 v[164:167], v[20:23], v[24:31], v3
    s_add_u32 s49, s49, 4096
    s_cmp_lt_u32 s49, 262144
    s_cbranch_scc1 L_p2_fb2
    s_nop 7
    s_nop 7
    s_nop 3
    v_add_f32 v160, v160, v161
    v_rcp_f32 v12, v160
    s_nop 0
    v_mul_f32 v128, v12, v128
    v_mul_f32 v129, v12, v129
    v_mul_f32 v130, v12, v130
    v_mul_f32 v131, v12, v131
    v_mul_f32 v132, v12, v132
    v_mul_f32 v133, v12, v133
    v_mul_f32 v134, v12, v134
    v_mul_f32_e64 v135, v12, v135
    v_cvt_pk_bf16_f32 v64, v128, v129
    v_cvt_pk_bf16_f32 v65, v130, v131
    v_cvt_pk_bf16_f32 v66, v132, v133
    v_cvt_pk_bf16_f32 v67, v134, v135
    buffer_store_dwordx4 v[64:67], v9, s[32:35], s41 offen offset:0 sc1
    v_mul_f32 v136, v12, v136
    v_mul_f32 v137, v12, v137
    v_mul_f32 v138, v12, v138
    v_mul_f32 v139, v12, v139
    v_mul_f32 v140, v12, v140
    v_mul_f32 v141, v12, v141
    v_mul_f32 v142, v12, v142
    v_mul_f32 v143, v12, v143
    v_cvt_pk_bf16_f32 v68, v136, v137
    v_cvt_pk_bf16_f32 v69, v138, v139
    v_cvt_pk_bf16_f32 v70, v140, v141
    v_cvt_pk_bf16_f32 v71, v142, v143
    buffer_store_dwordx4 v[68:71], v9, s[32:35], s48 offen offset:0 sc1
    v_add_f32 v164, v164, v165
    v_rcp_f32 v14, v164
    s_nop 0
    v_mul_f32 v144, v14, v144
    v_mul_f32 v145, v14, v145
    v_mul_f32 v146, v14, v146
    v_mul_f32 v147, v14, v147
    v_mul_f32 v148, v14, v148
    v_mul_f32 v149, v14, v149
    v_mul_f32 v150, v14, v150
    v_mul_f32_e64 v151, v14, v151
    v_cvt_pk_bf16_f32 v72, v144, v145
    v_cvt_pk_bf16_f32 v73, v146, v147
    v_cvt_pk_bf16_f32 v74, v148, v149
    v_cvt_pk_bf16_f32 v75, v150, v151
    buffer_store_dwordx4 v[72:75], v9, s[32:35], s41 offen offset:1024 sc1
    v_mul_f32 v152, v14, v152
    v_mul_f32 v153, v14, v153
    v_mul_f32 v154, v14, v154
    v_mul_f32 v155, v14, v155
    v_mul_f32 v156, v14, v156
    v_mul_f32 v157, v14, v157
    v_mul_f32 v158, v14, v158
    v_mul_f32 v159, v14, v159
    v_cvt_pk_bf16_f32 v76, v152, v153
    v_cvt_pk_bf16_f32 v77, v154, v155
    v_cvt_pk_bf16_f32 v78, v156, v157
    v_cvt_pk_bf16_f32 v79, v158, v159
    buffer_store_dwordx4 v[76:79], v9, s[32:35], s48 offen offset:1024 sc1
    s_waitcnt vmcnt(0)
    s_branch L_p2_ok
L_p2_spinh:
    s_mov_b32 s58, 0
L_p2_sph:
    buffer_load_dword v1, v11, s[32:35], s49 offen sc1
    s_add_u32 s58, s58, 1
    s_cmp_gt_u32 s58, 400000
    s_cbranch_scc1 L_p2_goh
    s_waitcnt vmcnt(0)
    v_cmp_ne_u32 vcc, s61, v1
    s_nop 3
    s_cbranch_vccnz L_p2_sph
    s_branch L_p2_goh
.section .rodata,"a"
.p2align 6
.amdhsa_kernel parallel_sum__mha_block__glu_gated_bilinear__prompt_kernel
  .amdhsa_next_free_vgpr 512
  .amdhsa_next_free_sgpr 102
  .amdhsa_accum_offset 256
  .amdhsa_group_segment_fixed_size 0
  .amdhsa_kernarg_size 80
  .amdhsa_user_sgpr_count 2
  .amdhsa_user_sgpr_kernarg_segment_ptr 1
  .amdhsa_system_sgpr_workgroup_id_x 1
  .amdhsa_float_denorm_mode_32 3
.end_amdhsa_kernel
```
